```python
import torch

def _softmax(x, axis=-1):
    return torch.softmax(x, dim=axis)
def _gelu(x):
    return torch.nn.functional.gelu(x, approximate="tanh")
def _silu(x):
    return torch.nn.functional.silu(x)
def _sigmoid(x):
    return torch.sigmoid(x)
def _layernorm(x, axis=-1, eps=1e-5):
    m = x.mean(dim=axis, keepdim=True)
    v = x.var(dim=axis, keepdim=True, unbiased=False)
    return (x - m) / torch.sqrt(v + eps)
def _scatter_add(tgt, idx, src, axis=0):
    return tgt.clone().index_add_(axis, idx, src)
def _segment_sum(src, seg, n):
    out = torch.zeros((n,) + src.shape[1:], dtype=src.dtype)
    return out.index_add_(0, seg, src)
def _pad(x, pw):
    flat = tuple(v for pair in reversed(pw) for v in pair)
    return torch.nn.functional.pad(x, flat)

kernel_name = 'sequential_preLN__sliding_local_dilated__geglu_ffn__prompt'

def setup_inputs():

    _w = (lambda a: (lambda t: t.to(torch.bfloat16) if t.is_floating_point() else t)(torch.as_tensor(a)))
    def _A_setup():
        B, S, D = 1, 2048, 576
        return {
            "x": _w((lambda *s: torch.randn(*s, dtype=torch.bfloat16) * 0.05)(B, S, D)),
            "wqkv": _w((lambda *s: torch.randn(*s, dtype=torch.bfloat16) * 0.05)(D, 3 * D)),
            "wo": _w((lambda *s: torch.randn(*s, dtype=torch.bfloat16) * 0.05)(D, D)),
        }
    _A_in = _A_setup()

    def _B_setup():
        B, S, D, F = 1, 2048, 576, 4608
        return {
            "x": _w((lambda *s: torch.randn(*s, dtype=torch.bfloat16) * 0.05)(B, S, D)),
            "w_gate": _w((lambda *s: torch.randn(*s, dtype=torch.bfloat16) * 0.05)(D, F)),
            "w_up": _w((lambda *s: torch.randn(*s, dtype=torch.bfloat16) * 0.05)(D, F)),
            "w_down": _w((lambda *s: torch.randn(*s, dtype=torch.bfloat16) * 0.05)(F, D)),
        }
    _B_in = _B_setup()

    return {
        "A_x": _A_in["x"],
        "A_wqkv": _A_in["wqkv"],
        "A_wo": _A_in["wo"],
        "B_x": _B_in["x"],
        "B_w_gate": _B_in["w_gate"],
        "B_w_up": _B_in["w_up"],
        "B_w_down": _B_in["w_down"],
    }

def reference(A_x, A_wqkv, A_wo, B_x, B_w_gate, B_w_up, B_w_down):
    def _A_ref(x, wqkv, wo):
        B, S, D = x.shape
        H = 32; Dh = D // H
        W, dil = 8, 2
        qkv = (lambda x, *d: x.permute(*d))((x @ wqkv).reshape(B, S, 3, H, Dh), 2, 0, 3, 1, 4)
        q, k, v = qkv[0], qkv[1], qkv[2]
        scale = Dh ** -0.5
        pos = torch.arange(S)
        off = torch.arange(W) * dil
        idx = pos[:, None] - off[None, :]
        mask = idx >= 0
        idx_c = torch.where(mask, idx, 0).reshape(-1)
        kg = k[:, :, idx_c, :].reshape(B, H, S, W, Dh)
        vg = v[:, :, idx_c, :].reshape(B, H, S, W, Dh)
        logits = torch.einsum("bhsd,bhswd->bhsw", q, kg) * scale
        logits = torch.where(mask[None, None, :, :], logits, -1e9)
        attn = _softmax(logits, axis=-1)
        o = torch.einsum("bhsw,bhswd->bhsd", attn, vg)
        return (lambda x, *d: x.permute(*d))(o, 0, 2, 1, 3).reshape(B, S, D) @ wo

    def _B_ref(x, w_gate, w_up, w_down):
        return (_gelu(x @ w_gate) * (x @ w_up)) @ w_down

    x = A_x
    h = x + _A_ref(_layernorm(x, axis=-1), A_wqkv, A_wo)
    h2 = h + _B_ref(_layernorm(h, axis=-1), B_w_gate, B_w_up, B_w_down)
    return h2
```

```asm
; @launch kernel=qkv_kernel grid=(256,1,1) block=(512,1,1) lds=153600
; @launch kernel=ffn_kernel grid=(256,1,1) block=(512,1,1) lds=163840
.amdgcn_target "amdgcn-amd-amdhsa--gfx950"
.text
.globl qkv_kernel
.p2align 8
.type qkv_kernel,@function
qkv_kernel:
    s_cmp_ge_u32 s2, 256
    s_cbranch_scc1 L_qkv_end
    s_load_dwordx16 s[16:31], s[0:1], 0
    s_load_dwordx4 s[32:35], s[0:1], 64
    v_lshrrev_b32 v1, 6, v0
    v_and_b32 v0, 63, v0
    s_nop 0
    v_readfirstlane_b32 s4, v1
    s_waitcnt lgkmcnt(0)
    s_and_b32 s9, s2, 7
    s_lshr_b32 s10, s2, 3
    s_mov_b32 s36, s16
    s_mov_b32 s37, s17
    s_mov_b32 s38, 0x240000
    s_mov_b32 s39, 0x00020000
    s_mov_b32 s40, s18
    s_mov_b32 s41, s19
    s_mov_b32 s42, 0x1e6000
    s_mov_b32 s43, 0x00020000
    s_mov_b32 s44, s34
    s_mov_b32 s45, s35
    s_mov_b32 s46, 0x240000
    s_mov_b32 s47, 0x00020000
    v_and_b32 v16, 15, v0
    v_lshrrev_b32 v17, 4, v0
    s_mul_i32 s64, s4, 24
    s_mul_i32 s65, s9, 144
    s_and_b32 s62, s65, 0xffffff80
    s_movk_i32 s63, 3456
    v_lshrrev_b32 v18, 3, v0
    v_add_u32 v18, s64, v18
    v_lshrrev_b32 v19, 1, v18
    v_xor_b32 v18, v18, v19
    v_and_b32 v18, 1, v18
    v_lshlrev_b32 v18, 7, v18
    v_bfe_u32 v20, v19, 1, 2
    v_bfe_u32 v21, v0, 1, 2
    v_xor_b32 v20, v20, v21
    v_lshlrev_b32 v20, 5, v20
    v_and_b32 v21, 1, v0
    v_lshlrev_b32 v21, 4, v21
    v_add3_u32 v18, v18, v20, v21
    v_lshrrev_b32 v23, 5, v19
    v_and_b32 v19, 31, v19
    v_and_b32 v20, 0x33, v19
    v_bfe_u32 v21, v19, 2, 1
    v_lshlrev_b32 v21, 3, v21
    v_bfe_u32 v22, v19, 3, 1
    v_lshlrev_b32 v22, 2, v22
    v_or3_b32 v20, v20, v21, v22
    v_mul_lo_u32 v20, v20, s63
    v_mul_u32_u24 v23, 1152, v23
    v_add_u32 v18, v18, v23
    v_add3_u32 v2, v20, v18, s62
    v_lshrrev_b32 v18, 3, v0
    v_add_u32 v18, s64, v18
    v_add_u32 v18, 8, v18
    v_lshrrev_b32 v19, 1, v18
    v_xor_b32 v18, v18, v19
    v_and_b32 v18, 1, v18
    v_lshlrev_b32 v18, 7, v18
    v_bfe_u32 v20, v19, 1, 2
    v_bfe_u32 v21, v0, 1, 2
    v_xor_b32 v20, v20, v21
    v_lshlrev_b32 v20, 5, v20
    v_and_b32 v21, 1, v0
    v_lshlrev_b32 v21, 4, v21
    v_add3_u32 v18, v18, v20, v21
    v_lshrrev_b32 v23, 5, v19
    v_and_b32 v19, 31, v19
    v_and_b32 v20, 0x33, v19
    v_bfe_u32 v21, v19, 2, 1
    v_lshlrev_b32 v21, 3, v21
    v_bfe_u32 v22, v19, 3, 1
    v_lshlrev_b32 v22, 2, v22
    v_or3_b32 v20, v20, v21, v22
    v_mul_lo_u32 v20, v20, s63
    v_mul_u32_u24 v23, 1152, v23
    v_add_u32 v18, v18, v23
    v_add3_u32 v3, v20, v18, s62
    v_lshrrev_b32 v18, 3, v0
    v_add_u32 v18, s64, v18
    v_add_u32 v18, 16, v18
    v_lshrrev_b32 v19, 1, v18
    v_xor_b32 v18, v18, v19
    v_and_b32 v18, 1, v18
    v_lshlrev_b32 v18, 7, v18
    v_bfe_u32 v20, v19, 1, 2
    v_bfe_u32 v21, v0, 1, 2
    v_xor_b32 v20, v20, v21
    v_lshlrev_b32 v20, 5, v20
    v_and_b32 v21, 1, v0
    v_lshlrev_b32 v21, 4, v21
    v_add3_u32 v18, v18, v20, v21
    v_lshrrev_b32 v23, 5, v19
    v_and_b32 v19, 31, v19
    v_and_b32 v20, 0x33, v19
    v_bfe_u32 v21, v19, 2, 1
    v_lshlrev_b32 v21, 3, v21
    v_bfe_u32 v22, v19, 3, 1
    v_lshlrev_b32 v22, 2, v22
    v_or3_b32 v20, v20, v21, v22
    v_mul_lo_u32 v20, v20, s63
    v_mul_u32_u24 v23, 1152, v23
    v_add_u32 v18, v18, v23
    v_add3_u32 v4, v20, v18, s62
    s_lshl_b32 s60, s10, 6
    s_lshl_b32 s61, s4, 4
    s_add_u32 s60, s60, s61
    s_sub_u32 s60, s60, 16
    v_add_u32 v18, s60, v16
    s_movk_i32 s63, 1152
    v_mul_lo_u32 v18, v18, s63
    v_lshlrev_b32 v19, 4, v17
    v_add_u32 v5, v18, v19
    v_add_u32 v6, 64, v5
    s_mov_b32 s56, 0
    s_mov_b32 s57, 0
    s_mul_i32 s58, s4, 3072
    s_lshl_b32 s59, s4, 11
    s_cmp_ge_u32 s4, 5
    s_cbranch_scc1 L_qkv_nx_1
    s_add_u32 m0, s59, 122880
    s_nop 0
    buffer_load_dwordx4 v5, s[36:39], s57 offen lds
    s_add_u32 m0, s59, 123904
    s_nop 0
    buffer_load_dwordx4 v6, s[36:39], s57 offen lds
    s_add_u32 s57, s57, 128
    s_add_u32 m0, s59, 133120
    s_nop 0
    buffer_load_dwordx4 v5, s[36:39], s57 offen lds
    s_add_u32 m0, s59, 134144
    s_nop 0
    buffer_load_dwordx4 v6, s[36:39], s57 offen lds
    s_add_u32 s57, s57, 128
L_qkv_nx_1:
    s_add_u32 m0, s58, 0
    s_nop 0
    buffer_load_dwordx4 v2, s[40:43], s56 offen lds
    s_add_u32 m0, s58, 1024
    s_nop 0
    buffer_load_dwordx4 v3, s[40:43], s56 offen lds
    s_add_u32 m0, s58, 2048
    s_nop 0
    buffer_load_dwordx4 v4, s[40:43], s56 offen lds
    s_add_u32 s56, s56, 110592
    s_add_u32 m0, s58, 24576
    s_nop 0
    buffer_load_dwordx4 v2, s[40:43], s56 offen lds
    s_add_u32 m0, s58, 25600
    s_nop 0
    buffer_load_dwordx4 v3, s[40:43], s56 offen lds
    s_add_u32 m0, s58, 26624
    s_nop 0
    buffer_load_dwordx4 v4, s[40:43], s56 offen lds
    s_add_u32 s56, s56, 110592
    s_add_u32 m0, s58, 49152
    s_nop 0
    buffer_load_dwordx4 v2, s[40:43], s56 offen lds
    s_add_u32 m0, s58, 50176
    s_nop 0
    buffer_load_dwordx4 v3, s[40:43], s56 offen lds
    s_add_u32 m0, s58, 51200
    s_nop 0
    buffer_load_dwordx4 v4, s[40:43], s56 offen lds
    s_add_u32 s56, s56, 110592
    s_add_u32 m0, s58, 73728
    s_nop 0
    buffer_load_dwordx4 v2, s[40:43], s56 offen lds
    s_add_u32 m0, s58, 74752
    s_nop 0
    buffer_load_dwordx4 v3, s[40:43], s56 offen lds
    s_add_u32 m0, s58, 75776
    s_nop 0
    buffer_load_dwordx4 v4, s[40:43], s56 offen lds
    s_add_u32 s56, s56, 110592
    s_add_u32 s84, s34, 0x880000
    s_addc_u32 s85, s35, 0
    s_mov_b32 s86, 0x8800
    s_mov_b32 s87, 0x00020000
    s_lshl_b32 s60, s2, 7
    v_mov_b32 v8, s60
    s_lshl_b32 s60, s2, 2
    s_add_u32 s60, s60, 32768
    v_mov_b32 v9, s60
    v_mov_b32 v20, 0
    v_mov_b32 v21, 0
    v_mov_b32 v22, 0
    v_mov_b32 v23, 0
    s_mov_b64 exec, 1
    buffer_store_dwordx4 v[20:23], v8, s[84:87], 0 offen
    buffer_store_dword v20, v9, s[84:87], 0 offen
    buffer_store_dword v20, v9, s[84:87], 0 offen offset:1024
    s_mov_b64 exec, -1
    s_nop 1
    s_mov_b32 s96, s18
    s_mov_b32 s97, s19
    s_mov_b32 s98, 0x1e6000
    s_mov_b32 s99, 0x00020000
    s_mul_i32 s60, s2, 8
    s_add_u32 s60, s60, s4
    s_mul_i32 s60, s60, 8
    v_add_u32 v18, s60, v0
    v_lshlrev_b32 v18, 7, v18
    s_mov_b32 exec_lo, 0xff
    s_mov_b32 exec_hi, 0x0
    buffer_load_dword v1, v18, s[96:99], 0 offen
    s_mov_b64 exec, -1
    s_mov_b32 s96, s16
    s_mov_b32 s97, s17
    s_mov_b32 s98, 0x240000
    s_mov_b32 s99, 0x00020000
    s_mul_i32 s60, s2, 8
    s_add_u32 s60, s60, s4
    s_mul_i32 s60, s60, 9
    v_add_u32 v18, s60, v0
    v_lshlrev_b32 v18, 7, v18
    s_mov_b32 exec_lo, 0x1ff
    s_mov_b32 exec_hi, 0x0
    buffer_load_dword v1, v18, s[96:99], 0 offen
    s_mov_b64 exec, -1
    s_mov_b32 s96, s20
    s_mov_b32 s97, s21
    s_mov_b32 s98, 0xa2000
    s_mov_b32 s99, 0x00020000
    s_mul_i32 s60, s2, 8
    s_add_u32 s60, s60, s4
    s_mul_i32 s60, s60, 3
    v_add_u32 v18, s60, v0
    v_lshlrev_b32 v18, 7, v18
    s_mov_b32 exec_lo, 0x7
    s_mov_b32 exec_hi, 0x0
    buffer_load_dword v1, v18, s[96:99], 0 offen
    s_mov_b64 exec, -1
    s_getpc_b64 s[88:89]
L_qkv_pc:
    s_add_u32 s88, s88, ffn_kernel-L_qkv_pc
    s_addc_u32 s89, s89, 0
    s_mov_b32 s96, s88
    s_mov_b32 s97, s89
    s_mov_b32 s98, 0xf700
    s_mov_b32 s99, 0x00020000
    s_mul_i32 s60, s2, 8
    s_add_u32 s60, s60, s4
    s_mul_i32 s60, s60, 8
    v_add_u32 v18, s60, v0
    v_lshlrev_b32 v18, 7, v18
    s_mov_b32 exec_lo, 0xff
    s_mov_b32 exec_hi, 0x0
    buffer_load_dword v1, v18, s[96:99], 0 offen
    s_mov_b64 exec, -1
    s_mul_i32 s13, s2, 3
    s_add_u32 s13, s13, s4
    s_sub_u32 s13, s13, 5
    s_mul_i32 s14, s13, 3641
    s_lshr_b32 s14, s14, 16
    s_mul_i32 s15, s14, 18
    s_sub_u32 s15, s13, s15
    s_lshl_b32 s60, s4, 5
    s_add_u32 s61, s60, 160
    s_add_u32 s62, s60, 320
    s_sub_u32 s60, s4, 5
    s_lshl_b32 s60, s60, 6
    s_add_u32 s63, s60, 32
    s_min_u32 s63, s63, 128
    s_cmp_lt_u32 s4, 5
    s_cselect_b32 s11, s61, s60
    s_cselect_b32 s12, s62, s63
    s_cselect_b32 s66, 8192, 0
    s_cselect_b32 s67, 16384, 0
    s_cselect_b32 s68, 160, 0
    s_cselect_b32 s69, 320, 0
    v_lshrrev_b32 v18, 5, v0
    v_lshlrev_b32 v8, 4, v18
    v_bfe_u32 v18, v0, 4, 1
    v_lshlrev_b32 v18, 2, v18
    v_add_u32 v8, v8, v18
    v_bfe_u32 v19, v0, 2, 2
    v_add_u32 v8, v8, v19
    v_bfe_u32 v9, v8, 1, 2
    v_and_b32 v10, 1, v8
    v_lshlrev_b32 v8, 8, v8
    v_and_b32 v11, 3, v0
    v_lshlrev_b32 v11, 3, v11
    s_and_b32 s65, s65, 127
    s_sub_u32 s60, s11, s68
    s_add_u32 s60, s60, s65
    v_add_u32 v18, s60, v11
    v_bfe_u32 v19, v18, 7, 1
    v_xor_b32 v19, v19, v10
    v_lshlrev_b32 v19, 7, v19
    v_bfe_u32 v12, v18, 5, 2
    v_xor_b32 v12, v12, v9
    v_lshlrev_b32 v12, 5, v12
    v_and_b32 v18, 31, v18
    v_add3_u32 v18, v18, v19, v12
    v_add3_u32 v20, v18, v8, s66
    s_sub_u32 s60, s12, s69
    s_add_u32 s60, s60, s65
    v_add_u32 v18, s60, v11
    v_bfe_u32 v19, v18, 7, 1
    v_xor_b32 v19, v19, v10
    v_lshlrev_b32 v19, 7, v19
    v_bfe_u32 v12, v18, 5, 2
    v_xor_b32 v12, v12, v9
    v_lshlrev_b32 v12, 5, v12
    v_and_b32 v18, 31, v18
    v_add3_u32 v18, v18, v19, v12
    v_add3_u32 v25, v18, v8, s67
    v_lshlrev_b32 v30, 4, v0
    v_add_u32 v30, 122880, v30
    v_add_u32 v33, s59, v30
    v_add_u32 v21, 24576, v20
    v_add_u32 v26, 24576, v25
    v_add_u32 v22, 49152, v20
    v_add_u32 v27, 49152, v25
    v_add_u32 v23, 73728, v20
    v_add_u32 v28, 73728, v25
    v_add_u32 v24, 98304, v20
    v_add_u32 v29, 98304, v25
    v_add_u32 v31, 10240, v30
    v_add_u32 v34, 10240, v33
    v_add_u32 v32, 20480, v30
    v_add_u32 v35, 20480, v33
    v_mov_b32 v36, 0x3f803f80
    v_mov_b32 v37, 0x3f803f80
    v_mov_b32 v38, 0x3f803f80
    v_mov_b32 v39, 0x3f803f80
    s_cmp_ge_u32 s4, 5
    s_cbranch_scc1 L_qkv_qpath_3
    s_waitcnt vmcnt(16)
    s_barrier
    ds_read_b64_tr_b16 v[216:217], v20 offset:0
    ds_read_b64_tr_b16 v[218:219], v20 offset:2048
    ds_read_b64_tr_b16 v[220:221], v25 offset:0
    ds_read_b64_tr_b16 v[222:223], v25 offset:2048
    ds_read_b128 v[96:99], v30 offset:0
    ds_read_b128 v[100:103], v30 offset:2048
    ds_read_b128 v[104:107], v30 offset:4096
    ds_read_b128 v[108:111], v30 offset:6144
    ds_read_b128 v[112:115], v30 offset:8192
    ds_read_b128 v[116:119], v33 offset:0
    s_waitcnt vmcnt(13)
    s_barrier
    s_waitcnt lgkmcnt(0)
    v_mfma_f32_16x16x32_bf16 v[40:43], v[216:219], v[96:99], 0
    ds_read_b64_tr_b16 v[224:225], v21 offset:0
    v_mfma_f32_16x16x32_bf16 v[44:47], v[216:219], v[100:103], 0
    ds_read_b64_tr_b16 v[226:227], v21 offset:2048
    v_mfma_f32_16x16x32_bf16 v[48:51], v[216:219], v[104:107], 0
    ds_read_b64_tr_b16 v[228:229], v26 offset:0
    v_mfma_f32_16x16x32_bf16 v[52:55], v[216:219], v[108:111], 0
    ds_read_b64_tr_b16 v[230:231], v26 offset:2048
    v_mfma_f32_16x16x32_bf16 v[56:59], v[216:219], v[112:115], 0
    ds_read_b128 v[120:123], v30 offset:1024
    v_mfma_f32_16x16x32_bf16 v[60:63], v[216:219], v[36:39], 0
    ds_read_b128 v[124:127], v30 offset:3072
    v_mfma_f32_16x16x32_bf16 v[64:67], v[220:223], v[96:99], 0
    ds_read_b128 v[128:131], v30 offset:5120
    v_mfma_f32_16x16x32_bf16 v[68:71], v[220:223], v[100:103], 0
    ds_read_b128 v[132:135], v30 offset:7168
    v_mfma_f32_16x16x32_bf16 v[72:75], v[220:223], v[104:107], 0
    ds_read_b128 v[136:139], v30 offset:9216
    v_mfma_f32_16x16x32_bf16 v[76:79], v[220:223], v[108:111], 0
    ds_read_b128 v[140:143], v33 offset:1024
    s_add_u32 m0, s59, 143360
    s_nop 0
    buffer_load_dwordx4 v5, s[36:39], s57 offen lds
    v_mfma_f32_16x16x32_bf16 v[80:83], v[220:223], v[112:115], 0
    s_add_u32 m0, s59, 144384
    s_nop 0
    buffer_load_dwordx4 v6, s[36:39], s57 offen lds
    s_add_u32 s57, s57, 128
    v_mfma_f32_16x16x32_bf16 v[84:87], v[220:223], v[36:39], 0
    s_add_u32 m0, s58, 98304
    s_nop 0
    buffer_load_dwordx4 v2, s[40:43], s56 offen lds
    v_mfma_f32_16x16x32_bf16 v[88:91], v[36:39], v[116:119], 0
    s_add_u32 m0, s58, 99328
    s_nop 0
    buffer_load_dwordx4 v3, s[40:43], s56 offen lds
    v_mfma_f32_16x16x32_bf16 v[92:95], v[116:119], v[116:119], 0
    s_add_u32 m0, s58, 100352
    s_nop 0
    buffer_load_dwordx4 v4, s[40:43], s56 offen lds
    s_add_u32 s56, s56, 110592
    s_waitcnt vmcnt(15)
    s_barrier
    s_waitcnt lgkmcnt(0)
    v_mfma_f32_16x16x32_bf16 v[40:43], v[224:227], v[120:123], v[40:43]
    ds_read_b64_tr_b16 v[216:217], v22 offset:0
    v_mfma_f32_16x16x32_bf16 v[44:47], v[224:227], v[124:127], v[44:47]
    ds_read_b64_tr_b16 v[218:219], v22 offset:2048
    v_mfma_f32_16x16x32_bf16 v[48:51], v[224:227], v[128:131], v[48:51]
    ds_read_b64_tr_b16 v[220:221], v27 offset:0
    v_mfma_f32_16x16x32_bf16 v[52:55], v[224:227], v[132:135], v[52:55]
    ds_read_b64_tr_b16 v[222:223], v27 offset:2048
    v_mfma_f32_16x16x32_bf16 v[56:59], v[224:227], v[136:139], v[56:59]
    ds_read_b128 v[96:99], v31 offset:0
    v_mfma_f32_16x16x32_bf16 v[60:63], v[224:227], v[36:39], v[60:63]
    ds_read_b128 v[100:103], v31 offset:2048
    v_mfma_f32_16x16x32_bf16 v[64:67], v[228:231], v[120:123], v[64:67]
    ds_read_b128 v[104:107], v31 offset:4096
    v_mfma_f32_16x16x32_bf16 v[68:71], v[228:231], v[124:127], v[68:71]
    ds_read_b128 v[108:111], v31 offset:6144
    v_mfma_f32_16x16x32_bf16 v[72:75], v[228:231], v[128:131], v[72:75]
    ds_read_b128 v[112:115], v31 offset:8192
    v_mfma_f32_16x16x32_bf16 v[76:79], v[228:231], v[132:135], v[76:79]
    ds_read_b128 v[116:119], v34 offset:0
    v_mfma_f32_16x16x32_bf16 v[80:83], v[228:231], v[136:139], v[80:83]
    v_mfma_f32_16x16x32_bf16 v[84:87], v[228:231], v[36:39], v[84:87]
    s_add_u32 m0, s58, 0
    s_nop 0
    buffer_load_dwordx4 v2, s[40:43], s56 offen lds
    v_mfma_f32_16x16x32_bf16 v[88:91], v[36:39], v[140:143], v[88:91]
    s_add_u32 m0, s58, 1024
    s_nop 0
    buffer_load_dwordx4 v3, s[40:43], s56 offen lds
    v_mfma_f32_16x16x32_bf16 v[92:95], v[140:143], v[140:143], v[92:95]
    s_add_u32 m0, s58, 2048
    s_nop 0
    buffer_load_dwordx4 v4, s[40:43], s56 offen lds
    s_add_u32 s56, s56, 110592
    s_waitcnt vmcnt(15)
    s_barrier
    s_waitcnt lgkmcnt(0)
    v_mfma_f32_16x16x32_bf16 v[40:43], v[216:219], v[96:99], v[40:43]
    ds_read_b64_tr_b16 v[224:225], v23 offset:0
    v_mfma_f32_16x16x32_bf16 v[44:47], v[216:219], v[100:103], v[44:47]
    ds_read_b64_tr_b16 v[226:227], v23 offset:2048
    v_mfma_f32_16x16x32_bf16 v[48:51], v[216:219], v[104:107], v[48:51]
    ds_read_b64_tr_b16 v[228:229], v28 offset:0
    v_mfma_f32_16x16x32_bf16 v[52:55], v[216:219], v[108:111], v[52:55]
    ds_read_b64_tr_b16 v[230:231], v28 offset:2048
    v_mfma_f32_16x16x32_bf16 v[56:59], v[216:219], v[112:115], v[56:59]
    ds_read_b128 v[120:123], v31 offset:1024
    v_mfma_f32_16x16x32_bf16 v[60:63], v[216:219], v[36:39], v[60:63]
    ds_read_b128 v[124:127], v31 offset:3072
    v_mfma_f32_16x16x32_bf16 v[64:67], v[220:223], v[96:99], v[64:67]
    ds_read_b128 v[128:131], v31 offset:5120
    v_mfma_f32_16x16x32_bf16 v[68:71], v[220:223], v[100:103], v[68:71]
    ds_read_b128 v[132:135], v31 offset:7168
    v_mfma_f32_16x16x32_bf16 v[72:75], v[220:223], v[104:107], v[72:75]
    ds_read_b128 v[136:139], v31 offset:9216
    v_mfma_f32_16x16x32_bf16 v[76:79], v[220:223], v[108:111], v[76:79]
    ds_read_b128 v[140:143], v34 offset:1024
    s_add_u32 m0, s59, 122880
    s_nop 0
    buffer_load_dwordx4 v5, s[36:39], s57 offen lds
    v_mfma_f32_16x16x32_bf16 v[80:83], v[220:223], v[112:115], v[80:83]
    s_add_u32 m0, s59, 123904
    s_nop 0
    buffer_load_dwordx4 v6, s[36:39], s57 offen lds
    s_add_u32 s57, s57, 128
    v_mfma_f32_16x16x32_bf16 v[84:87], v[220:223], v[36:39], v[84:87]
    s_add_u32 m0, s58, 24576
    s_nop 0
    buffer_load_dwordx4 v2, s[40:43], s56 offen lds
    v_mfma_f32_16x16x32_bf16 v[88:91], v[36:39], v[116:119], v[88:91]
    s_add_u32 m0, s58, 25600
    s_nop 0
    buffer_load_dwordx4 v3, s[40:43], s56 offen lds
    v_mfma_f32_16x16x32_bf16 v[92:95], v[116:119], v[116:119], v[92:95]
    s_add_u32 m0, s58, 26624
    s_nop 0
    buffer_load_dwordx4 v4, s[40:43], s56 offen lds
    s_add_u32 s56, s56, 110592
    s_waitcnt vmcnt(8)
    s_barrier
    s_waitcnt lgkmcnt(0)
    v_mfma_f32_16x16x32_bf16 v[40:43], v[224:227], v[120:123], v[40:43]
    ds_read_b64_tr_b16 v[216:217], v24 offset:0
    v_mfma_f32_16x16x32_bf16 v[44:47], v[224:227], v[124:127], v[44:47]
    ds_read_b64_tr_b16 v[218:219], v24 offset:2048
    v_mfma_f32_16x16x32_bf16 v[48:51], v[224:227], v[128:131], v[48:51]
    ds_read_b64_tr_b16 v[220:221], v29 offset:0
    v_mfma_f32_16x16x32_bf16 v[52:55], v[224:227], v[132:135], v[52:55]
    ds_read_b64_tr_b16 v[222:223], v29 offset:2048
    v_mfma_f32_16x16x32_bf16 v[56:59], v[224:227], v[136:139], v[56:59]
    ds_read_b128 v[96:99], v32 offset:0
    v_mfma_f32_16x16x32_bf16 v[60:63], v[224:227], v[36:39], v[60:63]
    ds_read_b128 v[100:103], v32 offset:2048
    v_mfma_f32_16x16x32_bf16 v[64:67], v[228:231], v[120:123], v[64:67]
    ds_read_b128 v[104:107], v32 offset:4096
    v_mfma_f32_16x16x32_bf16 v[68:71], v[228:231], v[124:127], v[68:71]
    ds_read_b128 v[108:111], v32 offset:6144
    v_mfma_f32_16x16x32_bf16 v[72:75], v[228:231], v[128:131], v[72:75]
    ds_read_b128 v[112:115], v32 offset:8192
    v_mfma_f32_16x16x32_bf16 v[76:79], v[228:231], v[132:135], v[76:79]
    ds_read_b128 v[116:119], v35 offset:0
    v_mfma_f32_16x16x32_bf16 v[80:83], v[228:231], v[136:139], v[80:83]
    v_mfma_f32_16x16x32_bf16 v[84:87], v[228:231], v[36:39], v[84:87]
    s_add_u32 m0, s58, 49152
    s_nop 0
    buffer_load_dwordx4 v2, s[40:43], s56 offen lds
    v_mfma_f32_16x16x32_bf16 v[88:91], v[36:39], v[140:143], v[88:91]
    s_add_u32 m0, s58, 50176
    s_nop 0
    buffer_load_dwordx4 v3, s[40:43], s56 offen lds
    v_mfma_f32_16x16x32_bf16 v[92:95], v[140:143], v[140:143], v[92:95]
    s_add_u32 m0, s58, 51200
    s_nop 0
    buffer_load_dwordx4 v4, s[40:43], s56 offen lds
    s_add_u32 s56, s56, 110592
    s_waitcnt vmcnt(8)
    s_barrier
    s_waitcnt lgkmcnt(0)
    v_mfma_f32_16x16x32_bf16 v[40:43], v[216:219], v[96:99], v[40:43]
    ds_read_b64_tr_b16 v[224:225], v20 offset:0
    v_mfma_f32_16x16x32_bf16 v[44:47], v[216:219], v[100:103], v[44:47]
    ds_read_b64_tr_b16 v[226:227], v20 offset:2048
    v_mfma_f32_16x16x32_bf16 v[48:51], v[216:219], v[104:107], v[48:51]
    ds_read_b64_tr_b16 v[228:229], v25 offset:0
    v_mfma_f32_16x16x32_bf16 v[52:55], v[216:219], v[108:111], v[52:55]
    ds_read_b64_tr_b16 v[230:231], v25 offset:2048
    v_mfma_f32_16x16x32_bf16 v[56:59], v[216:219], v[112:115], v[56:59]
    ds_read_b128 v[120:123], v32 offset:1024
    v_mfma_f32_16x16x32_bf16 v[60:63], v[216:219], v[36:39], v[60:63]
    ds_read_b128 v[124:127], v32 offset:3072
    v_mfma_f32_16x16x32_bf16 v[64:67], v[220:223], v[96:99], v[64:67]
    ds_read_b128 v[128:131], v32 offset:5120
    v_mfma_f32_16x16x32_bf16 v[68:71], v[220:223], v[100:103], v[68:71]
    ds_read_b128 v[132:135], v32 offset:7168
    v_mfma_f32_16x16x32_bf16 v[72:75], v[220:223], v[104:107], v[72:75]
    ds_read_b128 v[136:139], v32 offset:9216
    v_mfma_f32_16x16x32_bf16 v[76:79], v[220:223], v[108:111], v[76:79]
    ds_read_b128 v[140:143], v35 offset:1024
    s_add_u32 m0, s59, 133120
    s_nop 0
    buffer_load_dwordx4 v5, s[36:39], s57 offen lds
    v_mfma_f32_16x16x32_bf16 v[80:83], v[220:223], v[112:115], v[80:83]
    s_add_u32 m0, s59, 134144
    s_nop 0
    buffer_load_dwordx4 v6, s[36:39], s57 offen lds
    s_add_u32 s57, s57, 128
    v_mfma_f32_16x16x32_bf16 v[84:87], v[220:223], v[36:39], v[84:87]
    s_add_u32 m0, s58, 73728
    s_nop 0
    buffer_load_dwordx4 v2, s[40:43], s56 offen lds
    v_mfma_f32_16x16x32_bf16 v[88:91], v[36:39], v[116:119], v[88:91]
    s_add_u32 m0, s58, 74752
    s_nop 0
    buffer_load_dwordx4 v3, s[40:43], s56 offen lds
    v_mfma_f32_16x16x32_bf16 v[92:95], v[116:119], v[116:119], v[92:95]
    s_add_u32 m0, s58, 75776
    s_nop 0
    buffer_load_dwordx4 v4, s[40:43], s56 offen lds
    s_add_u32 s56, s56, 110592
    s_waitcnt vmcnt(8)
    s_barrier
    s_waitcnt lgkmcnt(0)
    v_mfma_f32_16x16x32_bf16 v[40:43], v[224:227], v[120:123], v[40:43]
    ds_read_b64_tr_b16 v[216:217], v21 offset:0
    v_mfma_f32_16x16x32_bf16 v[44:47], v[224:227], v[124:127], v[44:47]
    ds_read_b64_tr_b16 v[218:219], v21 offset:2048
    v_mfma_f32_16x16x32_bf16 v[48:51], v[224:227], v[128:131], v[48:51]
    ds_read_b64_tr_b16 v[220:221], v26 offset:0
    v_mfma_f32_16x16x32_bf16 v[52:55], v[224:227], v[132:135], v[52:55]
    ds_read_b64_tr_b16 v[222:223], v26 offset:2048
    v_mfma_f32_16x16x32_bf16 v[56:59], v[224:227], v[136:139], v[56:59]
    ds_read_b128 v[96:99], v30 offset:0
    v_mfma_f32_16x16x32_bf16 v[60:63], v[224:227], v[36:39], v[60:63]
    ds_read_b128 v[100:103], v30 offset:2048
    v_mfma_f32_16x16x32_bf16 v[64:67], v[228:231], v[120:123], v[64:67]
    ds_read_b128 v[104:107], v30 offset:4096
    v_mfma_f32_16x16x32_bf16 v[68:71], v[228:231], v[124:127], v[68:71]
    ds_read_b128 v[108:111], v30 offset:6144
    v_mfma_f32_16x16x32_bf16 v[72:75], v[228:231], v[128:131], v[72:75]
    ds_read_b128 v[112:115], v30 offset:8192
    v_mfma_f32_16x16x32_bf16 v[76:79], v[228:231], v[132:135], v[76:79]
    ds_read_b128 v[116:119], v33 offset:0
    v_mfma_f32_16x16x32_bf16 v[80:83], v[228:231], v[136:139], v[80:83]
    v_mfma_f32_16x16x32_bf16 v[84:87], v[228:231], v[36:39], v[84:87]
    s_add_u32 m0, s58, 98304
    s_nop 0
    buffer_load_dwordx4 v2, s[40:43], s56 offen lds
    v_mfma_f32_16x16x32_bf16 v[88:91], v[36:39], v[140:143], v[88:91]
    s_add_u32 m0, s58, 99328
    s_nop 0
    buffer_load_dwordx4 v3, s[40:43], s56 offen lds
    v_mfma_f32_16x16x32_bf16 v[92:95], v[140:143], v[140:143], v[92:95]
    s_add_u32 m0, s58, 100352
    s_nop 0
    buffer_load_dwordx4 v4, s[40:43], s56 offen lds
    s_add_u32 s56, s56, 110592
    s_waitcnt vmcnt(8)
    s_barrier
    s_waitcnt lgkmcnt(0)
    v_mfma_f32_16x16x32_bf16 v[40:43], v[216:219], v[96:99], v[40:43]
    ds_read_b64_tr_b16 v[224:225], v22 offset:0
    v_mfma_f32_16x16x32_bf16 v[44:47], v[216:219], v[100:103], v[44:47]
    ds_read_b64_tr_b16 v[226:227], v22 offset:2048
    v_mfma_f32_16x16x32_bf16 v[48:51], v[216:219], v[104:107], v[48:51]
    ds_read_b64_tr_b16 v[228:229], v27 offset:0
    v_mfma_f32_16x16x32_bf16 v[52:55], v[216:219], v[108:111], v[52:55]
    ds_read_b64_tr_b16 v[230:231], v27 offset:2048
    v_mfma_f32_16x16x32_bf16 v[56:59], v[216:219], v[112:115], v[56:59]
    ds_read_b128 v[120:123], v30 offset:1024
    v_mfma_f32_16x16x32_bf16 v[60:63], v[216:219], v[36:39], v[60:63]
    ds_read_b128 v[124:127], v30 offset:3072
    v_mfma_f32_16x16x32_bf16 v[64:67], v[220:223], v[96:99], v[64:67]
    ds_read_b128 v[128:131], v30 offset:5120
    v_mfma_f32_16x16x32_bf16 v[68:71], v[220:223], v[100:103], v[68:71]
    ds_read_b128 v[132:135], v30 offset:7168
    v_mfma_f32_16x16x32_bf16 v[72:75], v[220:223], v[104:107], v[72:75]
    ds_read_b128 v[136:139], v30 offset:9216
    v_mfma_f32_16x16x32_bf16 v[76:79], v[220:223], v[108:111], v[76:79]
    ds_read_b128 v[140:143], v33 offset:1024
    s_add_u32 m0, s59, 143360
    s_nop 0
    buffer_load_dwordx4 v5, s[36:39], s57 offen lds
    v_mfma_f32_16x16x32_bf16 v[80:83], v[220:223], v[112:115], v[80:83]
    s_add_u32 m0, s59, 144384
    s_nop 0
    buffer_load_dwordx4 v6, s[36:39], s57 offen lds
    s_add_u32 s57, s57, 128
    v_mfma_f32_16x16x32_bf16 v[84:87], v[220:223], v[36:39], v[84:87]
    s_add_u32 m0, s58, 0
    s_nop 0
    buffer_load_dwordx4 v2, s[40:43], s56 offen lds
    v_mfma_f32_16x16x32_bf16 v[88:91], v[36:39], v[116:119], v[88:91]
    s_add_u32 m0, s58, 1024
    s_nop 0
    buffer_load_dwordx4 v3, s[40:43], s56 offen lds
    v_mfma_f32_16x16x32_bf16 v[92:95], v[116:119], v[116:119], v[92:95]
    s_add_u32 m0, s58, 2048
    s_nop 0
    buffer_load_dwordx4 v4, s[40:43], s56 offen lds
    s_add_u32 s56, s56, 110592
    s_waitcnt vmcnt(8)
    s_barrier
    s_waitcnt lgkmcnt(0)
    v_mfma_f32_16x16x32_bf16 v[40:43], v[224:227], v[120:123], v[40:43]
    ds_read_b64_tr_b16 v[216:217], v23 offset:0
    v_mfma_f32_16x16x32_bf16 v[44:47], v[224:227], v[124:127], v[44:47]
    ds_read_b64_tr_b16 v[218:219], v23 offset:2048
    v_mfma_f32_16x16x32_bf16 v[48:51], v[224:227], v[128:131], v[48:51]
    ds_read_b64_tr_b16 v[220:221], v28 offset:0
    v_mfma_f32_16x16x32_bf16 v[52:55], v[224:227], v[132:135], v[52:55]
    ds_read_b64_tr_b16 v[222:223], v28 offset:2048
    v_mfma_f32_16x16x32_bf16 v[56:59], v[224:227], v[136:139], v[56:59]
    ds_read_b128 v[96:99], v31 offset:0
    v_mfma_f32_16x16x32_bf16 v[60:63], v[224:227], v[36:39], v[60:63]
    ds_read_b128 v[100:103], v31 offset:2048
    v_mfma_f32_16x16x32_bf16 v[64:67], v[228:231], v[120:123], v[64:67]
    ds_read_b128 v[104:107], v31 offset:4096
    v_mfma_f32_16x16x32_bf16 v[68:71], v[228:231], v[124:127], v[68:71]
    ds_read_b128 v[108:111], v31 offset:6144
    v_mfma_f32_16x16x32_bf16 v[72:75], v[228:231], v[128:131], v[72:75]
    ds_read_b128 v[112:115], v31 offset:8192
    v_mfma_f32_16x16x32_bf16 v[76:79], v[228:231], v[132:135], v[76:79]
    ds_read_b128 v[116:119], v34 offset:0
    v_mfma_f32_16x16x32_bf16 v[80:83], v[228:231], v[136:139], v[80:83]
    v_mfma_f32_16x16x32_bf16 v[84:87], v[228:231], v[36:39], v[84:87]
    s_add_u32 m0, s58, 24576
    s_nop 0
    buffer_load_dwordx4 v2, s[40:43], s56 offen lds
    v_mfma_f32_16x16x32_bf16 v[88:91], v[36:39], v[140:143], v[88:91]
    s_add_u32 m0, s58, 25600
    s_nop 0
    buffer_load_dwordx4 v3, s[40:43], s56 offen lds
    v_mfma_f32_16x16x32_bf16 v[92:95], v[140:143], v[140:143], v[92:95]
    s_add_u32 m0, s58, 26624
    s_nop 0
    buffer_load_dwordx4 v4, s[40:43], s56 offen lds
    s_add_u32 s56, s56, 110592
    s_waitcnt vmcnt(8)
    s_barrier
    s_waitcnt lgkmcnt(0)
    v_mfma_f32_16x16x32_bf16 v[40:43], v[216:219], v[96:99], v[40:43]
    ds_read_b64_tr_b16 v[224:225], v24 offset:0
    v_mfma_f32_16x16x32_bf16 v[44:47], v[216:219], v[100:103], v[44:47]
    ds_read_b64_tr_b16 v[226:227], v24 offset:2048
    v_mfma_f32_16x16x32_bf16 v[48:51], v[216:219], v[104:107], v[48:51]
    ds_read_b64_tr_b16 v[228:229], v29 offset:0
    v_mfma_f32_16x16x32_bf16 v[52:55], v[216:219], v[108:111], v[52:55]
    ds_read_b64_tr_b16 v[230:231], v29 offset:2048
    v_mfma_f32_16x16x32_bf16 v[56:59], v[216:219], v[112:115], v[56:59]
    ds_read_b128 v[120:123], v31 offset:1024
    v_mfma_f32_16x16x32_bf16 v[60:63], v[216:219], v[36:39], v[60:63]
    ds_read_b128 v[124:127], v31 offset:3072
    v_mfma_f32_16x16x32_bf16 v[64:67], v[220:223], v[96:99], v[64:67]
    ds_read_b128 v[128:131], v31 offset:5120
    v_mfma_f32_16x16x32_bf16 v[68:71], v[220:223], v[100:103], v[68:71]
    ds_read_b128 v[132:135], v31 offset:7168
    v_mfma_f32_16x16x32_bf16 v[72:75], v[220:223], v[104:107], v[72:75]
    ds_read_b128 v[136:139], v31 offset:9216
    v_mfma_f32_16x16x32_bf16 v[76:79], v[220:223], v[108:111], v[76:79]
    ds_read_b128 v[140:143], v34 offset:1024
    s_add_u32 m0, s59, 122880
    s_nop 0
    buffer_load_dwordx4 v5, s[36:39], s57 offen lds
    v_mfma_f32_16x16x32_bf16 v[80:83], v[220:223], v[112:115], v[80:83]
    s_add_u32 m0, s59, 123904
    s_nop 0
    buffer_load_dwordx4 v6, s[36:39], s57 offen lds
    s_add_u32 s57, s57, 128
    v_mfma_f32_16x16x32_bf16 v[84:87], v[220:223], v[36:39], v[84:87]
    s_add_u32 m0, s58, 49152
    s_nop 0
    buffer_load_dwordx4 v2, s[40:43], s56 offen lds
    v_mfma_f32_16x16x32_bf16 v[88:91], v[36:39], v[116:119], v[88:91]
    s_add_u32 m0, s58, 50176
    s_nop 0
    buffer_load_dwordx4 v3, s[40:43], s56 offen lds
    v_mfma_f32_16x16x32_bf16 v[92:95], v[116:119], v[116:119], v[92:95]
    s_add_u32 m0, s58, 51200
    s_nop 0
    buffer_load_dwordx4 v4, s[40:43], s56 offen lds
    s_add_u32 s56, s56, 110592
    s_waitcnt vmcnt(8)
    s_barrier
    s_waitcnt lgkmcnt(0)
    v_mfma_f32_16x16x32_bf16 v[40:43], v[224:227], v[120:123], v[40:43]
    ds_read_b64_tr_b16 v[216:217], v20 offset:0
    v_mfma_f32_16x16x32_bf16 v[44:47], v[224:227], v[124:127], v[44:47]
    ds_read_b64_tr_b16 v[218:219], v20 offset:2048
    v_mfma_f32_16x16x32_bf16 v[48:51], v[224:227], v[128:131], v[48:51]
    ds_read_b64_tr_b16 v[220:221], v25 offset:0
    v_mfma_f32_16x16x32_bf16 v[52:55], v[224:227], v[132:135], v[52:55]
    ds_read_b64_tr_b16 v[222:223], v25 offset:2048
    v_mfma_f32_16x16x32_bf16 v[56:59], v[224:227], v[136:139], v[56:59]
    ds_read_b128 v[96:99], v32 offset:0
    v_mfma_f32_16x16x32_bf16 v[60:63], v[224:227], v[36:39], v[60:63]
    ds_read_b128 v[100:103], v32 offset:2048
    v_mfma_f32_16x16x32_bf16 v[64:67], v[228:231], v[120:123], v[64:67]
    ds_read_b128 v[104:107], v32 offset:4096
    v_mfma_f32_16x16x32_bf16 v[68:71], v[228:231], v[124:127], v[68:71]
    ds_read_b128 v[108:111], v32 offset:6144
    v_mfma_f32_16x16x32_bf16 v[72:75], v[228:231], v[128:131], v[72:75]
    ds_read_b128 v[112:115], v32 offset:8192
    v_mfma_f32_16x16x32_bf16 v[76:79], v[228:231], v[132:135], v[76:79]
    ds_read_b128 v[116:119], v35 offset:0
    v_mfma_f32_16x16x32_bf16 v[80:83], v[228:231], v[136:139], v[80:83]
    v_mfma_f32_16x16x32_bf16 v[84:87], v[228:231], v[36:39], v[84:87]
    s_add_u32 m0, s58, 73728
    s_nop 0
    buffer_load_dwordx4 v2, s[40:43], s56 offen lds
    v_mfma_f32_16x16x32_bf16 v[88:91], v[36:39], v[140:143], v[88:91]
    s_add_u32 m0, s58, 74752
    s_nop 0
    buffer_load_dwordx4 v3, s[40:43], s56 offen lds
    v_mfma_f32_16x16x32_bf16 v[92:95], v[140:143], v[140:143], v[92:95]
    s_add_u32 m0, s58, 75776
    s_nop 0
    buffer_load_dwordx4 v4, s[40:43], s56 offen lds
    s_add_u32 s56, s56, 110592
    s_waitcnt vmcnt(8)
    s_barrier
    s_waitcnt lgkmcnt(0)
    v_mfma_f32_16x16x32_bf16 v[40:43], v[216:219], v[96:99], v[40:43]
    ds_read_b64_tr_b16 v[224:225], v21 offset:0
    v_mfma_f32_16x16x32_bf16 v[44:47], v[216:219], v[100:103], v[44:47]
    ds_read_b64_tr_b16 v[226:227], v21 offset:2048
    v_mfma_f32_16x16x32_bf16 v[48:51], v[216:219], v[104:107], v[48:51]
    ds_read_b64_tr_b16 v[228:229], v26 offset:0
    v_mfma_f32_16x16x32_bf16 v[52:55], v[216:219], v[108:111], v[52:55]
    ds_read_b64_tr_b16 v[230:231], v26 offset:2048
    v_mfma_f32_16x16x32_bf16 v[56:59], v[216:219], v[112:115], v[56:59]
    ds_read_b128 v[120:123], v32 offset:1024
    v_mfma_f32_16x16x32_bf16 v[60:63], v[216:219], v[36:39], v[60:63]
    ds_read_b128 v[124:127], v32 offset:3072
    v_mfma_f32_16x16x32_bf16 v[64:67], v[220:223], v[96:99], v[64:67]
    ds_read_b128 v[128:131], v32 offset:5120
    v_mfma_f32_16x16x32_bf16 v[68:71], v[220:223], v[100:103], v[68:71]
    ds_read_b128 v[132:135], v32 offset:7168
    v_mfma_f32_16x16x32_bf16 v[72:75], v[220:223], v[104:107], v[72:75]
    ds_read_b128 v[136:139], v32 offset:9216
    v_mfma_f32_16x16x32_bf16 v[76:79], v[220:223], v[108:111], v[76:79]
    ds_read_b128 v[140:143], v35 offset:1024
    s_add_u32 m0, s59, 133120
    s_nop 0
    buffer_load_dwordx4 v5, s[36:39], s57 offen lds
    v_mfma_f32_16x16x32_bf16 v[80:83], v[220:223], v[112:115], v[80:83]
    s_add_u32 m0, s59, 134144
    s_nop 0
    buffer_load_dwordx4 v6, s[36:39], s57 offen lds
    s_add_u32 s57, s57, 128
    v_mfma_f32_16x16x32_bf16 v[84:87], v[220:223], v[36:39], v[84:87]
    s_add_u32 m0, s58, 98304
    s_nop 0
    buffer_load_dwordx4 v2, s[40:43], s56 offen lds
    v_mfma_f32_16x16x32_bf16 v[88:91], v[36:39], v[116:119], v[88:91]
    s_add_u32 m0, s58, 99328
    s_nop 0
    buffer_load_dwordx4 v3, s[40:43], s56 offen lds
    v_mfma_f32_16x16x32_bf16 v[92:95], v[116:119], v[116:119], v[92:95]
    s_add_u32 m0, s58, 100352
    s_nop 0
    buffer_load_dwordx4 v4, s[40:43], s56 offen lds
    s_add_u32 s56, s56, 110592
    s_waitcnt vmcnt(8)
    s_barrier
    s_waitcnt lgkmcnt(0)
    v_mfma_f32_16x16x32_bf16 v[40:43], v[224:227], v[120:123], v[40:43]
    ds_read_b64_tr_b16 v[216:217], v22 offset:0
    v_mfma_f32_16x16x32_bf16 v[44:47], v[224:227], v[124:127], v[44:47]
    ds_read_b64_tr_b16 v[218:219], v22 offset:2048
    v_mfma_f32_16x16x32_bf16 v[48:51], v[224:227], v[128:131], v[48:51]
    ds_read_b64_tr_b16 v[220:221], v27 offset:0
    v_mfma_f32_16x16x32_bf16 v[52:55], v[224:227], v[132:135], v[52:55]
    ds_read_b64_tr_b16 v[222:223], v27 offset:2048
    v_mfma_f32_16x16x32_bf16 v[56:59], v[224:227], v[136:139], v[56:59]
    ds_read_b128 v[96:99], v30 offset:0
    v_mfma_f32_16x16x32_bf16 v[60:63], v[224:227], v[36:39], v[60:63]
    ds_read_b128 v[100:103], v30 offset:2048
    v_mfma_f32_16x16x32_bf16 v[64:67], v[228:231], v[120:123], v[64:67]
    ds_read_b128 v[104:107], v30 offset:4096
    v_mfma_f32_16x16x32_bf16 v[68:71], v[228:231], v[124:127], v[68:71]
    ds_read_b128 v[108:111], v30 offset:6144
    v_mfma_f32_16x16x32_bf16 v[72:75], v[228:231], v[128:131], v[72:75]
    ds_read_b128 v[112:115], v30 offset:8192
    v_mfma_f32_16x16x32_bf16 v[76:79], v[228:231], v[132:135], v[76:79]
    ds_read_b128 v[116:119], v33 offset:0
    v_mfma_f32_16x16x32_bf16 v[80:83], v[228:231], v[136:139], v[80:83]
    v_mfma_f32_16x16x32_bf16 v[84:87], v[228:231], v[36:39], v[84:87]
    s_add_u32 m0, s58, 0
    s_nop 0
    buffer_load_dwordx4 v2, s[40:43], s56 offen lds
    v_mfma_f32_16x16x32_bf16 v[88:91], v[36:39], v[140:143], v[88:91]
    s_add_u32 m0, s58, 1024
    s_nop 0
    buffer_load_dwordx4 v3, s[40:43], s56 offen lds
    v_mfma_f32_16x16x32_bf16 v[92:95], v[140:143], v[140:143], v[92:95]
    s_add_u32 m0, s58, 2048
    s_nop 0
    buffer_load_dwordx4 v4, s[40:43], s56 offen lds
    s_add_u32 s56, s56, 110592
    s_waitcnt vmcnt(8)
    s_barrier
    s_waitcnt lgkmcnt(0)
    v_mfma_f32_16x16x32_bf16 v[40:43], v[216:219], v[96:99], v[40:43]
    ds_read_b64_tr_b16 v[224:225], v23 offset:0
    v_mfma_f32_16x16x32_bf16 v[44:47], v[216:219], v[100:103], v[44:47]
    ds_read_b64_tr_b16 v[226:227], v23 offset:2048
    v_mfma_f32_16x16x32_bf16 v[48:51], v[216:219], v[104:107], v[48:51]
    ds_read_b64_tr_b16 v[228:229], v28 offset:0
    v_mfma_f32_16x16x32_bf16 v[52:55], v[216:219], v[108:111], v[52:55]
    ds_read_b64_tr_b16 v[230:231], v28 offset:2048
    v_mfma_f32_16x16x32_bf16 v[56:59], v[216:219], v[112:115], v[56:59]
    ds_read_b128 v[120:123], v30 offset:1024
    v_mfma_f32_16x16x32_bf16 v[60:63], v[216:219], v[36:39], v[60:63]
    ds_read_b128 v[124:127], v30 offset:3072
    v_mfma_f32_16x16x32_bf16 v[64:67], v[220:223], v[96:99], v[64:67]
    ds_read_b128 v[128:131], v30 offset:5120
    v_mfma_f32_16x16x32_bf16 v[68:71], v[220:223], v[100:103], v[68:71]
    ds_read_b128 v[132:135], v30 offset:7168
    v_mfma_f32_16x16x32_bf16 v[72:75], v[220:223], v[104:107], v[72:75]
    ds_read_b128 v[136:139], v30 offset:9216
    v_mfma_f32_16x16x32_bf16 v[76:79], v[220:223], v[108:111], v[76:79]
    ds_read_b128 v[140:143], v33 offset:1024
    s_add_u32 m0, s59, 143360
    s_nop 0
    buffer_load_dwordx4 v5, s[36:39], s57 offen lds
    v_mfma_f32_16x16x32_bf16 v[80:83], v[220:223], v[112:115], v[80:83]
    s_add_u32 m0, s59, 144384
    s_nop 0
    buffer_load_dwordx4 v6, s[36:39], s57 offen lds
    s_add_u32 s57, s57, 128
    v_mfma_f32_16x16x32_bf16 v[84:87], v[220:223], v[36:39], v[84:87]
    s_add_u32 m0, s58, 24576
    s_nop 0
    buffer_load_dwordx4 v2, s[40:43], s56 offen lds
    v_mfma_f32_16x16x32_bf16 v[88:91], v[36:39], v[116:119], v[88:91]
    s_add_u32 m0, s58, 25600
    s_nop 0
    buffer_load_dwordx4 v3, s[40:43], s56 offen lds
    v_mfma_f32_16x16x32_bf16 v[92:95], v[116:119], v[116:119], v[92:95]
    s_add_u32 m0, s58, 26624
    s_nop 0
    buffer_load_dwordx4 v4, s[40:43], s56 offen lds
    s_add_u32 s56, s56, 110592
    s_waitcnt vmcnt(8)
    s_barrier
    s_waitcnt lgkmcnt(0)
    v_mfma_f32_16x16x32_bf16 v[40:43], v[224:227], v[120:123], v[40:43]
    ds_read_b64_tr_b16 v[216:217], v24 offset:0
    v_mfma_f32_16x16x32_bf16 v[44:47], v[224:227], v[124:127], v[44:47]
    ds_read_b64_tr_b16 v[218:219], v24 offset:2048
    v_mfma_f32_16x16x32_bf16 v[48:51], v[224:227], v[128:131], v[48:51]
    ds_read_b64_tr_b16 v[220:221], v29 offset:0
    v_mfma_f32_16x16x32_bf16 v[52:55], v[224:227], v[132:135], v[52:55]
    ds_read_b64_tr_b16 v[222:223], v29 offset:2048
    v_mfma_f32_16x16x32_bf16 v[56:59], v[224:227], v[136:139], v[56:59]
    ds_read_b128 v[96:99], v31 offset:0
    v_mfma_f32_16x16x32_bf16 v[60:63], v[224:227], v[36:39], v[60:63]
    ds_read_b128 v[100:103], v31 offset:2048
    v_mfma_f32_16x16x32_bf16 v[64:67], v[228:231], v[120:123], v[64:67]
    ds_read_b128 v[104:107], v31 offset:4096
    v_mfma_f32_16x16x32_bf16 v[68:71], v[228:231], v[124:127], v[68:71]
    ds_read_b128 v[108:111], v31 offset:6144
    v_mfma_f32_16x16x32_bf16 v[72:75], v[228:231], v[128:131], v[72:75]
    ds_read_b128 v[112:115], v31 offset:8192
    v_mfma_f32_16x16x32_bf16 v[76:79], v[228:231], v[132:135], v[76:79]
    ds_read_b128 v[116:119], v34 offset:0
    v_mfma_f32_16x16x32_bf16 v[80:83], v[228:231], v[136:139], v[80:83]
    v_mfma_f32_16x16x32_bf16 v[84:87], v[228:231], v[36:39], v[84:87]
    s_add_u32 m0, s58, 49152
    s_nop 0
    buffer_load_dwordx4 v2, s[40:43], s56 offen lds
    v_mfma_f32_16x16x32_bf16 v[88:91], v[36:39], v[140:143], v[88:91]
    s_add_u32 m0, s58, 50176
    s_nop 0
    buffer_load_dwordx4 v3, s[40:43], s56 offen lds
    v_mfma_f32_16x16x32_bf16 v[92:95], v[140:143], v[140:143], v[92:95]
    s_add_u32 m0, s58, 51200
    s_nop 0
    buffer_load_dwordx4 v4, s[40:43], s56 offen lds
    s_add_u32 s56, s56, 110592
    s_waitcnt vmcnt(8)
    s_barrier
    s_waitcnt lgkmcnt(0)
    v_mfma_f32_16x16x32_bf16 v[40:43], v[216:219], v[96:99], v[40:43]
    ds_read_b64_tr_b16 v[224:225], v20 offset:0
    v_mfma_f32_16x16x32_bf16 v[44:47], v[216:219], v[100:103], v[44:47]
    ds_read_b64_tr_b16 v[226:227], v20 offset:2048
    v_mfma_f32_16x16x32_bf16 v[48:51], v[216:219], v[104:107], v[48:51]
    ds_read_b64_tr_b16 v[228:229], v25 offset:0
    v_mfma_f32_16x16x32_bf16 v[52:55], v[216:219], v[108:111], v[52:55]
    ds_read_b64_tr_b16 v[230:231], v25 offset:2048
    v_mfma_f32_16x16x32_bf16 v[56:59], v[216:219], v[112:115], v[56:59]
    ds_read_b128 v[120:123], v31 offset:1024
    v_mfma_f32_16x16x32_bf16 v[60:63], v[216:219], v[36:39], v[60:63]
    ds_read_b128 v[124:127], v31 offset:3072
    v_mfma_f32_16x16x32_bf16 v[64:67], v[220:223], v[96:99], v[64:67]
    ds_read_b128 v[128:131], v31 offset:5120
    v_mfma_f32_16x16x32_bf16 v[68:71], v[220:223], v[100:103], v[68:71]
    ds_read_b128 v[132:135], v31 offset:7168
    v_mfma_f32_16x16x32_bf16 v[72:75], v[220:223], v[104:107], v[72:75]
    ds_read_b128 v[136:139], v31 offset:9216
    v_mfma_f32_16x16x32_bf16 v[76:79], v[220:223], v[108:111], v[76:79]
    ds_read_b128 v[140:143], v34 offset:1024
    v_mfma_f32_16x16x32_bf16 v[80:83], v[220:223], v[112:115], v[80:83]
    v_mfma_f32_16x16x32_bf16 v[84:87], v[220:223], v[36:39], v[84:87]
    v_mfma_f32_16x16x32_bf16 v[88:91], v[36:39], v[116:119], v[88:91]
    v_mfma_f32_16x16x32_bf16 v[92:95], v[116:119], v[116:119], v[92:95]
    s_waitcnt vmcnt(3)
    s_barrier
    s_waitcnt lgkmcnt(0)
    v_mfma_f32_16x16x32_bf16 v[40:43], v[224:227], v[120:123], v[40:43]
    ds_read_b64_tr_b16 v[216:217], v21 offset:0
    v_mfma_f32_16x16x32_bf16 v[44:47], v[224:227], v[124:127], v[44:47]
    ds_read_b64_tr_b16 v[218:219], v21 offset:2048
    v_mfma_f32_16x16x32_bf16 v[48:51], v[224:227], v[128:131], v[48:51]
    ds_read_b64_tr_b16 v[220:221], v26 offset:0
    v_mfma_f32_16x16x32_bf16 v[52:55], v[224:227], v[132:135], v[52:55]
    ds_read_b64_tr_b16 v[222:223], v26 offset:2048
    v_mfma_f32_16x16x32_bf16 v[56:59], v[224:227], v[136:139], v[56:59]
    ds_read_b128 v[96:99], v32 offset:0
    v_mfma_f32_16x16x32_bf16 v[60:63], v[224:227], v[36:39], v[60:63]
    ds_read_b128 v[100:103], v32 offset:2048
    v_mfma_f32_16x16x32_bf16 v[64:67], v[228:231], v[120:123], v[64:67]
    ds_read_b128 v[104:107], v32 offset:4096
    v_mfma_f32_16x16x32_bf16 v[68:71], v[228:231], v[124:127], v[68:71]
    ds_read_b128 v[108:111], v32 offset:6144
    v_mfma_f32_16x16x32_bf16 v[72:75], v[228:231], v[128:131], v[72:75]
    ds_read_b128 v[112:115], v32 offset:8192
    v_mfma_f32_16x16x32_bf16 v[76:79], v[228:231], v[132:135], v[76:79]
    ds_read_b128 v[116:119], v35 offset:0
    v_mfma_f32_16x16x32_bf16 v[80:83], v[228:231], v[136:139], v[80:83]
    v_mfma_f32_16x16x32_bf16 v[84:87], v[228:231], v[36:39], v[84:87]
    v_mfma_f32_16x16x32_bf16 v[88:91], v[36:39], v[140:143], v[88:91]
    v_mfma_f32_16x16x32_bf16 v[92:95], v[140:143], v[140:143], v[92:95]
    s_waitcnt vmcnt(0)
    s_barrier
    s_waitcnt lgkmcnt(0)
    v_mfma_f32_16x16x32_bf16 v[40:43], v[216:219], v[96:99], v[40:43]
    ds_read_b64_tr_b16 v[224:225], v22 offset:0
    v_mfma_f32_16x16x32_bf16 v[44:47], v[216:219], v[100:103], v[44:47]
    ds_read_b64_tr_b16 v[226:227], v22 offset:2048
    v_mfma_f32_16x16x32_bf16 v[48:51], v[216:219], v[104:107], v[48:51]
    ds_read_b64_tr_b16 v[228:229], v27 offset:0
    v_mfma_f32_16x16x32_bf16 v[52:55], v[216:219], v[108:111], v[52:55]
    ds_read_b64_tr_b16 v[230:231], v27 offset:2048
    v_mfma_f32_16x16x32_bf16 v[56:59], v[216:219], v[112:115], v[56:59]
    ds_read_b128 v[120:123], v32 offset:1024
    v_mfma_f32_16x16x32_bf16 v[60:63], v[216:219], v[36:39], v[60:63]
    ds_read_b128 v[124:127], v32 offset:3072
    v_mfma_f32_16x16x32_bf16 v[64:67], v[220:223], v[96:99], v[64:67]
    ds_read_b128 v[128:131], v32 offset:5120
    v_mfma_f32_16x16x32_bf16 v[68:71], v[220:223], v[100:103], v[68:71]
    ds_read_b128 v[132:135], v32 offset:7168
    v_mfma_f32_16x16x32_bf16 v[72:75], v[220:223], v[104:107], v[72:75]
    ds_read_b128 v[136:139], v32 offset:9216
    v_mfma_f32_16x16x32_bf16 v[76:79], v[220:223], v[108:111], v[76:79]
    ds_read_b128 v[140:143], v35 offset:1024
    v_mfma_f32_16x16x32_bf16 v[80:83], v[220:223], v[112:115], v[80:83]
    v_mfma_f32_16x16x32_bf16 v[84:87], v[220:223], v[36:39], v[84:87]
    v_mfma_f32_16x16x32_bf16 v[88:91], v[36:39], v[116:119], v[88:91]
    v_mfma_f32_16x16x32_bf16 v[92:95], v[116:119], v[116:119], v[92:95]
    s_waitcnt lgkmcnt(0)
    v_mfma_f32_16x16x32_bf16 v[40:43], v[224:227], v[120:123], v[40:43]
    v_mfma_f32_16x16x32_bf16 v[44:47], v[224:227], v[124:127], v[44:47]
    v_mfma_f32_16x16x32_bf16 v[48:51], v[224:227], v[128:131], v[48:51]
    v_mfma_f32_16x16x32_bf16 v[52:55], v[224:227], v[132:135], v[52:55]
    v_mfma_f32_16x16x32_bf16 v[56:59], v[224:227], v[136:139], v[56:59]
    v_mfma_f32_16x16x32_bf16 v[60:63], v[224:227], v[36:39], v[60:63]
    v_mfma_f32_16x16x32_bf16 v[64:67], v[228:231], v[120:123], v[64:67]
    v_mfma_f32_16x16x32_bf16 v[68:71], v[228:231], v[124:127], v[68:71]
    v_mfma_f32_16x16x32_bf16 v[72:75], v[228:231], v[128:131], v[72:75]
    v_mfma_f32_16x16x32_bf16 v[76:79], v[228:231], v[132:135], v[76:79]
    v_mfma_f32_16x16x32_bf16 v[80:83], v[228:231], v[136:139], v[80:83]
    v_mfma_f32_16x16x32_bf16 v[84:87], v[228:231], v[36:39], v[84:87]
    v_mfma_f32_16x16x32_bf16 v[88:91], v[36:39], v[140:143], v[88:91]
    v_mfma_f32_16x16x32_bf16 v[92:95], v[140:143], v[140:143], v[92:95]
    s_branch L_qkv_post_4
L_qkv_qpath_3:
    s_waitcnt vmcnt(16)
    s_barrier
    ds_read_b64_tr_b16 v[216:217], v20 offset:0
    ds_read_b64_tr_b16 v[218:219], v20 offset:2048
    ds_read_b64_tr_b16 v[220:221], v25 offset:0
    ds_read_b64_tr_b16 v[222:223], v25 offset:2048
    ds_read_b128 v[100:103], v30 offset:2048
    ds_read_b128 v[104:107], v30 offset:4096
    ds_read_b128 v[108:111], v30 offset:6144
    ds_read_b128 v[112:115], v30 offset:8192
    s_waitcnt vmcnt(13)
    s_barrier
    s_waitcnt lgkmcnt(0)
    v_mfma_f32_16x16x32_bf16 v[44:47], v[216:219], v[100:103], 0
    ds_read_b64_tr_b16 v[224:225], v21 offset:0
    v_mfma_f32_16x16x32_bf16 v[48:51], v[216:219], v[104:107], 0
    ds_read_b64_tr_b16 v[226:227], v21 offset:2048
    v_mfma_f32_16x16x32_bf16 v[52:55], v[216:219], v[108:111], 0
    ds_read_b64_tr_b16 v[228:229], v26 offset:0
    v_mfma_f32_16x16x32_bf16 v[56:59], v[216:219], v[112:115], 0
    ds_read_b64_tr_b16 v[230:231], v26 offset:2048
    v_mfma_f32_16x16x32_bf16 v[60:63], v[216:219], v[36:39], 0
    ds_read_b128 v[124:127], v30 offset:3072
    v_mfma_f32_16x16x32_bf16 v[68:71], v[220:223], v[100:103], 0
    ds_read_b128 v[128:131], v30 offset:5120
    v_mfma_f32_16x16x32_bf16 v[72:75], v[220:223], v[104:107], 0
    ds_read_b128 v[132:135], v30 offset:7168
    v_mfma_f32_16x16x32_bf16 v[76:79], v[220:223], v[108:111], 0
    ds_read_b128 v[136:139], v30 offset:9216
    s_add_u32 m0, s58, 98304
    s_nop 0
    buffer_load_dwordx4 v2, s[40:43], s56 offen lds
    v_mfma_f32_16x16x32_bf16 v[80:83], v[220:223], v[112:115], 0
    s_add_u32 m0, s58, 99328
    s_nop 0
    buffer_load_dwordx4 v3, s[40:43], s56 offen lds
    v_mfma_f32_16x16x32_bf16 v[84:87], v[220:223], v[36:39], 0
    s_add_u32 m0, s58, 100352
    s_nop 0
    buffer_load_dwordx4 v4, s[40:43], s56 offen lds
    s_add_u32 s56, s56, 110592
    s_waitcnt vmcnt(13)
    s_barrier
    s_waitcnt lgkmcnt(0)
    v_mfma_f32_16x16x32_bf16 v[44:47], v[224:227], v[124:127], v[44:47]
    ds_read_b64_tr_b16 v[216:217], v22 offset:0
    v_mfma_f32_16x16x32_bf16 v[48:51], v[224:227], v[128:131], v[48:51]
    ds_read_b64_tr_b16 v[218:219], v22 offset:2048
    v_mfma_f32_16x16x32_bf16 v[52:55], v[224:227], v[132:135], v[52:55]
    ds_read_b64_tr_b16 v[220:221], v27 offset:0
    v_mfma_f32_16x16x32_bf16 v[56:59], v[224:227], v[136:139], v[56:59]
    ds_read_b64_tr_b16 v[222:223], v27 offset:2048
    v_mfma_f32_16x16x32_bf16 v[60:63], v[224:227], v[36:39], v[60:63]
    ds_read_b128 v[100:103], v31 offset:2048
    v_mfma_f32_16x16x32_bf16 v[68:71], v[228:231], v[124:127], v[68:71]
    ds_read_b128 v[104:107], v31 offset:4096
    v_mfma_f32_16x16x32_bf16 v[72:75], v[228:231], v[128:131], v[72:75]
    ds_read_b128 v[108:111], v31 offset:6144
    v_mfma_f32_16x16x32_bf16 v[76:79], v[228:231], v[132:135], v[76:79]
    ds_read_b128 v[112:115], v31 offset:8192
    s_add_u32 m0, s58, 0
    s_nop 0
    buffer_load_dwordx4 v2, s[40:43], s56 offen lds
    v_mfma_f32_16x16x32_bf16 v[80:83], v[228:231], v[136:139], v[80:83]
    s_add_u32 m0, s58, 1024
    s_nop 0
    buffer_load_dwordx4 v3, s[40:43], s56 offen lds
    v_mfma_f32_16x16x32_bf16 v[84:87], v[228:231], v[36:39], v[84:87]
    s_add_u32 m0, s58, 2048
    s_nop 0
    buffer_load_dwordx4 v4, s[40:43], s56 offen lds
    s_add_u32 s56, s56, 110592
    s_waitcnt vmcnt(13)
    s_barrier
    s_waitcnt lgkmcnt(0)
    v_mfma_f32_16x16x32_bf16 v[44:47], v[216:219], v[100:103], v[44:47]
    ds_read_b64_tr_b16 v[224:225], v23 offset:0
    v_mfma_f32_16x16x32_bf16 v[48:51], v[216:219], v[104:107], v[48:51]
    ds_read_b64_tr_b16 v[226:227], v23 offset:2048
    v_mfma_f32_16x16x32_bf16 v[52:55], v[216:219], v[108:111], v[52:55]
    ds_read_b64_tr_b16 v[228:229], v28 offset:0
    v_mfma_f32_16x16x32_bf16 v[56:59], v[216:219], v[112:115], v[56:59]
    ds_read_b64_tr_b16 v[230:231], v28 offset:2048
    v_mfma_f32_16x16x32_bf16 v[60:63], v[216:219], v[36:39], v[60:63]
    ds_read_b128 v[124:127], v31 offset:3072
    v_mfma_f32_16x16x32_bf16 v[68:71], v[220:223], v[100:103], v[68:71]
    ds_read_b128 v[128:131], v31 offset:5120
    v_mfma_f32_16x16x32_bf16 v[72:75], v[220:223], v[104:107], v[72:75]
    ds_read_b128 v[132:135], v31 offset:7168
    v_mfma_f32_16x16x32_bf16 v[76:79], v[220:223], v[108:111], v[76:79]
    ds_read_b128 v[136:139], v31 offset:9216
    s_add_u32 m0, s58, 24576
    s_nop 0
    buffer_load_dwordx4 v2, s[40:43], s56 offen lds
    v_mfma_f32_16x16x32_bf16 v[80:83], v[220:223], v[112:115], v[80:83]
    s_add_u32 m0, s58, 25600
    s_nop 0
    buffer_load_dwordx4 v3, s[40:43], s56 offen lds
    v_mfma_f32_16x16x32_bf16 v[84:87], v[220:223], v[36:39], v[84:87]
    s_add_u32 m0, s58, 26624
    s_nop 0
    buffer_load_dwordx4 v4, s[40:43], s56 offen lds
    s_add_u32 s56, s56, 110592
    s_waitcnt vmcnt(6)
    s_barrier
    s_waitcnt lgkmcnt(0)
    v_mfma_f32_16x16x32_bf16 v[44:47], v[224:227], v[124:127], v[44:47]
    ds_read_b64_tr_b16 v[216:217], v24 offset:0
    v_mfma_f32_16x16x32_bf16 v[48:51], v[224:227], v[128:131], v[48:51]
    ds_read_b64_tr_b16 v[218:219], v24 offset:2048
    v_mfma_f32_16x16x32_bf16 v[52:55], v[224:227], v[132:135], v[52:55]
    ds_read_b64_tr_b16 v[220:221], v29 offset:0
    v_mfma_f32_16x16x32_bf16 v[56:59], v[224:227], v[136:139], v[56:59]
    ds_read_b64_tr_b16 v[222:223], v29 offset:2048
    v_mfma_f32_16x16x32_bf16 v[60:63], v[224:227], v[36:39], v[60:63]
    ds_read_b128 v[100:103], v32 offset:2048
    v_mfma_f32_16x16x32_bf16 v[68:71], v[228:231], v[124:127], v[68:71]
    ds_read_b128 v[104:107], v32 offset:4096
    v_mfma_f32_16x16x32_bf16 v[72:75], v[228:231], v[128:131], v[72:75]
    ds_read_b128 v[108:111], v32 offset:6144
    v_mfma_f32_16x16x32_bf16 v[76:79], v[228:231], v[132:135], v[76:79]
    ds_read_b128 v[112:115], v32 offset:8192
    s_add_u32 m0, s58, 49152
    s_nop 0
    buffer_load_dwordx4 v2, s[40:43], s56 offen lds
    v_mfma_f32_16x16x32_bf16 v[80:83], v[228:231], v[136:139], v[80:83]
    s_add_u32 m0, s58, 50176
    s_nop 0
    buffer_load_dwordx4 v3, s[40:43], s56 offen lds
    v_mfma_f32_16x16x32_bf16 v[84:87], v[228:231], v[36:39], v[84:87]
    s_add_u32 m0, s58, 51200
    s_nop 0
    buffer_load_dwordx4 v4, s[40:43], s56 offen lds
    s_add_u32 s56, s56, 110592
    s_waitcnt vmcnt(6)
    s_barrier
    s_waitcnt lgkmcnt(0)
    v_mfma_f32_16x16x32_bf16 v[44:47], v[216:219], v[100:103], v[44:47]
    ds_read_b64_tr_b16 v[224:225], v20 offset:0
    v_mfma_f32_16x16x32_bf16 v[48:51], v[216:219], v[104:107], v[48:51]
    ds_read_b64_tr_b16 v[226:227], v20 offset:2048
    v_mfma_f32_16x16x32_bf16 v[52:55], v[216:219], v[108:111], v[52:55]
    ds_read_b64_tr_b16 v[228:229], v25 offset:0
    v_mfma_f32_16x16x32_bf16 v[56:59], v[216:219], v[112:115], v[56:59]
    ds_read_b64_tr_b16 v[230:231], v25 offset:2048
    v_mfma_f32_16x16x32_bf16 v[60:63], v[216:219], v[36:39], v[60:63]
    ds_read_b128 v[124:127], v32 offset:3072
    v_mfma_f32_16x16x32_bf16 v[68:71], v[220:223], v[100:103], v[68:71]
    ds_read_b128 v[128:131], v32 offset:5120
    v_mfma_f32_16x16x32_bf16 v[72:75], v[220:223], v[104:107], v[72:75]
    ds_read_b128 v[132:135], v32 offset:7168
    v_mfma_f32_16x16x32_bf16 v[76:79], v[220:223], v[108:111], v[76:79]
    ds_read_b128 v[136:139], v32 offset:9216
    s_add_u32 m0, s58, 73728
    s_nop 0
    buffer_load_dwordx4 v2, s[40:43], s56 offen lds
    v_mfma_f32_16x16x32_bf16 v[80:83], v[220:223], v[112:115], v[80:83]
    s_add_u32 m0, s58, 74752
    s_nop 0
    buffer_load_dwordx4 v3, s[40:43], s56 offen lds
    v_mfma_f32_16x16x32_bf16 v[84:87], v[220:223], v[36:39], v[84:87]
    s_add_u32 m0, s58, 75776
    s_nop 0
    buffer_load_dwordx4 v4, s[40:43], s56 offen lds
    s_add_u32 s56, s56, 110592
    s_waitcnt vmcnt(6)
    s_barrier
    s_waitcnt lgkmcnt(0)
    v_mfma_f32_16x16x32_bf16 v[44:47], v[224:227], v[124:127], v[44:47]
    ds_read_b64_tr_b16 v[216:217], v21 offset:0
    v_mfma_f32_16x16x32_bf16 v[48:51], v[224:227], v[128:131], v[48:51]
    ds_read_b64_tr_b16 v[218:219], v21 offset:2048
    v_mfma_f32_16x16x32_bf16 v[52:55], v[224:227], v[132:135], v[52:55]
    ds_read_b64_tr_b16 v[220:221], v26 offset:0
    v_mfma_f32_16x16x32_bf16 v[56:59], v[224:227], v[136:139], v[56:59]
    ds_read_b64_tr_b16 v[222:223], v26 offset:2048
    v_mfma_f32_16x16x32_bf16 v[60:63], v[224:227], v[36:39], v[60:63]
    ds_read_b128 v[100:103], v30 offset:2048
    v_mfma_f32_16x16x32_bf16 v[68:71], v[228:231], v[124:127], v[68:71]
    ds_read_b128 v[104:107], v30 offset:4096
    v_mfma_f32_16x16x32_bf16 v[72:75], v[228:231], v[128:131], v[72:75]
    ds_read_b128 v[108:111], v30 offset:6144
    v_mfma_f32_16x16x32_bf16 v[76:79], v[228:231], v[132:135], v[76:79]
    ds_read_b128 v[112:115], v30 offset:8192
    s_add_u32 m0, s58, 98304
    s_nop 0
    buffer_load_dwordx4 v2, s[40:43], s56 offen lds
    v_mfma_f32_16x16x32_bf16 v[80:83], v[228:231], v[136:139], v[80:83]
    s_add_u32 m0, s58, 99328
    s_nop 0
    buffer_load_dwordx4 v3, s[40:43], s56 offen lds
    v_mfma_f32_16x16x32_bf16 v[84:87], v[228:231], v[36:39], v[84:87]
    s_add_u32 m0, s58, 100352
    s_nop 0
    buffer_load_dwordx4 v4, s[40:43], s56 offen lds
    s_add_u32 s56, s56, 110592
    s_waitcnt vmcnt(6)
    s_barrier
    s_waitcnt lgkmcnt(0)
    v_mfma_f32_16x16x32_bf16 v[44:47], v[216:219], v[100:103], v[44:47]
    ds_read_b64_tr_b16 v[224:225], v22 offset:0
    v_mfma_f32_16x16x32_bf16 v[48:51], v[216:219], v[104:107], v[48:51]
    ds_read_b64_tr_b16 v[226:227], v22 offset:2048
    v_mfma_f32_16x16x32_bf16 v[52:55], v[216:219], v[108:111], v[52:55]
    ds_read_b64_tr_b16 v[228:229], v27 offset:0
    v_mfma_f32_16x16x32_bf16 v[56:59], v[216:219], v[112:115], v[56:59]
    ds_read_b64_tr_b16 v[230:231], v27 offset:2048
    v_mfma_f32_16x16x32_bf16 v[60:63], v[216:219], v[36:39], v[60:63]
    ds_read_b128 v[124:127], v30 offset:3072
    v_mfma_f32_16x16x32_bf16 v[68:71], v[220:223], v[100:103], v[68:71]
    ds_read_b128 v[128:131], v30 offset:5120
    v_mfma_f32_16x16x32_bf16 v[72:75], v[220:223], v[104:107], v[72:75]
    ds_read_b128 v[132:135], v30 offset:7168
    v_mfma_f32_16x16x32_bf16 v[76:79], v[220:223], v[108:111], v[76:79]
    ds_read_b128 v[136:139], v30 offset:9216
    s_add_u32 m0, s58, 0
    s_nop 0
    buffer_load_dwordx4 v2, s[40:43], s56 offen lds
    v_mfma_f32_16x16x32_bf16 v[80:83], v[220:223], v[112:115], v[80:83]
    s_add_u32 m0, s58, 1024
    s_nop 0
    buffer_load_dwordx4 v3, s[40:43], s56 offen lds
    v_mfma_f32_16x16x32_bf16 v[84:87], v[220:223], v[36:39], v[84:87]
    s_add_u32 m0, s58, 2048
    s_nop 0
    buffer_load_dwordx4 v4, s[40:43], s56 offen lds
    s_add_u32 s56, s56, 110592
    s_waitcnt vmcnt(6)
    s_barrier
    s_waitcnt lgkmcnt(0)
    v_mfma_f32_16x16x32_bf16 v[44:47], v[224:227], v[124:127], v[44:47]
    ds_read_b64_tr_b16 v[216:217], v23 offset:0
    v_mfma_f32_16x16x32_bf16 v[48:51], v[224:227], v[128:131], v[48:51]
    ds_read_b64_tr_b16 v[218:219], v23 offset:2048
    v_mfma_f32_16x16x32_bf16 v[52:55], v[224:227], v[132:135], v[52:55]
    ds_read_b64_tr_b16 v[220:221], v28 offset:0
    v_mfma_f32_16x16x32_bf16 v[56:59], v[224:227], v[136:139], v[56:59]
    ds_read_b64_tr_b16 v[222:223], v28 offset:2048
    v_mfma_f32_16x16x32_bf16 v[60:63], v[224:227], v[36:39], v[60:63]
    ds_read_b128 v[100:103], v31 offset:2048
    v_mfma_f32_16x16x32_bf16 v[68:71], v[228:231], v[124:127], v[68:71]
    ds_read_b128 v[104:107], v31 offset:4096
    v_mfma_f32_16x16x32_bf16 v[72:75], v[228:231], v[128:131], v[72:75]
    ds_read_b128 v[108:111], v31 offset:6144
    v_mfma_f32_16x16x32_bf16 v[76:79], v[228:231], v[132:135], v[76:79]
    ds_read_b128 v[112:115], v31 offset:8192
    s_add_u32 m0, s58, 24576
    s_nop 0
    buffer_load_dwordx4 v2, s[40:43], s56 offen lds
    v_mfma_f32_16x16x32_bf16 v[80:83], v[228:231], v[136:139], v[80:83]
    s_add_u32 m0, s58, 25600
    s_nop 0
    buffer_load_dwordx4 v3, s[40:43], s56 offen lds
    v_mfma_f32_16x16x32_bf16 v[84:87], v[228:231], v[36:39], v[84:87]
    s_add_u32 m0, s58, 26624
    s_nop 0
    buffer_load_dwordx4 v4, s[40:43], s56 offen lds
    s_add_u32 s56, s56, 110592
    s_waitcnt vmcnt(6)
    s_barrier
    s_waitcnt lgkmcnt(0)
    v_mfma_f32_16x16x32_bf16 v[44:47], v[216:219], v[100:103], v[44:47]
    ds_read_b64_tr_b16 v[224:225], v24 offset:0
    v_mfma_f32_16x16x32_bf16 v[48:51], v[216:219], v[104:107], v[48:51]
    ds_read_b64_tr_b16 v[226:227], v24 offset:2048
    v_mfma_f32_16x16x32_bf16 v[52:55], v[216:219], v[108:111], v[52:55]
    ds_read_b64_tr_b16 v[228:229], v29 offset:0
    v_mfma_f32_16x16x32_bf16 v[56:59], v[216:219], v[112:115], v[56:59]
    ds_read_b64_tr_b16 v[230:231], v29 offset:2048
    v_mfma_f32_16x16x32_bf16 v[60:63], v[216:219], v[36:39], v[60:63]
    ds_read_b128 v[124:127], v31 offset:3072
    v_mfma_f32_16x16x32_bf16 v[68:71], v[220:223], v[100:103], v[68:71]
    ds_read_b128 v[128:131], v31 offset:5120
    v_mfma_f32_16x16x32_bf16 v[72:75], v[220:223], v[104:107], v[72:75]
    ds_read_b128 v[132:135], v31 offset:7168
    v_mfma_f32_16x16x32_bf16 v[76:79], v[220:223], v[108:111], v[76:79]
    ds_read_b128 v[136:139], v31 offset:9216
    s_add_u32 m0, s58, 49152
    s_nop 0
    buffer_load_dwordx4 v2, s[40:43], s56 offen lds
    v_mfma_f32_16x16x32_bf16 v[80:83], v[220:223], v[112:115], v[80:83]
    s_add_u32 m0, s58, 50176
    s_nop 0
    buffer_load_dwordx4 v3, s[40:43], s56 offen lds
    v_mfma_f32_16x16x32_bf16 v[84:87], v[220:223], v[36:39], v[84:87]
    s_add_u32 m0, s58, 51200
    s_nop 0
    buffer_load_dwordx4 v4, s[40:43], s56 offen lds
    s_add_u32 s56, s56, 110592
    s_waitcnt vmcnt(6)
    s_barrier
    s_waitcnt lgkmcnt(0)
    v_mfma_f32_16x16x32_bf16 v[44:47], v[224:227], v[124:127], v[44:47]
    ds_read_b64_tr_b16 v[216:217], v20 offset:0
    v_mfma_f32_16x16x32_bf16 v[48:51], v[224:227], v[128:131], v[48:51]
    ds_read_b64_tr_b16 v[218:219], v20 offset:2048
    v_mfma_f32_16x16x32_bf16 v[52:55], v[224:227], v[132:135], v[52:55]
    ds_read_b64_tr_b16 v[220:221], v25 offset:0
    v_mfma_f32_16x16x32_bf16 v[56:59], v[224:227], v[136:139], v[56:59]
    ds_read_b64_tr_b16 v[222:223], v25 offset:2048
    v_mfma_f32_16x16x32_bf16 v[60:63], v[224:227], v[36:39], v[60:63]
    ds_read_b128 v[100:103], v32 offset:2048
    v_mfma_f32_16x16x32_bf16 v[68:71], v[228:231], v[124:127], v[68:71]
    ds_read_b128 v[104:107], v32 offset:4096
    v_mfma_f32_16x16x32_bf16 v[72:75], v[228:231], v[128:131], v[72:75]
    ds_read_b128 v[108:111], v32 offset:6144
    v_mfma_f32_16x16x32_bf16 v[76:79], v[228:231], v[132:135], v[76:79]
    ds_read_b128 v[112:115], v32 offset:8192
    s_add_u32 m0, s58, 73728
    s_nop 0
    buffer_load_dwordx4 v2, s[40:43], s56 offen lds
    v_mfma_f32_16x16x32_bf16 v[80:83], v[228:231], v[136:139], v[80:83]
    s_add_u32 m0, s58, 74752
    s_nop 0
    buffer_load_dwordx4 v3, s[40:43], s56 offen lds
    v_mfma_f32_16x16x32_bf16 v[84:87], v[228:231], v[36:39], v[84:87]
    s_add_u32 m0, s58, 75776
    s_nop 0
    buffer_load_dwordx4 v4, s[40:43], s56 offen lds
    s_add_u32 s56, s56, 110592
    s_waitcnt vmcnt(6)
    s_barrier
    s_waitcnt lgkmcnt(0)
    v_mfma_f32_16x16x32_bf16 v[44:47], v[216:219], v[100:103], v[44:47]
    ds_read_b64_tr_b16 v[224:225], v21 offset:0
    v_mfma_f32_16x16x32_bf16 v[48:51], v[216:219], v[104:107], v[48:51]
    ds_read_b64_tr_b16 v[226:227], v21 offset:2048
    v_mfma_f32_16x16x32_bf16 v[52:55], v[216:219], v[108:111], v[52:55]
    ds_read_b64_tr_b16 v[228:229], v26 offset:0
    v_mfma_f32_16x16x32_bf16 v[56:59], v[216:219], v[112:115], v[56:59]
    ds_read_b64_tr_b16 v[230:231], v26 offset:2048
    v_mfma_f32_16x16x32_bf16 v[60:63], v[216:219], v[36:39], v[60:63]
    ds_read_b128 v[124:127], v32 offset:3072
    v_mfma_f32_16x16x32_bf16 v[68:71], v[220:223], v[100:103], v[68:71]
    ds_read_b128 v[128:131], v32 offset:5120
    v_mfma_f32_16x16x32_bf16 v[72:75], v[220:223], v[104:107], v[72:75]
    ds_read_b128 v[132:135], v32 offset:7168
    v_mfma_f32_16x16x32_bf16 v[76:79], v[220:223], v[108:111], v[76:79]
    ds_read_b128 v[136:139], v32 offset:9216
    s_add_u32 m0, s58, 98304
    s_nop 0
    buffer_load_dwordx4 v2, s[40:43], s56 offen lds
    v_mfma_f32_16x16x32_bf16 v[80:83], v[220:223], v[112:115], v[80:83]
    s_add_u32 m0, s58, 99328
    s_nop 0
    buffer_load_dwordx4 v3, s[40:43], s56 offen lds
    v_mfma_f32_16x16x32_bf16 v[84:87], v[220:223], v[36:39], v[84:87]
    s_add_u32 m0, s58, 100352
    s_nop 0
    buffer_load_dwordx4 v4, s[40:43], s56 offen lds
    s_add_u32 s56, s56, 110592
    s_waitcnt vmcnt(6)
    s_barrier
    s_waitcnt lgkmcnt(0)
    v_mfma_f32_16x16x32_bf16 v[44:47], v[224:227], v[124:127], v[44:47]
    ds_read_b64_tr_b16 v[216:217], v22 offset:0
    v_mfma_f32_16x16x32_bf16 v[48:51], v[224:227], v[128:131], v[48:51]
    ds_read_b64_tr_b16 v[218:219], v22 offset:2048
    v_mfma_f32_16x16x32_bf16 v[52:55], v[224:227], v[132:135], v[52:55]
    ds_read_b64_tr_b16 v[220:221], v27 offset:0
    v_mfma_f32_16x16x32_bf16 v[56:59], v[224:227], v[136:139], v[56:59]
    ds_read_b64_tr_b16 v[222:223], v27 offset:2048
    v_mfma_f32_16x16x32_bf16 v[60:63], v[224:227], v[36:39], v[60:63]
    ds_read_b128 v[100:103], v30 offset:2048
    v_mfma_f32_16x16x32_bf16 v[68:71], v[228:231], v[124:127], v[68:71]
    ds_read_b128 v[104:107], v30 offset:4096
    v_mfma_f32_16x16x32_bf16 v[72:75], v[228:231], v[128:131], v[72:75]
    ds_read_b128 v[108:111], v30 offset:6144
    v_mfma_f32_16x16x32_bf16 v[76:79], v[228:231], v[132:135], v[76:79]
    ds_read_b128 v[112:115], v30 offset:8192
    s_add_u32 m0, s58, 0
    s_nop 0
    buffer_load_dwordx4 v2, s[40:43], s56 offen lds
    v_mfma_f32_16x16x32_bf16 v[80:83], v[228:231], v[136:139], v[80:83]
    s_add_u32 m0, s58, 1024
    s_nop 0
    buffer_load_dwordx4 v3, s[40:43], s56 offen lds
    v_mfma_f32_16x16x32_bf16 v[84:87], v[228:231], v[36:39], v[84:87]
    s_add_u32 m0, s58, 2048
    s_nop 0
    buffer_load_dwordx4 v4, s[40:43], s56 offen lds
    s_add_u32 s56, s56, 110592
    s_waitcnt vmcnt(6)
    s_barrier
    s_waitcnt lgkmcnt(0)
    v_mfma_f32_16x16x32_bf16 v[44:47], v[216:219], v[100:103], v[44:47]
    ds_read_b64_tr_b16 v[224:225], v23 offset:0
    v_mfma_f32_16x16x32_bf16 v[48:51], v[216:219], v[104:107], v[48:51]
    ds_read_b64_tr_b16 v[226:227], v23 offset:2048
    v_mfma_f32_16x16x32_bf16 v[52:55], v[216:219], v[108:111], v[52:55]
    ds_read_b64_tr_b16 v[228:229], v28 offset:0
    v_mfma_f32_16x16x32_bf16 v[56:59], v[216:219], v[112:115], v[56:59]
    ds_read_b64_tr_b16 v[230:231], v28 offset:2048
    v_mfma_f32_16x16x32_bf16 v[60:63], v[216:219], v[36:39], v[60:63]
    ds_read_b128 v[124:127], v30 offset:3072
    v_mfma_f32_16x16x32_bf16 v[68:71], v[220:223], v[100:103], v[68:71]
    ds_read_b128 v[128:131], v30 offset:5120
    v_mfma_f32_16x16x32_bf16 v[72:75], v[220:223], v[104:107], v[72:75]
    ds_read_b128 v[132:135], v30 offset:7168
    v_mfma_f32_16x16x32_bf16 v[76:79], v[220:223], v[108:111], v[76:79]
    ds_read_b128 v[136:139], v30 offset:9216
    s_add_u32 m0, s58, 24576
    s_nop 0
    buffer_load_dwordx4 v2, s[40:43], s56 offen lds
    v_mfma_f32_16x16x32_bf16 v[80:83], v[220:223], v[112:115], v[80:83]
    s_add_u32 m0, s58, 25600
    s_nop 0
    buffer_load_dwordx4 v3, s[40:43], s56 offen lds
    v_mfma_f32_16x16x32_bf16 v[84:87], v[220:223], v[36:39], v[84:87]
    s_add_u32 m0, s58, 26624
    s_nop 0
    buffer_load_dwordx4 v4, s[40:43], s56 offen lds
    s_add_u32 s56, s56, 110592
    s_waitcnt vmcnt(6)
    s_barrier
    s_waitcnt lgkmcnt(0)
    v_mfma_f32_16x16x32_bf16 v[44:47], v[224:227], v[124:127], v[44:47]
    ds_read_b64_tr_b16 v[216:217], v24 offset:0
    v_mfma_f32_16x16x32_bf16 v[48:51], v[224:227], v[128:131], v[48:51]
    ds_read_b64_tr_b16 v[218:219], v24 offset:2048
    v_mfma_f32_16x16x32_bf16 v[52:55], v[224:227], v[132:135], v[52:55]
    ds_read_b64_tr_b16 v[220:221], v29 offset:0
    v_mfma_f32_16x16x32_bf16 v[56:59], v[224:227], v[136:139], v[56:59]
    ds_read_b64_tr_b16 v[222:223], v29 offset:2048
    v_mfma_f32_16x16x32_bf16 v[60:63], v[224:227], v[36:39], v[60:63]
    ds_read_b128 v[100:103], v31 offset:2048
    v_mfma_f32_16x16x32_bf16 v[68:71], v[228:231], v[124:127], v[68:71]
    ds_read_b128 v[104:107], v31 offset:4096
    v_mfma_f32_16x16x32_bf16 v[72:75], v[228:231], v[128:131], v[72:75]
    ds_read_b128 v[108:111], v31 offset:6144
    v_mfma_f32_16x16x32_bf16 v[76:79], v[228:231], v[132:135], v[76:79]
    ds_read_b128 v[112:115], v31 offset:8192
    s_add_u32 m0, s58, 49152
    s_nop 0
    buffer_load_dwordx4 v2, s[40:43], s56 offen lds
    v_mfma_f32_16x16x32_bf16 v[80:83], v[228:231], v[136:139], v[80:83]
    s_add_u32 m0, s58, 50176
    s_nop 0
    buffer_load_dwordx4 v3, s[40:43], s56 offen lds
    v_mfma_f32_16x16x32_bf16 v[84:87], v[228:231], v[36:39], v[84:87]
    s_add_u32 m0, s58, 51200
    s_nop 0
    buffer_load_dwordx4 v4, s[40:43], s56 offen lds
    s_add_u32 s56, s56, 110592
    s_waitcnt vmcnt(6)
    s_barrier
    s_waitcnt lgkmcnt(0)
    v_mfma_f32_16x16x32_bf16 v[44:47], v[216:219], v[100:103], v[44:47]
    ds_read_b64_tr_b16 v[224:225], v20 offset:0
    v_mfma_f32_16x16x32_bf16 v[48:51], v[216:219], v[104:107], v[48:51]
    ds_read_b64_tr_b16 v[226:227], v20 offset:2048
    v_mfma_f32_16x16x32_bf16 v[52:55], v[216:219], v[108:111], v[52:55]
    ds_read_b64_tr_b16 v[228:229], v25 offset:0
    v_mfma_f32_16x16x32_bf16 v[56:59], v[216:219], v[112:115], v[56:59]
    ds_read_b64_tr_b16 v[230:231], v25 offset:2048
    v_mfma_f32_16x16x32_bf16 v[60:63], v[216:219], v[36:39], v[60:63]
    ds_read_b128 v[124:127], v31 offset:3072
    v_mfma_f32_16x16x32_bf16 v[68:71], v[220:223], v[100:103], v[68:71]
    ds_read_b128 v[128:131], v31 offset:5120
    v_mfma_f32_16x16x32_bf16 v[72:75], v[220:223], v[104:107], v[72:75]
    ds_read_b128 v[132:135], v31 offset:7168
    v_mfma_f32_16x16x32_bf16 v[76:79], v[220:223], v[108:111], v[76:79]
    ds_read_b128 v[136:139], v31 offset:9216
    v_mfma_f32_16x16x32_bf16 v[80:83], v[220:223], v[112:115], v[80:83]
    v_mfma_f32_16x16x32_bf16 v[84:87], v[220:223], v[36:39], v[84:87]
    s_waitcnt vmcnt(3)
    s_barrier
    s_waitcnt lgkmcnt(0)
    v_mfma_f32_16x16x32_bf16 v[44:47], v[224:227], v[124:127], v[44:47]
    ds_read_b64_tr_b16 v[216:217], v21 offset:0
    v_mfma_f32_16x16x32_bf16 v[48:51], v[224:227], v[128:131], v[48:51]
    ds_read_b64_tr_b16 v[218:219], v21 offset:2048
    v_mfma_f32_16x16x32_bf16 v[52:55], v[224:227], v[132:135], v[52:55]
    ds_read_b64_tr_b16 v[220:221], v26 offset:0
    v_mfma_f32_16x16x32_bf16 v[56:59], v[224:227], v[136:139], v[56:59]
    ds_read_b64_tr_b16 v[222:223], v26 offset:2048
    v_mfma_f32_16x16x32_bf16 v[60:63], v[224:227], v[36:39], v[60:63]
    ds_read_b128 v[100:103], v32 offset:2048
    v_mfma_f32_16x16x32_bf16 v[68:71], v[228:231], v[124:127], v[68:71]
    ds_read_b128 v[104:107], v32 offset:4096
    v_mfma_f32_16x16x32_bf16 v[72:75], v[228:231], v[128:131], v[72:75]
    ds_read_b128 v[108:111], v32 offset:6144
    v_mfma_f32_16x16x32_bf16 v[76:79], v[228:231], v[132:135], v[76:79]
    ds_read_b128 v[112:115], v32 offset:8192
    v_mfma_f32_16x16x32_bf16 v[80:83], v[228:231], v[136:139], v[80:83]
    v_mfma_f32_16x16x32_bf16 v[84:87], v[228:231], v[36:39], v[84:87]
    s_waitcnt vmcnt(0)
    s_barrier
    s_waitcnt lgkmcnt(0)
    v_mfma_f32_16x16x32_bf16 v[44:47], v[216:219], v[100:103], v[44:47]
    ds_read_b64_tr_b16 v[224:225], v22 offset:0
    v_mfma_f32_16x16x32_bf16 v[48:51], v[216:219], v[104:107], v[48:51]
    ds_read_b64_tr_b16 v[226:227], v22 offset:2048
    v_mfma_f32_16x16x32_bf16 v[52:55], v[216:219], v[108:111], v[52:55]
    ds_read_b64_tr_b16 v[228:229], v27 offset:0
    v_mfma_f32_16x16x32_bf16 v[56:59], v[216:219], v[112:115], v[56:59]
    ds_read_b64_tr_b16 v[230:231], v27 offset:2048
    v_mfma_f32_16x16x32_bf16 v[60:63], v[216:219], v[36:39], v[60:63]
    ds_read_b128 v[124:127], v32 offset:3072
    v_mfma_f32_16x16x32_bf16 v[68:71], v[220:223], v[100:103], v[68:71]
    ds_read_b128 v[128:131], v32 offset:5120
    v_mfma_f32_16x16x32_bf16 v[72:75], v[220:223], v[104:107], v[72:75]
    ds_read_b128 v[132:135], v32 offset:7168
    v_mfma_f32_16x16x32_bf16 v[76:79], v[220:223], v[108:111], v[76:79]
    ds_read_b128 v[136:139], v32 offset:9216
    v_mfma_f32_16x16x32_bf16 v[80:83], v[220:223], v[112:115], v[80:83]
    v_mfma_f32_16x16x32_bf16 v[84:87], v[220:223], v[36:39], v[84:87]
    s_waitcnt lgkmcnt(0)
    v_mfma_f32_16x16x32_bf16 v[44:47], v[224:227], v[124:127], v[44:47]
    v_mfma_f32_16x16x32_bf16 v[48:51], v[224:227], v[128:131], v[48:51]
    v_mfma_f32_16x16x32_bf16 v[52:55], v[224:227], v[132:135], v[52:55]
    v_mfma_f32_16x16x32_bf16 v[56:59], v[224:227], v[136:139], v[56:59]
    v_mfma_f32_16x16x32_bf16 v[60:63], v[224:227], v[36:39], v[60:63]
    v_mfma_f32_16x16x32_bf16 v[68:71], v[228:231], v[124:127], v[68:71]
    v_mfma_f32_16x16x32_bf16 v[72:75], v[228:231], v[128:131], v[72:75]
    v_mfma_f32_16x16x32_bf16 v[76:79], v[228:231], v[132:135], v[76:79]
    v_mfma_f32_16x16x32_bf16 v[80:83], v[228:231], v[136:139], v[80:83]
    v_mfma_f32_16x16x32_bf16 v[84:87], v[228:231], v[36:39], v[84:87]
L_qkv_post_4:
    s_nop 7
    s_nop 7
    s_barrier
    v_and_b32 v18, 3, v0
    v_cmp_eq_u32 vcc, 1, v18
    v_mov_b32 v19, v92
    s_nop 0
    v_cndmask_b32 v19, v19, v93, vcc
    v_cmp_eq_u32 vcc, 2, v18
    s_nop 1
    v_cndmask_b32 v19, v19, v94, vcc
    v_cmp_eq_u32 vcc, 3, v18
    s_nop 1
    v_cndmask_b32 v19, v19, v95, vcc
    s_mov_b32 s60, 0x3ae38e39
    s_mov_b32 s61, 0x3727c5ac
    v_mul_f32 v8, s60, v88
    v_mul_f32 v19, s60, v19
    v_fma_f32 v19, -v8, v8, v19
    v_max_f32 v19, 0, v19
    v_add_f32 v19, s61, v19
    v_rsq_f32 v9, v19
    v_sub_f32 v8, 0, v8
    v_lshrrev_b32 v18, 2, v16
    v_cmp_eq_u32 vcc, v18, v17
    s_lshl_b32 s60, s4, 7
    v_lshlrev_b32 v18, 3, v16
    v_add_u32 v18, s60, v18
    v_add_u32 v18, 78080, v18
    s_and_saveexec_b64 s[60:61], vcc
    ds_write_b64 v18, v[8:9]
    s_mov_b64 exec, -1
    s_waitcnt lgkmcnt(0)
    s_barrier
    v_lshlrev_b32 v18, 3, v16
    v_add_u32 v18, 78080, v18
    ds_read_b64 v[96:97], v18 offset:0
    ds_read_b64 v[98:99], v18 offset:128
    ds_read_b64 v[100:101], v18 offset:256
    ds_read_b64 v[102:103], v18 offset:384
    ds_read_b64 v[104:105], v18 offset:512
    s_lshl_b32 s60, s11, 1
    v_mul_u32_u24 v18, 976, v16
    v_lshlrev_b32 v19, 4, v17
    v_add3_u32 v8, v18, v19, s60
    s_lshl_b32 s60, s12, 1
    v_mul_u32_u24 v18, 976, v16
    v_lshlrev_b32 v19, 4, v17
    v_add3_u32 v9, v18, v19, s60
    s_waitcnt lgkmcnt(0)
    v_fma_f32 v40, v96, v60, v40
    v_fma_f32 v41, v96, v61, v41
    v_fma_f32 v42, v96, v62, v42
    v_fma_f32 v43, v96, v63, v43
    v_mul_f32 v40, v97, v40
    v_mul_f32 v41, v97, v41
    v_mul_f32 v42, v97, v42
    v_mul_f32 v43, v97, v43
    v_cvt_pk_bf16_f32 v18, v40, v41
    v_cvt_pk_bf16_f32 v19, v42, v43
    v_lshlrev_b32 v40, 16, v18
    v_and_b32 v41, 0xffff0000, v18
    v_lshlrev_b32 v42, 16, v19
    v_and_b32 v43, 0xffff0000, v19
    ds_write_b128 v8, v[40:43] offset:0
    v_fma_f32 v44, v98, v60, v44
    v_fma_f32 v45, v98, v61, v45
    v_fma_f32 v46, v98, v62, v46
    v_fma_f32 v47, v98, v63, v47
    v_mul_f32 v44, v99, v44
    v_mul_f32 v45, v99, v45
    v_mul_f32 v46, v99, v46
    v_mul_f32 v47, v99, v47
    v_cvt_pk_bf16_f32 v18, v44, v45
    v_cvt_pk_bf16_f32 v19, v46, v47
    v_lshlrev_b32 v44, 16, v18
    v_and_b32 v45, 0xffff0000, v18
    v_lshlrev_b32 v46, 16, v19
    v_and_b32 v47, 0xffff0000, v19
    ds_write_b128 v8, v[44:47] offset:15616
    v_fma_f32 v48, v100, v60, v48
    v_fma_f32 v49, v100, v61, v49
    v_fma_f32 v50, v100, v62, v50
    v_fma_f32 v51, v100, v63, v51
    v_mul_f32 v48, v101, v48
    v_mul_f32 v49, v101, v49
    v_mul_f32 v50, v101, v50
    v_mul_f32 v51, v101, v51
    v_cvt_pk_bf16_f32 v18, v48, v49
    v_cvt_pk_bf16_f32 v19, v50, v51
    v_lshlrev_b32 v48, 16, v18
    v_and_b32 v49, 0xffff0000, v18
    v_lshlrev_b32 v50, 16, v19
    v_and_b32 v51, 0xffff0000, v19
    ds_write_b128 v8, v[48:51] offset:31232
    v_fma_f32 v52, v102, v60, v52
    v_fma_f32 v53, v102, v61, v53
    v_fma_f32 v54, v102, v62, v54
    v_fma_f32 v55, v102, v63, v55
    v_mul_f32 v52, v103, v52
    v_mul_f32 v53, v103, v53
    v_mul_f32 v54, v103, v54
    v_mul_f32 v55, v103, v55
    v_cvt_pk_bf16_f32 v18, v52, v53
    v_cvt_pk_bf16_f32 v19, v54, v55
    v_lshlrev_b32 v52, 16, v18
    v_and_b32 v53, 0xffff0000, v18
    v_lshlrev_b32 v54, 16, v19
    v_and_b32 v55, 0xffff0000, v19
    ds_write_b128 v8, v[52:55] offset:46848
    v_fma_f32 v56, v104, v60, v56
    v_fma_f32 v57, v104, v61, v57
    v_fma_f32 v58, v104, v62, v58
    v_fma_f32 v59, v104, v63, v59
    v_mul_f32 v56, v105, v56
    v_mul_f32 v57, v105, v57
    v_mul_f32 v58, v105, v58
    v_mul_f32 v59, v105, v59
    v_cvt_pk_bf16_f32 v18, v56, v57
    v_cvt_pk_bf16_f32 v19, v58, v59
    v_lshlrev_b32 v56, 16, v18
    v_and_b32 v57, 0xffff0000, v18
    v_lshlrev_b32 v58, 16, v19
    v_and_b32 v59, 0xffff0000, v19
    ds_write_b128 v8, v[56:59] offset:62464
    v_fma_f32 v64, v96, v84, v64
    v_fma_f32 v65, v96, v85, v65
    v_fma_f32 v66, v96, v86, v66
    v_fma_f32 v67, v96, v87, v67
    v_mul_f32 v64, v97, v64
    v_mul_f32 v65, v97, v65
    v_mul_f32 v66, v97, v66
    v_mul_f32 v67, v97, v67
    v_cvt_pk_bf16_f32 v18, v64, v65
    v_cvt_pk_bf16_f32 v19, v66, v67
    v_lshlrev_b32 v64, 16, v18
    v_and_b32 v65, 0xffff0000, v18
    v_lshlrev_b32 v66, 16, v19
    v_and_b32 v67, 0xffff0000, v19
    ds_write_b128 v9, v[64:67] offset:0
    v_fma_f32 v68, v98, v84, v68
    v_fma_f32 v69, v98, v85, v69
    v_fma_f32 v70, v98, v86, v70
    v_fma_f32 v71, v98, v87, v71
    v_mul_f32 v68, v99, v68
    v_mul_f32 v69, v99, v69
    v_mul_f32 v70, v99, v70
    v_mul_f32 v71, v99, v71
    v_cvt_pk_bf16_f32 v18, v68, v69
    v_cvt_pk_bf16_f32 v19, v70, v71
    v_lshlrev_b32 v68, 16, v18
    v_and_b32 v69, 0xffff0000, v18
    v_lshlrev_b32 v70, 16, v19
    v_and_b32 v71, 0xffff0000, v19
    ds_write_b128 v9, v[68:71] offset:15616
    v_fma_f32 v72, v100, v84, v72
    v_fma_f32 v73, v100, v85, v73
    v_fma_f32 v74, v100, v86, v74
    v_fma_f32 v75, v100, v87, v75
    v_mul_f32 v72, v101, v72
    v_mul_f32 v73, v101, v73
    v_mul_f32 v74, v101, v74
    v_mul_f32 v75, v101, v75
    v_cvt_pk_bf16_f32 v18, v72, v73
    v_cvt_pk_bf16_f32 v19, v74, v75
    v_lshlrev_b32 v72, 16, v18
    v_and_b32 v73, 0xffff0000, v18
    v_lshlrev_b32 v74, 16, v19
    v_and_b32 v75, 0xffff0000, v19
    ds_write_b128 v9, v[72:75] offset:31232
    v_fma_f32 v76, v102, v84, v76
    v_fma_f32 v77, v102, v85, v77
    v_fma_f32 v78, v102, v86, v78
    v_fma_f32 v79, v102, v87, v79
    v_mul_f32 v76, v103, v76
    v_mul_f32 v77, v103, v77
    v_mul_f32 v78, v103, v78
    v_mul_f32 v79, v103, v79
    v_cvt_pk_bf16_f32 v18, v76, v77
    v_cvt_pk_bf16_f32 v19, v78, v79
    v_lshlrev_b32 v76, 16, v18
    v_and_b32 v77, 0xffff0000, v18
    v_lshlrev_b32 v78, 16, v19
    v_and_b32 v79, 0xffff0000, v19
    ds_write_b128 v9, v[76:79] offset:46848
    v_fma_f32 v80, v104, v84, v80
    v_fma_f32 v81, v104, v85, v81
    v_fma_f32 v82, v104, v86, v82
    v_fma_f32 v83, v104, v87, v83
    v_mul_f32 v80, v105, v80
    v_mul_f32 v81, v105, v81
    v_mul_f32 v82, v105, v82
    v_mul_f32 v83, v105, v83
    v_cvt_pk_bf16_f32 v18, v80, v81
    v_cvt_pk_bf16_f32 v19, v82, v83
    v_lshlrev_b32 v80, 16, v18
    v_and_b32 v81, 0xffff0000, v18
    v_lshlrev_b32 v82, 16, v19
    v_and_b32 v83, 0xffff0000, v19
    ds_write_b128 v9, v[80:83] offset:62464
    s_waitcnt lgkmcnt(0)
    s_barrier
    v_lshrrev_b32 v18, 3, v0
    s_lshl_b32 s60, s4, 3
    v_add_u32 v18, s60, v18
    v_bfe_u32 v19, v0, 1, 2
    v_and_b32 v26, 1, v0
    v_mul_u32_u24 v20, 976, v18
    v_mul_u32_u24 v21, 72, v19
    v_add_u32 v20, v20, v21
    v_mul_u32_u24 v21, 7808, v26
    v_sub_u32 v27, v20, v21
    v_add_u32 v27, 9760, v27
    ds_read_b64 v[32:33], v20 offset:15616
    ds_read_b64 v[34:35], v20 offset:15624
    ds_read_b64 v[36:37], v20 offset:15632
    ds_read_b64 v[38:39], v20 offset:15640
    ds_read_b64 v[40:41], v20 offset:15648
    ds_read_b64 v[42:43], v20 offset:15656
    ds_read_b64 v[44:45], v20 offset:15664
    ds_read_b64 v[46:47], v20 offset:15672
    ds_read_b64 v[48:49], v20 offset:15680
    ds_read_b64 v[52:53], v27 offset:6176
    ds_read_b64 v[54:55], v27 offset:6184
    ds_read_b64 v[56:57], v27 offset:6192
    ds_read_b64 v[58:59], v27 offset:6200
    ds_read_b64 v[60:61], v27 offset:6208
    ds_read_b64 v[62:63], v27 offset:6216
    ds_read_b64 v[64:65], v27 offset:6224
    ds_read_b64 v[66:67], v27 offset:6232
    ds_read_b64 v[68:69], v27 offset:6240
    ds_read_b64 v[70:71], v27 offset:4224
    ds_read_b64 v[72:73], v27 offset:4232
    ds_read_b64 v[74:75], v27 offset:4240
    ds_read_b64 v[76:77], v27 offset:4248
    ds_read_b64 v[78:79], v27 offset:4256
    ds_read_b64 v[80:81], v27 offset:4264
    ds_read_b64 v[82:83], v27 offset:4272
    ds_read_b64 v[84:85], v27 offset:4280
    ds_read_b64 v[86:87], v27 offset:4288
    ds_read_b64 v[88:89], v27 offset:2272
    ds_read_b64 v[90:91], v27 offset:2280
    ds_read_b64 v[92:93], v27 offset:2288
    ds_read_b64 v[94:95], v27 offset:2296
    ds_read_b64 v[96:97], v27 offset:2304
    ds_read_b64 v[98:99], v27 offset:2312
    ds_read_b64 v[100:101], v27 offset:2320
    ds_read_b64 v[102:103], v27 offset:2328
    ds_read_b64 v[104:105], v27 offset:2336
    ds_read_b64 v[106:107], v27 offset:320
    ds_read_b64 v[108:109], v27 offset:328
    ds_read_b64 v[110:111], v27 offset:336
    ds_read_b64 v[112:113], v27 offset:344
    ds_read_b64 v[114:115], v27 offset:352
    ds_read_b64 v[116:117], v27 offset:360
    ds_read_b64 v[118:119], v27 offset:368
    ds_read_b64 v[120:121], v27 offset:376
    ds_read_b64 v[122:123], v27 offset:384
    s_waitcnt lgkmcnt(15)
    v_mul_f32 v124, v32, v52
    v_mul_f32 v24, v33, v53
    v_fmac_f32 v124, v34, v54
    v_fmac_f32 v24, v35, v55
    v_fmac_f32 v124, v36, v56
    v_fmac_f32 v24, v37, v57
    v_fmac_f32 v124, v38, v58
    v_fmac_f32 v24, v39, v59
    v_fmac_f32 v124, v40, v60
    v_fmac_f32 v24, v41, v61
    v_fmac_f32 v124, v42, v62
    v_fmac_f32 v24, v43, v63
    v_fmac_f32 v124, v44, v64
    v_fmac_f32 v24, v45, v65
    v_fmac_f32 v124, v46, v66
    v_fmac_f32 v24, v47, v67
    v_fmac_f32 v124, v48, v68
    v_fmac_f32 v24, v49, v69
    v_add_f32 v124, v124, v24
    ds_read_b64 v[52:53], v27 offset:6496
    ds_read_b64 v[54:55], v27 offset:6504
    ds_read_b64 v[56:57], v27 offset:6512
    ds_read_b64 v[58:59], v27 offset:6520
    ds_read_b64 v[60:61], v27 offset:6528
    ds_read_b64 v[62:63], v27 offset:6536
    ds_read_b64 v[64:65], v27 offset:6544
    ds_read_b64 v[66:67], v27 offset:6552
    ds_read_b64 v[68:69], v27 offset:6560
    v_mul_f32 v125, v32, v70
    v_mul_f32 v24, v33, v71
    v_fmac_f32 v125, v34, v72
    v_fmac_f32 v24, v35, v73
    v_fmac_f32 v125, v36, v74
    v_fmac_f32 v24, v37, v75
    v_fmac_f32 v125, v38, v76
    v_fmac_f32 v24, v39, v77
    v_fmac_f32 v125, v40, v78
    v_fmac_f32 v24, v41, v79
    v_fmac_f32 v125, v42, v80
    v_fmac_f32 v24, v43, v81
    v_fmac_f32 v125, v44, v82
    v_fmac_f32 v24, v45, v83
    v_fmac_f32 v125, v46, v84
    v_fmac_f32 v24, v47, v85
    v_fmac_f32 v125, v48, v86
    v_fmac_f32 v24, v49, v87
    v_add_f32 v125, v125, v24
    ds_read_b64 v[70:71], v27 offset:4544
    ds_read_b64 v[72:73], v27 offset:4552
    ds_read_b64 v[74:75], v27 offset:4560
    ds_read_b64 v[76:77], v27 offset:4568
    ds_read_b64 v[78:79], v27 offset:4576
    ds_read_b64 v[80:81], v27 offset:4584
    ds_read_b64 v[82:83], v27 offset:4592
    ds_read_b64 v[84:85], v27 offset:4600
    ds_read_b64 v[86:87], v27 offset:4608
    s_waitcnt lgkmcnt(15)
    v_mul_f32 v126, v32, v88
    v_mul_f32 v24, v33, v89
    v_fmac_f32 v126, v34, v90
    v_fmac_f32 v24, v35, v91
    v_fmac_f32 v126, v36, v92
    v_fmac_f32 v24, v37, v93
    v_fmac_f32 v126, v38, v94
    v_fmac_f32 v24, v39, v95
    v_fmac_f32 v126, v40, v96
    v_fmac_f32 v24, v41, v97
    v_fmac_f32 v126, v42, v98
    v_fmac_f32 v24, v43, v99
    v_fmac_f32 v126, v44, v100
    v_fmac_f32 v24, v45, v101
    v_fmac_f32 v126, v46, v102
    v_fmac_f32 v24, v47, v103
    v_fmac_f32 v126, v48, v104
    v_fmac_f32 v24, v49, v105
    v_add_f32 v126, v126, v24
    ds_read_b64 v[88:89], v27 offset:2592
    ds_read_b64 v[90:91], v27 offset:2600
    ds_read_b64 v[92:93], v27 offset:2608
    ds_read_b64 v[94:95], v27 offset:2616
    ds_read_b64 v[96:97], v27 offset:2624
    ds_read_b64 v[98:99], v27 offset:2632
    ds_read_b64 v[100:101], v27 offset:2640
    ds_read_b64 v[102:103], v27 offset:2648
    ds_read_b64 v[104:105], v27 offset:2656
    v_mul_f32 v127, v32, v106
    v_mul_f32 v24, v33, v107
    v_fmac_f32 v127, v34, v108
    v_fmac_f32 v24, v35, v109
    v_fmac_f32 v127, v36, v110
    v_fmac_f32 v24, v37, v111
    v_fmac_f32 v127, v38, v112
    v_fmac_f32 v24, v39, v113
    v_fmac_f32 v127, v40, v114
    v_fmac_f32 v24, v41, v115
    v_fmac_f32 v127, v42, v116
    v_fmac_f32 v24, v43, v117
    v_fmac_f32 v127, v44, v118
    v_fmac_f32 v24, v45, v119
    v_fmac_f32 v127, v46, v120
    v_fmac_f32 v24, v47, v121
    v_fmac_f32 v127, v48, v122
    v_fmac_f32 v24, v49, v123
    v_add_f32 v127, v127, v24
    ds_read_b64 v[106:107], v27 offset:640
    ds_read_b64 v[108:109], v27 offset:648
    ds_read_b64 v[110:111], v27 offset:656
    ds_read_b64 v[112:113], v27 offset:664
    ds_read_b64 v[114:115], v27 offset:672
    ds_read_b64 v[116:117], v27 offset:680
    ds_read_b64 v[118:119], v27 offset:688
    ds_read_b64 v[120:121], v27 offset:696
    ds_read_b64 v[122:123], v27 offset:704
    s_mov_b32 s60, 0x3e715bef
    s_lshl_b32 s61, s10, 6
    v_add_u32 v22, s61, v18
    v_lshlrev_b32 v25, 3, v26
    v_sub_u32 v25, v22, v25
    v_mov_b32 v23, 0xce6e6b28
    v_mul_f32 v124, s60, v124
    v_mul_f32 v125, s60, v125
    v_mul_f32 v126, s60, v126
    v_mul_f32 v127, s60, v127
    v_cmp_le_i32 vcc, 0, v25
    s_nop 1
    v_cndmask_b32 v124, v23, v124, vcc
    v_cmp_le_i32 vcc, 2, v25
    s_nop 1
    v_cndmask_b32 v125, v23, v125, vcc
    v_cmp_le_i32 vcc, 4, v25
    s_nop 1
    v_cndmask_b32 v126, v23, v126, vcc
    v_cmp_le_i32 vcc, 6, v25
    s_nop 1
    v_cndmask_b32 v127, v23, v127, vcc
    v_max3_f32 v24, v124, v125, v126
    v_max_f32 v24, v24, v127
    s_nop 1
    v_max_f32 v24, v24, v24 quad_perm:[1,0,3,2] row_mask:0xf bank_mask:0xf
    s_mov_b32 s60, 0x3fb8aa3b
    v_sub_f32 v124, v124, v24
    v_sub_f32 v125, v125, v24
    v_sub_f32 v126, v126, v24
    v_sub_f32 v127, v127, v24
    v_mul_f32 v124, s60, v124
    v_mul_f32 v125, s60, v125
    v_mul_f32 v126, s60, v126
    v_mul_f32 v127, s60, v127
    v_exp_f32 v124, v124
    v_exp_f32 v125, v125
    v_exp_f32 v126, v126
    v_exp_f32 v127, v127
    s_nop 0
    v_add_f32 v24, v124, v125
    v_add_f32 v25, v126, v127
    v_add_f32 v24, v24, v25
    s_nop 1
    v_add_f32 v24, v24, v24 quad_perm:[1,0,3,2] row_mask:0xf bank_mask:0xf
    v_rcp_f32 v24, v24
    s_nop 0
    v_mul_f32 v124, v124, v24
    v_mul_f32 v125, v125, v24
    v_mul_f32 v126, v126, v24
    v_mul_f32 v127, v127, v24
    s_waitcnt lgkmcnt(15)
    v_mul_f32 v128, v124, v52
    v_mul_f32 v129, v124, v53
    v_mul_f32 v130, v124, v54
    v_mul_f32 v131, v124, v55
    v_mul_f32 v132, v124, v56
    v_mul_f32 v133, v124, v57
    v_mul_f32 v134, v124, v58
    v_mul_f32 v135, v124, v59
    v_mul_f32 v136, v124, v60
    v_mul_f32 v137, v124, v61
    v_mul_f32 v138, v124, v62
    v_mul_f32 v139, v124, v63
    v_mul_f32 v140, v124, v64
    v_mul_f32 v141, v124, v65
    v_mul_f32 v142, v124, v66
    v_mul_f32 v143, v124, v67
    v_mul_f32 v144, v124, v68
    v_mul_f32 v145, v124, v69
    v_fmac_f32 v128, v125, v70
    v_fmac_f32 v129, v125, v71
    v_fmac_f32 v130, v125, v72
    v_fmac_f32 v131, v125, v73
    v_fmac_f32 v132, v125, v74
    v_fmac_f32 v133, v125, v75
    v_fmac_f32 v134, v125, v76
    v_fmac_f32 v135, v125, v77
    v_fmac_f32 v136, v125, v78
    v_fmac_f32 v137, v125, v79
    v_fmac_f32 v138, v125, v80
    v_fmac_f32 v139, v125, v81
    v_fmac_f32 v140, v125, v82
    v_fmac_f32 v141, v125, v83
    v_fmac_f32 v142, v125, v84
    v_fmac_f32 v143, v125, v85
    v_fmac_f32 v144, v125, v86
    v_fmac_f32 v145, v125, v87
    s_waitcnt lgkmcnt(9)
    v_fmac_f32 v128, v126, v88
    v_fmac_f32 v129, v126, v89
    v_fmac_f32 v130, v126, v90
    v_fmac_f32 v131, v126, v91
    v_fmac_f32 v132, v126, v92
    v_fmac_f32 v133, v126, v93
    v_fmac_f32 v134, v126, v94
    v_fmac_f32 v135, v126, v95
    v_fmac_f32 v136, v126, v96
    v_fmac_f32 v137, v126, v97
    v_fmac_f32 v138, v126, v98
    v_fmac_f32 v139, v126, v99
    v_fmac_f32 v140, v126, v100
    v_fmac_f32 v141, v126, v101
    v_fmac_f32 v142, v126, v102
    v_fmac_f32 v143, v126, v103
    v_fmac_f32 v144, v126, v104
    v_fmac_f32 v145, v126, v105
    s_waitcnt lgkmcnt(0)
    v_fmac_f32 v128, v127, v106
    v_fmac_f32 v129, v127, v107
    v_fmac_f32 v130, v127, v108
    v_fmac_f32 v131, v127, v109
    v_fmac_f32 v132, v127, v110
    v_fmac_f32 v133, v127, v111
    v_fmac_f32 v134, v127, v112
    v_fmac_f32 v135, v127, v113
    v_fmac_f32 v136, v127, v114
    v_fmac_f32 v137, v127, v115
    v_fmac_f32 v138, v127, v116
    v_fmac_f32 v139, v127, v117
    v_fmac_f32 v140, v127, v118
    v_fmac_f32 v141, v127, v119
    v_fmac_f32 v142, v127, v120
    v_fmac_f32 v143, v127, v121
    v_fmac_f32 v144, v127, v122
    v_fmac_f32 v145, v127, v123
    s_nop 1
    v_add_f32 v52, v128, v128 quad_perm:[1,0,3,2] row_mask:0xf bank_mask:0xf
    v_add_f32 v53, v129, v129 quad_perm:[1,0,3,2] row_mask:0xf bank_mask:0xf
    v_add_f32 v54, v130, v130 quad_perm:[1,0,3,2] row_mask:0xf bank_mask:0xf
    v_add_f32 v55, v131, v131 quad_perm:[1,0,3,2] row_mask:0xf bank_mask:0xf
    v_add_f32 v56, v132, v132 quad_perm:[1,0,3,2] row_mask:0xf bank_mask:0xf
    v_add_f32 v57, v133, v133 quad_perm:[1,0,3,2] row_mask:0xf bank_mask:0xf
    v_add_f32 v58, v134, v134 quad_perm:[1,0,3,2] row_mask:0xf bank_mask:0xf
    v_add_f32 v59, v135, v135 quad_perm:[1,0,3,2] row_mask:0xf bank_mask:0xf
    v_add_f32 v60, v136, v136 quad_perm:[1,0,3,2] row_mask:0xf bank_mask:0xf
    v_add_f32 v61, v137, v137 quad_perm:[1,0,3,2] row_mask:0xf bank_mask:0xf
    v_add_f32 v62, v138, v138 quad_perm:[1,0,3,2] row_mask:0xf bank_mask:0xf
    v_add_f32 v63, v139, v139 quad_perm:[1,0,3,2] row_mask:0xf bank_mask:0xf
    v_add_f32 v64, v140, v140 quad_perm:[1,0,3,2] row_mask:0xf bank_mask:0xf
    v_add_f32 v65, v141, v141 quad_perm:[1,0,3,2] row_mask:0xf bank_mask:0xf
    v_add_f32 v66, v142, v142 quad_perm:[1,0,3,2] row_mask:0xf bank_mask:0xf
    v_add_f32 v67, v143, v143 quad_perm:[1,0,3,2] row_mask:0xf bank_mask:0xf
    v_add_f32 v68, v144, v144 quad_perm:[1,0,3,2] row_mask:0xf bank_mask:0xf
    v_add_f32 v69, v145, v145 quad_perm:[1,0,3,2] row_mask:0xf bank_mask:0xf
    v_cvt_pk_bf16_f32 v32, v52, v53
    v_cvt_pk_bf16_f32 v33, v54, v55
    v_cvt_pk_bf16_f32 v34, v56, v57
    v_cvt_pk_bf16_f32 v35, v58, v59
    v_cvt_pk_bf16_f32 v36, v60, v61
    v_cvt_pk_bf16_f32 v37, v62, v63
    v_cvt_pk_bf16_f32 v38, v64, v65
    v_cvt_pk_bf16_f32 v39, v66, v67
    v_cvt_pk_bf16_f32 v40, v68, v69
    v_cmp_eq_u32 vcc, 1, v26
    v_lshrrev_b32 v23, 4, v22
    v_mul_u32_u24 v23, 18432, v23
    v_and_b32 v24, 15, v22
    v_lshlrev_b32 v24, 4, v24
    v_add_u32 v23, v23, v24
    v_mul_u32_u24 v21, 18, v19
    s_mul_i32 s60, s9, 72
    v_add_u32 v21, s60, v21
    v_lshlrev_b32 v24, 3, v26
    v_add_u32 v21, v21, v24
    v_cndmask_b32 v128, v32, v36, vcc
    v_add_u32 v24, 0, v21
    v_lshrrev_b32 v25, 3, v24
    v_lshlrev_b32 v25, 8, v25
    v_and_b32 v24, 7, v24
    v_lshlrev_b32 v24, 1, v24
    v_add3_u32 v136, v23, v24, v25
    buffer_store_dword v128, v136, s[44:47], 0 offen
    v_cndmask_b32 v129, v33, v37, vcc
    v_add_u32 v24, 2, v21
    v_lshrrev_b32 v25, 3, v24
    v_lshlrev_b32 v25, 8, v25
    v_and_b32 v24, 7, v24
    v_lshlrev_b32 v24, 1, v24
    v_add3_u32 v137, v23, v24, v25
    buffer_store_dword v129, v137, s[44:47], 0 offen
    v_cndmask_b32 v130, v34, v38, vcc
    v_add_u32 v24, 4, v21
    v_lshrrev_b32 v25, 3, v24
    v_lshlrev_b32 v25, 8, v25
    v_and_b32 v24, 7, v24
    v_lshlrev_b32 v24, 1, v24
    v_add3_u32 v138, v23, v24, v25
    buffer_store_dword v130, v138, s[44:47], 0 offen
    v_cndmask_b32 v131, v35, v39, vcc
    v_add_u32 v24, 6, v21
    v_lshrrev_b32 v25, 3, v24
    v_lshlrev_b32 v25, 8, v25
    v_and_b32 v24, 7, v24
    v_lshlrev_b32 v24, 1, v24
    v_add3_u32 v139, v23, v24, v25
    buffer_store_dword v131, v139, s[44:47], 0 offen
    v_cndmask_b32 v132, v36, v40, vcc
    v_add_u32 v24, 8, v21
    v_lshrrev_b32 v25, 3, v24
    v_lshlrev_b32 v25, 8, v25
    v_and_b32 v24, 7, v24
    v_lshlrev_b32 v24, 1, v24
    v_add3_u32 v140, v23, v24, v25
    buffer_store_dword v132, v140, s[44:47], 0 offen
L_qkv_cs3_2:
L_qkv_end:
    s_endpgm
.globl ffn_kernel
.p2align 8
.type ffn_kernel,@function
ffn_kernel:
    s_cmp_ge_u32 s2, 256
    s_cbranch_scc1 L_ffn_end
    s_load_dwordx16 s[16:31], s[0:1], 0
    s_load_dwordx4 s[32:35], s[0:1], 64
    v_lshrrev_b32 v1, 6, v0
    v_and_b32 v0, 63, v0
    s_nop 0
    v_readfirstlane_b32 s4, v1
    s_waitcnt lgkmcnt(0)
    s_and_b32 s9, s2, 3
    s_lshr_b32 s60, s2, 2
    s_lshl_b32 s7, s60, 5
    s_mul_i32 s8, s9, 144
    s_lshr_b32 s5, s4, 1
    s_and_b32 s6, s4, 1
    s_mov_b32 s36, s34
    s_mov_b32 s37, s35
    s_mov_b32 s38, 0x240000
    s_mov_b32 s39, 0x00020000
    s_mov_b32 s40, s20
    s_mov_b32 s41, s21
    s_mov_b32 s42, 0xa2000
    s_mov_b32 s43, 0x00020000
    s_mov_b32 s44, s16
    s_mov_b32 s45, s17
    s_mov_b32 s46, 0x240000
    s_mov_b32 s47, 0x00020000
    s_add_u32 s48, s34, 0x400000
    s_addc_u32 s49, s35, 0
    s_mov_b32 s50, 0x240000
    s_mov_b32 s51, 0x00020000
    s_add_u32 s52, s34, 0x800000
    s_addc_u32 s53, s35, 0
    s_mov_b32 s54, 0x10000
    s_mov_b32 s55, 0x00020000
    s_cmp_ge_u32 s4, 4
    s_cbranch_scc1 L_ffn_idle_1
    v_and_b32 v16, 15, v0
    v_lshrrev_b32 v17, 4, v0
    s_lshl_b32 s60, s5, 4
    s_add_u32 s60, s60, s7
    v_add_u32 v31, s60, v16
    s_movk_i32 s63, 1152
    v_mul_lo_u32 v18, v31, s63
    v_lshlrev_b32 v19, 3, v17
    s_lshl_b32 s62, s8, 1
    v_add3_u32 v32, v18, v19, s62
    buffer_load_dwordx2 v[80:81], v32, s[44:47], 0 offen offset:0
    buffer_load_dwordx2 v[82:83], v32, s[44:47], 0 offen offset:32
    buffer_load_dwordx2 v[84:85], v32, s[44:47], 0 offen offset:64
    buffer_load_dwordx2 v[86:87], v32, s[44:47], 0 offen offset:96
    buffer_load_dwordx2 v[88:89], v32, s[44:47], 0 offen offset:128
    buffer_load_dwordx2 v[90:91], v32, s[44:47], 0 offen offset:160
    buffer_load_dwordx2 v[92:93], v32, s[44:47], 0 offen offset:192
    buffer_load_dwordx2 v[94:95], v32, s[44:47], 0 offen offset:224
    buffer_load_dwordx2 v[96:97], v32, s[44:47], 0 offen offset:256
    s_lshr_b32 s60, s7, 4
    s_add_u32 s60, s60, s5
    s_mul_i32 s60, s60, 18432
    s_lshl_b32 s61, s6, 10
    s_add_u32 s61, s60, s61
    v_lshlrev_b32 v19, 4, v0
    v_add_u32 v2, s61, v19
    v_lshrrev_b32 v18, 1, v17
    v_lshlrev_b32 v37, 8, v18
    v_lshlrev_b32 v18, 4, v16
    v_add_u32 v37, v37, v18
    v_and_b32 v18, 1, v17
    v_lshlrev_b32 v18, 3, v18
    v_add_u32 v37, v37, v18
    s_lshl_b32 s61, s8, 5
    s_add_u32 s60, s60, s61
    v_add_u32 v37, s60, v37
    s_mul_i32 s88, s4, 48
    s_lshl_b32 s62, s8, 1
    s_and_b32 s62, s62, 0xffffff80
    s_movk_i32 s63, 1152
    v_lshrrev_b32 v18, 3, v0
    v_add_u32 v18, s88, v18
    v_mul_u32_u24 v19, 21846, v18
    v_lshrrev_b32 v19, 16, v19
    v_mul_u32_u24 v20, 3, v19
    v_sub_u32 v18, v18, v20
    v_lshlrev_b32 v18, 7, v18
    v_bfe_u32 v20, v19, 1, 2
    v_bfe_u32 v21, v0, 1, 2
    v_xor_b32 v20, v20, v21
    v_lshlrev_b32 v20, 5, v20
    v_and_b32 v21, 1, v0
    v_lshlrev_b32 v21, 4, v21
    v_add3_u32 v18, v18, v20, v21
    v_lshrrev_b32 v23, 5, v19
    v_and_b32 v19, 31, v19
    v_and_b32 v20, 0x33, v19
    v_bfe_u32 v21, v19, 2, 1
    v_lshlrev_b32 v21, 3, v21
    v_bfe_u32 v22, v19, 3, 1
    v_lshlrev_b32 v22, 2, v22
    v_or3_b32 v20, v20, v21, v22
    v_mul_u32_u24 v21, 32, v23
    v_add_u32 v20, v20, v21
    v_mul_lo_u32 v20, v20, s63
    v_add3_u32 v8, v20, v18, s62
    v_lshrrev_b32 v18, 3, v0
    v_add_u32 v18, s88, v18
    v_add_u32 v18, 8, v18
    v_mul_u32_u24 v19, 21846, v18
    v_lshrrev_b32 v19, 16, v19
    v_mul_u32_u24 v20, 3, v19
    v_sub_u32 v18, v18, v20
    v_lshlrev_b32 v18, 7, v18
    v_bfe_u32 v20, v19, 1, 2
    v_bfe_u32 v21, v0, 1, 2
    v_xor_b32 v20, v20, v21
    v_lshlrev_b32 v20, 5, v20
    v_and_b32 v21, 1, v0
    v_lshlrev_b32 v21, 4, v21
    v_add3_u32 v18, v18, v20, v21
    v_lshrrev_b32 v23, 5, v19
    v_and_b32 v19, 31, v19
    v_and_b32 v20, 0x33, v19
    v_bfe_u32 v21, v19, 2, 1
    v_lshlrev_b32 v21, 3, v21
    v_bfe_u32 v22, v19, 3, 1
    v_lshlrev_b32 v22, 2, v22
    v_or3_b32 v20, v20, v21, v22
    v_mul_u32_u24 v21, 32, v23
    v_add_u32 v20, v20, v21
    v_mul_lo_u32 v20, v20, s63
    v_add3_u32 v9, v20, v18, s62
    v_lshrrev_b32 v18, 3, v0
    v_add_u32 v18, s88, v18
    v_add_u32 v18, 16, v18
    v_mul_u32_u24 v19, 21846, v18
    v_lshrrev_b32 v19, 16, v19
    v_mul_u32_u24 v20, 3, v19
    v_sub_u32 v18, v18, v20
    v_lshlrev_b32 v18, 7, v18
    v_bfe_u32 v20, v19, 1, 2
    v_bfe_u32 v21, v0, 1, 2
    v_xor_b32 v20, v20, v21
    v_lshlrev_b32 v20, 5, v20
    v_and_b32 v21, 1, v0
    v_lshlrev_b32 v21, 4, v21
    v_add3_u32 v18, v18, v20, v21
    v_lshrrev_b32 v23, 5, v19
    v_and_b32 v19, 31, v19
    v_and_b32 v20, 0x33, v19
    v_bfe_u32 v21, v19, 2, 1
    v_lshlrev_b32 v21, 3, v21
    v_bfe_u32 v22, v19, 3, 1
    v_lshlrev_b32 v22, 2, v22
    v_or3_b32 v20, v20, v21, v22
    v_mul_u32_u24 v21, 32, v23
    v_add_u32 v20, v20, v21
    v_mul_lo_u32 v20, v20, s63
    v_add3_u32 v10, v20, v18, s62
    v_lshrrev_b32 v18, 3, v0
    v_add_u32 v18, s88, v18
    v_add_u32 v18, 24, v18
    v_mul_u32_u24 v19, 21846, v18
    v_lshrrev_b32 v19, 16, v19
    v_mul_u32_u24 v20, 3, v19
    v_sub_u32 v18, v18, v20
    v_lshlrev_b32 v18, 7, v18
    v_bfe_u32 v20, v19, 1, 2
    v_bfe_u32 v21, v0, 1, 2
    v_xor_b32 v20, v20, v21
    v_lshlrev_b32 v20, 5, v20
    v_and_b32 v21, 1, v0
    v_lshlrev_b32 v21, 4, v21
    v_add3_u32 v18, v18, v20, v21
    v_lshrrev_b32 v23, 5, v19
    v_and_b32 v19, 31, v19
    v_and_b32 v20, 0x33, v19
    v_bfe_u32 v21, v19, 2, 1
    v_lshlrev_b32 v21, 3, v21
    v_bfe_u32 v22, v19, 3, 1
    v_lshlrev_b32 v22, 2, v22
    v_or3_b32 v20, v20, v21, v22
    v_mul_u32_u24 v21, 32, v23
    v_add_u32 v20, v20, v21
    v_mul_lo_u32 v20, v20, s63
    v_add3_u32 v11, v20, v18, s62
    v_lshrrev_b32 v18, 3, v0
    v_add_u32 v18, s88, v18
    v_add_u32 v18, 32, v18
    v_mul_u32_u24 v19, 21846, v18
    v_lshrrev_b32 v19, 16, v19
    v_mul_u32_u24 v20, 3, v19
    v_sub_u32 v18, v18, v20
    v_lshlrev_b32 v18, 7, v18
    v_bfe_u32 v20, v19, 1, 2
    v_bfe_u32 v21, v0, 1, 2
    v_xor_b32 v20, v20, v21
    v_lshlrev_b32 v20, 5, v20
    v_and_b32 v21, 1, v0
    v_lshlrev_b32 v21, 4, v21
    v_add3_u32 v18, v18, v20, v21
    v_lshrrev_b32 v23, 5, v19
    v_and_b32 v19, 31, v19
    v_and_b32 v20, 0x33, v19
    v_bfe_u32 v21, v19, 2, 1
    v_lshlrev_b32 v21, 3, v21
    v_bfe_u32 v22, v19, 3, 1
    v_lshlrev_b32 v22, 2, v22
    v_or3_b32 v20, v20, v21, v22
    v_mul_u32_u24 v21, 32, v23
    v_add_u32 v20, v20, v21
    v_mul_lo_u32 v20, v20, s63
    v_add3_u32 v12, v20, v18, s62
    v_lshrrev_b32 v18, 3, v0
    v_add_u32 v18, s88, v18
    v_add_u32 v18, 40, v18
    v_mul_u32_u24 v19, 21846, v18
    v_lshrrev_b32 v19, 16, v19
    v_mul_u32_u24 v20, 3, v19
    v_sub_u32 v18, v18, v20
    v_lshlrev_b32 v18, 7, v18
    v_bfe_u32 v20, v19, 1, 2
    v_bfe_u32 v21, v0, 1, 2
    v_xor_b32 v20, v20, v21
    v_lshlrev_b32 v20, 5, v20
    v_and_b32 v21, 1, v0
    v_lshlrev_b32 v21, 4, v21
    v_add3_u32 v18, v18, v20, v21
    v_lshrrev_b32 v23, 5, v19
    v_and_b32 v19, 31, v19
    v_and_b32 v20, 0x33, v19
    v_bfe_u32 v21, v19, 2, 1
    v_lshlrev_b32 v21, 3, v21
    v_bfe_u32 v22, v19, 3, 1
    v_lshlrev_b32 v22, 2, v22
    v_or3_b32 v20, v20, v21, v22
    v_mul_u32_u24 v21, 32, v23
    v_add_u32 v20, v20, v21
    v_mul_lo_u32 v20, v20, s63
    v_add3_u32 v13, v20, v18, s62
    s_mov_b32 s56, 0
    s_mov_b32 s57, 0
    s_lshl_b32 s58, s4, 10
    s_mul_i32 s59, s4, 6144
    s_add_u32 s59, s59, 4096
    s_add_u32 m0, s58, 0
    s_nop 0
    buffer_load_dwordx4 v2, s[36:39], s56 offen lds
    s_add_u32 m0, s59, 0
    s_nop 0
    buffer_load_dwordx4 v8, s[40:43], s57 offen lds
    s_add_u32 m0, s59, 1024
    s_nop 0
    buffer_load_dwordx4 v9, s[40:43], s57 offen lds
    s_add_u32 m0, s59, 2048
    s_nop 0
    buffer_load_dwordx4 v10, s[40:43], s57 offen lds
    s_add_u32 m0, s59, 3072
    s_nop 0
    buffer_load_dwordx4 v11, s[40:43], s57 offen lds
    s_add_u32 m0, s59, 4096
    s_nop 0
    buffer_load_dwordx4 v12, s[40:43], s57 offen lds
    s_add_u32 m0, s59, 5120
    s_nop 0
    buffer_load_dwordx4 v13, s[40:43], s57 offen lds
    s_add_u32 s56, s56, 2048
    s_add_u32 s57, s57, 73728
    s_add_u32 m0, s58, 28672
    s_nop 0
    buffer_load_dwordx4 v2, s[36:39], s56 offen lds
    s_add_u32 m0, s59, 28672
    s_nop 0
    buffer_load_dwordx4 v8, s[40:43], s57 offen lds
    s_add_u32 m0, s59, 29696
    s_nop 0
    buffer_load_dwordx4 v9, s[40:43], s57 offen lds
    s_add_u32 m0, s59, 30720
    s_nop 0
    buffer_load_dwordx4 v10, s[40:43], s57 offen lds
    s_add_u32 m0, s59, 31744
    s_nop 0
    buffer_load_dwordx4 v11, s[40:43], s57 offen lds
    s_add_u32 m0, s59, 32768
    s_nop 0
    buffer_load_dwordx4 v12, s[40:43], s57 offen lds
    s_add_u32 m0, s59, 33792
    s_nop 0
    buffer_load_dwordx4 v13, s[40:43], s57 offen lds
    s_add_u32 s56, s56, 2048
    s_add_u32 s57, s57, 73728
    s_add_u32 m0, s58, 57344
    s_nop 0
    buffer_load_dwordx4 v2, s[36:39], s56 offen lds
    s_add_u32 m0, s59, 57344
    s_nop 0
    buffer_load_dwordx4 v8, s[40:43], s57 offen lds
    s_add_u32 m0, s59, 58368
    s_nop 0
    buffer_load_dwordx4 v9, s[40:43], s57 offen lds
    s_add_u32 m0, s59, 59392
    s_nop 0
    buffer_load_dwordx4 v10, s[40:43], s57 offen lds
    s_add_u32 m0, s59, 60416
    s_nop 0
    buffer_load_dwordx4 v11, s[40:43], s57 offen lds
    s_add_u32 m0, s59, 61440
    s_nop 0
    buffer_load_dwordx4 v12, s[40:43], s57 offen lds
    s_add_u32 m0, s59, 62464
    s_nop 0
    buffer_load_dwordx4 v13, s[40:43], s57 offen lds
    s_add_u32 s56, s56, 2048
    s_add_u32 s57, s57, 73728
    s_add_u32 m0, s58, 86016
    s_nop 0
    buffer_load_dwordx4 v2, s[36:39], s56 offen lds
    s_add_u32 m0, s59, 86016
    s_nop 0
    buffer_load_dwordx4 v8, s[40:43], s57 offen lds
    s_add_u32 m0, s59, 87040
    s_nop 0
    buffer_load_dwordx4 v9, s[40:43], s57 offen lds
    s_add_u32 m0, s59, 88064
    s_nop 0
    buffer_load_dwordx4 v10, s[40:43], s57 offen lds
    s_add_u32 m0, s59, 89088
    s_nop 0
    buffer_load_dwordx4 v11, s[40:43], s57 offen lds
    s_add_u32 m0, s59, 90112
    s_nop 0
    buffer_load_dwordx4 v12, s[40:43], s57 offen lds
    s_add_u32 m0, s59, 91136
    s_nop 0
    buffer_load_dwordx4 v13, s[40:43], s57 offen lds
    s_add_u32 s56, s56, 2048
    s_add_u32 s57, s57, 73728
    v_lshlrev_b32 v18, 4, v0
    v_add_u32 v24, s58, v18
    v_add_u32 v25, 57344, v24
    v_add_u32 v26, 114688, v24
    s_bfe_u32 s62, s8, 0x20004
    s_mul_i32 s63, s6, 12288
    s_add_u32 s63, s63, 4096
    v_lshrrev_b32 v19, 5, v0
    v_lshlrev_b32 v18, 4, v19
    v_bfe_u32 v19, v0, 4, 1
    v_lshlrev_b32 v19, 2, v19
    v_add_u32 v18, v18, v19
    v_bfe_u32 v20, v0, 2, 2
    v_add_u32 v18, v18, v20
    v_bfe_u32 v19, v18, 1, 2
    v_mul_u32_u24 v18, 384, v18
    v_and_b32 v20, 3, v0
    v_lshlrev_b32 v20, 3, v20
    v_add3_u32 v18, v18, v20, s63
    s_add_u32 s60, s62, 0
    s_and_b32 s61, s60, 3
    s_lshr_b32 s60, s60, 2
    s_lshl_b32 s60, s60, 7
    v_xor_b32 v20, s61, v19
    v_lshlrev_b32 v20, 5, v20
    v_add3_u32 v100, v18, v20, s60
    s_add_u32 s60, s62, 1
    s_and_b32 s61, s60, 3
    s_lshr_b32 s60, s60, 2
    s_lshl_b32 s60, s60, 7
    v_xor_b32 v20, s61, v19
    v_lshlrev_b32 v20, 5, v20
    v_add3_u32 v101, v18, v20, s60
    s_add_u32 s60, s62, 2
    s_and_b32 s61, s60, 3
    s_lshr_b32 s60, s60, 2
    s_lshl_b32 s60, s60, 7
    v_xor_b32 v20, s61, v19
    v_lshlrev_b32 v20, 5, v20
    v_add3_u32 v102, v18, v20, s60
    s_add_u32 s60, s62, 3
    s_and_b32 s61, s60, 3
    s_lshr_b32 s60, s60, 2
    s_lshl_b32 s60, s60, 7
    v_xor_b32 v20, s61, v19
    v_lshlrev_b32 v20, 5, v20
    v_add3_u32 v103, v18, v20, s60
    v_add_u32 v104, 57344, v100
    v_add_u32 v105, 57344, v101
    v_add_u32 v106, 57344, v102
    v_add_u32 v107, 57344, v103
    v_add_u32 v108, 114688, v100
    v_add_u32 v109, 114688, v101
    v_add_u32 v110, 114688, v102
    v_add_u32 v111, 114688, v103
    s_waitcnt vmcnt(21)
    s_barrier
    ds_read_b128 v[48:51], v24 offset:0
    ds_read_b64_tr_b16 v[56:57], v100 offset:0
    ds_read_b64_tr_b16 v[58:59], v100 offset:3072
    ds_read_b64_tr_b16 v[60:61], v101 offset:0
    ds_read_b64_tr_b16 v[62:63], v101 offset:3072
    ds_read_b64_tr_b16 v[64:65], v102 offset:0
    ds_read_b64_tr_b16 v[66:67], v102 offset:3072
    ds_read_b64_tr_b16 v[68:69], v103 offset:0
    ds_read_b64_tr_b16 v[70:71], v103 offset:3072
    s_waitcnt vmcnt(14)
    s_barrier
    s_waitcnt lgkmcnt(8)
    s_waitcnt lgkmcnt(6)
    v_mfma_f32_16x16x32_bf16 v[112:115], v[56:59], v[48:51], 0
    ds_read_b64_tr_b16 v[72:73], v100 offset:128
    ds_read_b64_tr_b16 v[74:75], v100 offset:3200
    s_add_u32 m0, s58, 114688
    s_nop 0
    buffer_load_dwordx4 v2, s[36:39], s56 offen lds
    s_waitcnt lgkmcnt(6)
    v_mfma_f32_16x16x32_bf16 v[116:119], v[60:63], v[48:51], 0
    ds_read_b64_tr_b16 v[76:77], v101 offset:128
    ds_read_b64_tr_b16 v[78:79], v101 offset:3200
    s_add_u32 m0, s59, 114688
    s_nop 0
    buffer_load_dwordx4 v8, s[40:43], s57 offen lds
    s_waitcnt lgkmcnt(6)
    v_mfma_f32_16x16x32_bf16 v[120:123], v[64:67], v[48:51], 0
    ds_read_b64_tr_b16 v[56:57], v102 offset:128
    ds_read_b64_tr_b16 v[58:59], v102 offset:3200
    ds_read_b128 v[52:55], v24 offset:28672
    s_add_u32 m0, s59, 115712
    s_nop 0
    buffer_load_dwordx4 v9, s[40:43], s57 offen lds
    s_waitcnt lgkmcnt(7)
    v_mfma_f32_16x16x32_bf16 v[124:127], v[68:71], v[48:51], 0
    ds_read_b64_tr_b16 v[60:61], v103 offset:128
    ds_read_b64_tr_b16 v[62:63], v103 offset:3200
    s_add_u32 m0, s59, 116736
    s_nop 0
    buffer_load_dwordx4 v10, s[40:43], s57 offen lds
    s_waitcnt lgkmcnt(7)
    v_mfma_f32_16x16x32_bf16 v[128:131], v[72:75], v[48:51], 0
    ds_read_b64_tr_b16 v[64:65], v100 offset:256
    ds_read_b64_tr_b16 v[66:67], v100 offset:3328
    s_add_u32 m0, s59, 117760
    s_nop 0
    buffer_load_dwordx4 v11, s[40:43], s57 offen lds
    s_waitcnt lgkmcnt(7)
    v_mfma_f32_16x16x32_bf16 v[132:135], v[76:79], v[48:51], 0
    ds_read_b64_tr_b16 v[68:69], v100 offset:28672
    ds_read_b64_tr_b16 v[70:71], v100 offset:31744
    s_add_u32 m0, s59, 118784
    s_nop 0
    buffer_load_dwordx4 v12, s[40:43], s57 offen lds
    s_waitcnt lgkmcnt(7)
    v_mfma_f32_16x16x32_bf16 v[136:139], v[56:59], v[48:51], 0
    ds_read_b64_tr_b16 v[72:73], v101 offset:28672
    ds_read_b64_tr_b16 v[74:75], v101 offset:31744
    s_add_u32 m0, s59, 119808
    s_nop 0
    buffer_load_dwordx4 v13, s[40:43], s57 offen lds
    s_add_u32 s56, s56, 2048
    s_add_u32 s57, s57, 73728
    s_waitcnt lgkmcnt(6)
    v_mfma_f32_16x16x32_bf16 v[140:143], v[60:63], v[48:51], 0
    ds_read_b64_tr_b16 v[76:77], v102 offset:28672
    ds_read_b64_tr_b16 v[78:79], v102 offset:31744
    s_waitcnt lgkmcnt(6)
    v_mfma_f32_16x16x32_bf16 v[144:147], v[64:67], v[48:51], 0
    ds_read_b64_tr_b16 v[56:57], v103 offset:28672
    ds_read_b64_tr_b16 v[58:59], v103 offset:31744
    s_waitcnt vmcnt(14)
    s_barrier
    s_waitcnt lgkmcnt(6)
    v_mfma_f32_16x16x32_bf16 v[112:115], v[68:71], v[52:55], v[112:115]
    ds_read_b64_tr_b16 v[60:61], v100 offset:28800
    ds_read_b64_tr_b16 v[62:63], v100 offset:31872
    s_add_u32 m0, s58, 0
    s_nop 0
    buffer_load_dwordx4 v2, s[36:39], s56 offen lds
    s_waitcnt lgkmcnt(6)
    v_mfma_f32_16x16x32_bf16 v[116:119], v[72:75], v[52:55], v[116:119]
    ds_read_b64_tr_b16 v[64:65], v101 offset:28800
    ds_read_b64_tr_b16 v[66:67], v101 offset:31872
    s_add_u32 m0, s59, 0
    s_nop 0
    buffer_load_dwordx4 v8, s[40:43], s57 offen lds
    s_waitcnt lgkmcnt(6)
    v_mfma_f32_16x16x32_bf16 v[120:123], v[76:79], v[52:55], v[120:123]
    ds_read_b64_tr_b16 v[68:69], v102 offset:28800
    ds_read_b64_tr_b16 v[70:71], v102 offset:31872
    ds_read_b128 v[48:51], v25 offset:0
    s_add_u32 m0, s59, 1024
    s_nop 0
    buffer_load_dwordx4 v9, s[40:43], s57 offen lds
    s_waitcnt lgkmcnt(7)
    v_mfma_f32_16x16x32_bf16 v[124:127], v[56:59], v[52:55], v[124:127]
    ds_read_b64_tr_b16 v[72:73], v103 offset:28800
    ds_read_b64_tr_b16 v[74:75], v103 offset:31872
    s_add_u32 m0, s59, 2048
    s_nop 0
    buffer_load_dwordx4 v10, s[40:43], s57 offen lds
    s_waitcnt lgkmcnt(7)
    v_mfma_f32_16x16x32_bf16 v[128:131], v[60:63], v[52:55], v[128:131]
    ds_read_b64_tr_b16 v[76:77], v100 offset:28928
    ds_read_b64_tr_b16 v[78:79], v100 offset:32000
    s_add_u32 m0, s59, 3072
    s_nop 0
    buffer_load_dwordx4 v11, s[40:43], s57 offen lds
    s_waitcnt lgkmcnt(7)
    v_mfma_f32_16x16x32_bf16 v[132:135], v[64:67], v[52:55], v[132:135]
    ds_read_b64_tr_b16 v[56:57], v104 offset:0
    ds_read_b64_tr_b16 v[58:59], v104 offset:3072
    s_add_u32 m0, s59, 4096
    s_nop 0
    buffer_load_dwordx4 v12, s[40:43], s57 offen lds
    s_waitcnt lgkmcnt(7)
    v_mfma_f32_16x16x32_bf16 v[136:139], v[68:71], v[52:55], v[136:139]
    ds_read_b64_tr_b16 v[60:61], v105 offset:0
    ds_read_b64_tr_b16 v[62:63], v105 offset:3072
    s_add_u32 m0, s59, 5120
    s_nop 0
    buffer_load_dwordx4 v13, s[40:43], s57 offen lds
    s_add_u32 s56, s56, 2048
    s_add_u32 s57, s57, 73728
    s_waitcnt lgkmcnt(6)
    v_mfma_f32_16x16x32_bf16 v[140:143], v[72:75], v[52:55], v[140:143]
    ds_read_b64_tr_b16 v[64:65], v106 offset:0
    ds_read_b64_tr_b16 v[66:67], v106 offset:3072
    s_waitcnt lgkmcnt(6)
    v_mfma_f32_16x16x32_bf16 v[144:147], v[76:79], v[52:55], v[144:147]
    ds_read_b64_tr_b16 v[68:69], v107 offset:0
    ds_read_b64_tr_b16 v[70:71], v107 offset:3072
    s_waitcnt vmcnt(14)
    s_barrier
    s_waitcnt lgkmcnt(6)
    v_mfma_f32_16x16x32_bf16 v[112:115], v[56:59], v[48:51], v[112:115]
    ds_read_b64_tr_b16 v[72:73], v104 offset:128
    ds_read_b64_tr_b16 v[74:75], v104 offset:3200
    s_add_u32 m0, s58, 28672
    s_nop 0
    buffer_load_dwordx4 v2, s[36:39], s56 offen lds
    s_waitcnt lgkmcnt(6)
    v_mfma_f32_16x16x32_bf16 v[116:119], v[60:63], v[48:51], v[116:119]
    ds_read_b64_tr_b16 v[76:77], v105 offset:128
    ds_read_b64_tr_b16 v[78:79], v105 offset:3200
    s_add_u32 m0, s59, 28672
    s_nop 0
    buffer_load_dwordx4 v8, s[40:43], s57 offen lds
    s_waitcnt lgkmcnt(6)
    v_mfma_f32_16x16x32_bf16 v[120:123], v[64:67], v[48:51], v[120:123]
    ds_read_b64_tr_b16 v[56:57], v106 offset:128
    ds_read_b64_tr_b16 v[58:59], v106 offset:3200
    ds_read_b128 v[52:55], v25 offset:28672
    s_add_u32 m0, s59, 29696
    s_nop 0
    buffer_load_dwordx4 v9, s[40:43], s57 offen lds
    s_waitcnt lgkmcnt(7)
    v_mfma_f32_16x16x32_bf16 v[124:127], v[68:71], v[48:51], v[124:127]
    ds_read_b64_tr_b16 v[60:61], v107 offset:128
    ds_read_b64_tr_b16 v[62:63], v107 offset:3200
    s_add_u32 m0, s59, 30720
    s_nop 0
    buffer_load_dwordx4 v10, s[40:43], s57 offen lds
    s_waitcnt lgkmcnt(7)
    v_mfma_f32_16x16x32_bf16 v[128:131], v[72:75], v[48:51], v[128:131]
    ds_read_b64_tr_b16 v[64:65], v104 offset:256
    ds_read_b64_tr_b16 v[66:67], v104 offset:3328
    s_add_u32 m0, s59, 31744
    s_nop 0
    buffer_load_dwordx4 v11, s[40:43], s57 offen lds
    s_waitcnt lgkmcnt(7)
    v_mfma_f32_16x16x32_bf16 v[132:135], v[76:79], v[48:51], v[132:135]
    ds_read_b64_tr_b16 v[68:69], v104 offset:28672
    ds_read_b64_tr_b16 v[70:71], v104 offset:31744
    s_add_u32 m0, s59, 32768
    s_nop 0
    buffer_load_dwordx4 v12, s[40:43], s57 offen lds
    s_waitcnt lgkmcnt(7)
    v_mfma_f32_16x16x32_bf16 v[136:139], v[56:59], v[48:51], v[136:139]
    ds_read_b64_tr_b16 v[72:73], v105 offset:28672
    ds_read_b64_tr_b16 v[74:75], v105 offset:31744
    s_add_u32 m0, s59, 33792
    s_nop 0
    buffer_load_dwordx4 v13, s[40:43], s57 offen lds
    s_add_u32 s56, s56, 2048
    s_add_u32 s57, s57, 73728
    s_waitcnt lgkmcnt(6)
    v_mfma_f32_16x16x32_bf16 v[140:143], v[60:63], v[48:51], v[140:143]
    ds_read_b64_tr_b16 v[76:77], v106 offset:28672
    ds_read_b64_tr_b16 v[78:79], v106 offset:31744
    s_waitcnt lgkmcnt(6)
    v_mfma_f32_16x16x32_bf16 v[144:147], v[64:67], v[48:51], v[144:147]
    ds_read_b64_tr_b16 v[56:57], v107 offset:28672
    ds_read_b64_tr_b16 v[58:59], v107 offset:31744
    s_waitcnt vmcnt(14)
    s_barrier
    s_waitcnt lgkmcnt(6)
    v_mfma_f32_16x16x32_bf16 v[112:115], v[68:71], v[52:55], v[112:115]
    ds_read_b64_tr_b16 v[60:61], v104 offset:28800
    ds_read_b64_tr_b16 v[62:63], v104 offset:31872
    s_add_u32 m0, s58, 57344
    s_nop 0
    buffer_load_dwordx4 v2, s[36:39], s56 offen lds
    s_waitcnt lgkmcnt(6)
    v_mfma_f32_16x16x32_bf16 v[116:119], v[72:75], v[52:55], v[116:119]
    ds_read_b64_tr_b16 v[64:65], v105 offset:28800
    ds_read_b64_tr_b16 v[66:67], v105 offset:31872
    s_add_u32 m0, s59, 57344
    s_nop 0
    buffer_load_dwordx4 v8, s[40:43], s57 offen lds
    s_waitcnt lgkmcnt(6)
    v_mfma_f32_16x16x32_bf16 v[120:123], v[76:79], v[52:55], v[120:123]
    ds_read_b64_tr_b16 v[68:69], v106 offset:28800
    ds_read_b64_tr_b16 v[70:71], v106 offset:31872
    ds_read_b128 v[48:51], v26 offset:0
    s_add_u32 m0, s59, 58368
    s_nop 0
    buffer_load_dwordx4 v9, s[40:43], s57 offen lds
    s_waitcnt lgkmcnt(7)
    v_mfma_f32_16x16x32_bf16 v[124:127], v[56:59], v[52:55], v[124:127]
    ds_read_b64_tr_b16 v[72:73], v107 offset:28800
    ds_read_b64_tr_b16 v[74:75], v107 offset:31872
    s_add_u32 m0, s59, 59392
    s_nop 0
    buffer_load_dwordx4 v10, s[40:43], s57 offen lds
    s_waitcnt lgkmcnt(7)
    v_mfma_f32_16x16x32_bf16 v[128:131], v[60:63], v[52:55], v[128:131]
    ds_read_b64_tr_b16 v[76:77], v104 offset:28928
    ds_read_b64_tr_b16 v[78:79], v104 offset:32000
    s_add_u32 m0, s59, 60416
    s_nop 0
    buffer_load_dwordx4 v11, s[40:43], s57 offen lds
    s_waitcnt lgkmcnt(7)
    v_mfma_f32_16x16x32_bf16 v[132:135], v[64:67], v[52:55], v[132:135]
    ds_read_b64_tr_b16 v[56:57], v108 offset:0
    ds_read_b64_tr_b16 v[58:59], v108 offset:3072
    s_add_u32 m0, s59, 61440
    s_nop 0
    buffer_load_dwordx4 v12, s[40:43], s57 offen lds
    s_waitcnt lgkmcnt(7)
    v_mfma_f32_16x16x32_bf16 v[136:139], v[68:71], v[52:55], v[136:139]
    ds_read_b64_tr_b16 v[60:61], v109 offset:0
    ds_read_b64_tr_b16 v[62:63], v109 offset:3072
    s_add_u32 m0, s59, 62464
    s_nop 0
    buffer_load_dwordx4 v13, s[40:43], s57 offen lds
    s_add_u32 s56, s56, 2048
    s_add_u32 s57, s57, 73728
    s_waitcnt lgkmcnt(6)
    v_mfma_f32_16x16x32_bf16 v[140:143], v[72:75], v[52:55], v[140:143]
    ds_read_b64_tr_b16 v[64:65], v110 offset:0
    ds_read_b64_tr_b16 v[66:67], v110 offset:3072
    s_waitcnt lgkmcnt(6)
    v_mfma_f32_16x16x32_bf16 v[144:147], v[76:79], v[52:55], v[144:147]
    ds_read_b64_tr_b16 v[68:69], v111 offset:0
    ds_read_b64_tr_b16 v[70:71], v111 offset:3072
    s_waitcnt vmcnt(14)
    s_barrier
    s_waitcnt lgkmcnt(6)
    v_mfma_f32_16x16x32_bf16 v[112:115], v[56:59], v[48:51], v[112:115]
    ds_read_b64_tr_b16 v[72:73], v108 offset:128
    ds_read_b64_tr_b16 v[74:75], v108 offset:3200
    s_add_u32 m0, s58, 86016
    s_nop 0
    buffer_load_dwordx4 v2, s[36:39], s56 offen lds
    s_waitcnt lgkmcnt(6)
    v_mfma_f32_16x16x32_bf16 v[116:119], v[60:63], v[48:51], v[116:119]
    ds_read_b64_tr_b16 v[76:77], v109 offset:128
    ds_read_b64_tr_b16 v[78:79], v109 offset:3200
    s_add_u32 m0, s59, 86016
    s_nop 0
    buffer_load_dwordx4 v8, s[40:43], s57 offen lds
    s_waitcnt lgkmcnt(6)
    v_mfma_f32_16x16x32_bf16 v[120:123], v[64:67], v[48:51], v[120:123]
    ds_read_b64_tr_b16 v[56:57], v110 offset:128
    ds_read_b64_tr_b16 v[58:59], v110 offset:3200
    ds_read_b128 v[52:55], v24 offset:0
    s_add_u32 m0, s59, 87040
    s_nop 0
    buffer_load_dwordx4 v9, s[40:43], s57 offen lds
    s_waitcnt lgkmcnt(7)
    v_mfma_f32_16x16x32_bf16 v[124:127], v[68:71], v[48:51], v[124:127]
    ds_read_b64_tr_b16 v[60:61], v111 offset:128
    ds_read_b64_tr_b16 v[62:63], v111 offset:3200
    s_add_u32 m0, s59, 88064
    s_nop 0
    buffer_load_dwordx4 v10, s[40:43], s57 offen lds
    s_waitcnt lgkmcnt(7)
    v_mfma_f32_16x16x32_bf16 v[128:131], v[72:75], v[48:51], v[128:131]
    ds_read_b64_tr_b16 v[64:65], v108 offset:256
    ds_read_b64_tr_b16 v[66:67], v108 offset:3328
    s_add_u32 m0, s59, 89088
    s_nop 0
    buffer_load_dwordx4 v11, s[40:43], s57 offen lds
    s_waitcnt lgkmcnt(7)
    v_mfma_f32_16x16x32_bf16 v[132:135], v[76:79], v[48:51], v[132:135]
    ds_read_b64_tr_b16 v[68:69], v100 offset:0
    ds_read_b64_tr_b16 v[70:71], v100 offset:3072
    s_add_u32 m0, s59, 90112
    s_nop 0
    buffer_load_dwordx4 v12, s[40:43], s57 offen lds
    s_waitcnt lgkmcnt(7)
    v_mfma_f32_16x16x32_bf16 v[136:139], v[56:59], v[48:51], v[136:139]
    ds_read_b64_tr_b16 v[72:73], v101 offset:0
    ds_read_b64_tr_b16 v[74:75], v101 offset:3072
    s_add_u32 m0, s59, 91136
    s_nop 0
    buffer_load_dwordx4 v13, s[40:43], s57 offen lds
    s_add_u32 s56, s56, 2048
    s_add_u32 s57, s57, 73728
    s_waitcnt lgkmcnt(6)
    v_mfma_f32_16x16x32_bf16 v[140:143], v[60:63], v[48:51], v[140:143]
    ds_read_b64_tr_b16 v[76:77], v102 offset:0
    ds_read_b64_tr_b16 v[78:79], v102 offset:3072
    s_waitcnt lgkmcnt(6)
    v_mfma_f32_16x16x32_bf16 v[144:147], v[64:67], v[48:51], v[144:147]
    ds_read_b64_tr_b16 v[56:57], v103 offset:0
    ds_read_b64_tr_b16 v[58:59], v103 offset:3072
    s_waitcnt vmcnt(14)
    s_barrier
    s_waitcnt lgkmcnt(6)
    v_mfma_f32_16x16x32_bf16 v[112:115], v[68:71], v[52:55], v[112:115]
    ds_read_b64_tr_b16 v[60:61], v100 offset:128
    ds_read_b64_tr_b16 v[62:63], v100 offset:3200
    s_waitcnt lgkmcnt(6)
    v_mfma_f32_16x16x32_bf16 v[116:119], v[72:75], v[52:55], v[116:119]
    ds_read_b64_tr_b16 v[64:65], v101 offset:128
    ds_read_b64_tr_b16 v[66:67], v101 offset:3200
    s_waitcnt lgkmcnt(6)
    v_mfma_f32_16x16x32_bf16 v[120:123], v[76:79], v[52:55], v[120:123]
    ds_read_b64_tr_b16 v[68:69], v102 offset:128
    ds_read_b64_tr_b16 v[70:71], v102 offset:3200
    ds_read_b128 v[48:51], v24 offset:28672
    s_waitcnt lgkmcnt(7)
    v_mfma_f32_16x16x32_bf16 v[124:127], v[56:59], v[52:55], v[124:127]
    ds_read_b64_tr_b16 v[72:73], v103 offset:128
    ds_read_b64_tr_b16 v[74:75], v103 offset:3200
    s_waitcnt lgkmcnt(7)
    v_mfma_f32_16x16x32_bf16 v[128:131], v[60:63], v[52:55], v[128:131]
    ds_read_b64_tr_b16 v[76:77], v100 offset:256
    ds_read_b64_tr_b16 v[78:79], v100 offset:3328
    s_waitcnt lgkmcnt(7)
    v_mfma_f32_16x16x32_bf16 v[132:135], v[64:67], v[52:55], v[132:135]
    ds_read_b64_tr_b16 v[56:57], v100 offset:28672
    ds_read_b64_tr_b16 v[58:59], v100 offset:31744
    s_waitcnt lgkmcnt(7)
    v_mfma_f32_16x16x32_bf16 v[136:139], v[68:71], v[52:55], v[136:139]
    ds_read_b64_tr_b16 v[60:61], v101 offset:28672
    ds_read_b64_tr_b16 v[62:63], v101 offset:31744
    s_waitcnt lgkmcnt(6)
    v_mfma_f32_16x16x32_bf16 v[140:143], v[72:75], v[52:55], v[140:143]
    ds_read_b64_tr_b16 v[64:65], v102 offset:28672
    ds_read_b64_tr_b16 v[66:67], v102 offset:31744
    s_waitcnt lgkmcnt(6)
    v_mfma_f32_16x16x32_bf16 v[144:147], v[76:79], v[52:55], v[144:147]
    ds_read_b64_tr_b16 v[68:69], v103 offset:28672
    ds_read_b64_tr_b16 v[70:71], v103 offset:31744
    s_waitcnt vmcnt(7)
    s_barrier
    s_waitcnt lgkmcnt(6)
    v_mfma_f32_16x16x32_bf16 v[112:115], v[56:59], v[48:51], v[112:115]
    ds_read_b64_tr_b16 v[72:73], v100 offset:28800
    ds_read_b64_tr_b16 v[74:75], v100 offset:31872
    s_waitcnt lgkmcnt(6)
    v_mfma_f32_16x16x32_bf16 v[116:119], v[60:63], v[48:51], v[116:119]
    ds_read_b64_tr_b16 v[76:77], v101 offset:28800
    ds_read_b64_tr_b16 v[78:79], v101 offset:31872
    s_waitcnt lgkmcnt(6)
    v_mfma_f32_16x16x32_bf16 v[120:123], v[64:67], v[48:51], v[120:123]
    ds_read_b64_tr_b16 v[56:57], v102 offset:28800
    ds_read_b64_tr_b16 v[58:59], v102 offset:31872
    ds_read_b128 v[52:55], v25 offset:0
    s_waitcnt lgkmcnt(7)
    v_mfma_f32_16x16x32_bf16 v[124:127], v[68:71], v[48:51], v[124:127]
    ds_read_b64_tr_b16 v[60:61], v103 offset:28800
    ds_read_b64_tr_b16 v[62:63], v103 offset:31872
    s_waitcnt lgkmcnt(7)
    v_mfma_f32_16x16x32_bf16 v[128:131], v[72:75], v[48:51], v[128:131]
    ds_read_b64_tr_b16 v[64:65], v100 offset:28928
    ds_read_b64_tr_b16 v[66:67], v100 offset:32000
    s_waitcnt lgkmcnt(7)
    v_mfma_f32_16x16x32_bf16 v[132:135], v[76:79], v[48:51], v[132:135]
    ds_read_b64_tr_b16 v[68:69], v104 offset:0
    ds_read_b64_tr_b16 v[70:71], v104 offset:3072
    s_waitcnt lgkmcnt(7)
    v_mfma_f32_16x16x32_bf16 v[136:139], v[56:59], v[48:51], v[136:139]
    ds_read_b64_tr_b16 v[72:73], v105 offset:0
    ds_read_b64_tr_b16 v[74:75], v105 offset:3072
    s_waitcnt lgkmcnt(6)
    v_mfma_f32_16x16x32_bf16 v[140:143], v[60:63], v[48:51], v[140:143]
    ds_read_b64_tr_b16 v[76:77], v106 offset:0
    ds_read_b64_tr_b16 v[78:79], v106 offset:3072
    s_waitcnt lgkmcnt(6)
    v_mfma_f32_16x16x32_bf16 v[144:147], v[64:67], v[48:51], v[144:147]
    ds_read_b64_tr_b16 v[56:57], v107 offset:0
    ds_read_b64_tr_b16 v[58:59], v107 offset:3072
    s_waitcnt vmcnt(0)
    s_barrier
    s_waitcnt lgkmcnt(6)
    v_mfma_f32_16x16x32_bf16 v[112:115], v[68:71], v[52:55], v[112:115]
    ds_read_b64_tr_b16 v[60:61], v104 offset:128
    ds_read_b64_tr_b16 v[62:63], v104 offset:3200
    s_waitcnt lgkmcnt(6)
    v_mfma_f32_16x16x32_bf16 v[116:119], v[72:75], v[52:55], v[116:119]
    ds_read_b64_tr_b16 v[64:65], v105 offset:128
    ds_read_b64_tr_b16 v[66:67], v105 offset:3200
    s_waitcnt lgkmcnt(6)
    v_mfma_f32_16x16x32_bf16 v[120:123], v[76:79], v[52:55], v[120:123]
    ds_read_b64_tr_b16 v[68:69], v106 offset:128
    ds_read_b64_tr_b16 v[70:71], v106 offset:3200
    ds_read_b128 v[48:51], v25 offset:28672
    s_waitcnt lgkmcnt(7)
    v_mfma_f32_16x16x32_bf16 v[124:127], v[56:59], v[52:55], v[124:127]
    ds_read_b64_tr_b16 v[72:73], v107 offset:128
    ds_read_b64_tr_b16 v[74:75], v107 offset:3200
    s_waitcnt lgkmcnt(7)
    v_mfma_f32_16x16x32_bf16 v[128:131], v[60:63], v[52:55], v[128:131]
    ds_read_b64_tr_b16 v[76:77], v104 offset:256
    ds_read_b64_tr_b16 v[78:79], v104 offset:3328
    s_waitcnt lgkmcnt(7)
    v_mfma_f32_16x16x32_bf16 v[132:135], v[64:67], v[52:55], v[132:135]
    ds_read_b64_tr_b16 v[56:57], v104 offset:28672
    ds_read_b64_tr_b16 v[58:59], v104 offset:31744
    s_waitcnt lgkmcnt(7)
    v_mfma_f32_16x16x32_bf16 v[136:139], v[68:71], v[52:55], v[136:139]
    ds_read_b64_tr_b16 v[60:61], v105 offset:28672
    ds_read_b64_tr_b16 v[62:63], v105 offset:31744
    s_waitcnt lgkmcnt(6)
    v_mfma_f32_16x16x32_bf16 v[140:143], v[72:75], v[52:55], v[140:143]
    ds_read_b64_tr_b16 v[64:65], v106 offset:28672
    ds_read_b64_tr_b16 v[66:67], v106 offset:31744
    s_waitcnt lgkmcnt(6)
    v_mfma_f32_16x16x32_bf16 v[144:147], v[76:79], v[52:55], v[144:147]
    ds_read_b64_tr_b16 v[68:69], v107 offset:28672
    ds_read_b64_tr_b16 v[70:71], v107 offset:31744
    s_waitcnt lgkmcnt(6)
    v_mfma_f32_16x16x32_bf16 v[112:115], v[56:59], v[48:51], v[112:115]
    ds_read_b64_tr_b16 v[72:73], v104 offset:28800
    ds_read_b64_tr_b16 v[74:75], v104 offset:31872
    s_waitcnt lgkmcnt(6)
    v_mfma_f32_16x16x32_bf16 v[116:119], v[60:63], v[48:51], v[116:119]
    ds_read_b64_tr_b16 v[76:77], v105 offset:28800
    ds_read_b64_tr_b16 v[78:79], v105 offset:31872
    s_waitcnt lgkmcnt(6)
    v_mfma_f32_16x16x32_bf16 v[120:123], v[64:67], v[48:51], v[120:123]
    ds_read_b64_tr_b16 v[56:57], v106 offset:28800
    ds_read_b64_tr_b16 v[58:59], v106 offset:31872
    s_waitcnt lgkmcnt(6)
    v_mfma_f32_16x16x32_bf16 v[124:127], v[68:71], v[48:51], v[124:127]
    ds_read_b64_tr_b16 v[60:61], v107 offset:28800
    ds_read_b64_tr_b16 v[62:63], v107 offset:31872
    s_waitcnt lgkmcnt(6)
    v_mfma_f32_16x16x32_bf16 v[128:131], v[72:75], v[48:51], v[128:131]
    ds_read_b64_tr_b16 v[64:65], v104 offset:28928
    ds_read_b64_tr_b16 v[66:67], v104 offset:32000
    s_waitcnt lgkmcnt(6)
    v_mfma_f32_16x16x32_bf16 v[132:135], v[76:79], v[48:51], v[132:135]
    s_waitcnt lgkmcnt(4)
    v_mfma_f32_16x16x32_bf16 v[136:139], v[56:59], v[48:51], v[136:139]
    s_waitcnt lgkmcnt(2)
    v_mfma_f32_16x16x32_bf16 v[140:143], v[60:63], v[48:51], v[140:143]
    s_waitcnt lgkmcnt(0)
    v_mfma_f32_16x16x32_bf16 v[144:147], v[64:67], v[48:51], v[144:147]
    s_nop 7
    s_nop 7
    s_barrier
    s_mul_i32 s60, s5, 9216
    v_lshlrev_b32 v18, 4, v0
    v_add_u32 v19, s60, v18
    s_cmp_eq_u32 s6, 0
    s_cbranch_scc1 L_ffn_recv_3
    ds_write_b128 v19, v[112:115] offset:0
    ds_write_b128 v19, v[116:119] offset:1024
    ds_write_b128 v19, v[120:123] offset:2048
    ds_write_b128 v19, v[124:127] offset:3072
    ds_write_b128 v19, v[128:131] offset:4096
    ds_write_b128 v19, v[132:135] offset:5120
    ds_write_b128 v19, v[136:139] offset:6144
    ds_write_b128 v19, v[140:143] offset:7168
    ds_write_b128 v19, v[144:147] offset:8192
    s_waitcnt lgkmcnt(0)
    s_barrier
    s_branch L_ffn_p2done_2
L_ffn_recv_3:
    s_barrier
    ds_read_b128 v[148:151], v19 offset:0
    ds_read_b128 v[152:155], v19 offset:1024
    ds_read_b128 v[156:159], v19 offset:2048
    ds_read_b128 v[160:163], v19 offset:3072
    ds_read_b128 v[164:167], v19 offset:4096
    ds_read_b128 v[168:171], v19 offset:5120
    ds_read_b128 v[172:175], v19 offset:6144
    ds_read_b128 v[176:179], v19 offset:7168
    ds_read_b128 v[180:183], v19 offset:8192
    v_mov_b32 v40, 0
    v_mov_b32 v41, 0
    s_waitcnt lgkmcnt(8)
    v_add_f32 v112, v112, v148
    v_add_f32 v113, v113, v149
    v_add_f32 v114, v114, v150
    v_add_f32 v115, v115, v151
    v_lshlrev_b32 v42, 16, v80
    v_and_b32 v43, 0xffff0000, v80
    v_add_f32 v112, v112, v42
    v_add_f32 v113, v113, v43
    v_lshlrev_b32 v42, 16, v81
    v_and_b32 v43, 0xffff0000, v81
    v_add_f32 v114, v114, v42
    v_add_f32 v115, v115, v43
    v_cvt_pk_bf16_f32 v80, v112, v113
    v_cvt_pk_bf16_f32 v81, v114, v115
    buffer_store_dwordx2 v[80:81], v37, s[48:51], 0 offen offset:0 sc1
    v_lshlrev_b32 v42, 16, v80
    v_and_b32 v43, 0xffff0000, v80
    v_add_f32 v40, v40, v42
    v_fmac_f32 v41, v42, v42
    v_add_f32 v40, v40, v43
    v_fmac_f32 v41, v43, v43
    v_lshlrev_b32 v42, 16, v81
    v_and_b32 v43, 0xffff0000, v81
    v_add_f32 v40, v40, v42
    v_fmac_f32 v41, v42, v42
    v_add_f32 v40, v40, v43
    v_fmac_f32 v41, v43, v43
    s_waitcnt lgkmcnt(7)
    v_add_f32 v116, v116, v152
    v_add_f32 v117, v117, v153
    v_add_f32 v118, v118, v154
    v_add_f32 v119, v119, v155
    v_lshlrev_b32 v42, 16, v82
    v_and_b32 v43, 0xffff0000, v82
    v_add_f32 v116, v116, v42
    v_add_f32 v117, v117, v43
    v_lshlrev_b32 v42, 16, v83
    v_and_b32 v43, 0xffff0000, v83
    v_add_f32 v118, v118, v42
    v_add_f32 v119, v119, v43
    v_cvt_pk_bf16_f32 v82, v116, v117
    v_cvt_pk_bf16_f32 v83, v118, v119
    buffer_store_dwordx2 v[82:83], v37, s[48:51], 0 offen offset:512 sc1
    v_lshlrev_b32 v42, 16, v82
    v_and_b32 v43, 0xffff0000, v82
    v_add_f32 v40, v40, v42
    v_fmac_f32 v41, v42, v42
    v_add_f32 v40, v40, v43
    v_fmac_f32 v41, v43, v43
    v_lshlrev_b32 v42, 16, v83
    v_and_b32 v43, 0xffff0000, v83
    v_add_f32 v40, v40, v42
    v_fmac_f32 v41, v42, v42
    v_add_f32 v40, v40, v43
    v_fmac_f32 v41, v43, v43
    s_waitcnt lgkmcnt(6)
    v_add_f32 v120, v120, v156
    v_add_f32 v121, v121, v157
    v_add_f32 v122, v122, v158
    v_add_f32 v123, v123, v159
    v_lshlrev_b32 v42, 16, v84
    v_and_b32 v43, 0xffff0000, v84
    v_add_f32 v120, v120, v42
    v_add_f32 v121, v121, v43
    v_lshlrev_b32 v42, 16, v85
    v_and_b32 v43, 0xffff0000, v85
    v_add_f32 v122, v122, v42
    v_add_f32 v123, v123, v43
    v_cvt_pk_bf16_f32 v84, v120, v121
    v_cvt_pk_bf16_f32 v85, v122, v123
    buffer_store_dwordx2 v[84:85], v37, s[48:51], 0 offen offset:1024 sc1
    v_lshlrev_b32 v42, 16, v84
    v_and_b32 v43, 0xffff0000, v84
    v_add_f32 v40, v40, v42
    v_fmac_f32 v41, v42, v42
    v_add_f32 v40, v40, v43
    v_fmac_f32 v41, v43, v43
    v_lshlrev_b32 v42, 16, v85
    v_and_b32 v43, 0xffff0000, v85
    v_add_f32 v40, v40, v42
    v_fmac_f32 v41, v42, v42
    v_add_f32 v40, v40, v43
    v_fmac_f32 v41, v43, v43
    s_waitcnt lgkmcnt(5)
    v_add_f32 v124, v124, v160
    v_add_f32 v125, v125, v161
    v_add_f32 v126, v126, v162
    v_add_f32 v127, v127, v163
    v_lshlrev_b32 v42, 16, v86
    v_and_b32 v43, 0xffff0000, v86
    v_add_f32 v124, v124, v42
    v_add_f32 v125, v125, v43
    v_lshlrev_b32 v42, 16, v87
    v_and_b32 v43, 0xffff0000, v87
    v_add_f32 v126, v126, v42
    v_add_f32 v127, v127, v43
    v_cvt_pk_bf16_f32 v86, v124, v125
    v_cvt_pk_bf16_f32 v87, v126, v127
    buffer_store_dwordx2 v[86:87], v37, s[48:51], 0 offen offset:1536 sc1
    v_lshlrev_b32 v42, 16, v86
    v_and_b32 v43, 0xffff0000, v86
    v_add_f32 v40, v40, v42
    v_fmac_f32 v41, v42, v42
    v_add_f32 v40, v40, v43
    v_fmac_f32 v41, v43, v43
    v_lshlrev_b32 v42, 16, v87
    v_and_b32 v43, 0xffff0000, v87
    v_add_f32 v40, v40, v42
    v_fmac_f32 v41, v42, v42
    v_add_f32 v40, v40, v43
    v_fmac_f32 v41, v43, v43
    s_waitcnt lgkmcnt(4)
    v_add_f32 v128, v128, v164
    v_add_f32 v129, v129, v165
    v_add_f32 v130, v130, v166
    v_add_f32 v131, v131, v167
    v_lshlrev_b32 v42, 16, v88
    v_and_b32 v43, 0xffff0000, v88
    v_add_f32 v128, v128, v42
    v_add_f32 v129, v129, v43
    v_lshlrev_b32 v42, 16, v89
    v_and_b32 v43, 0xffff0000, v89
    v_add_f32 v130, v130, v42
    v_add_f32 v131, v131, v43
    v_cvt_pk_bf16_f32 v88, v128, v129
    v_cvt_pk_bf16_f32 v89, v130, v131
    buffer_store_dwordx2 v[88:89], v37, s[48:51], 0 offen offset:2048 sc1
    v_lshlrev_b32 v42, 16, v88
    v_and_b32 v43, 0xffff0000, v88
    v_add_f32 v40, v40, v42
    v_fmac_f32 v41, v42, v42
    v_add_f32 v40, v40, v43
    v_fmac_f32 v41, v43, v43
    v_lshlrev_b32 v42, 16, v89
    v_and_b32 v43, 0xffff0000, v89
    v_add_f32 v40, v40, v42
    v_fmac_f32 v41, v42, v42
    v_add_f32 v40, v40, v43
    v_fmac_f32 v41, v43, v43
    s_waitcnt lgkmcnt(3)
    v_add_f32 v132, v132, v168
    v_add_f32 v133, v133, v169
    v_add_f32 v134, v134, v170
    v_add_f32 v135, v135, v171
    v_lshlrev_b32 v42, 16, v90
    v_and_b32 v43, 0xffff0000, v90
    v_add_f32 v132, v132, v42
    v_add_f32 v133, v133, v43
    v_lshlrev_b32 v42, 16, v91
    v_and_b32 v43, 0xffff0000, v91
    v_add_f32 v134, v134, v42
    v_add_f32 v135, v135, v43
    v_cvt_pk_bf16_f32 v90, v132, v133
    v_cvt_pk_bf16_f32 v91, v134, v135
    buffer_store_dwordx2 v[90:91], v37, s[48:51], 0 offen offset:2560 sc1
    v_lshlrev_b32 v42, 16, v90
    v_and_b32 v43, 0xffff0000, v90
    v_add_f32 v40, v40, v42
    v_fmac_f32 v41, v42, v42
    v_add_f32 v40, v40, v43
    v_fmac_f32 v41, v43, v43
    v_lshlrev_b32 v42, 16, v91
    v_and_b32 v43, 0xffff0000, v91
    v_add_f32 v40, v40, v42
    v_fmac_f32 v41, v42, v42
    v_add_f32 v40, v40, v43
    v_fmac_f32 v41, v43, v43
    s_waitcnt lgkmcnt(2)
    v_add_f32 v136, v136, v172
    v_add_f32 v137, v137, v173
    v_add_f32 v138, v138, v174
    v_add_f32 v139, v139, v175
    v_lshlrev_b32 v42, 16, v92
    v_and_b32 v43, 0xffff0000, v92
    v_add_f32 v136, v136, v42
    v_add_f32 v137, v137, v43
    v_lshlrev_b32 v42, 16, v93
    v_and_b32 v43, 0xffff0000, v93
    v_add_f32 v138, v138, v42
    v_add_f32 v139, v139, v43
    v_cvt_pk_bf16_f32 v92, v136, v137
    v_cvt_pk_bf16_f32 v93, v138, v139
    buffer_store_dwordx2 v[92:93], v37, s[48:51], 0 offen offset:3072 sc1
    v_lshlrev_b32 v42, 16, v92
    v_and_b32 v43, 0xffff0000, v92
    v_add_f32 v40, v40, v42
    v_fmac_f32 v41, v42, v42
    v_add_f32 v40, v40, v43
    v_fmac_f32 v41, v43, v43
    v_lshlrev_b32 v42, 16, v93
    v_and_b32 v43, 0xffff0000, v93
    v_add_f32 v40, v40, v42
    v_fmac_f32 v41, v42, v42
    v_add_f32 v40, v40, v43
    v_fmac_f32 v41, v43, v43
    s_waitcnt lgkmcnt(1)
    v_add_f32 v140, v140, v176
    v_add_f32 v141, v141, v177
    v_add_f32 v142, v142, v178
    v_add_f32 v143, v143, v179
    v_lshlrev_b32 v42, 16, v94
    v_and_b32 v43, 0xffff0000, v94
    v_add_f32 v140, v140, v42
    v_add_f32 v141, v141, v43
    v_lshlrev_b32 v42, 16, v95
    v_and_b32 v43, 0xffff0000, v95
    v_add_f32 v142, v142, v42
    v_add_f32 v143, v143, v43
    v_cvt_pk_bf16_f32 v94, v140, v141
    v_cvt_pk_bf16_f32 v95, v142, v143
    buffer_store_dwordx2 v[94:95], v37, s[48:51], 0 offen offset:3584 sc1
    v_lshlrev_b32 v42, 16, v94
    v_and_b32 v43, 0xffff0000, v94
    v_add_f32 v40, v40, v42
    v_fmac_f32 v41, v42, v42
    v_add_f32 v40, v40, v43
    v_fmac_f32 v41, v43, v43
    v_lshlrev_b32 v42, 16, v95
    v_and_b32 v43, 0xffff0000, v95
    v_add_f32 v40, v40, v42
    v_fmac_f32 v41, v42, v42
    v_add_f32 v40, v40, v43
    v_fmac_f32 v41, v43, v43
    s_waitcnt lgkmcnt(0)
    v_add_f32 v144, v144, v180
    v_add_f32 v145, v145, v181
    v_add_f32 v146, v146, v182
    v_add_f32 v147, v147, v183
    v_lshlrev_b32 v42, 16, v96
    v_and_b32 v43, 0xffff0000, v96
    v_add_f32 v144, v144, v42
    v_add_f32 v145, v145, v43
    v_lshlrev_b32 v42, 16, v97
    v_and_b32 v43, 0xffff0000, v97
    v_add_f32 v146, v146, v42
    v_add_f32 v147, v147, v43
    v_cvt_pk_bf16_f32 v96, v144, v145
    v_cvt_pk_bf16_f32 v97, v146, v147
    s_movk_i32 s60, 4096
    buffer_store_dwordx2 v[96:97], v37, s[48:51], s60 offen offset:0 sc1
    v_lshlrev_b32 v42, 16, v96
    v_and_b32 v43, 0xffff0000, v96
    v_add_f32 v40, v40, v42
    v_fmac_f32 v41, v42, v42
    v_add_f32 v40, v40, v43
    v_fmac_f32 v41, v43, v43
    v_lshlrev_b32 v42, 16, v97
    v_and_b32 v43, 0xffff0000, v97
    v_add_f32 v40, v40, v42
    v_fmac_f32 v41, v42, v42
    v_add_f32 v40, v40, v43
    v_fmac_f32 v41, v43, v43
    v_xor_b32 v44, 16, v0
    v_lshlrev_b32 v44, 2, v44
    v_xor_b32 v45, 32, v0
    v_lshlrev_b32 v45, 2, v45
    ds_bpermute_b32 v42, v44, v40
    ds_bpermute_b32 v43, v44, v41
    s_waitcnt lgkmcnt(0)
    v_add_f32 v40, v40, v42
    v_add_f32 v41, v41, v43
    ds_bpermute_b32 v42, v45, v40
    ds_bpermute_b32 v43, v45, v41
    s_waitcnt lgkmcnt(0)
    v_add_f32 v40, v40, v42
    v_add_f32 v41, v41, v43
    v_lshlrev_b32 v42, 5, v31
    s_lshl_b32 s60, s9, 3
    v_add_u32 v42, s60, v42
    s_mov_b64 exec, 0xffff
    buffer_store_dwordx2 v[40:41], v42, s[52:55], 0 offen sc1
    s_mov_b64 exec, -1
    s_mov_b64 exec, -1
    s_branch L_ffn_p2done_2
L_ffn_idle_1:
    s_barrier
    s_barrier
    s_barrier
    s_barrier
    s_barrier
    s_barrier
    s_barrier
    s_barrier
    s_barrier
    s_barrier
    s_barrier
L_ffn_p2done_2:
    s_add_u32 s64, s34, 0x888400
    s_addc_u32 s65, s35, 0
    s_mov_b32 s66, 0x400
    s_mov_b32 s67, 0x00020000
    s_lshl_b32 s60, s2, 2
    v_mov_b32 v1, s60
    v_mov_b32 v2, 1
    s_waitcnt vmcnt(0) lgkmcnt(0)
    s_barrier
    s_cmp_lg_u32 s4, 0
    s_cbranch_scc1 L_ffn_nf_4
    s_mov_b64 exec, 1
    buffer_store_dword v2, v1, s[64:67], 0 offen sc1
    s_mov_b64 exec, -1
L_ffn_nf_4:
L_ffn_p3start:
    s_and_b32 s60, s2, 7
    s_lshr_b32 s61, s2, 3
    s_and_b32 s62, s61, 3
    s_lshl_b32 s60, s60, 2
    s_add_u32 s9, s60, s62
    s_lshr_b32 s61, s61, 2
    s_lshl_b32 s7, s61, 8
    s_mul_i32 s8, s9, 144
    s_and_b32 s5, s4, 3
    s_lshr_b32 s6, s4, 2
    s_add_u32 s36, s34, 0x400000
    s_addc_u32 s37, s35, 0
    s_mov_b32 s38, 0x240000
    s_mov_b32 s39, 0x00020000
    s_cmp_lt_u32 s4, 4
    s_cselect_b32 s40, s24, s26
    s_cselect_b32 s41, s25, s27
    s_mov_b32 s42, 0x510000
    s_mov_b32 s43, 0x00020000
    s_add_u32 s44, s34, 0x800000
    s_addc_u32 s45, s35, 0
    s_mov_b32 s46, 0x10000
    s_mov_b32 s47, 0x00020000
    s_add_u32 s52, s34, 0x1000000
    s_addc_u32 s53, s35, 0
    s_mov_b32 s54, 0x1200000
    s_mov_b32 s55, 0x00020000
    v_and_b32 v16, 15, v0
    v_lshrrev_b32 v17, 4, v0
    s_lshr_b32 s60, s7, 4
    s_lshl_b32 s61, s4, 1
    s_add_u32 s60, s60, s61
    s_mul_i32 s60, s60, 18432
    v_lshlrev_b32 v19, 4, v0
    v_add_u32 v2, s60, v19
    v_add_u32 v3, 18432, v2
    s_and_b32 s60, s4, 3
    s_mul_i32 s68, s60, 24
    s_lshl_b32 s62, s8, 1
    s_and_b32 s62, s62, 0xffffff80
    s_movk_i32 s63, 9216
    v_lshrrev_b32 v18, 3, v0
    v_add_u32 v18, s68, v18
    v_mul_u32_u24 v19, 21846, v18
    v_lshrrev_b32 v19, 16, v19
    v_mul_u32_u24 v20, 3, v19
    v_sub_u32 v18, v18, v20
    v_lshlrev_b32 v18, 7, v18
    v_bfe_u32 v20, v19, 1, 2
    v_bfe_u32 v21, v0, 1, 2
    v_xor_b32 v20, v20, v21
    v_lshlrev_b32 v20, 5, v20
    v_and_b32 v21, 1, v0
    v_lshlrev_b32 v21, 4, v21
    v_add3_u32 v18, v18, v20, v21
    v_lshrrev_b32 v23, 5, v19
    v_and_b32 v19, 31, v19
    v_and_b32 v20, 0x33, v19
    v_bfe_u32 v21, v19, 2, 1
    v_lshlrev_b32 v21, 3, v21
    v_bfe_u32 v22, v19, 3, 1
    v_lshlrev_b32 v22, 2, v22
    v_or3_b32 v20, v20, v21, v22
    v_mul_lo_u32 v20, v20, s63
    v_add3_u32 v4, v20, v18, s62
    v_lshrrev_b32 v18, 3, v0
    v_add_u32 v18, s68, v18
    v_add_u32 v18, 8, v18
    v_mul_u32_u24 v19, 21846, v18
    v_lshrrev_b32 v19, 16, v19
    v_mul_u32_u24 v20, 3, v19
    v_sub_u32 v18, v18, v20
    v_lshlrev_b32 v18, 7, v18
    v_bfe_u32 v20, v19, 1, 2
    v_bfe_u32 v21, v0, 1, 2
    v_xor_b32 v20, v20, v21
    v_lshlrev_b32 v20, 5, v20
    v_and_b32 v21, 1, v0
    v_lshlrev_b32 v21, 4, v21
    v_add3_u32 v18, v18, v20, v21
    v_lshrrev_b32 v23, 5, v19
    v_and_b32 v19, 31, v19
    v_and_b32 v20, 0x33, v19
    v_bfe_u32 v21, v19, 2, 1
    v_lshlrev_b32 v21, 3, v21
    v_bfe_u32 v22, v19, 3, 1
    v_lshlrev_b32 v22, 2, v22
    v_or3_b32 v20, v20, v21, v22
    v_mul_lo_u32 v20, v20, s63
    v_add3_u32 v5, v20, v18, s62
    v_lshrrev_b32 v18, 3, v0
    v_add_u32 v18, s68, v18
    v_add_u32 v18, 16, v18
    v_mul_u32_u24 v19, 21846, v18
    v_lshrrev_b32 v19, 16, v19
    v_mul_u32_u24 v20, 3, v19
    v_sub_u32 v18, v18, v20
    v_lshlrev_b32 v18, 7, v18
    v_bfe_u32 v20, v19, 1, 2
    v_bfe_u32 v21, v0, 1, 2
    v_xor_b32 v20, v20, v21
    v_lshlrev_b32 v20, 5, v20
    v_and_b32 v21, 1, v0
    v_lshlrev_b32 v21, 4, v21
    v_add3_u32 v18, v18, v20, v21
    v_lshrrev_b32 v23, 5, v19
    v_and_b32 v19, 31, v19
    v_and_b32 v20, 0x33, v19
    v_bfe_u32 v21, v19, 2, 1
    v_lshlrev_b32 v21, 3, v21
    v_bfe_u32 v22, v19, 3, 1
    v_lshlrev_b32 v22, 2, v22
    v_or3_b32 v20, v20, v21, v22
    v_mul_lo_u32 v20, v20, s63
    v_add3_u32 v6, v20, v18, s62
    s_mov_b32 s56, 0
    s_mov_b32 s57, 0
    s_lshl_b32 s58, s4, 11
    s_mul_i32 s59, s4, 3072
    s_add_u32 s59, s59, 16384
    s_add_u32 m0, s59, 0
    s_nop 0
    buffer_load_dwordx4 v4, s[40:43], s57 offen lds
    s_add_u32 m0, s59, 1024
    s_nop 0
    buffer_load_dwordx4 v5, s[40:43], s57 offen lds
    s_add_u32 m0, s59, 2048
    s_nop 0
    buffer_load_dwordx4 v6, s[40:43], s57 offen lds
    s_add_u32 s57, s57, 294912
    s_add_u32 m0, s59, 40960
    s_nop 0
    buffer_load_dwordx4 v4, s[40:43], s57 offen lds
    s_add_u32 m0, s59, 41984
    s_nop 0
    buffer_load_dwordx4 v5, s[40:43], s57 offen lds
    s_add_u32 m0, s59, 43008
    s_nop 0
    buffer_load_dwordx4 v6, s[40:43], s57 offen lds
    s_add_u32 s57, s57, 294912
    s_add_u32 m0, s59, 81920
    s_nop 0
    buffer_load_dwordx4 v4, s[40:43], s57 offen lds
    s_add_u32 m0, s59, 82944
    s_nop 0
    buffer_load_dwordx4 v5, s[40:43], s57 offen lds
    s_add_u32 m0, s59, 83968
    s_nop 0
    buffer_load_dwordx4 v6, s[40:43], s57 offen lds
    s_add_u32 s57, s57, 294912
    s_add_u32 s64, s34, 0x888400
    s_addc_u32 s65, s35, 0
    s_mov_b32 s66, 0x400
    s_mov_b32 s67, 0x00020000
    s_lshr_b32 s60, s7, 3
    v_and_b32 v18, 31, v0
    v_add_u32 v18, s60, v18
    v_lshlrev_b32 v18, 2, v18
L_ffn_pollH_5:
    buffer_load_dword v19, v18, s[64:67], 0 offen sc1
    s_waitcnt vmcnt(0)
    v_cmp_ne_u32 vcc, 1, v19
    s_nop 1
    s_cmp_eq_u64 vcc, 0
    s_cbranch_scc1 L_ffn_goH_6
    s_sleep 2
    s_branch L_ffn_pollH_5
L_ffn_goH_6:
    s_lshl_b32 s60, s5, 6
    s_add_u32 s60, s60, s7
    v_add_u32 v18, s60, v16
    v_lshlrev_b32 v18, 5, v18
    buffer_load_dwordx4 v[96:99], v18, s[44:47], 0 offen offset:0 sc1
    buffer_load_dwordx4 v[100:103], v18, s[44:47], 0 offen offset:16 sc1
    buffer_load_dwordx4 v[104:107], v18, s[44:47], 0 offen offset:512 sc1
    buffer_load_dwordx4 v[108:111], v18, s[44:47], 0 offen offset:528 sc1
    buffer_load_dwordx4 v[112:115], v18, s[44:47], 0 offen offset:1024 sc1
    buffer_load_dwordx4 v[116:119], v18, s[44:47], 0 offen offset:1040 sc1
    buffer_load_dwordx4 v[120:123], v18, s[44:47], 0 offen offset:1536 sc1
    buffer_load_dwordx4 v[124:127], v18, s[44:47], 0 offen offset:1552 sc1
    s_add_u32 m0, s58, 0
    s_nop 0
    buffer_load_dwordx4 v2, s[36:39], s56 offen sc1 lds
    s_add_u32 m0, s58, 1024
    s_nop 0
    buffer_load_dwordx4 v3, s[36:39], s56 offen sc1 lds
    s_add_u32 s56, s56, 1024
    s_add_u32 m0, s58, 40960
    s_nop 0
    buffer_load_dwordx4 v2, s[36:39], s56 offen sc1 lds
    s_add_u32 m0, s58, 41984
    s_nop 0
    buffer_load_dwordx4 v3, s[36:39], s56 offen sc1 lds
    s_add_u32 s56, s56, 1024
    s_add_u32 m0, s58, 81920
    s_nop 0
    buffer_load_dwordx4 v2, s[36:39], s56 offen sc1 lds
    s_add_u32 m0, s58, 82944
    s_nop 0
    buffer_load_dwordx4 v3, s[36:39], s56 offen sc1 lds
    s_add_u32 s56, s56, 1024
    s_mov_b32 s64, s28
    s_mov_b32 s65, s29
    s_mov_b32 s66, 0x510000
    s_mov_b32 s67, 0x00020000
    s_mul_i32 s60, s2, 8
    s_add_u32 s60, s60, s4
    s_mul_i32 s60, s60, 21
    v_add_u32 v18, s60, v0
    v_lshlrev_b32 v18, 7, v18
    s_mov_b32 exec_lo, 0x1fffff
    s_mov_b32 exec_hi, 0x0
    buffer_load_dword v1, v18, s[64:67], 0 offen
    s_mov_b64 exec, -1
    s_lshl_b32 s60, s5, 12
    v_lshlrev_b32 v18, 4, v0
    v_add_u32 v8, s60, v18
    v_add_u32 v9, 81920, v8
    s_bfe_u32 s62, s8, 0x20004
    s_mul_i32 s63, s6, 5
    s_add_u32 s62, s62, s63
    s_movk_i32 s63, 16384
    v_lshrrev_b32 v19, 5, v0
    v_lshlrev_b32 v18, 4, v19
    v_bfe_u32 v19, v0, 4, 1
    v_lshlrev_b32 v19, 2, v19
    v_add_u32 v18, v18, v19
    v_bfe_u32 v20, v0, 2, 2
    v_add_u32 v18, v18, v20
    v_bfe_u32 v19, v18, 1, 2
    v_mul_u32_u24 v18, 384, v18
    v_and_b32 v20, 3, v0
    v_lshlrev_b32 v20, 3, v20
    v_add3_u32 v18, v18, v20, s63
    s_add_u32 s60, s62, 0
    s_and_b32 s61, s60, 3
    s_lshr_b32 s60, s60, 2
    s_lshl_b32 s60, s60, 7
    v_xor_b32 v20, s61, v19
    v_lshlrev_b32 v20, 5, v20
    v_add3_u32 v24, v18, v20, s60
    s_add_u32 s60, s62, 1
    s_and_b32 s61, s60, 3
    s_lshr_b32 s60, s60, 2
    s_lshl_b32 s60, s60, 7
    v_xor_b32 v20, s61, v19
    v_lshlrev_b32 v20, 5, v20
    v_add3_u32 v25, v18, v20, s60
    s_add_u32 s60, s62, 2
    s_and_b32 s61, s60, 3
    s_lshr_b32 s60, s60, 2
    s_lshl_b32 s60, s60, 7
    v_xor_b32 v20, s61, v19
    v_lshlrev_b32 v20, 5, v20
    v_add3_u32 v26, v18, v20, s60
    s_add_u32 s60, s62, 3
    s_and_b32 s61, s60, 3
    s_lshr_b32 s60, s60, 2
    s_lshl_b32 s60, s60, 7
    v_xor_b32 v20, s61, v19
    v_lshlrev_b32 v20, 5, v20
    v_add3_u32 v27, v18, v20, s60
    v_add_u32 v28, 81920, v24
    v_add_u32 v29, 81920, v25
    v_add_u32 v30, 81920, v26
    v_add_u32 v31, 81920, v27
    v_lshrrev_b32 v18, 1, v17
    v_lshlrev_b32 v14, 8, v18
    v_lshlrev_b32 v18, 4, v16
    v_add_u32 v14, v14, v18
    v_and_b32 v18, 1, v17
    v_mul_u32_u24 v15, 147456, v18
    v_add_u32 v15, v15, v14
    v_lshlrev_b32 v18, 9, v18
    v_add_u32 v14, v14, v18
    s_lshr_b32 s60, s7, 4
    s_lshl_b32 s61, s5, 2
    s_add_u32 s60, s60, s61
    s_mul_i32 s60, s60, 147456
    s_mul_i32 s61, s9, 9
    s_mul_i32 s62, s6, 5
    s_add_u32 s61, s61, s62
    s_lshl_b32 s61, s61, 9
    s_add_u32 s60, s60, s61
    v_add_u32 v14, s60, v14
    v_add_u32 v15, s60, v15
    s_waitcnt vmcnt(7)
    s_mov_b32 s60, 0x3ae38e39
    s_mov_b32 s61, 0x3727c5ac
    v_add_f32 v18, v96, v98
    v_add_f32 v19, v100, v102
    v_add_f32 v20, v97, v99
    v_add_f32 v21, v101, v103
    v_add_f32 v18, v18, v19
    v_add_f32 v20, v20, v21
    v_mul_f32 v18, s60, v18
    v_mul_f32 v20, s60, v20
    v_fma_f32 v20, -v18, v18, v20
    v_max_f32 v20, 0, v20
    v_add_f32 v20, s61, v20
    v_rsq_f32 v40, v20
    v_sub_f32 v44, 0, v18
    v_add_f32 v18, v104, v106
    v_add_f32 v19, v108, v110
    v_add_f32 v20, v105, v107
    v_add_f32 v21, v109, v111
    v_add_f32 v18, v18, v19
    v_add_f32 v20, v20, v21
    v_mul_f32 v18, s60, v18
    v_mul_f32 v20, s60, v20
    v_fma_f32 v20, -v18, v18, v20
    v_max_f32 v20, 0, v20
    v_add_f32 v20, s61, v20
    v_rsq_f32 v41, v20
    v_sub_f32 v45, 0, v18
    v_add_f32 v18, v112, v114
    v_add_f32 v19, v116, v118
    v_add_f32 v20, v113, v115
    v_add_f32 v21, v117, v119
    v_add_f32 v18, v18, v19
    v_add_f32 v20, v20, v21
    v_mul_f32 v18, s60, v18
    v_mul_f32 v20, s60, v20
    v_fma_f32 v20, -v18, v18, v20
    v_max_f32 v20, 0, v20
    v_add_f32 v20, s61, v20
    v_rsq_f32 v42, v20
    v_sub_f32 v46, 0, v18
    v_add_f32 v18, v120, v122
    v_add_f32 v19, v124, v126
    v_add_f32 v20, v121, v123
    v_add_f32 v21, v125, v127
    v_add_f32 v18, v18, v19
    v_add_f32 v20, v20, v21
    v_mul_f32 v18, s60, v18
    v_mul_f32 v20, s60, v20
    v_fma_f32 v20, -v18, v18, v20
    v_max_f32 v20, 0, v20
    v_add_f32 v20, s61, v20
    v_rsq_f32 v43, v20
    v_sub_f32 v47, 0, v18
    s_cmp_eq_u32 s6, 1
    s_cbranch_scc1 L_ffn_wn1_7
    v_mov_b32 v20, 0x3f803f80
    v_mov_b32 v21, 0x3f803f80
    v_mov_b32 v22, 0x3f803f80
    v_mov_b32 v23, 0x3f803f80
    s_waitcnt vmcnt(5)
    s_barrier
    ds_read_b128 v[48:51], v8 offset:0
    ds_read_b128 v[52:55], v8 offset:1024
    ds_read_b128 v[56:59], v8 offset:2048
    ds_read_b128 v[60:63], v8 offset:3072
    ds_read_b64_tr_b16 v[80:81], v24 offset:0
    ds_read_b64_tr_b16 v[82:83], v24 offset:3072
    ds_read_b64_tr_b16 v[84:85], v24 offset:12288
    ds_read_b64_tr_b16 v[86:87], v24 offset:15360
    s_waitcnt vmcnt(3)
    s_barrier
    s_waitcnt lgkmcnt(4)
    s_waitcnt lgkmcnt(2)
    v_mfma_f32_16x16x32_bf16 v[96:99], v[80:83], v[48:51], 0
    ds_read_b64_tr_b16 v[88:89], v25 offset:0
    ds_read_b64_tr_b16 v[90:91], v25 offset:3072
    v_mfma_f32_16x16x32_bf16 v[136:139], v[80:83], v[52:55], 0
    v_mfma_f32_16x16x32_bf16 v[176:179], v[80:83], v[56:59], 0
    s_add_u32 m0, s58, 122880
    s_nop 0
    buffer_load_dwordx4 v2, s[36:39], s56 offen sc1 lds
    v_mfma_f32_16x16x32_bf16 v[216:219], v[80:83], v[60:63], 0
    s_waitcnt lgkmcnt(2)
    v_mfma_f32_16x16x32_bf16 v[100:103], v[84:87], v[48:51], 0
    ds_read_b64_tr_b16 v[92:93], v25 offset:12288
    ds_read_b64_tr_b16 v[94:95], v25 offset:15360
    v_mfma_f32_16x16x32_bf16 v[140:143], v[84:87], v[52:55], 0
    v_mfma_f32_16x16x32_bf16 v[180:183], v[84:87], v[56:59], 0
    s_add_u32 m0, s58, 123904
    s_nop 0
    buffer_load_dwordx4 v3, s[36:39], s56 offen sc1 lds
    s_add_u32 s56, s56, 1024
    v_mfma_f32_16x16x32_bf16 v[220:223], v[84:87], v[60:63], 0
    s_cmp_eq_u32 s5, 0
    s_cbranch_scc0 L_ffn_cw_9
    v_mfma_f32_16x16x32_bf16 v[32:35], v[80:83], v[20:23], 0
    v_mfma_f32_16x16x32_bf16 v[36:39], v[84:87], v[20:23], 0
L_ffn_cw_9:
    s_waitcnt lgkmcnt(2)
    v_mfma_f32_16x16x32_bf16 v[104:107], v[88:91], v[48:51], 0
    ds_read_b64_tr_b16 v[80:81], v26 offset:0
    ds_read_b64_tr_b16 v[82:83], v26 offset:3072
    v_mfma_f32_16x16x32_bf16 v[144:147], v[88:91], v[52:55], 0
    ds_read_b128 v[64:67], v8 offset:40960
    v_mfma_f32_16x16x32_bf16 v[184:187], v[88:91], v[56:59], 0
    s_add_u32 m0, s59, 122880
    s_nop 0
    buffer_load_dwordx4 v4, s[40:43], s57 offen lds
    v_mfma_f32_16x16x32_bf16 v[224:227], v[88:91], v[60:63], 0
    s_waitcnt lgkmcnt(3)
    v_mfma_f32_16x16x32_bf16 v[108:111], v[92:95], v[48:51], 0
    ds_read_b64_tr_b16 v[84:85], v26 offset:12288
    ds_read_b64_tr_b16 v[86:87], v26 offset:15360
    v_mfma_f32_16x16x32_bf16 v[148:151], v[92:95], v[52:55], 0
    ds_read_b128 v[68:71], v8 offset:41984
    v_mfma_f32_16x16x32_bf16 v[188:191], v[92:95], v[56:59], 0
    s_add_u32 m0, s59, 123904
    s_nop 0
    buffer_load_dwordx4 v5, s[40:43], s57 offen lds
    v_mfma_f32_16x16x32_bf16 v[228:231], v[92:95], v[60:63], 0
    s_cmp_eq_u32 s5, 1
    s_cbranch_scc0 L_ffn_cw_10
    v_mfma_f32_16x16x32_bf16 v[32:35], v[88:91], v[20:23], 0
    v_mfma_f32_16x16x32_bf16 v[36:39], v[92:95], v[20:23], 0
L_ffn_cw_10:
    s_waitcnt lgkmcnt(4)
    v_mfma_f32_16x16x32_bf16 v[112:115], v[80:83], v[48:51], 0
    ds_read_b64_tr_b16 v[88:89], v27 offset:0
    ds_read_b64_tr_b16 v[90:91], v27 offset:3072
    v_mfma_f32_16x16x32_bf16 v[152:155], v[80:83], v[52:55], 0
    ds_read_b128 v[72:75], v8 offset:43008
    v_mfma_f32_16x16x32_bf16 v[192:195], v[80:83], v[56:59], 0
    s_add_u32 m0, s59, 124928
    s_nop 0
    buffer_load_dwordx4 v6, s[40:43], s57 offen lds
    s_add_u32 s57, s57, 294912
    v_mfma_f32_16x16x32_bf16 v[232:235], v[80:83], v[60:63], 0
    s_waitcnt lgkmcnt(4)
    v_mfma_f32_16x16x32_bf16 v[116:119], v[84:87], v[48:51], 0
    ds_read_b64_tr_b16 v[92:93], v27 offset:12288
    ds_read_b64_tr_b16 v[94:95], v27 offset:15360
    v_mfma_f32_16x16x32_bf16 v[156:159], v[84:87], v[52:55], 0
    ds_read_b128 v[76:79], v8 offset:44032
    v_mfma_f32_16x16x32_bf16 v[196:199], v[84:87], v[56:59], 0
    v_mfma_f32_16x16x32_bf16 v[236:239], v[84:87], v[60:63], 0
    s_cmp_eq_u32 s5, 2
    s_cbranch_scc0 L_ffn_cw_11
    v_mfma_f32_16x16x32_bf16 v[32:35], v[80:83], v[20:23], 0
    v_mfma_f32_16x16x32_bf16 v[36:39], v[84:87], v[20:23], 0
L_ffn_cw_11:
    s_waitcnt lgkmcnt(4)
    v_mfma_f32_16x16x32_bf16 v[120:123], v[88:91], v[48:51], 0
    ds_read_b64_tr_b16 v[80:81], v24 offset:128
    ds_read_b64_tr_b16 v[82:83], v24 offset:3200
    v_mfma_f32_16x16x32_bf16 v[160:163], v[88:91], v[52:55], 0
    v_mfma_f32_16x16x32_bf16 v[200:203], v[88:91], v[56:59], 0
    v_mfma_f32_16x16x32_bf16 v[240:243], v[88:91], v[60:63], 0
    s_waitcnt lgkmcnt(3)
    v_mfma_f32_16x16x32_bf16 v[124:127], v[92:95], v[48:51], 0
    ds_read_b64_tr_b16 v[84:85], v24 offset:12416
    ds_read_b64_tr_b16 v[86:87], v24 offset:15488
    v_mfma_f32_16x16x32_bf16 v[164:167], v[92:95], v[52:55], 0
    v_mfma_f32_16x16x32_bf16 v[204:207], v[92:95], v[56:59], 0
    v_mfma_f32_16x16x32_bf16 v[244:247], v[92:95], v[60:63], 0
    s_cmp_eq_u32 s5, 3
    s_cbranch_scc0 L_ffn_cw_12
    v_mfma_f32_16x16x32_bf16 v[32:35], v[88:91], v[20:23], 0
    v_mfma_f32_16x16x32_bf16 v[36:39], v[92:95], v[20:23], 0
L_ffn_cw_12:
    s_waitcnt lgkmcnt(2)
    v_mfma_f32_16x16x32_bf16 v[128:131], v[80:83], v[48:51], 0
    ds_read_b64_tr_b16 v[88:89], v24 offset:40960
    ds_read_b64_tr_b16 v[90:91], v24 offset:44032
    v_mfma_f32_16x16x32_bf16 v[168:171], v[80:83], v[52:55], 0
    v_mfma_f32_16x16x32_bf16 v[208:211], v[80:83], v[56:59], 0
    v_mfma_f32_16x16x32_bf16 v[248:251], v[80:83], v[60:63], 0
    s_waitcnt lgkmcnt(2)
    v_mfma_f32_16x16x32_bf16 v[132:135], v[84:87], v[48:51], 0
    ds_read_b64_tr_b16 v[92:93], v24 offset:53248
    ds_read_b64_tr_b16 v[94:95], v24 offset:56320
    v_mfma_f32_16x16x32_bf16 v[172:175], v[84:87], v[52:55], 0
    v_mfma_f32_16x16x32_bf16 v[212:215], v[84:87], v[56:59], 0
    v_mfma_f32_16x16x32_bf16 v[252:255], v[84:87], v[60:63], 0
    s_cmp_eq_u32 s5, 0
    s_cbranch_scc0 L_ffn_cw_13
    v_mfma_f32_16x16x32_bf16 v[10:13], v[80:83], v[20:23], 0
    v_mfma_f32_16x16x32_bf16 v[16:19], v[84:87], v[20:23], 0
L_ffn_cw_13:
    s_waitcnt vmcnt(6)
    s_barrier
    s_waitcnt lgkmcnt(2)
    v_mfma_f32_16x16x32_bf16 v[96:99], v[88:91], v[64:67], v[96:99]
    ds_read_b64_tr_b16 v[80:81], v25 offset:40960
    ds_read_b64_tr_b16 v[82:83], v25 offset:44032
    v_mfma_f32_16x16x32_bf16 v[136:139], v[88:91], v[68:71], v[136:139]
    v_mfma_f32_16x16x32_bf16 v[176:179], v[88:91], v[72:75], v[176:179]
    s_add_u32 m0, s58, 0
    s_nop 0
    buffer_load_dwordx4 v2, s[36:39], s56 offen sc1 lds
    v_mfma_f32_16x16x32_bf16 v[216:219], v[88:91], v[76:79], v[216:219]
    s_waitcnt lgkmcnt(2)
    v_mfma_f32_16x16x32_bf16 v[100:103], v[92:95], v[64:67], v[100:103]
    ds_read_b64_tr_b16 v[84:85], v25 offset:53248
    ds_read_b64_tr_b16 v[86:87], v25 offset:56320
    v_mfma_f32_16x16x32_bf16 v[140:143], v[92:95], v[68:71], v[140:143]
    v_mfma_f32_16x16x32_bf16 v[180:183], v[92:95], v[72:75], v[180:183]
    s_add_u32 m0, s58, 1024
    s_nop 0
    buffer_load_dwordx4 v3, s[36:39], s56 offen sc1 lds
    s_add_u32 s56, s56, 1024
    v_mfma_f32_16x16x32_bf16 v[220:223], v[92:95], v[76:79], v[220:223]
    s_cmp_eq_u32 s5, 0
    s_cbranch_scc0 L_ffn_cw_14
    v_mfma_f32_16x16x32_bf16 v[32:35], v[88:91], v[20:23], v[32:35]
    v_mfma_f32_16x16x32_bf16 v[36:39], v[92:95], v[20:23], v[36:39]
L_ffn_cw_14:
    s_waitcnt lgkmcnt(2)
    v_mfma_f32_16x16x32_bf16 v[104:107], v[80:83], v[64:67], v[104:107]
    ds_read_b64_tr_b16 v[88:89], v26 offset:40960
    ds_read_b64_tr_b16 v[90:91], v26 offset:44032
    v_mfma_f32_16x16x32_bf16 v[144:147], v[80:83], v[68:71], v[144:147]
    ds_read_b128 v[48:51], v9 offset:0
    v_mfma_f32_16x16x32_bf16 v[184:187], v[80:83], v[72:75], v[184:187]
    s_add_u32 m0, s59, 0
    s_nop 0
    buffer_load_dwordx4 v4, s[40:43], s57 offen lds
    v_mfma_f32_16x16x32_bf16 v[224:227], v[80:83], v[76:79], v[224:227]
    s_waitcnt lgkmcnt(3)
    v_mfma_f32_16x16x32_bf16 v[108:111], v[84:87], v[64:67], v[108:111]
    ds_read_b64_tr_b16 v[92:93], v26 offset:53248
    ds_read_b64_tr_b16 v[94:95], v26 offset:56320
    v_mfma_f32_16x16x32_bf16 v[148:151], v[84:87], v[68:71], v[148:151]
    ds_read_b128 v[52:55], v9 offset:1024
    v_mfma_f32_16x16x32_bf16 v[188:191], v[84:87], v[72:75], v[188:191]
    s_add_u32 m0, s59, 1024
    s_nop 0
    buffer_load_dwordx4 v5, s[40:43], s57 offen lds
    v_mfma_f32_16x16x32_bf16 v[228:231], v[84:87], v[76:79], v[228:231]
    s_cmp_eq_u32 s5, 1
    s_cbranch_scc0 L_ffn_cw_15
    v_mfma_f32_16x16x32_bf16 v[32:35], v[80:83], v[20:23], v[32:35]
    v_mfma_f32_16x16x32_bf16 v[36:39], v[84:87], v[20:23], v[36:39]
L_ffn_cw_15:
    s_waitcnt lgkmcnt(4)
    v_mfma_f32_16x16x32_bf16 v[112:115], v[88:91], v[64:67], v[112:115]
    ds_read_b64_tr_b16 v[80:81], v27 offset:40960
    ds_read_b64_tr_b16 v[82:83], v27 offset:44032
    v_mfma_f32_16x16x32_bf16 v[152:155], v[88:91], v[68:71], v[152:155]
    ds_read_b128 v[56:59], v9 offset:2048
    v_mfma_f32_16x16x32_bf16 v[192:195], v[88:91], v[72:75], v[192:195]
    s_add_u32 m0, s59, 2048
    s_nop 0
    buffer_load_dwordx4 v6, s[40:43], s57 offen lds
    s_add_u32 s57, s57, 294912
    v_mfma_f32_16x16x32_bf16 v[232:235], v[88:91], v[76:79], v[232:235]
    s_waitcnt lgkmcnt(4)
    v_mfma_f32_16x16x32_bf16 v[116:119], v[92:95], v[64:67], v[116:119]
    ds_read_b64_tr_b16 v[84:85], v27 offset:53248
    ds_read_b64_tr_b16 v[86:87], v27 offset:56320
    v_mfma_f32_16x16x32_bf16 v[156:159], v[92:95], v[68:71], v[156:159]
    ds_read_b128 v[60:63], v9 offset:3072
    v_mfma_f32_16x16x32_bf16 v[196:199], v[92:95], v[72:75], v[196:199]
    v_mfma_f32_16x16x32_bf16 v[236:239], v[92:95], v[76:79], v[236:239]
    s_cmp_eq_u32 s5, 2
    s_cbranch_scc0 L_ffn_cw_16
    v_mfma_f32_16x16x32_bf16 v[32:35], v[88:91], v[20:23], v[32:35]
    v_mfma_f32_16x16x32_bf16 v[36:39], v[92:95], v[20:23], v[36:39]
L_ffn_cw_16:
    s_waitcnt lgkmcnt(4)
    v_mfma_f32_16x16x32_bf16 v[120:123], v[80:83], v[64:67], v[120:123]
    ds_read_b64_tr_b16 v[88:89], v24 offset:41088
    ds_read_b64_tr_b16 v[90:91], v24 offset:44160
    v_mfma_f32_16x16x32_bf16 v[160:163], v[80:83], v[68:71], v[160:163]
    v_mfma_f32_16x16x32_bf16 v[200:203], v[80:83], v[72:75], v[200:203]
    v_mfma_f32_16x16x32_bf16 v[240:243], v[80:83], v[76:79], v[240:243]
    s_waitcnt lgkmcnt(3)
    v_mfma_f32_16x16x32_bf16 v[124:127], v[84:87], v[64:67], v[124:127]
    ds_read_b64_tr_b16 v[92:93], v24 offset:53376
    ds_read_b64_tr_b16 v[94:95], v24 offset:56448
    v_mfma_f32_16x16x32_bf16 v[164:167], v[84:87], v[68:71], v[164:167]
    v_mfma_f32_16x16x32_bf16 v[204:207], v[84:87], v[72:75], v[204:207]
    v_mfma_f32_16x16x32_bf16 v[244:247], v[84:87], v[76:79], v[244:247]
    s_cmp_eq_u32 s5, 3
    s_cbranch_scc0 L_ffn_cw_17
    v_mfma_f32_16x16x32_bf16 v[32:35], v[80:83], v[20:23], v[32:35]
    v_mfma_f32_16x16x32_bf16 v[36:39], v[84:87], v[20:23], v[36:39]
L_ffn_cw_17:
    s_waitcnt lgkmcnt(2)
    v_mfma_f32_16x16x32_bf16 v[128:131], v[88:91], v[64:67], v[128:131]
    ds_read_b64_tr_b16 v[80:81], v28 offset:0
    ds_read_b64_tr_b16 v[82:83], v28 offset:3072
    v_mfma_f32_16x16x32_bf16 v[168:171], v[88:91], v[68:71], v[168:171]
    v_mfma_f32_16x16x32_bf16 v[208:211], v[88:91], v[72:75], v[208:211]
    v_mfma_f32_16x16x32_bf16 v[248:251], v[88:91], v[76:79], v[248:251]
    s_waitcnt lgkmcnt(2)
    v_mfma_f32_16x16x32_bf16 v[132:135], v[92:95], v[64:67], v[132:135]
    ds_read_b64_tr_b16 v[84:85], v28 offset:12288
    ds_read_b64_tr_b16 v[86:87], v28 offset:15360
    v_mfma_f32_16x16x32_bf16 v[172:175], v[92:95], v[68:71], v[172:175]
    v_mfma_f32_16x16x32_bf16 v[212:215], v[92:95], v[72:75], v[212:215]
    v_mfma_f32_16x16x32_bf16 v[252:255], v[92:95], v[76:79], v[252:255]
    s_cmp_eq_u32 s5, 0
    s_cbranch_scc0 L_ffn_cw_18
    v_mfma_f32_16x16x32_bf16 v[10:13], v[88:91], v[20:23], v[10:13]
    v_mfma_f32_16x16x32_bf16 v[16:19], v[92:95], v[20:23], v[16:19]
L_ffn_cw_18:
    s_waitcnt vmcnt(5)
    s_barrier
    s_waitcnt lgkmcnt(2)
    v_mfma_f32_16x16x32_bf16 v[96:99], v[80:83], v[48:51], v[96:99]
    ds_read_b64_tr_b16 v[88:89], v29 offset:0
    ds_read_b64_tr_b16 v[90:91], v29 offset:3072
    v_mfma_f32_16x16x32_bf16 v[136:139], v[80:83], v[52:55], v[136:139]
    v_mfma_f32_16x16x32_bf16 v[176:179], v[80:83], v[56:59], v[176:179]
    s_add_u32 m0, s58, 40960
    s_nop 0
    buffer_load_dwordx4 v2, s[36:39], s56 offen sc1 lds
    v_mfma_f32_16x16x32_bf16 v[216:219], v[80:83], v[60:63], v[216:219]
    s_waitcnt lgkmcnt(2)
    v_mfma_f32_16x16x32_bf16 v[100:103], v[84:87], v[48:51], v[100:103]
    ds_read_b64_tr_b16 v[92:93], v29 offset:12288
    ds_read_b64_tr_b16 v[94:95], v29 offset:15360
    v_mfma_f32_16x16x32_bf16 v[140:143], v[84:87], v[52:55], v[140:143]
    v_mfma_f32_16x16x32_bf16 v[180:183], v[84:87], v[56:59], v[180:183]
    s_add_u32 m0, s58, 41984
    s_nop 0
    buffer_load_dwordx4 v3, s[36:39], s56 offen sc1 lds
    s_add_u32 s56, s56, 1024
    v_mfma_f32_16x16x32_bf16 v[220:223], v[84:87], v[60:63], v[220:223]
    s_cmp_eq_u32 s5, 0
    s_cbranch_scc0 L_ffn_cw_19
    v_mfma_f32_16x16x32_bf16 v[32:35], v[80:83], v[20:23], v[32:35]
    v_mfma_f32_16x16x32_bf16 v[36:39], v[84:87], v[20:23], v[36:39]
L_ffn_cw_19:
    s_waitcnt lgkmcnt(2)
    v_mfma_f32_16x16x32_bf16 v[104:107], v[88:91], v[48:51], v[104:107]
    ds_read_b64_tr_b16 v[80:81], v30 offset:0
    ds_read_b64_tr_b16 v[82:83], v30 offset:3072
    v_mfma_f32_16x16x32_bf16 v[144:147], v[88:91], v[52:55], v[144:147]
    ds_read_b128 v[64:67], v9 offset:40960
    v_mfma_f32_16x16x32_bf16 v[184:187], v[88:91], v[56:59], v[184:187]
    s_add_u32 m0, s59, 40960
    s_nop 0
    buffer_load_dwordx4 v4, s[40:43], s57 offen lds
    v_mfma_f32_16x16x32_bf16 v[224:227], v[88:91], v[60:63], v[224:227]
    s_waitcnt lgkmcnt(3)
    v_mfma_f32_16x16x32_bf16 v[108:111], v[92:95], v[48:51], v[108:111]
    ds_read_b64_tr_b16 v[84:85], v30 offset:12288
    ds_read_b64_tr_b16 v[86:87], v30 offset:15360
    v_mfma_f32_16x16x32_bf16 v[148:151], v[92:95], v[52:55], v[148:151]
    ds_read_b128 v[68:71], v9 offset:41984
    v_mfma_f32_16x16x32_bf16 v[188:191], v[92:95], v[56:59], v[188:191]
    s_add_u32 m0, s59, 41984
    s_nop 0
    buffer_load_dwordx4 v5, s[40:43], s57 offen lds
    v_mfma_f32_16x16x32_bf16 v[228:231], v[92:95], v[60:63], v[228:231]
    s_cmp_eq_u32 s5, 1
    s_cbranch_scc0 L_ffn_cw_20
    v_mfma_f32_16x16x32_bf16 v[32:35], v[88:91], v[20:23], v[32:35]
    v_mfma_f32_16x16x32_bf16 v[36:39], v[92:95], v[20:23], v[36:39]
L_ffn_cw_20:
    s_waitcnt lgkmcnt(4)
    v_mfma_f32_16x16x32_bf16 v[112:115], v[80:83], v[48:51], v[112:115]
    ds_read_b64_tr_b16 v[88:89], v31 offset:0
    ds_read_b64_tr_b16 v[90:91], v31 offset:3072
    v_mfma_f32_16x16x32_bf16 v[152:155], v[80:83], v[52:55], v[152:155]
    ds_read_b128 v[72:75], v9 offset:43008
    v_mfma_f32_16x16x32_bf16 v[192:195], v[80:83], v[56:59], v[192:195]
    s_add_u32 m0, s59, 43008
    s_nop 0
    buffer_load_dwordx4 v6, s[40:43], s57 offen lds
    s_add_u32 s57, s57, 294912
    v_mfma_f32_16x16x32_bf16 v[232:235], v[80:83], v[60:63], v[232:235]
    s_waitcnt lgkmcnt(4)
    v_mfma_f32_16x16x32_bf16 v[116:119], v[84:87], v[48:51], v[116:119]
    ds_read_b64_tr_b16 v[92:93], v31 offset:12288
    ds_read_b64_tr_b16 v[94:95], v31 offset:15360
    v_mfma_f32_16x16x32_bf16 v[156:159], v[84:87], v[52:55], v[156:159]
    ds_read_b128 v[76:79], v9 offset:44032
    v_mfma_f32_16x16x32_bf16 v[196:199], v[84:87], v[56:59], v[196:199]
    v_mfma_f32_16x16x32_bf16 v[236:239], v[84:87], v[60:63], v[236:239]
    s_cmp_eq_u32 s5, 2
    s_cbranch_scc0 L_ffn_cw_21
    v_mfma_f32_16x16x32_bf16 v[32:35], v[80:83], v[20:23], v[32:35]
    v_mfma_f32_16x16x32_bf16 v[36:39], v[84:87], v[20:23], v[36:39]
L_ffn_cw_21:
    s_waitcnt lgkmcnt(4)
    v_mfma_f32_16x16x32_bf16 v[120:123], v[88:91], v[48:51], v[120:123]
    ds_read_b64_tr_b16 v[80:81], v28 offset:128
    ds_read_b64_tr_b16 v[82:83], v28 offset:3200
    v_mfma_f32_16x16x32_bf16 v[160:163], v[88:91], v[52:55], v[160:163]
    v_mfma_f32_16x16x32_bf16 v[200:203], v[88:91], v[56:59], v[200:203]
    v_mfma_f32_16x16x32_bf16 v[240:243], v[88:91], v[60:63], v[240:243]
    s_waitcnt lgkmcnt(3)
    v_mfma_f32_16x16x32_bf16 v[124:127], v[92:95], v[48:51], v[124:127]
    ds_read_b64_tr_b16 v[84:85], v28 offset:12416
    ds_read_b64_tr_b16 v[86:87], v28 offset:15488
    v_mfma_f32_16x16x32_bf16 v[164:167], v[92:95], v[52:55], v[164:167]
    v_mfma_f32_16x16x32_bf16 v[204:207], v[92:95], v[56:59], v[204:207]
    v_mfma_f32_16x16x32_bf16 v[244:247], v[92:95], v[60:63], v[244:247]
    s_cmp_eq_u32 s5, 3
    s_cbranch_scc0 L_ffn_cw_22
    v_mfma_f32_16x16x32_bf16 v[32:35], v[88:91], v[20:23], v[32:35]
    v_mfma_f32_16x16x32_bf16 v[36:39], v[92:95], v[20:23], v[36:39]
L_ffn_cw_22:
    s_waitcnt lgkmcnt(2)
    v_mfma_f32_16x16x32_bf16 v[128:131], v[80:83], v[48:51], v[128:131]
    ds_read_b64_tr_b16 v[88:89], v28 offset:40960
    ds_read_b64_tr_b16 v[90:91], v28 offset:44032
    v_mfma_f32_16x16x32_bf16 v[168:171], v[80:83], v[52:55], v[168:171]
    v_mfma_f32_16x16x32_bf16 v[208:211], v[80:83], v[56:59], v[208:211]
    v_mfma_f32_16x16x32_bf16 v[248:251], v[80:83], v[60:63], v[248:251]
    s_waitcnt lgkmcnt(2)
    v_mfma_f32_16x16x32_bf16 v[132:135], v[84:87], v[48:51], v[132:135]
    ds_read_b64_tr_b16 v[92:93], v28 offset:53248
    ds_read_b64_tr_b16 v[94:95], v28 offset:56320
    v_mfma_f32_16x16x32_bf16 v[172:175], v[84:87], v[52:55], v[172:175]
    v_mfma_f32_16x16x32_bf16 v[212:215], v[84:87], v[56:59], v[212:215]
    v_mfma_f32_16x16x32_bf16 v[252:255], v[84:87], v[60:63], v[252:255]
    s_cmp_eq_u32 s5, 0
    s_cbranch_scc0 L_ffn_cw_23
    v_mfma_f32_16x16x32_bf16 v[10:13], v[80:83], v[20:23], v[10:13]
    v_mfma_f32_16x16x32_bf16 v[16:19], v[84:87], v[20:23], v[16:19]
L_ffn_cw_23:
    s_waitcnt vmcnt(5)
    s_barrier
    s_waitcnt lgkmcnt(2)
    v_mfma_f32_16x16x32_bf16 v[96:99], v[88:91], v[64:67], v[96:99]
    ds_read_b64_tr_b16 v[80:81], v29 offset:40960
    ds_read_b64_tr_b16 v[82:83], v29 offset:44032
    v_mfma_f32_16x16x32_bf16 v[136:139], v[88:91], v[68:71], v[136:139]
    v_mfma_f32_16x16x32_bf16 v[176:179], v[88:91], v[72:75], v[176:179]
    s_add_u32 m0, s58, 81920
    s_nop 0
    buffer_load_dwordx4 v2, s[36:39], s56 offen sc1 lds
    v_mfma_f32_16x16x32_bf16 v[216:219], v[88:91], v[76:79], v[216:219]
    s_waitcnt lgkmcnt(2)
    v_mfma_f32_16x16x32_bf16 v[100:103], v[92:95], v[64:67], v[100:103]
    ds_read_b64_tr_b16 v[84:85], v29 offset:53248
    ds_read_b64_tr_b16 v[86:87], v29 offset:56320
    v_mfma_f32_16x16x32_bf16 v[140:143], v[92:95], v[68:71], v[140:143]
    v_mfma_f32_16x16x32_bf16 v[180:183], v[92:95], v[72:75], v[180:183]
    s_add_u32 m0, s58, 82944
    s_nop 0
    buffer_load_dwordx4 v3, s[36:39], s56 offen sc1 lds
    s_add_u32 s56, s56, 1024
    v_mfma_f32_16x16x32_bf16 v[220:223], v[92:95], v[76:79], v[220:223]
    s_cmp_eq_u32 s5, 0
    s_cbranch_scc0 L_ffn_cw_24
    v_mfma_f32_16x16x32_bf16 v[32:35], v[88:91], v[20:23], v[32:35]
    v_mfma_f32_16x16x32_bf16 v[36:39], v[92:95], v[20:23], v[36:39]
L_ffn_cw_24:
    s_waitcnt lgkmcnt(2)
    v_mfma_f32_16x16x32_bf16 v[104:107], v[80:83], v[64:67], v[104:107]
    ds_read_b64_tr_b16 v[88:89], v30 offset:40960
    ds_read_b64_tr_b16 v[90:91], v30 offset:44032
    v_mfma_f32_16x16x32_bf16 v[144:147], v[80:83], v[68:71], v[144:147]
    ds_read_b128 v[48:51], v8 offset:0
    v_mfma_f32_16x16x32_bf16 v[184:187], v[80:83], v[72:75], v[184:187]
    s_add_u32 m0, s59, 81920
    s_nop 0
    buffer_load_dwordx4 v4, s[40:43], s57 offen lds
    v_mfma_f32_16x16x32_bf16 v[224:227], v[80:83], v[76:79], v[224:227]
    s_waitcnt lgkmcnt(3)
    v_mfma_f32_16x16x32_bf16 v[108:111], v[84:87], v[64:67], v[108:111]
    ds_read_b64_tr_b16 v[92:93], v30 offset:53248
    ds_read_b64_tr_b16 v[94:95], v30 offset:56320
    v_mfma_f32_16x16x32_bf16 v[148:151], v[84:87], v[68:71], v[148:151]
    ds_read_b128 v[52:55], v8 offset:1024
    v_mfma_f32_16x16x32_bf16 v[188:191], v[84:87], v[72:75], v[188:191]
    s_add_u32 m0, s59, 82944
    s_nop 0
    buffer_load_dwordx4 v5, s[40:43], s57 offen lds
    v_mfma_f32_16x16x32_bf16 v[228:231], v[84:87], v[76:79], v[228:231]
    s_cmp_eq_u32 s5, 1
    s_cbranch_scc0 L_ffn_cw_25
    v_mfma_f32_16x16x32_bf16 v[32:35], v[80:83], v[20:23], v[32:35]
    v_mfma_f32_16x16x32_bf16 v[36:39], v[84:87], v[20:23], v[36:39]
L_ffn_cw_25:
    s_waitcnt lgkmcnt(4)
    v_mfma_f32_16x16x32_bf16 v[112:115], v[88:91], v[64:67], v[112:115]
    ds_read_b64_tr_b16 v[80:81], v31 offset:40960
    ds_read_b64_tr_b16 v[82:83], v31 offset:44032
    v_mfma_f32_16x16x32_bf16 v[152:155], v[88:91], v[68:71], v[152:155]
    ds_read_b128 v[56:59], v8 offset:2048
    v_mfma_f32_16x16x32_bf16 v[192:195], v[88:91], v[72:75], v[192:195]
    s_add_u32 m0, s59, 83968
    s_nop 0
    buffer_load_dwordx4 v6, s[40:43], s57 offen lds
    s_add_u32 s57, s57, 294912
    v_mfma_f32_16x16x32_bf16 v[232:235], v[88:91], v[76:79], v[232:235]
    s_waitcnt lgkmcnt(4)
    v_mfma_f32_16x16x32_bf16 v[116:119], v[92:95], v[64:67], v[116:119]
    ds_read_b64_tr_b16 v[84:85], v31 offset:53248
    ds_read_b64_tr_b16 v[86:87], v31 offset:56320
    v_mfma_f32_16x16x32_bf16 v[156:159], v[92:95], v[68:71], v[156:159]
    ds_read_b128 v[60:63], v8 offset:3072
    v_mfma_f32_16x16x32_bf16 v[196:199], v[92:95], v[72:75], v[196:199]
    v_mfma_f32_16x16x32_bf16 v[236:239], v[92:95], v[76:79], v[236:239]
    s_cmp_eq_u32 s5, 2
    s_cbranch_scc0 L_ffn_cw_26
    v_mfma_f32_16x16x32_bf16 v[32:35], v[88:91], v[20:23], v[32:35]
    v_mfma_f32_16x16x32_bf16 v[36:39], v[92:95], v[20:23], v[36:39]
L_ffn_cw_26:
    s_waitcnt lgkmcnt(4)
    v_mfma_f32_16x16x32_bf16 v[120:123], v[80:83], v[64:67], v[120:123]
    ds_read_b64_tr_b16 v[88:89], v28 offset:41088
    ds_read_b64_tr_b16 v[90:91], v28 offset:44160
    v_mfma_f32_16x16x32_bf16 v[160:163], v[80:83], v[68:71], v[160:163]
    v_mfma_f32_16x16x32_bf16 v[200:203], v[80:83], v[72:75], v[200:203]
    v_mfma_f32_16x16x32_bf16 v[240:243], v[80:83], v[76:79], v[240:243]
    s_waitcnt lgkmcnt(3)
    v_mfma_f32_16x16x32_bf16 v[124:127], v[84:87], v[64:67], v[124:127]
    ds_read_b64_tr_b16 v[92:93], v28 offset:53376
    ds_read_b64_tr_b16 v[94:95], v28 offset:56448
    v_mfma_f32_16x16x32_bf16 v[164:167], v[84:87], v[68:71], v[164:167]
    v_mfma_f32_16x16x32_bf16 v[204:207], v[84:87], v[72:75], v[204:207]
    v_mfma_f32_16x16x32_bf16 v[244:247], v[84:87], v[76:79], v[244:247]
    s_cmp_eq_u32 s5, 3
    s_cbranch_scc0 L_ffn_cw_27
    v_mfma_f32_16x16x32_bf16 v[32:35], v[80:83], v[20:23], v[32:35]
    v_mfma_f32_16x16x32_bf16 v[36:39], v[84:87], v[20:23], v[36:39]
L_ffn_cw_27:
    s_waitcnt lgkmcnt(2)
    v_mfma_f32_16x16x32_bf16 v[128:131], v[88:91], v[64:67], v[128:131]
    ds_read_b64_tr_b16 v[80:81], v24 offset:0
    ds_read_b64_tr_b16 v[82:83], v24 offset:3072
    v_mfma_f32_16x16x32_bf16 v[168:171], v[88:91], v[68:71], v[168:171]
    v_mfma_f32_16x16x32_bf16 v[208:211], v[88:91], v[72:75], v[208:211]
    v_mfma_f32_16x16x32_bf16 v[248:251], v[88:91], v[76:79], v[248:251]
    s_waitcnt lgkmcnt(2)
    v_mfma_f32_16x16x32_bf16 v[132:135], v[92:95], v[64:67], v[132:135]
    ds_read_b64_tr_b16 v[84:85], v24 offset:12288
    ds_read_b64_tr_b16 v[86:87], v24 offset:15360
    v_mfma_f32_16x16x32_bf16 v[172:175], v[92:95], v[68:71], v[172:175]
    v_mfma_f32_16x16x32_bf16 v[212:215], v[92:95], v[72:75], v[212:215]
    v_mfma_f32_16x16x32_bf16 v[252:255], v[92:95], v[76:79], v[252:255]
    s_cmp_eq_u32 s5, 0
    s_cbranch_scc0 L_ffn_cw_28
    v_mfma_f32_16x16x32_bf16 v[10:13], v[88:91], v[20:23], v[10:13]
    v_mfma_f32_16x16x32_bf16 v[16:19], v[92:95], v[20:23], v[16:19]
L_ffn_cw_28:
    s_waitcnt vmcnt(5)
    s_barrier
    s_waitcnt lgkmcnt(2)
    v_mfma_f32_16x16x32_bf16 v[96:99], v[80:83], v[48:51], v[96:99]
    ds_read_b64_tr_b16 v[88:89], v25 offset:0
    ds_read_b64_tr_b16 v[90:91], v25 offset:3072
    v_mfma_f32_16x16x32_bf16 v[136:139], v[80:83], v[52:55], v[136:139]
    v_mfma_f32_16x16x32_bf16 v[176:179], v[80:83], v[56:59], v[176:179]
    s_add_u32 m0, s58, 122880
    s_nop 0
    buffer_load_dwordx4 v2, s[36:39], s56 offen sc1 lds
    v_mfma_f32_16x16x32_bf16 v[216:219], v[80:83], v[60:63], v[216:219]
    s_waitcnt lgkmcnt(2)
    v_mfma_f32_16x16x32_bf16 v[100:103], v[84:87], v[48:51], v[100:103]
    ds_read_b64_tr_b16 v[92:93], v25 offset:12288
    ds_read_b64_tr_b16 v[94:95], v25 offset:15360
    v_mfma_f32_16x16x32_bf16 v[140:143], v[84:87], v[52:55], v[140:143]
    v_mfma_f32_16x16x32_bf16 v[180:183], v[84:87], v[56:59], v[180:183]
    s_add_u32 m0, s58, 123904
    s_nop 0
    buffer_load_dwordx4 v3, s[36:39], s56 offen sc1 lds
    s_add_u32 s56, s56, 1024
    v_mfma_f32_16x16x32_bf16 v[220:223], v[84:87], v[60:63], v[220:223]
    s_cmp_eq_u32 s5, 0
    s_cbranch_scc0 L_ffn_cw_29
    v_mfma_f32_16x16x32_bf16 v[32:35], v[80:83], v[20:23], v[32:35]
    v_mfma_f32_16x16x32_bf16 v[36:39], v[84:87], v[20:23], v[36:39]
L_ffn_cw_29:
    s_waitcnt lgkmcnt(2)
    v_mfma_f32_16x16x32_bf16 v[104:107], v[88:91], v[48:51], v[104:107]
    ds_read_b64_tr_b16 v[80:81], v26 offset:0
    ds_read_b64_tr_b16 v[82:83], v26 offset:3072
    v_mfma_f32_16x16x32_bf16 v[144:147], v[88:91], v[52:55], v[144:147]
    ds_read_b128 v[64:67], v8 offset:40960
    v_mfma_f32_16x16x32_bf16 v[184:187], v[88:91], v[56:59], v[184:187]
    s_add_u32 m0, s59, 122880
    s_nop 0
    buffer_load_dwordx4 v4, s[40:43], s57 offen lds
    v_mfma_f32_16x16x32_bf16 v[224:227], v[88:91], v[60:63], v[224:227]
    s_waitcnt lgkmcnt(3)
    v_mfma_f32_16x16x32_bf16 v[108:111], v[92:95], v[48:51], v[108:111]
    ds_read_b64_tr_b16 v[84:85], v26 offset:12288
    ds_read_b64_tr_b16 v[86:87], v26 offset:15360
    v_mfma_f32_16x16x32_bf16 v[148:151], v[92:95], v[52:55], v[148:151]
    ds_read_b128 v[68:71], v8 offset:41984
    v_mfma_f32_16x16x32_bf16 v[188:191], v[92:95], v[56:59], v[188:191]
    s_add_u32 m0, s59, 123904
    s_nop 0
    buffer_load_dwordx4 v5, s[40:43], s57 offen lds
    v_mfma_f32_16x16x32_bf16 v[228:231], v[92:95], v[60:63], v[228:231]
    s_cmp_eq_u32 s5, 1
    s_cbranch_scc0 L_ffn_cw_30
    v_mfma_f32_16x16x32_bf16 v[32:35], v[88:91], v[20:23], v[32:35]
    v_mfma_f32_16x16x32_bf16 v[36:39], v[92:95], v[20:23], v[36:39]
L_ffn_cw_30:
    s_waitcnt lgkmcnt(4)
    v_mfma_f32_16x16x32_bf16 v[112:115], v[80:83], v[48:51], v[112:115]
    ds_read_b64_tr_b16 v[88:89], v27 offset:0
    ds_read_b64_tr_b16 v[90:91], v27 offset:3072
    v_mfma_f32_16x16x32_bf16 v[152:155], v[80:83], v[52:55], v[152:155]
    ds_read_b128 v[72:75], v8 offset:43008
    v_mfma_f32_16x16x32_bf16 v[192:195], v[80:83], v[56:59], v[192:195]
    s_add_u32 m0, s59, 124928
    s_nop 0
    buffer_load_dwordx4 v6, s[40:43], s57 offen lds
    s_add_u32 s57, s57, 294912
    v_mfma_f32_16x16x32_bf16 v[232:235], v[80:83], v[60:63], v[232:235]
    s_waitcnt lgkmcnt(4)
    v_mfma_f32_16x16x32_bf16 v[116:119], v[84:87], v[48:51], v[116:119]
    ds_read_b64_tr_b16 v[92:93], v27 offset:12288
    ds_read_b64_tr_b16 v[94:95], v27 offset:15360
    v_mfma_f32_16x16x32_bf16 v[156:159], v[84:87], v[52:55], v[156:159]
    ds_read_b128 v[76:79], v8 offset:44032
    v_mfma_f32_16x16x32_bf16 v[196:199], v[84:87], v[56:59], v[196:199]
    v_mfma_f32_16x16x32_bf16 v[236:239], v[84:87], v[60:63], v[236:239]
    s_cmp_eq_u32 s5, 2
    s_cbranch_scc0 L_ffn_cw_31
    v_mfma_f32_16x16x32_bf16 v[32:35], v[80:83], v[20:23], v[32:35]
    v_mfma_f32_16x16x32_bf16 v[36:39], v[84:87], v[20:23], v[36:39]
L_ffn_cw_31:
    s_waitcnt lgkmcnt(4)
    v_mfma_f32_16x16x32_bf16 v[120:123], v[88:91], v[48:51], v[120:123]
    ds_read_b64_tr_b16 v[80:81], v24 offset:128
    ds_read_b64_tr_b16 v[82:83], v24 offset:3200
    v_mfma_f32_16x16x32_bf16 v[160:163], v[88:91], v[52:55], v[160:163]
    v_mfma_f32_16x16x32_bf16 v[200:203], v[88:91], v[56:59], v[200:203]
    v_mfma_f32_16x16x32_bf16 v[240:243], v[88:91], v[60:63], v[240:243]
    s_waitcnt lgkmcnt(3)
    v_mfma_f32_16x16x32_bf16 v[124:127], v[92:95], v[48:51], v[124:127]
    ds_read_b64_tr_b16 v[84:85], v24 offset:12416
    ds_read_b64_tr_b16 v[86:87], v24 offset:15488
    v_mfma_f32_16x16x32_bf16 v[164:167], v[92:95], v[52:55], v[164:167]
    v_mfma_f32_16x16x32_bf16 v[204:207], v[92:95], v[56:59], v[204:207]
    v_mfma_f32_16x16x32_bf16 v[244:247], v[92:95], v[60:63], v[244:247]
    s_cmp_eq_u32 s5, 3
    s_cbranch_scc0 L_ffn_cw_32
    v_mfma_f32_16x16x32_bf16 v[32:35], v[88:91], v[20:23], v[32:35]
    v_mfma_f32_16x16x32_bf16 v[36:39], v[92:95], v[20:23], v[36:39]
L_ffn_cw_32:
    s_waitcnt lgkmcnt(2)
    v_mfma_f32_16x16x32_bf16 v[128:131], v[80:83], v[48:51], v[128:131]
    ds_read_b64_tr_b16 v[88:89], v24 offset:40960
    ds_read_b64_tr_b16 v[90:91], v24 offset:44032
    v_mfma_f32_16x16x32_bf16 v[168:171], v[80:83], v[52:55], v[168:171]
    v_mfma_f32_16x16x32_bf16 v[208:211], v[80:83], v[56:59], v[208:211]
    v_mfma_f32_16x16x32_bf16 v[248:251], v[80:83], v[60:63], v[248:251]
    s_waitcnt lgkmcnt(2)
    v_mfma_f32_16x16x32_bf16 v[132:135], v[84:87], v[48:51], v[132:135]
    ds_read_b64_tr_b16 v[92:93], v24 offset:53248
    ds_read_b64_tr_b16 v[94:95], v24 offset:56320
    v_mfma_f32_16x16x32_bf16 v[172:175], v[84:87], v[52:55], v[172:175]
    v_mfma_f32_16x16x32_bf16 v[212:215], v[84:87], v[56:59], v[212:215]
    v_mfma_f32_16x16x32_bf16 v[252:255], v[84:87], v[60:63], v[252:255]
    s_cmp_eq_u32 s5, 0
    s_cbranch_scc0 L_ffn_cw_33
    v_mfma_f32_16x16x32_bf16 v[10:13], v[80:83], v[20:23], v[10:13]
    v_mfma_f32_16x16x32_bf16 v[16:19], v[84:87], v[20:23], v[16:19]
L_ffn_cw_33:
    s_waitcnt vmcnt(5)
    s_barrier
    s_waitcnt lgkmcnt(2)
    v_mfma_f32_16x16x32_bf16 v[96:99], v[88:91], v[64:67], v[96:99]
    ds_read_b64_tr_b16 v[80:81], v25 offset:40960
    ds_read_b64_tr_b16 v[82:83], v25 offset:44032
    v_mfma_f32_16x16x32_bf16 v[136:139], v[88:91], v[68:71], v[136:139]
    v_mfma_f32_16x16x32_bf16 v[176:179], v[88:91], v[72:75], v[176:179]
    s_add_u32 m0, s58, 0
    s_nop 0
    buffer_load_dwordx4 v2, s[36:39], s56 offen sc1 lds
    v_mfma_f32_16x16x32_bf16 v[216:219], v[88:91], v[76:79], v[216:219]
    s_waitcnt lgkmcnt(2)
    v_mfma_f32_16x16x32_bf16 v[100:103], v[92:95], v[64:67], v[100:103]
    ds_read_b64_tr_b16 v[84:85], v25 offset:53248
    ds_read_b64_tr_b16 v[86:87], v25 offset:56320
    v_mfma_f32_16x16x32_bf16 v[140:143], v[92:95], v[68:71], v[140:143]
    v_mfma_f32_16x16x32_bf16 v[180:183], v[92:95], v[72:75], v[180:183]
    s_add_u32 m0, s58, 1024
    s_nop 0
    buffer_load_dwordx4 v3, s[36:39], s56 offen sc1 lds
    s_add_u32 s56, s56, 1024
    v_mfma_f32_16x16x32_bf16 v[220:223], v[92:95], v[76:79], v[220:223]
    s_cmp_eq_u32 s5, 0
    s_cbranch_scc0 L_ffn_cw_34
    v_mfma_f32_16x16x32_bf16 v[32:35], v[88:91], v[20:23], v[32:35]
    v_mfma_f32_16x16x32_bf16 v[36:39], v[92:95], v[20:23], v[36:39]
L_ffn_cw_34:
    s_waitcnt lgkmcnt(2)
    v_mfma_f32_16x16x32_bf16 v[104:107], v[80:83], v[64:67], v[104:107]
    ds_read_b64_tr_b16 v[88:89], v26 offset:40960
    ds_read_b64_tr_b16 v[90:91], v26 offset:44032
    v_mfma_f32_16x16x32_bf16 v[144:147], v[80:83], v[68:71], v[144:147]
    ds_read_b128 v[48:51], v9 offset:0
    v_mfma_f32_16x16x32_bf16 v[184:187], v[80:83], v[72:75], v[184:187]
    s_add_u32 m0, s59, 0
    s_nop 0
    buffer_load_dwordx4 v4, s[40:43], s57 offen lds
    v_mfma_f32_16x16x32_bf16 v[224:227], v[80:83], v[76:79], v[224:227]
    s_waitcnt lgkmcnt(3)
    v_mfma_f32_16x16x32_bf16 v[108:111], v[84:87], v[64:67], v[108:111]
    ds_read_b64_tr_b16 v[92:93], v26 offset:53248
    ds_read_b64_tr_b16 v[94:95], v26 offset:56320
    v_mfma_f32_16x16x32_bf16 v[148:151], v[84:87], v[68:71], v[148:151]
    ds_read_b128 v[52:55], v9 offset:1024
    v_mfma_f32_16x16x32_bf16 v[188:191], v[84:87], v[72:75], v[188:191]
    s_add_u32 m0, s59, 1024
    s_nop 0
    buffer_load_dwordx4 v5, s[40:43], s57 offen lds
    v_mfma_f32_16x16x32_bf16 v[228:231], v[84:87], v[76:79], v[228:231]
    s_cmp_eq_u32 s5, 1
    s_cbranch_scc0 L_ffn_cw_35
    v_mfma_f32_16x16x32_bf16 v[32:35], v[80:83], v[20:23], v[32:35]
    v_mfma_f32_16x16x32_bf16 v[36:39], v[84:87], v[20:23], v[36:39]
L_ffn_cw_35:
    s_waitcnt lgkmcnt(4)
    v_mfma_f32_16x16x32_bf16 v[112:115], v[88:91], v[64:67], v[112:115]
    ds_read_b64_tr_b16 v[80:81], v27 offset:40960
    ds_read_b64_tr_b16 v[82:83], v27 offset:44032
    v_mfma_f32_16x16x32_bf16 v[152:155], v[88:91], v[68:71], v[152:155]
    ds_read_b128 v[56:59], v9 offset:2048
    v_mfma_f32_16x16x32_bf16 v[192:195], v[88:91], v[72:75], v[192:195]
    s_add_u32 m0, s59, 2048
    s_nop 0
    buffer_load_dwordx4 v6, s[40:43], s57 offen lds
    s_add_u32 s57, s57, 294912
    v_mfma_f32_16x16x32_bf16 v[232:235], v[88:91], v[76:79], v[232:235]
    s_waitcnt lgkmcnt(4)
    v_mfma_f32_16x16x32_bf16 v[116:119], v[92:95], v[64:67], v[116:119]
    ds_read_b64_tr_b16 v[84:85], v27 offset:53248
    ds_read_b64_tr_b16 v[86:87], v27 offset:56320
    v_mfma_f32_16x16x32_bf16 v[156:159], v[92:95], v[68:71], v[156:159]
    ds_read_b128 v[60:63], v9 offset:3072
    v_mfma_f32_16x16x32_bf16 v[196:199], v[92:95], v[72:75], v[196:199]
    v_mfma_f32_16x16x32_bf16 v[236:239], v[92:95], v[76:79], v[236:239]
    s_cmp_eq_u32 s5, 2
    s_cbranch_scc0 L_ffn_cw_36
    v_mfma_f32_16x16x32_bf16 v[32:35], v[88:91], v[20:23], v[32:35]
    v_mfma_f32_16x16x32_bf16 v[36:39], v[92:95], v[20:23], v[36:39]
L_ffn_cw_36:
    s_waitcnt lgkmcnt(4)
    v_mfma_f32_16x16x32_bf16 v[120:123], v[80:83], v[64:67], v[120:123]
    ds_read_b64_tr_b16 v[88:89], v24 offset:41088
    ds_read_b64_tr_b16 v[90:91], v24 offset:44160
    v_mfma_f32_16x16x32_bf16 v[160:163], v[80:83], v[68:71], v[160:163]
    v_mfma_f32_16x16x32_bf16 v[200:203], v[80:83], v[72:75], v[200:203]
    v_mfma_f32_16x16x32_bf16 v[240:243], v[80:83], v[76:79], v[240:243]
    s_waitcnt lgkmcnt(3)
    v_mfma_f32_16x16x32_bf16 v[124:127], v[84:87], v[64:67], v[124:127]
    ds_read_b64_tr_b16 v[92:93], v24 offset:53376
    ds_read_b64_tr_b16 v[94:95], v24 offset:56448
    v_mfma_f32_16x16x32_bf16 v[164:167], v[84:87], v[68:71], v[164:167]
    v_mfma_f32_16x16x32_bf16 v[204:207], v[84:87], v[72:75], v[204:207]
    v_mfma_f32_16x16x32_bf16 v[244:247], v[84:87], v[76:79], v[244:247]
    s_cmp_eq_u32 s5, 3
    s_cbranch_scc0 L_ffn_cw_37
    v_mfma_f32_16x16x32_bf16 v[32:35], v[80:83], v[20:23], v[32:35]
    v_mfma_f32_16x16x32_bf16 v[36:39], v[84:87], v[20:23], v[36:39]
L_ffn_cw_37:
    s_waitcnt lgkmcnt(2)
    v_mfma_f32_16x16x32_bf16 v[128:131], v[88:91], v[64:67], v[128:131]
    ds_read_b64_tr_b16 v[80:81], v28 offset:0
    ds_read_b64_tr_b16 v[82:83], v28 offset:3072
    v_mfma_f32_16x16x32_bf16 v[168:171], v[88:91], v[68:71], v[168:171]
    v_mfma_f32_16x16x32_bf16 v[208:211], v[88:91], v[72:75], v[208:211]
    v_mfma_f32_16x16x32_bf16 v[248:251], v[88:91], v[76:79], v[248:251]
    s_waitcnt lgkmcnt(2)
    v_mfma_f32_16x16x32_bf16 v[132:135], v[92:95], v[64:67], v[132:135]
    ds_read_b64_tr_b16 v[84:85], v28 offset:12288
    ds_read_b64_tr_b16 v[86:87], v28 offset:15360
    v_mfma_f32_16x16x32_bf16 v[172:175], v[92:95], v[68:71], v[172:175]
    v_mfma_f32_16x16x32_bf16 v[212:215], v[92:95], v[72:75], v[212:215]
    v_mfma_f32_16x16x32_bf16 v[252:255], v[92:95], v[76:79], v[252:255]
    s_cmp_eq_u32 s5, 0
    s_cbranch_scc0 L_ffn_cw_38
    v_mfma_f32_16x16x32_bf16 v[10:13], v[88:91], v[20:23], v[10:13]
    v_mfma_f32_16x16x32_bf16 v[16:19], v[92:95], v[20:23], v[16:19]
L_ffn_cw_38:
    s_waitcnt vmcnt(5)
    s_barrier
    s_waitcnt lgkmcnt(2)
    v_mfma_f32_16x16x32_bf16 v[96:99], v[80:83], v[48:51], v[96:99]
    ds_read_b64_tr_b16 v[88:89], v29 offset:0
    ds_read_b64_tr_b16 v[90:91], v29 offset:3072
    v_mfma_f32_16x16x32_bf16 v[136:139], v[80:83], v[52:55], v[136:139]
    v_mfma_f32_16x16x32_bf16 v[176:179], v[80:83], v[56:59], v[176:179]
    s_add_u32 m0, s58, 40960
    s_nop 0
    buffer_load_dwordx4 v2, s[36:39], s56 offen sc1 lds
    v_mfma_f32_16x16x32_bf16 v[216:219], v[80:83], v[60:63], v[216:219]
    s_waitcnt lgkmcnt(2)
    v_mfma_f32_16x16x32_bf16 v[100:103], v[84:87], v[48:51], v[100:103]
    ds_read_b64_tr_b16 v[92:93], v29 offset:12288
    ds_read_b64_tr_b16 v[94:95], v29 offset:15360
    v_mfma_f32_16x16x32_bf16 v[140:143], v[84:87], v[52:55], v[140:143]
    v_mfma_f32_16x16x32_bf16 v[180:183], v[84:87], v[56:59], v[180:183]
    s_add_u32 m0, s58, 41984
    s_nop 0
    buffer_load_dwordx4 v3, s[36:39], s56 offen sc1 lds
    s_add_u32 s56, s56, 1024
    v_mfma_f32_16x16x32_bf16 v[220:223], v[84:87], v[60:63], v[220:223]
    s_cmp_eq_u32 s5, 0
    s_cbranch_scc0 L_ffn_cw_39
    v_mfma_f32_16x16x32_bf16 v[32:35], v[80:83], v[20:23], v[32:35]
    v_mfma_f32_16x16x32_bf16 v[36:39], v[84:87], v[20:23], v[36:39]
L_ffn_cw_39:
    s_waitcnt lgkmcnt(2)
    v_mfma_f32_16x16x32_bf16 v[104:107], v[88:91], v[48:51], v[104:107]
    ds_read_b64_tr_b16 v[80:81], v30 offset:0
    ds_read_b64_tr_b16 v[82:83], v30 offset:3072
    v_mfma_f32_16x16x32_bf16 v[144:147], v[88:91], v[52:55], v[144:147]
    ds_read_b128 v[64:67], v9 offset:40960
    v_mfma_f32_16x16x32_bf16 v[184:187], v[88:91], v[56:59], v[184:187]
    s_add_u32 m0, s59, 40960
    s_nop 0
    buffer_load_dwordx4 v4, s[40:43], s57 offen lds
    v_mfma_f32_16x16x32_bf16 v[224:227], v[88:91], v[60:63], v[224:227]
    s_waitcnt lgkmcnt(3)
    v_mfma_f32_16x16x32_bf16 v[108:111], v[92:95], v[48:51], v[108:111]
    ds_read_b64_tr_b16 v[84:85], v30 offset:12288
    ds_read_b64_tr_b16 v[86:87], v30 offset:15360
    v_mfma_f32_16x16x32_bf16 v[148:151], v[92:95], v[52:55], v[148:151]
    ds_read_b128 v[68:71], v9 offset:41984
    v_mfma_f32_16x16x32_bf16 v[188:191], v[92:95], v[56:59], v[188:191]
    s_add_u32 m0, s59, 41984
    s_nop 0
    buffer_load_dwordx4 v5, s[40:43], s57 offen lds
    v_mfma_f32_16x16x32_bf16 v[228:231], v[92:95], v[60:63], v[228:231]
    s_cmp_eq_u32 s5, 1
    s_cbranch_scc0 L_ffn_cw_40
    v_mfma_f32_16x16x32_bf16 v[32:35], v[88:91], v[20:23], v[32:35]
    v_mfma_f32_16x16x32_bf16 v[36:39], v[92:95], v[20:23], v[36:39]
L_ffn_cw_40:
    s_waitcnt lgkmcnt(4)
    v_mfma_f32_16x16x32_bf16 v[112:115], v[80:83], v[48:51], v[112:115]
    ds_read_b64_tr_b16 v[88:89], v31 offset:0
    ds_read_b64_tr_b16 v[90:91], v31 offset:3072
    v_mfma_f32_16x16x32_bf16 v[152:155], v[80:83], v[52:55], v[152:155]
    ds_read_b128 v[72:75], v9 offset:43008
    v_mfma_f32_16x16x32_bf16 v[192:195], v[80:83], v[56:59], v[192:195]
    s_add_u32 m0, s59, 43008
    s_nop 0
    buffer_load_dwordx4 v6, s[40:43], s57 offen lds
    s_add_u32 s57, s57, 294912
    v_mfma_f32_16x16x32_bf16 v[232:235], v[80:83], v[60:63], v[232:235]
    s_waitcnt lgkmcnt(4)
    v_mfma_f32_16x16x32_bf16 v[116:119], v[84:87], v[48:51], v[116:119]
    ds_read_b64_tr_b16 v[92:93], v31 offset:12288
    ds_read_b64_tr_b16 v[94:95], v31 offset:15360
    v_mfma_f32_16x16x32_bf16 v[156:159], v[84:87], v[52:55], v[156:159]
    ds_read_b128 v[76:79], v9 offset:44032
    v_mfma_f32_16x16x32_bf16 v[196:199], v[84:87], v[56:59], v[196:199]
    v_mfma_f32_16x16x32_bf16 v[236:239], v[84:87], v[60:63], v[236:239]
    s_cmp_eq_u32 s5, 2
    s_cbranch_scc0 L_ffn_cw_41
    v_mfma_f32_16x16x32_bf16 v[32:35], v[80:83], v[20:23], v[32:35]
    v_mfma_f32_16x16x32_bf16 v[36:39], v[84:87], v[20:23], v[36:39]
L_ffn_cw_41:
    s_waitcnt lgkmcnt(4)
    v_mfma_f32_16x16x32_bf16 v[120:123], v[88:91], v[48:51], v[120:123]
    ds_read_b64_tr_b16 v[80:81], v28 offset:128
    ds_read_b64_tr_b16 v[82:83], v28 offset:3200
    v_mfma_f32_16x16x32_bf16 v[160:163], v[88:91], v[52:55], v[160:163]
    v_mfma_f32_16x16x32_bf16 v[200:203], v[88:91], v[56:59], v[200:203]
    v_mfma_f32_16x16x32_bf16 v[240:243], v[88:91], v[60:63], v[240:243]
    s_waitcnt lgkmcnt(3)
    v_mfma_f32_16x16x32_bf16 v[124:127], v[92:95], v[48:51], v[124:127]
    ds_read_b64_tr_b16 v[84:85], v28 offset:12416
    ds_read_b64_tr_b16 v[86:87], v28 offset:15488
    v_mfma_f32_16x16x32_bf16 v[164:167], v[92:95], v[52:55], v[164:167]
    v_mfma_f32_16x16x32_bf16 v[204:207], v[92:95], v[56:59], v[204:207]
    v_mfma_f32_16x16x32_bf16 v[244:247], v[92:95], v[60:63], v[244:247]
    s_cmp_eq_u32 s5, 3
    s_cbranch_scc0 L_ffn_cw_42
    v_mfma_f32_16x16x32_bf16 v[32:35], v[88:91], v[20:23], v[32:35]
    v_mfma_f32_16x16x32_bf16 v[36:39], v[92:95], v[20:23], v[36:39]
L_ffn_cw_42:
    s_waitcnt lgkmcnt(2)
    v_mfma_f32_16x16x32_bf16 v[128:131], v[80:83], v[48:51], v[128:131]
    ds_read_b64_tr_b16 v[88:89], v28 offset:40960
    ds_read_b64_tr_b16 v[90:91], v28 offset:44032
    v_mfma_f32_16x16x32_bf16 v[168:171], v[80:83], v[52:55], v[168:171]
    v_mfma_f32_16x16x32_bf16 v[208:211], v[80:83], v[56:59], v[208:211]
    v_mfma_f32_16x16x32_bf16 v[248:251], v[80:83], v[60:63], v[248:251]
    s_waitcnt lgkmcnt(2)
    v_mfma_f32_16x16x32_bf16 v[132:135], v[84:87], v[48:51], v[132:135]
    ds_read_b64_tr_b16 v[92:93], v28 offset:53248
    ds_read_b64_tr_b16 v[94:95], v28 offset:56320
    v_mfma_f32_16x16x32_bf16 v[172:175], v[84:87], v[52:55], v[172:175]
    v_mfma_f32_16x16x32_bf16 v[212:215], v[84:87], v[56:59], v[212:215]
    v_mfma_f32_16x16x32_bf16 v[252:255], v[84:87], v[60:63], v[252:255]
    s_cmp_eq_u32 s5, 0
    s_cbranch_scc0 L_ffn_cw_43
    v_mfma_f32_16x16x32_bf16 v[10:13], v[80:83], v[20:23], v[10:13]
    v_mfma_f32_16x16x32_bf16 v[16:19], v[84:87], v[20:23], v[16:19]
L_ffn_cw_43:
    s_waitcnt vmcnt(5)
    s_barrier
    s_waitcnt lgkmcnt(2)
    v_mfma_f32_16x16x32_bf16 v[96:99], v[88:91], v[64:67], v[96:99]
    ds_read_b64_tr_b16 v[80:81], v29 offset:40960
    ds_read_b64_tr_b16 v[82:83], v29 offset:44032
    v_mfma_f32_16x16x32_bf16 v[136:139], v[88:91], v[68:71], v[136:139]
    v_mfma_f32_16x16x32_bf16 v[176:179], v[88:91], v[72:75], v[176:179]
    s_add_u32 m0, s58, 81920
    s_nop 0
    buffer_load_dwordx4 v2, s[36:39], s56 offen sc1 lds
    v_mfma_f32_16x16x32_bf16 v[216:219], v[88:91], v[76:79], v[216:219]
    s_waitcnt lgkmcnt(2)
    v_mfma_f32_16x16x32_bf16 v[100:103], v[92:95], v[64:67], v[100:103]
    ds_read_b64_tr_b16 v[84:85], v29 offset:53248
    ds_read_b64_tr_b16 v[86:87], v29 offset:56320
    v_mfma_f32_16x16x32_bf16 v[140:143], v[92:95], v[68:71], v[140:143]
    v_mfma_f32_16x16x32_bf16 v[180:183], v[92:95], v[72:75], v[180:183]
    s_add_u32 m0, s58, 82944
    s_nop 0
    buffer_load_dwordx4 v3, s[36:39], s56 offen sc1 lds
    s_add_u32 s56, s56, 1024
    v_mfma_f32_16x16x32_bf16 v[220:223], v[92:95], v[76:79], v[220:223]
    s_cmp_eq_u32 s5, 0
    s_cbranch_scc0 L_ffn_cw_44
    v_mfma_f32_16x16x32_bf16 v[32:35], v[88:91], v[20:23], v[32:35]
    v_mfma_f32_16x16x32_bf16 v[36:39], v[92:95], v[20:23], v[36:39]
L_ffn_cw_44:
    s_waitcnt lgkmcnt(2)
    v_mfma_f32_16x16x32_bf16 v[104:107], v[80:83], v[64:67], v[104:107]
    ds_read_b64_tr_b16 v[88:89], v30 offset:40960
    ds_read_b64_tr_b16 v[90:91], v30 offset:44032
    v_mfma_f32_16x16x32_bf16 v[144:147], v[80:83], v[68:71], v[144:147]
    ds_read_b128 v[48:51], v8 offset:0
    v_mfma_f32_16x16x32_bf16 v[184:187], v[80:83], v[72:75], v[184:187]
    s_add_u32 m0, s59, 81920
    s_nop 0
    buffer_load_dwordx4 v4, s[40:43], s57 offen lds
    v_mfma_f32_16x16x32_bf16 v[224:227], v[80:83], v[76:79], v[224:227]
    s_waitcnt lgkmcnt(3)
    v_mfma_f32_16x16x32_bf16 v[108:111], v[84:87], v[64:67], v[108:111]
    ds_read_b64_tr_b16 v[92:93], v30 offset:53248
    ds_read_b64_tr_b16 v[94:95], v30 offset:56320
    v_mfma_f32_16x16x32_bf16 v[148:151], v[84:87], v[68:71], v[148:151]
    ds_read_b128 v[52:55], v8 offset:1024
    v_mfma_f32_16x16x32_bf16 v[188:191], v[84:87], v[72:75], v[188:191]
    s_add_u32 m0, s59, 82944
    s_nop 0
    buffer_load_dwordx4 v5, s[40:43], s57 offen lds
    v_mfma_f32_16x16x32_bf16 v[228:231], v[84:87], v[76:79], v[228:231]
    s_cmp_eq_u32 s5, 1
    s_cbranch_scc0 L_ffn_cw_45
    v_mfma_f32_16x16x32_bf16 v[32:35], v[80:83], v[20:23], v[32:35]
    v_mfma_f32_16x16x32_bf16 v[36:39], v[84:87], v[20:23], v[36:39]
L_ffn_cw_45:
    s_waitcnt lgkmcnt(4)
    v_mfma_f32_16x16x32_bf16 v[112:115], v[88:91], v[64:67], v[112:115]
    ds_read_b64_tr_b16 v[80:81], v31 offset:40960
    ds_read_b64_tr_b16 v[82:83], v31 offset:44032
    v_mfma_f32_16x16x32_bf16 v[152:155], v[88:91], v[68:71], v[152:155]
    ds_read_b128 v[56:59], v8 offset:2048
    v_mfma_f32_16x16x32_bf16 v[192:195], v[88:91], v[72:75], v[192:195]
    s_add_u32 m0, s59, 83968
    s_nop 0
    buffer_load_dwordx4 v6, s[40:43], s57 offen lds
    s_add_u32 s57, s57, 294912
    v_mfma_f32_16x16x32_bf16 v[232:235], v[88:91], v[76:79], v[232:235]
    s_waitcnt lgkmcnt(4)
    v_mfma_f32_16x16x32_bf16 v[116:119], v[92:95], v[64:67], v[116:119]
    ds_read_b64_tr_b16 v[84:85], v31 offset:53248
    ds_read_b64_tr_b16 v[86:87], v31 offset:56320
    v_mfma_f32_16x16x32_bf16 v[156:159], v[92:95], v[68:71], v[156:159]
    ds_read_b128 v[60:63], v8 offset:3072
    v_mfma_f32_16x16x32_bf16 v[196:199], v[92:95], v[72:75], v[196:199]
    v_mfma_f32_16x16x32_bf16 v[236:239], v[92:95], v[76:79], v[236:239]
    s_cmp_eq_u32 s5, 2
    s_cbranch_scc0 L_ffn_cw_46
    v_mfma_f32_16x16x32_bf16 v[32:35], v[88:91], v[20:23], v[32:35]
    v_mfma_f32_16x16x32_bf16 v[36:39], v[92:95], v[20:23], v[36:39]
L_ffn_cw_46:
    s_waitcnt lgkmcnt(4)
    v_mfma_f32_16x16x32_bf16 v[120:123], v[80:83], v[64:67], v[120:123]
    ds_read_b64_tr_b16 v[88:89], v28 offset:41088
    ds_read_b64_tr_b16 v[90:91], v28 offset:44160
    v_mfma_f32_16x16x32_bf16 v[160:163], v[80:83], v[68:71], v[160:163]
    v_mfma_f32_16x16x32_bf16 v[200:203], v[80:83], v[72:75], v[200:203]
    v_mfma_f32_16x16x32_bf16 v[240:243], v[80:83], v[76:79], v[240:243]
    s_waitcnt lgkmcnt(3)
    v_mfma_f32_16x16x32_bf16 v[124:127], v[84:87], v[64:67], v[124:127]
    ds_read_b64_tr_b16 v[92:93], v28 offset:53376
    ds_read_b64_tr_b16 v[94:95], v28 offset:56448
    v_mfma_f32_16x16x32_bf16 v[164:167], v[84:87], v[68:71], v[164:167]
    v_mfma_f32_16x16x32_bf16 v[204:207], v[84:87], v[72:75], v[204:207]
    v_mfma_f32_16x16x32_bf16 v[244:247], v[84:87], v[76:79], v[244:247]
    s_cmp_eq_u32 s5, 3
    s_cbranch_scc0 L_ffn_cw_47
    v_mfma_f32_16x16x32_bf16 v[32:35], v[80:83], v[20:23], v[32:35]
    v_mfma_f32_16x16x32_bf16 v[36:39], v[84:87], v[20:23], v[36:39]
L_ffn_cw_47:
    s_waitcnt lgkmcnt(2)
    v_mfma_f32_16x16x32_bf16 v[128:131], v[88:91], v[64:67], v[128:131]
    ds_read_b64_tr_b16 v[80:81], v24 offset:0
    ds_read_b64_tr_b16 v[82:83], v24 offset:3072
    v_mfma_f32_16x16x32_bf16 v[168:171], v[88:91], v[68:71], v[168:171]
    v_mfma_f32_16x16x32_bf16 v[208:211], v[88:91], v[72:75], v[208:211]
    v_mfma_f32_16x16x32_bf16 v[248:251], v[88:91], v[76:79], v[248:251]
    s_waitcnt lgkmcnt(2)
    v_mfma_f32_16x16x32_bf16 v[132:135], v[92:95], v[64:67], v[132:135]
    ds_read_b64_tr_b16 v[84:85], v24 offset:12288
    ds_read_b64_tr_b16 v[86:87], v24 offset:15360
    v_mfma_f32_16x16x32_bf16 v[172:175], v[92:95], v[68:71], v[172:175]
    v_mfma_f32_16x16x32_bf16 v[212:215], v[92:95], v[72:75], v[212:215]
    v_mfma_f32_16x16x32_bf16 v[252:255], v[92:95], v[76:79], v[252:255]
    s_cmp_eq_u32 s5, 0
    s_cbranch_scc0 L_ffn_cw_48
    v_mfma_f32_16x16x32_bf16 v[10:13], v[88:91], v[20:23], v[10:13]
    v_mfma_f32_16x16x32_bf16 v[16:19], v[92:95], v[20:23], v[16:19]
L_ffn_cw_48:
    s_waitcnt vmcnt(5)
    s_barrier
    s_waitcnt lgkmcnt(2)
    v_mfma_f32_16x16x32_bf16 v[96:99], v[80:83], v[48:51], v[96:99]
    ds_read_b64_tr_b16 v[88:89], v25 offset:0
    ds_read_b64_tr_b16 v[90:91], v25 offset:3072
    v_mfma_f32_16x16x32_bf16 v[136:139], v[80:83], v[52:55], v[136:139]
    v_mfma_f32_16x16x32_bf16 v[176:179], v[80:83], v[56:59], v[176:179]
    s_add_u32 m0, s58, 122880
    s_nop 0
    buffer_load_dwordx4 v2, s[36:39], s56 offen sc1 lds
    v_mfma_f32_16x16x32_bf16 v[216:219], v[80:83], v[60:63], v[216:219]
    s_waitcnt lgkmcnt(2)
    v_mfma_f32_16x16x32_bf16 v[100:103], v[84:87], v[48:51], v[100:103]
    ds_read_b64_tr_b16 v[92:93], v25 offset:12288
    ds_read_b64_tr_b16 v[94:95], v25 offset:15360
    v_mfma_f32_16x16x32_bf16 v[140:143], v[84:87], v[52:55], v[140:143]
    v_mfma_f32_16x16x32_bf16 v[180:183], v[84:87], v[56:59], v[180:183]
    s_add_u32 m0, s58, 123904
    s_nop 0
    buffer_load_dwordx4 v3, s[36:39], s56 offen sc1 lds
    s_add_u32 s56, s56, 1024
    v_mfma_f32_16x16x32_bf16 v[220:223], v[84:87], v[60:63], v[220:223]
    s_cmp_eq_u32 s5, 0
    s_cbranch_scc0 L_ffn_cw_49
    v_mfma_f32_16x16x32_bf16 v[32:35], v[80:83], v[20:23], v[32:35]
    v_mfma_f32_16x16x32_bf16 v[36:39], v[84:87], v[20:23], v[36:39]
L_ffn_cw_49:
    s_waitcnt lgkmcnt(2)
    v_mfma_f32_16x16x32_bf16 v[104:107], v[88:91], v[48:51], v[104:107]
    ds_read_b64_tr_b16 v[80:81], v26 offset:0
    ds_read_b64_tr_b16 v[82:83], v26 offset:3072
    v_mfma_f32_16x16x32_bf16 v[144:147], v[88:91], v[52:55], v[144:147]
    ds_read_b128 v[64:67], v8 offset:40960
    v_mfma_f32_16x16x32_bf16 v[184:187], v[88:91], v[56:59], v[184:187]
    s_add_u32 m0, s59, 122880
    s_nop 0
    buffer_load_dwordx4 v4, s[40:43], s57 offen lds
    v_mfma_f32_16x16x32_bf16 v[224:227], v[88:91], v[60:63], v[224:227]
    s_waitcnt lgkmcnt(3)
    v_mfma_f32_16x16x32_bf16 v[108:111], v[92:95], v[48:51], v[108:111]
    ds_read_b64_tr_b16 v[84:85], v26 offset:12288
    ds_read_b64_tr_b16 v[86:87], v26 offset:15360
    v_mfma_f32_16x16x32_bf16 v[148:151], v[92:95], v[52:55], v[148:151]
    ds_read_b128 v[68:71], v8 offset:41984
    v_mfma_f32_16x16x32_bf16 v[188:191], v[92:95], v[56:59], v[188:191]
    s_add_u32 m0, s59, 123904
    s_nop 0
    buffer_load_dwordx4 v5, s[40:43], s57 offen lds
    v_mfma_f32_16x16x32_bf16 v[228:231], v[92:95], v[60:63], v[228:231]
    s_cmp_eq_u32 s5, 1
    s_cbranch_scc0 L_ffn_cw_50
    v_mfma_f32_16x16x32_bf16 v[32:35], v[88:91], v[20:23], v[32:35]
    v_mfma_f32_16x16x32_bf16 v[36:39], v[92:95], v[20:23], v[36:39]
L_ffn_cw_50:
    s_waitcnt lgkmcnt(4)
    v_mfma_f32_16x16x32_bf16 v[112:115], v[80:83], v[48:51], v[112:115]
    ds_read_b64_tr_b16 v[88:89], v27 offset:0
    ds_read_b64_tr_b16 v[90:91], v27 offset:3072
    v_mfma_f32_16x16x32_bf16 v[152:155], v[80:83], v[52:55], v[152:155]
    ds_read_b128 v[72:75], v8 offset:43008
    v_mfma_f32_16x16x32_bf16 v[192:195], v[80:83], v[56:59], v[192:195]
    s_add_u32 m0, s59, 124928
    s_nop 0
    buffer_load_dwordx4 v6, s[40:43], s57 offen lds
    s_add_u32 s57, s57, 294912
    v_mfma_f32_16x16x32_bf16 v[232:235], v[80:83], v[60:63], v[232:235]
    s_waitcnt lgkmcnt(4)
    v_mfma_f32_16x16x32_bf16 v[116:119], v[84:87], v[48:51], v[116:119]
    ds_read_b64_tr_b16 v[92:93], v27 offset:12288
    ds_read_b64_tr_b16 v[94:95], v27 offset:15360
    v_mfma_f32_16x16x32_bf16 v[156:159], v[84:87], v[52:55], v[156:159]
    ds_read_b128 v[76:79], v8 offset:44032
    v_mfma_f32_16x16x32_bf16 v[196:199], v[84:87], v[56:59], v[196:199]
    v_mfma_f32_16x16x32_bf16 v[236:239], v[84:87], v[60:63], v[236:239]
    s_cmp_eq_u32 s5, 2
    s_cbranch_scc0 L_ffn_cw_51
    v_mfma_f32_16x16x32_bf16 v[32:35], v[80:83], v[20:23], v[32:35]
    v_mfma_f32_16x16x32_bf16 v[36:39], v[84:87], v[20:23], v[36:39]
L_ffn_cw_51:
    s_waitcnt lgkmcnt(4)
    v_mfma_f32_16x16x32_bf16 v[120:123], v[88:91], v[48:51], v[120:123]
    ds_read_b64_tr_b16 v[80:81], v24 offset:128
    ds_read_b64_tr_b16 v[82:83], v24 offset:3200
    v_mfma_f32_16x16x32_bf16 v[160:163], v[88:91], v[52:55], v[160:163]
    v_mfma_f32_16x16x32_bf16 v[200:203], v[88:91], v[56:59], v[200:203]
    v_mfma_f32_16x16x32_bf16 v[240:243], v[88:91], v[60:63], v[240:243]
    s_waitcnt lgkmcnt(3)
    v_mfma_f32_16x16x32_bf16 v[124:127], v[92:95], v[48:51], v[124:127]
    ds_read_b64_tr_b16 v[84:85], v24 offset:12416
    ds_read_b64_tr_b16 v[86:87], v24 offset:15488
    v_mfma_f32_16x16x32_bf16 v[164:167], v[92:95], v[52:55], v[164:167]
    v_mfma_f32_16x16x32_bf16 v[204:207], v[92:95], v[56:59], v[204:207]
    v_mfma_f32_16x16x32_bf16 v[244:247], v[92:95], v[60:63], v[244:247]
    s_cmp_eq_u32 s5, 3
    s_cbranch_scc0 L_ffn_cw_52
    v_mfma_f32_16x16x32_bf16 v[32:35], v[88:91], v[20:23], v[32:35]
    v_mfma_f32_16x16x32_bf16 v[36:39], v[92:95], v[20:23], v[36:39]
L_ffn_cw_52:
    s_waitcnt lgkmcnt(2)
    v_mfma_f32_16x16x32_bf16 v[128:131], v[80:83], v[48:51], v[128:131]
    ds_read_b64_tr_b16 v[88:89], v24 offset:40960
    ds_read_b64_tr_b16 v[90:91], v24 offset:44032
    v_mfma_f32_16x16x32_bf16 v[168:171], v[80:83], v[52:55], v[168:171]
    v_mfma_f32_16x16x32_bf16 v[208:211], v[80:83], v[56:59], v[208:211]
    v_mfma_f32_16x16x32_bf16 v[248:251], v[80:83], v[60:63], v[248:251]
    s_waitcnt lgkmcnt(2)
    v_mfma_f32_16x16x32_bf16 v[132:135], v[84:87], v[48:51], v[132:135]
    ds_read_b64_tr_b16 v[92:93], v24 offset:53248
    ds_read_b64_tr_b16 v[94:95], v24 offset:56320
    v_mfma_f32_16x16x32_bf16 v[172:175], v[84:87], v[52:55], v[172:175]
    v_mfma_f32_16x16x32_bf16 v[212:215], v[84:87], v[56:59], v[212:215]
    v_mfma_f32_16x16x32_bf16 v[252:255], v[84:87], v[60:63], v[252:255]
    s_cmp_eq_u32 s5, 0
    s_cbranch_scc0 L_ffn_cw_53
    v_mfma_f32_16x16x32_bf16 v[10:13], v[80:83], v[20:23], v[10:13]
    v_mfma_f32_16x16x32_bf16 v[16:19], v[84:87], v[20:23], v[16:19]
L_ffn_cw_53:
    s_waitcnt vmcnt(5)
    s_barrier
    s_waitcnt lgkmcnt(2)
    v_mfma_f32_16x16x32_bf16 v[96:99], v[88:91], v[64:67], v[96:99]
    ds_read_b64_tr_b16 v[80:81], v25 offset:40960
    ds_read_b64_tr_b16 v[82:83], v25 offset:44032
    v_mfma_f32_16x16x32_bf16 v[136:139], v[88:91], v[68:71], v[136:139]
    v_mfma_f32_16x16x32_bf16 v[176:179], v[88:91], v[72:75], v[176:179]
    s_add_u32 m0, s58, 0
    s_nop 0
    buffer_load_dwordx4 v2, s[36:39], s56 offen sc1 lds
    v_mfma_f32_16x16x32_bf16 v[216:219], v[88:91], v[76:79], v[216:219]
    s_waitcnt lgkmcnt(2)
    v_mfma_f32_16x16x32_bf16 v[100:103], v[92:95], v[64:67], v[100:103]
    ds_read_b64_tr_b16 v[84:85], v25 offset:53248
    ds_read_b64_tr_b16 v[86:87], v25 offset:56320
    v_mfma_f32_16x16x32_bf16 v[140:143], v[92:95], v[68:71], v[140:143]
    v_mfma_f32_16x16x32_bf16 v[180:183], v[92:95], v[72:75], v[180:183]
    s_add_u32 m0, s58, 1024
    s_nop 0
    buffer_load_dwordx4 v3, s[36:39], s56 offen sc1 lds
    s_add_u32 s56, s56, 1024
    v_mfma_f32_16x16x32_bf16 v[220:223], v[92:95], v[76:79], v[220:223]
    s_cmp_eq_u32 s5, 0
    s_cbranch_scc0 L_ffn_cw_54
    v_mfma_f32_16x16x32_bf16 v[32:35], v[88:91], v[20:23], v[32:35]
    v_mfma_f32_16x16x32_bf16 v[36:39], v[92:95], v[20:23], v[36:39]
L_ffn_cw_54:
    s_waitcnt lgkmcnt(2)
    v_mfma_f32_16x16x32_bf16 v[104:107], v[80:83], v[64:67], v[104:107]
    ds_read_b64_tr_b16 v[88:89], v26 offset:40960
    ds_read_b64_tr_b16 v[90:91], v26 offset:44032
    v_mfma_f32_16x16x32_bf16 v[144:147], v[80:83], v[68:71], v[144:147]
    ds_read_b128 v[48:51], v9 offset:0
    v_mfma_f32_16x16x32_bf16 v[184:187], v[80:83], v[72:75], v[184:187]
    s_add_u32 m0, s59, 0
    s_nop 0
    buffer_load_dwordx4 v4, s[40:43], s57 offen lds
    v_mfma_f32_16x16x32_bf16 v[224:227], v[80:83], v[76:79], v[224:227]
    s_waitcnt lgkmcnt(3)
    v_mfma_f32_16x16x32_bf16 v[108:111], v[84:87], v[64:67], v[108:111]
    ds_read_b64_tr_b16 v[92:93], v26 offset:53248
    ds_read_b64_tr_b16 v[94:95], v26 offset:56320
    v_mfma_f32_16x16x32_bf16 v[148:151], v[84:87], v[68:71], v[148:151]
    ds_read_b128 v[52:55], v9 offset:1024
    v_mfma_f32_16x16x32_bf16 v[188:191], v[84:87], v[72:75], v[188:191]
    s_add_u32 m0, s59, 1024
    s_nop 0
    buffer_load_dwordx4 v5, s[40:43], s57 offen lds
    v_mfma_f32_16x16x32_bf16 v[228:231], v[84:87], v[76:79], v[228:231]
    s_cmp_eq_u32 s5, 1
    s_cbranch_scc0 L_ffn_cw_55
    v_mfma_f32_16x16x32_bf16 v[32:35], v[80:83], v[20:23], v[32:35]
    v_mfma_f32_16x16x32_bf16 v[36:39], v[84:87], v[20:23], v[36:39]
L_ffn_cw_55:
    s_waitcnt lgkmcnt(4)
    v_mfma_f32_16x16x32_bf16 v[112:115], v[88:91], v[64:67], v[112:115]
    ds_read_b64_tr_b16 v[80:81], v27 offset:40960
    ds_read_b64_tr_b16 v[82:83], v27 offset:44032
    v_mfma_f32_16x16x32_bf16 v[152:155], v[88:91], v[68:71], v[152:155]
    ds_read_b128 v[56:59], v9 offset:2048
    v_mfma_f32_16x16x32_bf16 v[192:195], v[88:91], v[72:75], v[192:195]
    s_add_u32 m0, s59, 2048
    s_nop 0
    buffer_load_dwordx4 v6, s[40:43], s57 offen lds
    s_add_u32 s57, s57, 294912
    v_mfma_f32_16x16x32_bf16 v[232:235], v[88:91], v[76:79], v[232:235]
    s_waitcnt lgkmcnt(4)
    v_mfma_f32_16x16x32_bf16 v[116:119], v[92:95], v[64:67], v[116:119]
    ds_read_b64_tr_b16 v[84:85], v27 offset:53248
    ds_read_b64_tr_b16 v[86:87], v27 offset:56320
    v_mfma_f32_16x16x32_bf16 v[156:159], v[92:95], v[68:71], v[156:159]
    ds_read_b128 v[60:63], v9 offset:3072
    v_mfma_f32_16x16x32_bf16 v[196:199], v[92:95], v[72:75], v[196:199]
    v_mfma_f32_16x16x32_bf16 v[236:239], v[92:95], v[76:79], v[236:239]
    s_cmp_eq_u32 s5, 2
    s_cbranch_scc0 L_ffn_cw_56
    v_mfma_f32_16x16x32_bf16 v[32:35], v[88:91], v[20:23], v[32:35]
    v_mfma_f32_16x16x32_bf16 v[36:39], v[92:95], v[20:23], v[36:39]
L_ffn_cw_56:
    s_waitcnt lgkmcnt(4)
    v_mfma_f32_16x16x32_bf16 v[120:123], v[80:83], v[64:67], v[120:123]
    ds_read_b64_tr_b16 v[88:89], v24 offset:41088
    ds_read_b64_tr_b16 v[90:91], v24 offset:44160
    v_mfma_f32_16x16x32_bf16 v[160:163], v[80:83], v[68:71], v[160:163]
    v_mfma_f32_16x16x32_bf16 v[200:203], v[80:83], v[72:75], v[200:203]
    v_mfma_f32_16x16x32_bf16 v[240:243], v[80:83], v[76:79], v[240:243]
    s_waitcnt lgkmcnt(3)
    v_mfma_f32_16x16x32_bf16 v[124:127], v[84:87], v[64:67], v[124:127]
    ds_read_b64_tr_b16 v[92:93], v24 offset:53376
    ds_read_b64_tr_b16 v[94:95], v24 offset:56448
    v_mfma_f32_16x16x32_bf16 v[164:167], v[84:87], v[68:71], v[164:167]
    v_mfma_f32_16x16x32_bf16 v[204:207], v[84:87], v[72:75], v[204:207]
    v_mfma_f32_16x16x32_bf16 v[244:247], v[84:87], v[76:79], v[244:247]
    s_cmp_eq_u32 s5, 3
    s_cbranch_scc0 L_ffn_cw_57
    v_mfma_f32_16x16x32_bf16 v[32:35], v[80:83], v[20:23], v[32:35]
    v_mfma_f32_16x16x32_bf16 v[36:39], v[84:87], v[20:23], v[36:39]
L_ffn_cw_57:
    s_waitcnt lgkmcnt(2)
    v_mfma_f32_16x16x32_bf16 v[128:131], v[88:91], v[64:67], v[128:131]
    ds_read_b64_tr_b16 v[80:81], v28 offset:0
    ds_read_b64_tr_b16 v[82:83], v28 offset:3072
    v_mfma_f32_16x16x32_bf16 v[168:171], v[88:91], v[68:71], v[168:171]
    v_mfma_f32_16x16x32_bf16 v[208:211], v[88:91], v[72:75], v[208:211]
    v_mfma_f32_16x16x32_bf16 v[248:251], v[88:91], v[76:79], v[248:251]
    s_waitcnt lgkmcnt(2)
    v_mfma_f32_16x16x32_bf16 v[132:135], v[92:95], v[64:67], v[132:135]
    ds_read_b64_tr_b16 v[84:85], v28 offset:12288
    ds_read_b64_tr_b16 v[86:87], v28 offset:15360
    v_mfma_f32_16x16x32_bf16 v[172:175], v[92:95], v[68:71], v[172:175]
    v_mfma_f32_16x16x32_bf16 v[212:215], v[92:95], v[72:75], v[212:215]
    v_mfma_f32_16x16x32_bf16 v[252:255], v[92:95], v[76:79], v[252:255]
    s_cmp_eq_u32 s5, 0
    s_cbranch_scc0 L_ffn_cw_58
    v_mfma_f32_16x16x32_bf16 v[10:13], v[88:91], v[20:23], v[10:13]
    v_mfma_f32_16x16x32_bf16 v[16:19], v[92:95], v[20:23], v[16:19]
L_ffn_cw_58:
    s_waitcnt vmcnt(5)
    s_barrier
    s_waitcnt lgkmcnt(2)
    v_mfma_f32_16x16x32_bf16 v[96:99], v[80:83], v[48:51], v[96:99]
    ds_read_b64_tr_b16 v[88:89], v29 offset:0
    ds_read_b64_tr_b16 v[90:91], v29 offset:3072
    v_mfma_f32_16x16x32_bf16 v[136:139], v[80:83], v[52:55], v[136:139]
    v_mfma_f32_16x16x32_bf16 v[176:179], v[80:83], v[56:59], v[176:179]
    s_add_u32 m0, s58, 40960
    s_nop 0
    buffer_load_dwordx4 v2, s[36:39], s56 offen sc1 lds
    v_mfma_f32_16x16x32_bf16 v[216:219], v[80:83], v[60:63], v[216:219]
    s_waitcnt lgkmcnt(2)
    v_mfma_f32_16x16x32_bf16 v[100:103], v[84:87], v[48:51], v[100:103]
    ds_read_b64_tr_b16 v[92:93], v29 offset:12288
    ds_read_b64_tr_b16 v[94:95], v29 offset:15360
    v_mfma_f32_16x16x32_bf16 v[140:143], v[84:87], v[52:55], v[140:143]
    v_mfma_f32_16x16x32_bf16 v[180:183], v[84:87], v[56:59], v[180:183]
    s_add_u32 m0, s58, 41984
    s_nop 0
    buffer_load_dwordx4 v3, s[36:39], s56 offen sc1 lds
    s_add_u32 s56, s56, 1024
    v_mfma_f32_16x16x32_bf16 v[220:223], v[84:87], v[60:63], v[220:223]
    s_cmp_eq_u32 s5, 0
    s_cbranch_scc0 L_ffn_cw_59
    v_mfma_f32_16x16x32_bf16 v[32:35], v[80:83], v[20:23], v[32:35]
    v_mfma_f32_16x16x32_bf16 v[36:39], v[84:87], v[20:23], v[36:39]
L_ffn_cw_59:
    s_waitcnt lgkmcnt(2)
    v_mfma_f32_16x16x32_bf16 v[104:107], v[88:91], v[48:51], v[104:107]
    ds_read_b64_tr_b16 v[80:81], v30 offset:0
    ds_read_b64_tr_b16 v[82:83], v30 offset:3072
    v_mfma_f32_16x16x32_bf16 v[144:147], v[88:91], v[52:55], v[144:147]
    ds_read_b128 v[64:67], v9 offset:40960
    v_mfma_f32_16x16x32_bf16 v[184:187], v[88:91], v[56:59], v[184:187]
    s_add_u32 m0, s59, 40960
    s_nop 0
    buffer_load_dwordx4 v4, s[40:43], s57 offen lds
    v_mfma_f32_16x16x32_bf16 v[224:227], v[88:91], v[60:63], v[224:227]
    s_waitcnt lgkmcnt(3)
    v_mfma_f32_16x16x32_bf16 v[108:111], v[92:95], v[48:51], v[108:111]
    ds_read_b64_tr_b16 v[84:85], v30 offset:12288
    ds_read_b64_tr_b16 v[86:87], v30 offset:15360
    v_mfma_f32_16x16x32_bf16 v[148:151], v[92:95], v[52:55], v[148:151]
    ds_read_b128 v[68:71], v9 offset:41984
    v_mfma_f32_16x16x32_bf16 v[188:191], v[92:95], v[56:59], v[188:191]
    s_add_u32 m0, s59, 41984
    s_nop 0
    buffer_load_dwordx4 v5, s[40:43], s57 offen lds
    v_mfma_f32_16x16x32_bf16 v[228:231], v[92:95], v[60:63], v[228:231]
    s_cmp_eq_u32 s5, 1
    s_cbranch_scc0 L_ffn_cw_60
    v_mfma_f32_16x16x32_bf16 v[32:35], v[88:91], v[20:23], v[32:35]
    v_mfma_f32_16x16x32_bf16 v[36:39], v[92:95], v[20:23], v[36:39]
L_ffn_cw_60:
    s_waitcnt lgkmcnt(4)
    v_mfma_f32_16x16x32_bf16 v[112:115], v[80:83], v[48:51], v[112:115]
    ds_read_b64_tr_b16 v[88:89], v31 offset:0
    ds_read_b64_tr_b16 v[90:91], v31 offset:3072
    v_mfma_f32_16x16x32_bf16 v[152:155], v[80:83], v[52:55], v[152:155]
    ds_read_b128 v[72:75], v9 offset:43008
    v_mfma_f32_16x16x32_bf16 v[192:195], v[80:83], v[56:59], v[192:195]
    s_add_u32 m0, s59, 43008
    s_nop 0
    buffer_load_dwordx4 v6, s[40:43], s57 offen lds
    s_add_u32 s57, s57, 294912
    v_mfma_f32_16x16x32_bf16 v[232:235], v[80:83], v[60:63], v[232:235]
    s_waitcnt lgkmcnt(4)
    v_mfma_f32_16x16x32_bf16 v[116:119], v[84:87], v[48:51], v[116:119]
    ds_read_b64_tr_b16 v[92:93], v31 offset:12288
    ds_read_b64_tr_b16 v[94:95], v31 offset:15360
    v_mfma_f32_16x16x32_bf16 v[156:159], v[84:87], v[52:55], v[156:159]
    ds_read_b128 v[76:79], v9 offset:44032
    v_mfma_f32_16x16x32_bf16 v[196:199], v[84:87], v[56:59], v[196:199]
    v_mfma_f32_16x16x32_bf16 v[236:239], v[84:87], v[60:63], v[236:239]
    s_cmp_eq_u32 s5, 2
    s_cbranch_scc0 L_ffn_cw_61
    v_mfma_f32_16x16x32_bf16 v[32:35], v[80:83], v[20:23], v[32:35]
    v_mfma_f32_16x16x32_bf16 v[36:39], v[84:87], v[20:23], v[36:39]
L_ffn_cw_61:
    s_waitcnt lgkmcnt(4)
    v_mfma_f32_16x16x32_bf16 v[120:123], v[88:91], v[48:51], v[120:123]
    ds_read_b64_tr_b16 v[80:81], v28 offset:128
    ds_read_b64_tr_b16 v[82:83], v28 offset:3200
    v_mfma_f32_16x16x32_bf16 v[160:163], v[88:91], v[52:55], v[160:163]
    v_mfma_f32_16x16x32_bf16 v[200:203], v[88:91], v[56:59], v[200:203]
    v_mfma_f32_16x16x32_bf16 v[240:243], v[88:91], v[60:63], v[240:243]
    s_waitcnt lgkmcnt(3)
    v_mfma_f32_16x16x32_bf16 v[124:127], v[92:95], v[48:51], v[124:127]
    ds_read_b64_tr_b16 v[84:85], v28 offset:12416
    ds_read_b64_tr_b16 v[86:87], v28 offset:15488
    v_mfma_f32_16x16x32_bf16 v[164:167], v[92:95], v[52:55], v[164:167]
    v_mfma_f32_16x16x32_bf16 v[204:207], v[92:95], v[56:59], v[204:207]
    v_mfma_f32_16x16x32_bf16 v[244:247], v[92:95], v[60:63], v[244:247]
    s_cmp_eq_u32 s5, 3
    s_cbranch_scc0 L_ffn_cw_62
    v_mfma_f32_16x16x32_bf16 v[32:35], v[88:91], v[20:23], v[32:35]
    v_mfma_f32_16x16x32_bf16 v[36:39], v[92:95], v[20:23], v[36:39]
L_ffn_cw_62:
    s_waitcnt lgkmcnt(2)
    v_mfma_f32_16x16x32_bf16 v[128:131], v[80:83], v[48:51], v[128:131]
    ds_read_b64_tr_b16 v[88:89], v28 offset:40960
    ds_read_b64_tr_b16 v[90:91], v28 offset:44032
    v_mfma_f32_16x16x32_bf16 v[168:171], v[80:83], v[52:55], v[168:171]
    v_mfma_f32_16x16x32_bf16 v[208:211], v[80:83], v[56:59], v[208:211]
    v_mfma_f32_16x16x32_bf16 v[248:251], v[80:83], v[60:63], v[248:251]
    s_waitcnt lgkmcnt(2)
    v_mfma_f32_16x16x32_bf16 v[132:135], v[84:87], v[48:51], v[132:135]
    ds_read_b64_tr_b16 v[92:93], v28 offset:53248
    ds_read_b64_tr_b16 v[94:95], v28 offset:56320
    v_mfma_f32_16x16x32_bf16 v[172:175], v[84:87], v[52:55], v[172:175]
    v_mfma_f32_16x16x32_bf16 v[212:215], v[84:87], v[56:59], v[212:215]
    v_mfma_f32_16x16x32_bf16 v[252:255], v[84:87], v[60:63], v[252:255]
    s_cmp_eq_u32 s5, 0
    s_cbranch_scc0 L_ffn_cw_63
    v_mfma_f32_16x16x32_bf16 v[10:13], v[80:83], v[20:23], v[10:13]
    v_mfma_f32_16x16x32_bf16 v[16:19], v[84:87], v[20:23], v[16:19]
L_ffn_cw_63:
    s_waitcnt vmcnt(5)
    s_barrier
    s_waitcnt lgkmcnt(2)
    v_mfma_f32_16x16x32_bf16 v[96:99], v[88:91], v[64:67], v[96:99]
    ds_read_b64_tr_b16 v[80:81], v29 offset:40960
    ds_read_b64_tr_b16 v[82:83], v29 offset:44032
    v_mfma_f32_16x16x32_bf16 v[136:139], v[88:91], v[68:71], v[136:139]
    v_mfma_f32_16x16x32_bf16 v[176:179], v[88:91], v[72:75], v[176:179]
    s_add_u32 m0, s58, 81920
    s_nop 0
    buffer_load_dwordx4 v2, s[36:39], s56 offen sc1 lds
    v_mfma_f32_16x16x32_bf16 v[216:219], v[88:91], v[76:79], v[216:219]
    s_waitcnt lgkmcnt(2)
    v_mfma_f32_16x16x32_bf16 v[100:103], v[92:95], v[64:67], v[100:103]
    ds_read_b64_tr_b16 v[84:85], v29 offset:53248
    ds_read_b64_tr_b16 v[86:87], v29 offset:56320
    v_mfma_f32_16x16x32_bf16 v[140:143], v[92:95], v[68:71], v[140:143]
    v_mfma_f32_16x16x32_bf16 v[180:183], v[92:95], v[72:75], v[180:183]
    s_add_u32 m0, s58, 82944
    s_nop 0
    buffer_load_dwordx4 v3, s[36:39], s56 offen sc1 lds
    s_add_u32 s56, s56, 1024
    v_mfma_f32_16x16x32_bf16 v[220:223], v[92:95], v[76:79], v[220:223]
    s_cmp_eq_u32 s5, 0
    s_cbranch_scc0 L_ffn_cw_64
    v_mfma_f32_16x16x32_bf16 v[32:35], v[88:91], v[20:23], v[32:35]
    v_mfma_f32_16x16x32_bf16 v[36:39], v[92:95], v[20:23], v[36:39]
L_ffn_cw_64:
    s_waitcnt lgkmcnt(2)
    v_mfma_f32_16x16x32_bf16 v[104:107], v[80:83], v[64:67], v[104:107]
    ds_read_b64_tr_b16 v[88:89], v30 offset:40960
    ds_read_b64_tr_b16 v[90:91], v30 offset:44032
    v_mfma_f32_16x16x32_bf16 v[144:147], v[80:83], v[68:71], v[144:147]
    ds_read_b128 v[48:51], v8 offset:0
    v_mfma_f32_16x16x32_bf16 v[184:187], v[80:83], v[72:75], v[184:187]
    s_add_u32 m0, s59, 81920
    s_nop 0
    buffer_load_dwordx4 v4, s[40:43], s57 offen lds
    v_mfma_f32_16x16x32_bf16 v[224:227], v[80:83], v[76:79], v[224:227]
    s_waitcnt lgkmcnt(3)
    v_mfma_f32_16x16x32_bf16 v[108:111], v[84:87], v[64:67], v[108:111]
    ds_read_b64_tr_b16 v[92:93], v30 offset:53248
    ds_read_b64_tr_b16 v[94:95], v30 offset:56320
    v_mfma_f32_16x16x32_bf16 v[148:151], v[84:87], v[68:71], v[148:151]
    ds_read_b128 v[52:55], v8 offset:1024
    v_mfma_f32_16x16x32_bf16 v[188:191], v[84:87], v[72:75], v[188:191]
    s_add_u32 m0, s59, 82944
    s_nop 0
    buffer_load_dwordx4 v5, s[40:43], s57 offen lds
    v_mfma_f32_16x16x32_bf16 v[228:231], v[84:87], v[76:79], v[228:231]
    s_cmp_eq_u32 s5, 1
    s_cbranch_scc0 L_ffn_cw_65
    v_mfma_f32_16x16x32_bf16 v[32:35], v[80:83], v[20:23], v[32:35]
    v_mfma_f32_16x16x32_bf16 v[36:39], v[84:87], v[20:23], v[36:39]
L_ffn_cw_65:
    s_waitcnt lgkmcnt(4)
    v_mfma_f32_16x16x32_bf16 v[112:115], v[88:91], v[64:67], v[112:115]
    ds_read_b64_tr_b16 v[80:81], v31 offset:40960
    ds_read_b64_tr_b16 v[82:83], v31 offset:44032
    v_mfma_f32_16x16x32_bf16 v[152:155], v[88:91], v[68:71], v[152:155]
    ds_read_b128 v[56:59], v8 offset:2048
    v_mfma_f32_16x16x32_bf16 v[192:195], v[88:91], v[72:75], v[192:195]
    s_add_u32 m0, s59, 83968
    s_nop 0
    buffer_load_dwordx4 v6, s[40:43], s57 offen lds
    s_add_u32 s57, s57, 294912
    v_mfma_f32_16x16x32_bf16 v[232:235], v[88:91], v[76:79], v[232:235]
    s_waitcnt lgkmcnt(4)
    v_mfma_f32_16x16x32_bf16 v[116:119], v[92:95], v[64:67], v[116:119]
    ds_read_b64_tr_b16 v[84:85], v31 offset:53248
    ds_read_b64_tr_b16 v[86:87], v31 offset:56320
    v_mfma_f32_16x16x32_bf16 v[156:159], v[92:95], v[68:71], v[156:159]
    ds_read_b128 v[60:63], v8 offset:3072
    v_mfma_f32_16x16x32_bf16 v[196:199], v[92:95], v[72:75], v[196:199]
    v_mfma_f32_16x16x32_bf16 v[236:239], v[92:95], v[76:79], v[236:239]
    s_cmp_eq_u32 s5, 2
    s_cbranch_scc0 L_ffn_cw_66
    v_mfma_f32_16x16x32_bf16 v[32:35], v[88:91], v[20:23], v[32:35]
    v_mfma_f32_16x16x32_bf16 v[36:39], v[92:95], v[20:23], v[36:39]
L_ffn_cw_66:
    s_waitcnt lgkmcnt(4)
    v_mfma_f32_16x16x32_bf16 v[120:123], v[80:83], v[64:67], v[120:123]
    ds_read_b64_tr_b16 v[88:89], v28 offset:41088
    ds_read_b64_tr_b16 v[90:91], v28 offset:44160
    v_mfma_f32_16x16x32_bf16 v[160:163], v[80:83], v[68:71], v[160:163]
    v_mfma_f32_16x16x32_bf16 v[200:203], v[80:83], v[72:75], v[200:203]
    v_mfma_f32_16x16x32_bf16 v[240:243], v[80:83], v[76:79], v[240:243]
    s_waitcnt lgkmcnt(3)
    v_mfma_f32_16x16x32_bf16 v[124:127], v[84:87], v[64:67], v[124:127]
    ds_read_b64_tr_b16 v[92:93], v28 offset:53376
    ds_read_b64_tr_b16 v[94:95], v28 offset:56448
    v_mfma_f32_16x16x32_bf16 v[164:167], v[84:87], v[68:71], v[164:167]
    v_mfma_f32_16x16x32_bf16 v[204:207], v[84:87], v[72:75], v[204:207]
    v_mfma_f32_16x16x32_bf16 v[244:247], v[84:87], v[76:79], v[244:247]
    s_cmp_eq_u32 s5, 3
    s_cbranch_scc0 L_ffn_cw_67
    v_mfma_f32_16x16x32_bf16 v[32:35], v[80:83], v[20:23], v[32:35]
    v_mfma_f32_16x16x32_bf16 v[36:39], v[84:87], v[20:23], v[36:39]
L_ffn_cw_67:
    s_waitcnt lgkmcnt(2)
    v_mfma_f32_16x16x32_bf16 v[128:131], v[88:91], v[64:67], v[128:131]
    ds_read_b64_tr_b16 v[80:81], v24 offset:0
    ds_read_b64_tr_b16 v[82:83], v24 offset:3072
    v_mfma_f32_16x16x32_bf16 v[168:171], v[88:91], v[68:71], v[168:171]
    v_mfma_f32_16x16x32_bf16 v[208:211], v[88:91], v[72:75], v[208:211]
    v_mfma_f32_16x16x32_bf16 v[248:251], v[88:91], v[76:79], v[248:251]
    s_waitcnt lgkmcnt(2)
    v_mfma_f32_16x16x32_bf16 v[132:135], v[92:95], v[64:67], v[132:135]
    ds_read_b64_tr_b16 v[84:85], v24 offset:12288
    ds_read_b64_tr_b16 v[86:87], v24 offset:15360
    v_mfma_f32_16x16x32_bf16 v[172:175], v[92:95], v[68:71], v[172:175]
    v_mfma_f32_16x16x32_bf16 v[212:215], v[92:95], v[72:75], v[212:215]
    v_mfma_f32_16x16x32_bf16 v[252:255], v[92:95], v[76:79], v[252:255]
    s_cmp_eq_u32 s5, 0
    s_cbranch_scc0 L_ffn_cw_68
    v_mfma_f32_16x16x32_bf16 v[10:13], v[88:91], v[20:23], v[10:13]
    v_mfma_f32_16x16x32_bf16 v[16:19], v[92:95], v[20:23], v[16:19]
L_ffn_cw_68:
    s_waitcnt vmcnt(5)
    s_barrier
    s_waitcnt lgkmcnt(2)
    v_mfma_f32_16x16x32_bf16 v[96:99], v[80:83], v[48:51], v[96:99]
    ds_read_b64_tr_b16 v[88:89], v25 offset:0
    ds_read_b64_tr_b16 v[90:91], v25 offset:3072
    v_mfma_f32_16x16x32_bf16 v[136:139], v[80:83], v[52:55], v[136:139]
    v_mfma_f32_16x16x32_bf16 v[176:179], v[80:83], v[56:59], v[176:179]
    s_add_u32 m0, s58, 122880
    s_nop 0
    buffer_load_dwordx4 v2, s[36:39], s56 offen sc1 lds
    v_mfma_f32_16x16x32_bf16 v[216:219], v[80:83], v[60:63], v[216:219]
    s_waitcnt lgkmcnt(2)
    v_mfma_f32_16x16x32_bf16 v[100:103], v[84:87], v[48:51], v[100:103]
    ds_read_b64_tr_b16 v[92:93], v25 offset:12288
    ds_read_b64_tr_b16 v[94:95], v25 offset:15360
    v_mfma_f32_16x16x32_bf16 v[140:143], v[84:87], v[52:55], v[140:143]
    v_mfma_f32_16x16x32_bf16 v[180:183], v[84:87], v[56:59], v[180:183]
    s_add_u32 m0, s58, 123904
    s_nop 0
    buffer_load_dwordx4 v3, s[36:39], s56 offen sc1 lds
    s_add_u32 s56, s56, 1024
    v_mfma_f32_16x16x32_bf16 v[220:223], v[84:87], v[60:63], v[220:223]
    s_cmp_eq_u32 s5, 0
    s_cbranch_scc0 L_ffn_cw_69
    v_mfma_f32_16x16x32_bf16 v[32:35], v[80:83], v[20:23], v[32:35]
    v_mfma_f32_16x16x32_bf16 v[36:39], v[84:87], v[20:23], v[36:39]
L_ffn_cw_69:
    s_waitcnt lgkmcnt(2)
    v_mfma_f32_16x16x32_bf16 v[104:107], v[88:91], v[48:51], v[104:107]
    ds_read_b64_tr_b16 v[80:81], v26 offset:0
    ds_read_b64_tr_b16 v[82:83], v26 offset:3072
    v_mfma_f32_16x16x32_bf16 v[144:147], v[88:91], v[52:55], v[144:147]
    ds_read_b128 v[64:67], v8 offset:40960
    v_mfma_f32_16x16x32_bf16 v[184:187], v[88:91], v[56:59], v[184:187]
    s_add_u32 m0, s59, 122880
    s_nop 0
    buffer_load_dwordx4 v4, s[40:43], s57 offen lds
    v_mfma_f32_16x16x32_bf16 v[224:227], v[88:91], v[60:63], v[224:227]
    s_waitcnt lgkmcnt(3)
    v_mfma_f32_16x16x32_bf16 v[108:111], v[92:95], v[48:51], v[108:111]
    ds_read_b64_tr_b16 v[84:85], v26 offset:12288
    ds_read_b64_tr_b16 v[86:87], v26 offset:15360
    v_mfma_f32_16x16x32_bf16 v[148:151], v[92:95], v[52:55], v[148:151]
    ds_read_b128 v[68:71], v8 offset:41984
    v_mfma_f32_16x16x32_bf16 v[188:191], v[92:95], v[56:59], v[188:191]
    s_add_u32 m0, s59, 123904
    s_nop 0
    buffer_load_dwordx4 v5, s[40:43], s57 offen lds
    v_mfma_f32_16x16x32_bf16 v[228:231], v[92:95], v[60:63], v[228:231]
    s_cmp_eq_u32 s5, 1
    s_cbranch_scc0 L_ffn_cw_70
    v_mfma_f32_16x16x32_bf16 v[32:35], v[88:91], v[20:23], v[32:35]
    v_mfma_f32_16x16x32_bf16 v[36:39], v[92:95], v[20:23], v[36:39]
L_ffn_cw_70:
    s_waitcnt lgkmcnt(4)
    v_mfma_f32_16x16x32_bf16 v[112:115], v[80:83], v[48:51], v[112:115]
    ds_read_b64_tr_b16 v[88:89], v27 offset:0
    ds_read_b64_tr_b16 v[90:91], v27 offset:3072
    v_mfma_f32_16x16x32_bf16 v[152:155], v[80:83], v[52:55], v[152:155]
    ds_read_b128 v[72:75], v8 offset:43008
    v_mfma_f32_16x16x32_bf16 v[192:195], v[80:83], v[56:59], v[192:195]
    s_add_u32 m0, s59, 124928
    s_nop 0
    buffer_load_dwordx4 v6, s[40:43], s57 offen lds
    s_add_u32 s57, s57, 294912
    v_mfma_f32_16x16x32_bf16 v[232:235], v[80:83], v[60:63], v[232:235]
    s_waitcnt lgkmcnt(4)
    v_mfma_f32_16x16x32_bf16 v[116:119], v[84:87], v[48:51], v[116:119]
    ds_read_b64_tr_b16 v[92:93], v27 offset:12288
    ds_read_b64_tr_b16 v[94:95], v27 offset:15360
    v_mfma_f32_16x16x32_bf16 v[156:159], v[84:87], v[52:55], v[156:159]
    ds_read_b128 v[76:79], v8 offset:44032
    v_mfma_f32_16x16x32_bf16 v[196:199], v[84:87], v[56:59], v[196:199]
    v_mfma_f32_16x16x32_bf16 v[236:239], v[84:87], v[60:63], v[236:239]
    s_cmp_eq_u32 s5, 2
    s_cbranch_scc0 L_ffn_cw_71
    v_mfma_f32_16x16x32_bf16 v[32:35], v[80:83], v[20:23], v[32:35]
    v_mfma_f32_16x16x32_bf16 v[36:39], v[84:87], v[20:23], v[36:39]
L_ffn_cw_71:
    s_waitcnt lgkmcnt(4)
    v_mfma_f32_16x16x32_bf16 v[120:123], v[88:91], v[48:51], v[120:123]
    ds_read_b64_tr_b16 v[80:81], v24 offset:128
    ds_read_b64_tr_b16 v[82:83], v24 offset:3200
    v_mfma_f32_16x16x32_bf16 v[160:163], v[88:91], v[52:55], v[160:163]
    v_mfma_f32_16x16x32_bf16 v[200:203], v[88:91], v[56:59], v[200:203]
    v_mfma_f32_16x16x32_bf16 v[240:243], v[88:91], v[60:63], v[240:243]
    s_waitcnt lgkmcnt(3)
    v_mfma_f32_16x16x32_bf16 v[124:127], v[92:95], v[48:51], v[124:127]
    ds_read_b64_tr_b16 v[84:85], v24 offset:12416
    ds_read_b64_tr_b16 v[86:87], v24 offset:15488
    v_mfma_f32_16x16x32_bf16 v[164:167], v[92:95], v[52:55], v[164:167]
    v_mfma_f32_16x16x32_bf16 v[204:207], v[92:95], v[56:59], v[204:207]
    v_mfma_f32_16x16x32_bf16 v[244:247], v[92:95], v[60:63], v[244:247]
    s_cmp_eq_u32 s5, 3
    s_cbranch_scc0 L_ffn_cw_72
    v_mfma_f32_16x16x32_bf16 v[32:35], v[88:91], v[20:23], v[32:35]
    v_mfma_f32_16x16x32_bf16 v[36:39], v[92:95], v[20:23], v[36:39]
L_ffn_cw_72:
    s_waitcnt lgkmcnt(2)
    v_mfma_f32_16x16x32_bf16 v[128:131], v[80:83], v[48:51], v[128:131]
    ds_read_b64_tr_b16 v[88:89], v24 offset:40960
    ds_read_b64_tr_b16 v[90:91], v24 offset:44032
    v_mfma_f32_16x16x32_bf16 v[168:171], v[80:83], v[52:55], v[168:171]
    v_mfma_f32_16x16x32_bf16 v[208:211], v[80:83], v[56:59], v[208:211]
    v_mfma_f32_16x16x32_bf16 v[248:251], v[80:83], v[60:63], v[248:251]
    s_waitcnt lgkmcnt(2)
    v_mfma_f32_16x16x32_bf16 v[132:135], v[84:87], v[48:51], v[132:135]
    ds_read_b64_tr_b16 v[92:93], v24 offset:53248
    ds_read_b64_tr_b16 v[94:95], v24 offset:56320
    v_mfma_f32_16x16x32_bf16 v[172:175], v[84:87], v[52:55], v[172:175]
    v_mfma_f32_16x16x32_bf16 v[212:215], v[84:87], v[56:59], v[212:215]
    v_mfma_f32_16x16x32_bf16 v[252:255], v[84:87], v[60:63], v[252:255]
    s_cmp_eq_u32 s5, 0
    s_cbranch_scc0 L_ffn_cw_73
    v_mfma_f32_16x16x32_bf16 v[10:13], v[80:83], v[20:23], v[10:13]
    v_mfma_f32_16x16x32_bf16 v[16:19], v[84:87], v[20:23], v[16:19]
L_ffn_cw_73:
    s_waitcnt vmcnt(5)
    s_barrier
    s_waitcnt lgkmcnt(2)
    v_mfma_f32_16x16x32_bf16 v[96:99], v[88:91], v[64:67], v[96:99]
    ds_read_b64_tr_b16 v[80:81], v25 offset:40960
    ds_read_b64_tr_b16 v[82:83], v25 offset:44032
    v_mfma_f32_16x16x32_bf16 v[136:139], v[88:91], v[68:71], v[136:139]
    v_mfma_f32_16x16x32_bf16 v[176:179], v[88:91], v[72:75], v[176:179]
    s_add_u32 m0, s58, 0
    s_nop 0
    buffer_load_dwordx4 v2, s[36:39], s56 offen sc1 lds
    v_mfma_f32_16x16x32_bf16 v[216:219], v[88:91], v[76:79], v[216:219]
    s_waitcnt lgkmcnt(2)
    v_mfma_f32_16x16x32_bf16 v[100:103], v[92:95], v[64:67], v[100:103]
    ds_read_b64_tr_b16 v[84:85], v25 offset:53248
    ds_read_b64_tr_b16 v[86:87], v25 offset:56320
    v_mfma_f32_16x16x32_bf16 v[140:143], v[92:95], v[68:71], v[140:143]
    v_mfma_f32_16x16x32_bf16 v[180:183], v[92:95], v[72:75], v[180:183]
    s_add_u32 m0, s58, 1024
    s_nop 0
    buffer_load_dwordx4 v3, s[36:39], s56 offen sc1 lds
    s_add_u32 s56, s56, 1024
    v_mfma_f32_16x16x32_bf16 v[220:223], v[92:95], v[76:79], v[220:223]
    s_cmp_eq_u32 s5, 0
    s_cbranch_scc0 L_ffn_cw_74
    v_mfma_f32_16x16x32_bf16 v[32:35], v[88:91], v[20:23], v[32:35]
    v_mfma_f32_16x16x32_bf16 v[36:39], v[92:95], v[20:23], v[36:39]
L_ffn_cw_74:
    s_waitcnt lgkmcnt(2)
    v_mfma_f32_16x16x32_bf16 v[104:107], v[80:83], v[64:67], v[104:107]
    ds_read_b64_tr_b16 v[88:89], v26 offset:40960
    ds_read_b64_tr_b16 v[90:91], v26 offset:44032
    v_mfma_f32_16x16x32_bf16 v[144:147], v[80:83], v[68:71], v[144:147]
    ds_read_b128 v[48:51], v9 offset:0
    v_mfma_f32_16x16x32_bf16 v[184:187], v[80:83], v[72:75], v[184:187]
    s_add_u32 m0, s59, 0
    s_nop 0
    buffer_load_dwordx4 v4, s[40:43], s57 offen lds
    v_mfma_f32_16x16x32_bf16 v[224:227], v[80:83], v[76:79], v[224:227]
    s_waitcnt lgkmcnt(3)
    v_mfma_f32_16x16x32_bf16 v[108:111], v[84:87], v[64:67], v[108:111]
    ds_read_b64_tr_b16 v[92:93], v26 offset:53248
    ds_read_b64_tr_b16 v[94:95], v26 offset:56320
    v_mfma_f32_16x16x32_bf16 v[148:151], v[84:87], v[68:71], v[148:151]
    ds_read_b128 v[52:55], v9 offset:1024
    v_mfma_f32_16x16x32_bf16 v[188:191], v[84:87], v[72:75], v[188:191]
    s_add_u32 m0, s59, 1024
    s_nop 0
    buffer_load_dwordx4 v5, s[40:43], s57 offen lds
    v_mfma_f32_16x16x32_bf16 v[228:231], v[84:87], v[76:79], v[228:231]
    s_cmp_eq_u32 s5, 1
    s_cbranch_scc0 L_ffn_cw_75
    v_mfma_f32_16x16x32_bf16 v[32:35], v[80:83], v[20:23], v[32:35]
    v_mfma_f32_16x16x32_bf16 v[36:39], v[84:87], v[20:23], v[36:39]
L_ffn_cw_75:
    s_waitcnt lgkmcnt(4)
    v_mfma_f32_16x16x32_bf16 v[112:115], v[88:91], v[64:67], v[112:115]
    ds_read_b64_tr_b16 v[80:81], v27 offset:40960
    ds_read_b64_tr_b16 v[82:83], v27 offset:44032
    v_mfma_f32_16x16x32_bf16 v[152:155], v[88:91], v[68:71], v[152:155]
    ds_read_b128 v[56:59], v9 offset:2048
    v_mfma_f32_16x16x32_bf16 v[192:195], v[88:91], v[72:75], v[192:195]
    s_add_u32 m0, s59, 2048
    s_nop 0
    buffer_load_dwordx4 v6, s[40:43], s57 offen lds
    s_add_u32 s57, s57, 294912
    v_mfma_f32_16x16x32_bf16 v[232:235], v[88:91], v[76:79], v[232:235]
    s_waitcnt lgkmcnt(4)
    v_mfma_f32_16x16x32_bf16 v[116:119], v[92:95], v[64:67], v[116:119]
    ds_read_b64_tr_b16 v[84:85], v27 offset:53248
    ds_read_b64_tr_b16 v[86:87], v27 offset:56320
    v_mfma_f32_16x16x32_bf16 v[156:159], v[92:95], v[68:71], v[156:159]
    ds_read_b128 v[60:63], v9 offset:3072
    v_mfma_f32_16x16x32_bf16 v[196:199], v[92:95], v[72:75], v[196:199]
    v_mfma_f32_16x16x32_bf16 v[236:239], v[92:95], v[76:79], v[236:239]
    s_cmp_eq_u32 s5, 2
    s_cbranch_scc0 L_ffn_cw_76
    v_mfma_f32_16x16x32_bf16 v[32:35], v[88:91], v[20:23], v[32:35]
    v_mfma_f32_16x16x32_bf16 v[36:39], v[92:95], v[20:23], v[36:39]
L_ffn_cw_76:
    s_waitcnt lgkmcnt(4)
    v_mfma_f32_16x16x32_bf16 v[120:123], v[80:83], v[64:67], v[120:123]
    ds_read_b64_tr_b16 v[88:89], v24 offset:41088
    ds_read_b64_tr_b16 v[90:91], v24 offset:44160
    v_mfma_f32_16x16x32_bf16 v[160:163], v[80:83], v[68:71], v[160:163]
    v_mfma_f32_16x16x32_bf16 v[200:203], v[80:83], v[72:75], v[200:203]
    v_mfma_f32_16x16x32_bf16 v[240:243], v[80:83], v[76:79], v[240:243]
    s_waitcnt lgkmcnt(3)
    v_mfma_f32_16x16x32_bf16 v[124:127], v[84:87], v[64:67], v[124:127]
    ds_read_b64_tr_b16 v[92:93], v24 offset:53376
    ds_read_b64_tr_b16 v[94:95], v24 offset:56448
    v_mfma_f32_16x16x32_bf16 v[164:167], v[84:87], v[68:71], v[164:167]
    v_mfma_f32_16x16x32_bf16 v[204:207], v[84:87], v[72:75], v[204:207]
    v_mfma_f32_16x16x32_bf16 v[244:247], v[84:87], v[76:79], v[244:247]
    s_cmp_eq_u32 s5, 3
    s_cbranch_scc0 L_ffn_cw_77
    v_mfma_f32_16x16x32_bf16 v[32:35], v[80:83], v[20:23], v[32:35]
    v_mfma_f32_16x16x32_bf16 v[36:39], v[84:87], v[20:23], v[36:39]
L_ffn_cw_77:
    s_waitcnt lgkmcnt(2)
    v_mfma_f32_16x16x32_bf16 v[128:131], v[88:91], v[64:67], v[128:131]
    ds_read_b64_tr_b16 v[80:81], v28 offset:0
    ds_read_b64_tr_b16 v[82:83], v28 offset:3072
    v_mfma_f32_16x16x32_bf16 v[168:171], v[88:91], v[68:71], v[168:171]
    v_mfma_f32_16x16x32_bf16 v[208:211], v[88:91], v[72:75], v[208:211]
    v_mfma_f32_16x16x32_bf16 v[248:251], v[88:91], v[76:79], v[248:251]
    s_waitcnt lgkmcnt(2)
    v_mfma_f32_16x16x32_bf16 v[132:135], v[92:95], v[64:67], v[132:135]
    ds_read_b64_tr_b16 v[84:85], v28 offset:12288
    ds_read_b64_tr_b16 v[86:87], v28 offset:15360
    v_mfma_f32_16x16x32_bf16 v[172:175], v[92:95], v[68:71], v[172:175]
    v_mfma_f32_16x16x32_bf16 v[212:215], v[92:95], v[72:75], v[212:215]
    v_mfma_f32_16x16x32_bf16 v[252:255], v[92:95], v[76:79], v[252:255]
    s_cmp_eq_u32 s5, 0
    s_cbranch_scc0 L_ffn_cw_78
    v_mfma_f32_16x16x32_bf16 v[10:13], v[88:91], v[20:23], v[10:13]
    v_mfma_f32_16x16x32_bf16 v[16:19], v[92:95], v[20:23], v[16:19]
L_ffn_cw_78:
    s_waitcnt vmcnt(5)
    s_barrier
    s_waitcnt lgkmcnt(2)
    v_mfma_f32_16x16x32_bf16 v[96:99], v[80:83], v[48:51], v[96:99]
    ds_read_b64_tr_b16 v[88:89], v29 offset:0
    ds_read_b64_tr_b16 v[90:91], v29 offset:3072
    v_mfma_f32_16x16x32_bf16 v[136:139], v[80:83], v[52:55], v[136:139]
    v_mfma_f32_16x16x32_bf16 v[176:179], v[80:83], v[56:59], v[176:179]
    s_add_u32 m0, s58, 40960
    s_nop 0
    buffer_load_dwordx4 v2, s[36:39], s56 offen sc1 lds
    v_mfma_f32_16x16x32_bf16 v[216:219], v[80:83], v[60:63], v[216:219]
    s_waitcnt lgkmcnt(2)
    v_mfma_f32_16x16x32_bf16 v[100:103], v[84:87], v[48:51], v[100:103]
    ds_read_b64_tr_b16 v[92:93], v29 offset:12288
    ds_read_b64_tr_b16 v[94:95], v29 offset:15360
    v_mfma_f32_16x16x32_bf16 v[140:143], v[84:87], v[52:55], v[140:143]
    v_mfma_f32_16x16x32_bf16 v[180:183], v[84:87], v[56:59], v[180:183]
    s_add_u32 m0, s58, 41984
    s_nop 0
    buffer_load_dwordx4 v3, s[36:39], s56 offen sc1 lds
    s_add_u32 s56, s56, 1024
    v_mfma_f32_16x16x32_bf16 v[220:223], v[84:87], v[60:63], v[220:223]
    s_cmp_eq_u32 s5, 0
    s_cbranch_scc0 L_ffn_cw_79
    v_mfma_f32_16x16x32_bf16 v[32:35], v[80:83], v[20:23], v[32:35]
    v_mfma_f32_16x16x32_bf16 v[36:39], v[84:87], v[20:23], v[36:39]
L_ffn_cw_79:
    s_waitcnt lgkmcnt(2)
    v_mfma_f32_16x16x32_bf16 v[104:107], v[88:91], v[48:51], v[104:107]
    ds_read_b64_tr_b16 v[80:81], v30 offset:0
    ds_read_b64_tr_b16 v[82:83], v30 offset:3072
    v_mfma_f32_16x16x32_bf16 v[144:147], v[88:91], v[52:55], v[144:147]
    ds_read_b128 v[64:67], v9 offset:40960
    v_mfma_f32_16x16x32_bf16 v[184:187], v[88:91], v[56:59], v[184:187]
    s_add_u32 m0, s59, 40960
    s_nop 0
    buffer_load_dwordx4 v4, s[40:43], s57 offen lds
    v_mfma_f32_16x16x32_bf16 v[224:227], v[88:91], v[60:63], v[224:227]
    s_waitcnt lgkmcnt(3)
    v_mfma_f32_16x16x32_bf16 v[108:111], v[92:95], v[48:51], v[108:111]
    ds_read_b64_tr_b16 v[84:85], v30 offset:12288
    ds_read_b64_tr_b16 v[86:87], v30 offset:15360
    v_mfma_f32_16x16x32_bf16 v[148:151], v[92:95], v[52:55], v[148:151]
    ds_read_b128 v[68:71], v9 offset:41984
    v_mfma_f32_16x16x32_bf16 v[188:191], v[92:95], v[56:59], v[188:191]
    s_add_u32 m0, s59, 41984
    s_nop 0
    buffer_load_dwordx4 v5, s[40:43], s57 offen lds
    v_mfma_f32_16x16x32_bf16 v[228:231], v[92:95], v[60:63], v[228:231]
    s_cmp_eq_u32 s5, 1
    s_cbranch_scc0 L_ffn_cw_80
    v_mfma_f32_16x16x32_bf16 v[32:35], v[88:91], v[20:23], v[32:35]
    v_mfma_f32_16x16x32_bf16 v[36:39], v[92:95], v[20:23], v[36:39]
L_ffn_cw_80:
    s_waitcnt lgkmcnt(4)
    v_mfma_f32_16x16x32_bf16 v[112:115], v[80:83], v[48:51], v[112:115]
    ds_read_b64_tr_b16 v[88:89], v31 offset:0
    ds_read_b64_tr_b16 v[90:91], v31 offset:3072
    v_mfma_f32_16x16x32_bf16 v[152:155], v[80:83], v[52:55], v[152:155]
    ds_read_b128 v[72:75], v9 offset:43008
    v_mfma_f32_16x16x32_bf16 v[192:195], v[80:83], v[56:59], v[192:195]
    s_add_u32 m0, s59, 43008
    s_nop 0
    buffer_load_dwordx4 v6, s[40:43], s57 offen lds
    s_add_u32 s57, s57, 294912
    v_mfma_f32_16x16x32_bf16 v[232:235], v[80:83], v[60:63], v[232:235]
    s_waitcnt lgkmcnt(4)
    v_mfma_f32_16x16x32_bf16 v[116:119], v[84:87], v[48:51], v[116:119]
    ds_read_b64_tr_b16 v[92:93], v31 offset:12288
    ds_read_b64_tr_b16 v[94:95], v31 offset:15360
    v_mfma_f32_16x16x32_bf16 v[156:159], v[84:87], v[52:55], v[156:159]
    ds_read_b128 v[76:79], v9 offset:44032
    v_mfma_f32_16x16x32_bf16 v[196:199], v[84:87], v[56:59], v[196:199]
    v_mfma_f32_16x16x32_bf16 v[236:239], v[84:87], v[60:63], v[236:239]
    s_cmp_eq_u32 s5, 2
    s_cbranch_scc0 L_ffn_cw_81
    v_mfma_f32_16x16x32_bf16 v[32:35], v[80:83], v[20:23], v[32:35]
    v_mfma_f32_16x16x32_bf16 v[36:39], v[84:87], v[20:23], v[36:39]
L_ffn_cw_81:
    s_waitcnt lgkmcnt(4)
    v_mfma_f32_16x16x32_bf16 v[120:123], v[88:91], v[48:51], v[120:123]
    ds_read_b64_tr_b16 v[80:81], v28 offset:128
    ds_read_b64_tr_b16 v[82:83], v28 offset:3200
    v_mfma_f32_16x16x32_bf16 v[160:163], v[88:91], v[52:55], v[160:163]
    v_mfma_f32_16x16x32_bf16 v[200:203], v[88:91], v[56:59], v[200:203]
    v_mfma_f32_16x16x32_bf16 v[240:243], v[88:91], v[60:63], v[240:243]
    s_waitcnt lgkmcnt(3)
    v_mfma_f32_16x16x32_bf16 v[124:127], v[92:95], v[48:51], v[124:127]
    ds_read_b64_tr_b16 v[84:85], v28 offset:12416
    ds_read_b64_tr_b16 v[86:87], v28 offset:15488
    v_mfma_f32_16x16x32_bf16 v[164:167], v[92:95], v[52:55], v[164:167]
    v_mfma_f32_16x16x32_bf16 v[204:207], v[92:95], v[56:59], v[204:207]
    v_mfma_f32_16x16x32_bf16 v[244:247], v[92:95], v[60:63], v[244:247]
    s_cmp_eq_u32 s5, 3
    s_cbranch_scc0 L_ffn_cw_82
    v_mfma_f32_16x16x32_bf16 v[32:35], v[88:91], v[20:23], v[32:35]
    v_mfma_f32_16x16x32_bf16 v[36:39], v[92:95], v[20:23], v[36:39]
L_ffn_cw_82:
    s_waitcnt lgkmcnt(2)
    v_mfma_f32_16x16x32_bf16 v[128:131], v[80:83], v[48:51], v[128:131]
    ds_read_b64_tr_b16 v[88:89], v28 offset:40960
    ds_read_b64_tr_b16 v[90:91], v28 offset:44032
    v_mfma_f32_16x16x32_bf16 v[168:171], v[80:83], v[52:55], v[168:171]
    v_mfma_f32_16x16x32_bf16 v[208:211], v[80:83], v[56:59], v[208:211]
    v_mfma_f32_16x16x32_bf16 v[248:251], v[80:83], v[60:63], v[248:251]
    s_waitcnt lgkmcnt(2)
    v_mfma_f32_16x16x32_bf16 v[132:135], v[84:87], v[48:51], v[132:135]
    ds_read_b64_tr_b16 v[92:93], v28 offset:53248
    ds_read_b64_tr_b16 v[94:95], v28 offset:56320
    v_mfma_f32_16x16x32_bf16 v[172:175], v[84:87], v[52:55], v[172:175]
    v_mfma_f32_16x16x32_bf16 v[212:215], v[84:87], v[56:59], v[212:215]
    v_mfma_f32_16x16x32_bf16 v[252:255], v[84:87], v[60:63], v[252:255]
    s_cmp_eq_u32 s5, 0
    s_cbranch_scc0 L_ffn_cw_83
    v_mfma_f32_16x16x32_bf16 v[10:13], v[80:83], v[20:23], v[10:13]
    v_mfma_f32_16x16x32_bf16 v[16:19], v[84:87], v[20:23], v[16:19]
L_ffn_cw_83:
    s_waitcnt vmcnt(5)
    s_barrier
    s_waitcnt lgkmcnt(2)
    v_mfma_f32_16x16x32_bf16 v[96:99], v[88:91], v[64:67], v[96:99]
    ds_read_b64_tr_b16 v[80:81], v29 offset:40960
    ds_read_b64_tr_b16 v[82:83], v29 offset:44032
    v_mfma_f32_16x16x32_bf16 v[136:139], v[88:91], v[68:71], v[136:139]
    v_mfma_f32_16x16x32_bf16 v[176:179], v[88:91], v[72:75], v[176:179]
    v_mfma_f32_16x16x32_bf16 v[216:219], v[88:91], v[76:79], v[216:219]
    s_waitcnt lgkmcnt(2)
    v_mfma_f32_16x16x32_bf16 v[100:103], v[92:95], v[64:67], v[100:103]
    ds_read_b64_tr_b16 v[84:85], v29 offset:53248
    ds_read_b64_tr_b16 v[86:87], v29 offset:56320
    v_mfma_f32_16x16x32_bf16 v[140:143], v[92:95], v[68:71], v[140:143]
    v_mfma_f32_16x16x32_bf16 v[180:183], v[92:95], v[72:75], v[180:183]
    v_mfma_f32_16x16x32_bf16 v[220:223], v[92:95], v[76:79], v[220:223]
    s_cmp_eq_u32 s5, 0
    s_cbranch_scc0 L_ffn_cw_84
    v_mfma_f32_16x16x32_bf16 v[32:35], v[88:91], v[20:23], v[32:35]
    v_mfma_f32_16x16x32_bf16 v[36:39], v[92:95], v[20:23], v[36:39]
L_ffn_cw_84:
    s_waitcnt lgkmcnt(2)
    v_mfma_f32_16x16x32_bf16 v[104:107], v[80:83], v[64:67], v[104:107]
    ds_read_b64_tr_b16 v[88:89], v30 offset:40960
    ds_read_b64_tr_b16 v[90:91], v30 offset:44032
    v_mfma_f32_16x16x32_bf16 v[144:147], v[80:83], v[68:71], v[144:147]
    ds_read_b128 v[48:51], v8 offset:0
    v_mfma_f32_16x16x32_bf16 v[184:187], v[80:83], v[72:75], v[184:187]
    v_mfma_f32_16x16x32_bf16 v[224:227], v[80:83], v[76:79], v[224:227]
    s_waitcnt lgkmcnt(3)
    v_mfma_f32_16x16x32_bf16 v[108:111], v[84:87], v[64:67], v[108:111]
    ds_read_b64_tr_b16 v[92:93], v30 offset:53248
    ds_read_b64_tr_b16 v[94:95], v30 offset:56320
    v_mfma_f32_16x16x32_bf16 v[148:151], v[84:87], v[68:71], v[148:151]
    ds_read_b128 v[52:55], v8 offset:1024
    v_mfma_f32_16x16x32_bf16 v[188:191], v[84:87], v[72:75], v[188:191]
    v_mfma_f32_16x16x32_bf16 v[228:231], v[84:87], v[76:79], v[228:231]
    s_cmp_eq_u32 s5, 1
    s_cbranch_scc0 L_ffn_cw_85
    v_mfma_f32_16x16x32_bf16 v[32:35], v[80:83], v[20:23], v[32:35]
    v_mfma_f32_16x16x32_bf16 v[36:39], v[84:87], v[20:23], v[36:39]
L_ffn_cw_85:
    s_waitcnt lgkmcnt(4)
    v_mfma_f32_16x16x32_bf16 v[112:115], v[88:91], v[64:67], v[112:115]
    ds_read_b64_tr_b16 v[80:81], v31 offset:40960
    ds_read_b64_tr_b16 v[82:83], v31 offset:44032
    v_mfma_f32_16x16x32_bf16 v[152:155], v[88:91], v[68:71], v[152:155]
    ds_read_b128 v[56:59], v8 offset:2048
    v_mfma_f32_16x16x32_bf16 v[192:195], v[88:91], v[72:75], v[192:195]
    v_mfma_f32_16x16x32_bf16 v[232:235], v[88:91], v[76:79], v[232:235]
    s_waitcnt lgkmcnt(4)
    v_mfma_f32_16x16x32_bf16 v[116:119], v[92:95], v[64:67], v[116:119]
    ds_read_b64_tr_b16 v[84:85], v31 offset:53248
    ds_read_b64_tr_b16 v[86:87], v31 offset:56320
    v_mfma_f32_16x16x32_bf16 v[156:159], v[92:95], v[68:71], v[156:159]
    ds_read_b128 v[60:63], v8 offset:3072
    v_mfma_f32_16x16x32_bf16 v[196:199], v[92:95], v[72:75], v[196:199]
    v_mfma_f32_16x16x32_bf16 v[236:239], v[92:95], v[76:79], v[236:239]
    s_cmp_eq_u32 s5, 2
    s_cbranch_scc0 L_ffn_cw_86
    v_mfma_f32_16x16x32_bf16 v[32:35], v[88:91], v[20:23], v[32:35]
    v_mfma_f32_16x16x32_bf16 v[36:39], v[92:95], v[20:23], v[36:39]
L_ffn_cw_86:
    s_waitcnt lgkmcnt(4)
    v_mfma_f32_16x16x32_bf16 v[120:123], v[80:83], v[64:67], v[120:123]
    ds_read_b64_tr_b16 v[88:89], v28 offset:41088
    ds_read_b64_tr_b16 v[90:91], v28 offset:44160
    v_mfma_f32_16x16x32_bf16 v[160:163], v[80:83], v[68:71], v[160:163]
    v_mfma_f32_16x16x32_bf16 v[200:203], v[80:83], v[72:75], v[200:203]
    v_mfma_f32_16x16x32_bf16 v[240:243], v[80:83], v[76:79], v[240:243]
    s_waitcnt lgkmcnt(3)
    v_mfma_f32_16x16x32_bf16 v[124:127], v[84:87], v[64:67], v[124:127]
    ds_read_b64_tr_b16 v[92:93], v28 offset:53376
    ds_read_b64_tr_b16 v[94:95], v28 offset:56448
    v_mfma_f32_16x16x32_bf16 v[164:167], v[84:87], v[68:71], v[164:167]
    v_mfma_f32_16x16x32_bf16 v[204:207], v[84:87], v[72:75], v[204:207]
    v_mfma_f32_16x16x32_bf16 v[244:247], v[84:87], v[76:79], v[244:247]
    s_cmp_eq_u32 s5, 3
    s_cbranch_scc0 L_ffn_cw_87
    v_mfma_f32_16x16x32_bf16 v[32:35], v[80:83], v[20:23], v[32:35]
    v_mfma_f32_16x16x32_bf16 v[36:39], v[84:87], v[20:23], v[36:39]
L_ffn_cw_87:
    s_waitcnt lgkmcnt(2)
    v_mfma_f32_16x16x32_bf16 v[128:131], v[88:91], v[64:67], v[128:131]
    ds_read_b64_tr_b16 v[80:81], v24 offset:0
    ds_read_b64_tr_b16 v[82:83], v24 offset:3072
    v_mfma_f32_16x16x32_bf16 v[168:171], v[88:91], v[68:71], v[168:171]
    v_mfma_f32_16x16x32_bf16 v[208:211], v[88:91], v[72:75], v[208:211]
    v_mfma_f32_16x16x32_bf16 v[248:251], v[88:91], v[76:79], v[248:251]
    s_waitcnt lgkmcnt(2)
    v_mfma_f32_16x16x32_bf16 v[132:135], v[92:95], v[64:67], v[132:135]
    ds_read_b64_tr_b16 v[84:85], v24 offset:12288
    ds_read_b64_tr_b16 v[86:87], v24 offset:15360
    v_mfma_f32_16x16x32_bf16 v[172:175], v[92:95], v[68:71], v[172:175]
    v_mfma_f32_16x16x32_bf16 v[212:215], v[92:95], v[72:75], v[212:215]
    v_mfma_f32_16x16x32_bf16 v[252:255], v[92:95], v[76:79], v[252:255]
    s_cmp_eq_u32 s5, 0
    s_cbranch_scc0 L_ffn_cw_88
    v_mfma_f32_16x16x32_bf16 v[10:13], v[88:91], v[20:23], v[10:13]
    v_mfma_f32_16x16x32_bf16 v[16:19], v[92:95], v[20:23], v[16:19]
L_ffn_cw_88:
    s_waitcnt vmcnt(0)
    s_barrier
    s_waitcnt lgkmcnt(2)
    v_mfma_f32_16x16x32_bf16 v[96:99], v[80:83], v[48:51], v[96:99]
    ds_read_b64_tr_b16 v[88:89], v25 offset:0
    ds_read_b64_tr_b16 v[90:91], v25 offset:3072
    v_mfma_f32_16x16x32_bf16 v[136:139], v[80:83], v[52:55], v[136:139]
    v_mfma_f32_16x16x32_bf16 v[176:179], v[80:83], v[56:59], v[176:179]
    v_mfma_f32_16x16x32_bf16 v[216:219], v[80:83], v[60:63], v[216:219]
    s_waitcnt lgkmcnt(2)
    v_mfma_f32_16x16x32_bf16 v[100:103], v[84:87], v[48:51], v[100:103]
    ds_read_b64_tr_b16 v[92:93], v25 offset:12288
    ds_read_b64_tr_b16 v[94:95], v25 offset:15360
    v_mfma_f32_16x16x32_bf16 v[140:143], v[84:87], v[52:55], v[140:143]
    v_mfma_f32_16x16x32_bf16 v[180:183], v[84:87], v[56:59], v[180:183]
    v_mfma_f32_16x16x32_bf16 v[220:223], v[84:87], v[60:63], v[220:223]
    s_cmp_eq_u32 s5, 0
    s_cbranch_scc0 L_ffn_cw_89
    v_mfma_f32_16x16x32_bf16 v[32:35], v[80:83], v[20:23], v[32:35]
    v_mfma_f32_16x16x32_bf16 v[36:39], v[84:87], v[20:23], v[36:39]
L_ffn_cw_89:
    s_waitcnt lgkmcnt(2)
    v_mfma_f32_16x16x32_bf16 v[104:107], v[88:91], v[48:51], v[104:107]
    ds_read_b64_tr_b16 v[80:81], v26 offset:0
    ds_read_b64_tr_b16 v[82:83], v26 offset:3072
    v_mfma_f32_16x16x32_bf16 v[144:147], v[88:91], v[52:55], v[144:147]
    ds_read_b128 v[64:67], v8 offset:40960
    v_mfma_f32_16x16x32_bf16 v[184:187], v[88:91], v[56:59], v[184:187]
    v_mfma_f32_16x16x32_bf16 v[224:227], v[88:91], v[60:63], v[224:227]
    s_waitcnt lgkmcnt(3)
    v_mfma_f32_16x16x32_bf16 v[108:111], v[92:95], v[48:51], v[108:111]
    ds_read_b64_tr_b16 v[84:85], v26 offset:12288
    ds_read_b64_tr_b16 v[86:87], v26 offset:15360
    v_mfma_f32_16x16x32_bf16 v[148:151], v[92:95], v[52:55], v[148:151]
    ds_read_b128 v[68:71], v8 offset:41984
    v_mfma_f32_16x16x32_bf16 v[188:191], v[92:95], v[56:59], v[188:191]
    v_mfma_f32_16x16x32_bf16 v[228:231], v[92:95], v[60:63], v[228:231]
    s_cmp_eq_u32 s5, 1
    s_cbranch_scc0 L_ffn_cw_90
    v_mfma_f32_16x16x32_bf16 v[32:35], v[88:91], v[20:23], v[32:35]
    v_mfma_f32_16x16x32_bf16 v[36:39], v[92:95], v[20:23], v[36:39]
L_ffn_cw_90:
    s_waitcnt lgkmcnt(4)
    v_mfma_f32_16x16x32_bf16 v[112:115], v[80:83], v[48:51], v[112:115]
    ds_read_b64_tr_b16 v[88:89], v27 offset:0
    ds_read_b64_tr_b16 v[90:91], v27 offset:3072
    v_mfma_f32_16x16x32_bf16 v[152:155], v[80:83], v[52:55], v[152:155]
    ds_read_b128 v[72:75], v8 offset:43008
    v_mfma_f32_16x16x32_bf16 v[192:195], v[80:83], v[56:59], v[192:195]
    v_mfma_f32_16x16x32_bf16 v[232:235], v[80:83], v[60:63], v[232:235]
    s_waitcnt lgkmcnt(4)
    v_mfma_f32_16x16x32_bf16 v[116:119], v[84:87], v[48:51], v[116:119]
    ds_read_b64_tr_b16 v[92:93], v27 offset:12288
    ds_read_b64_tr_b16 v[94:95], v27 offset:15360
    v_mfma_f32_16x16x32_bf16 v[156:159], v[84:87], v[52:55], v[156:159]
    ds_read_b128 v[76:79], v8 offset:44032
    v_mfma_f32_16x16x32_bf16 v[196:199], v[84:87], v[56:59], v[196:199]
    v_mfma_f32_16x16x32_bf16 v[236:239], v[84:87], v[60:63], v[236:239]
    s_cmp_eq_u32 s5, 2
    s_cbranch_scc0 L_ffn_cw_91
    v_mfma_f32_16x16x32_bf16 v[32:35], v[80:83], v[20:23], v[32:35]
    v_mfma_f32_16x16x32_bf16 v[36:39], v[84:87], v[20:23], v[36:39]
L_ffn_cw_91:
    s_waitcnt lgkmcnt(4)
    v_mfma_f32_16x16x32_bf16 v[120:123], v[88:91], v[48:51], v[120:123]
    ds_read_b64_tr_b16 v[80:81], v24 offset:128
    ds_read_b64_tr_b16 v[82:83], v24 offset:3200
    v_mfma_f32_16x16x32_bf16 v[160:163], v[88:91], v[52:55], v[160:163]
    v_mfma_f32_16x16x32_bf16 v[200:203], v[88:91], v[56:59], v[200:203]
    v_mfma_f32_16x16x32_bf16 v[240:243], v[88:91], v[60:63], v[240:243]
    s_waitcnt lgkmcnt(3)
    v_mfma_f32_16x16x32_bf16 v[124:127], v[92:95], v[48:51], v[124:127]
    ds_read_b64_tr_b16 v[84:85], v24 offset:12416
    ds_read_b64_tr_b16 v[86:87], v24 offset:15488
    v_mfma_f32_16x16x32_bf16 v[164:167], v[92:95], v[52:55], v[164:167]
    v_mfma_f32_16x16x32_bf16 v[204:207], v[92:95], v[56:59], v[204:207]
    v_mfma_f32_16x16x32_bf16 v[244:247], v[92:95], v[60:63], v[244:247]
    s_cmp_eq_u32 s5, 3
    s_cbranch_scc0 L_ffn_cw_92
    v_mfma_f32_16x16x32_bf16 v[32:35], v[88:91], v[20:23], v[32:35]
    v_mfma_f32_16x16x32_bf16 v[36:39], v[92:95], v[20:23], v[36:39]
L_ffn_cw_92:
    s_waitcnt lgkmcnt(2)
    v_mfma_f32_16x16x32_bf16 v[128:131], v[80:83], v[48:51], v[128:131]
    ds_read_b64_tr_b16 v[88:89], v24 offset:40960
    ds_read_b64_tr_b16 v[90:91], v24 offset:44032
    v_mfma_f32_16x16x32_bf16 v[168:171], v[80:83], v[52:55], v[168:171]
    v_mfma_f32_16x16x32_bf16 v[208:211], v[80:83], v[56:59], v[208:211]
    v_mfma_f32_16x16x32_bf16 v[248:251], v[80:83], v[60:63], v[248:251]
    s_waitcnt lgkmcnt(2)
    v_mfma_f32_16x16x32_bf16 v[132:135], v[84:87], v[48:51], v[132:135]
    ds_read_b64_tr_b16 v[92:93], v24 offset:53248
    ds_read_b64_tr_b16 v[94:95], v24 offset:56320
    v_mfma_f32_16x16x32_bf16 v[172:175], v[84:87], v[52:55], v[172:175]
    v_mfma_f32_16x16x32_bf16 v[212:215], v[84:87], v[56:59], v[212:215]
    v_mfma_f32_16x16x32_bf16 v[252:255], v[84:87], v[60:63], v[252:255]
    s_cmp_eq_u32 s5, 0
    s_cbranch_scc0 L_ffn_cw_93
    v_mfma_f32_16x16x32_bf16 v[10:13], v[80:83], v[20:23], v[10:13]
    v_mfma_f32_16x16x32_bf16 v[16:19], v[84:87], v[20:23], v[16:19]
L_ffn_cw_93:
    s_waitcnt lgkmcnt(2)
    v_mfma_f32_16x16x32_bf16 v[96:99], v[88:91], v[64:67], v[96:99]
    ds_read_b64_tr_b16 v[80:81], v25 offset:40960
    ds_read_b64_tr_b16 v[82:83], v25 offset:44032
    v_mfma_f32_16x16x32_bf16 v[136:139], v[88:91], v[68:71], v[136:139]
    v_mfma_f32_16x16x32_bf16 v[176:179], v[88:91], v[72:75], v[176:179]
    v_mfma_f32_16x16x32_bf16 v[216:219], v[88:91], v[76:79], v[216:219]
    s_waitcnt lgkmcnt(2)
    v_mfma_f32_16x16x32_bf16 v[100:103], v[92:95], v[64:67], v[100:103]
    ds_read_b64_tr_b16 v[84:85], v25 offset:53248
    ds_read_b64_tr_b16 v[86:87], v25 offset:56320
    v_mfma_f32_16x16x32_bf16 v[140:143], v[92:95], v[68:71], v[140:143]
    v_mfma_f32_16x16x32_bf16 v[180:183], v[92:95], v[72:75], v[180:183]
    v_mfma_f32_16x16x32_bf16 v[220:223], v[92:95], v[76:79], v[220:223]
    s_cmp_eq_u32 s5, 0
    s_cbranch_scc0 L_ffn_cw_94
    v_mfma_f32_16x16x32_bf16 v[32:35], v[88:91], v[20:23], v[32:35]
    v_mfma_f32_16x16x32_bf16 v[36:39], v[92:95], v[20:23], v[36:39]
L_ffn_cw_94:
    s_waitcnt lgkmcnt(2)
    v_mfma_f32_16x16x32_bf16 v[104:107], v[80:83], v[64:67], v[104:107]
    ds_read_b64_tr_b16 v[88:89], v26 offset:40960
    ds_read_b64_tr_b16 v[90:91], v26 offset:44032
    v_mfma_f32_16x16x32_bf16 v[144:147], v[80:83], v[68:71], v[144:147]
    v_mfma_f32_16x16x32_bf16 v[184:187], v[80:83], v[72:75], v[184:187]
    v_mfma_f32_16x16x32_bf16 v[224:227], v[80:83], v[76:79], v[224:227]
    s_waitcnt lgkmcnt(2)
    v_mfma_f32_16x16x32_bf16 v[108:111], v[84:87], v[64:67], v[108:111]
    ds_read_b64_tr_b16 v[92:93], v26 offset:53248
    ds_read_b64_tr_b16 v[94:95], v26 offset:56320
    v_mfma_f32_16x16x32_bf16 v[148:151], v[84:87], v[68:71], v[148:151]
    v_mfma_f32_16x16x32_bf16 v[188:191], v[84:87], v[72:75], v[188:191]
    v_mfma_f32_16x16x32_bf16 v[228:231], v[84:87], v[76:79], v[228:231]
    s_cmp_eq_u32 s5, 1
    s_cbranch_scc0 L_ffn_cw_95
    v_mfma_f32_16x16x32_bf16 v[32:35], v[80:83], v[20:23], v[32:35]
    v_mfma_f32_16x16x32_bf16 v[36:39], v[84:87], v[20:23], v[36:39]
L_ffn_cw_95:
    s_waitcnt lgkmcnt(2)
    v_mfma_f32_16x16x32_bf16 v[112:115], v[88:91], v[64:67], v[112:115]
    ds_read_b64_tr_b16 v[80:81], v27 offset:40960
    ds_read_b64_tr_b16 v[82:83], v27 offset:44032
    v_mfma_f32_16x16x32_bf16 v[152:155], v[88:91], v[68:71], v[152:155]
    v_mfma_f32_16x16x32_bf16 v[192:195], v[88:91], v[72:75], v[192:195]
    v_mfma_f32_16x16x32_bf16 v[232:235], v[88:91], v[76:79], v[232:235]
    s_waitcnt lgkmcnt(2)
    v_mfma_f32_16x16x32_bf16 v[116:119], v[92:95], v[64:67], v[116:119]
    ds_read_b64_tr_b16 v[84:85], v27 offset:53248
    ds_read_b64_tr_b16 v[86:87], v27 offset:56320
    v_mfma_f32_16x16x32_bf16 v[156:159], v[92:95], v[68:71], v[156:159]
    v_mfma_f32_16x16x32_bf16 v[196:199], v[92:95], v[72:75], v[196:199]
    v_mfma_f32_16x16x32_bf16 v[236:239], v[92:95], v[76:79], v[236:239]
    s_cmp_eq_u32 s5, 2
    s_cbranch_scc0 L_ffn_cw_96
    v_mfma_f32_16x16x32_bf16 v[32:35], v[88:91], v[20:23], v[32:35]
    v_mfma_f32_16x16x32_bf16 v[36:39], v[92:95], v[20:23], v[36:39]
L_ffn_cw_96:
    s_waitcnt lgkmcnt(2)
    v_mfma_f32_16x16x32_bf16 v[120:123], v[80:83], v[64:67], v[120:123]
    ds_read_b64_tr_b16 v[88:89], v24 offset:41088
    ds_read_b64_tr_b16 v[90:91], v24 offset:44160
    v_mfma_f32_16x16x32_bf16 v[160:163], v[80:83], v[68:71], v[160:163]
    v_mfma_f32_16x16x32_bf16 v[200:203], v[80:83], v[72:75], v[200:203]
    v_mfma_f32_16x16x32_bf16 v[240:243], v[80:83], v[76:79], v[240:243]
    s_waitcnt lgkmcnt(2)
    v_mfma_f32_16x16x32_bf16 v[124:127], v[84:87], v[64:67], v[124:127]
    ds_read_b64_tr_b16 v[92:93], v24 offset:53376
    ds_read_b64_tr_b16 v[94:95], v24 offset:56448
    v_mfma_f32_16x16x32_bf16 v[164:167], v[84:87], v[68:71], v[164:167]
    v_mfma_f32_16x16x32_bf16 v[204:207], v[84:87], v[72:75], v[204:207]
    v_mfma_f32_16x16x32_bf16 v[244:247], v[84:87], v[76:79], v[244:247]
    s_cmp_eq_u32 s5, 3
    s_cbranch_scc0 L_ffn_cw_97
    v_mfma_f32_16x16x32_bf16 v[32:35], v[80:83], v[20:23], v[32:35]
    v_mfma_f32_16x16x32_bf16 v[36:39], v[84:87], v[20:23], v[36:39]
L_ffn_cw_97:
    s_waitcnt lgkmcnt(2)
    v_mfma_f32_16x16x32_bf16 v[128:131], v[88:91], v[64:67], v[128:131]
    v_mfma_f32_16x16x32_bf16 v[168:171], v[88:91], v[68:71], v[168:171]
    v_mfma_f32_16x16x32_bf16 v[208:211], v[88:91], v[72:75], v[208:211]
    v_mfma_f32_16x16x32_bf16 v[248:251], v[88:91], v[76:79], v[248:251]
    s_waitcnt lgkmcnt(0)
    v_mfma_f32_16x16x32_bf16 v[132:135], v[92:95], v[64:67], v[132:135]
    v_mfma_f32_16x16x32_bf16 v[172:175], v[92:95], v[68:71], v[172:175]
    v_mfma_f32_16x16x32_bf16 v[212:215], v[92:95], v[72:75], v[212:215]
    v_mfma_f32_16x16x32_bf16 v[252:255], v[92:95], v[76:79], v[252:255]
    s_cmp_eq_u32 s5, 0
    s_cbranch_scc0 L_ffn_cw_98
    v_mfma_f32_16x16x32_bf16 v[10:13], v[88:91], v[20:23], v[10:13]
    v_mfma_f32_16x16x32_bf16 v[16:19], v[92:95], v[20:23], v[16:19]
L_ffn_cw_98:
    s_nop 7
    s_barrier
    v_lshlrev_b32 v1, 4, v0
    v_add_u32 v1, 0, v1
    s_cmp_eq_u32 s5, 0
    s_cbranch_scc0 L_ffn_cww_99
    ds_write_b128 v1, v[32:35] offset:0
    ds_write_b128 v1, v[36:39] offset:1024
L_ffn_cww_99:
    s_cmp_eq_u32 s5, 1
    s_cbranch_scc0 L_ffn_cww_100
    ds_write_b128 v1, v[32:35] offset:2048
    ds_write_b128 v1, v[36:39] offset:3072
L_ffn_cww_100:
    s_cmp_eq_u32 s5, 2
    s_cbranch_scc0 L_ffn_cww_101
    ds_write_b128 v1, v[32:35] offset:4096
    ds_write_b128 v1, v[36:39] offset:5120
L_ffn_cww_101:
    s_cmp_eq_u32 s5, 3
    s_cbranch_scc0 L_ffn_cww_102
    ds_write_b128 v1, v[32:35] offset:6144
    ds_write_b128 v1, v[36:39] offset:7168
L_ffn_cww_102:
    s_cmp_eq_u32 s5, 0
    s_cbranch_scc0 L_ffn_cww_103
    ds_write_b128 v1, v[10:13] offset:8192
    ds_write_b128 v1, v[16:19] offset:9216
L_ffn_cww_103:
    s_waitcnt lgkmcnt(0)
    s_barrier
    ds_read_b128 v[48:51], v1 offset:0
    ds_read_b128 v[52:55], v1 offset:1024
    ds_read_b128 v[56:59], v1 offset:2048
    ds_read_b128 v[60:63], v1 offset:3072
    ds_read_b128 v[64:67], v1 offset:4096
    ds_read_b128 v[68:71], v1 offset:5120
    ds_read_b128 v[72:75], v1 offset:6144
    ds_read_b128 v[76:79], v1 offset:7168
    ds_read_b128 v[80:83], v1 offset:8192
    ds_read_b128 v[84:87], v1 offset:9216
    s_waitcnt lgkmcnt(0)
    v_mov_b32 v20, 1.0
    v_mov_b32 v21, 1.0
    s_mov_b32 s60, 0xc0135761
    s_mov_b32 s61, 0xbdd2d3e8
    s_mov_b32 s62, 0
    s_nop 7
    v_mul_f32 v22, s60, v40
    v_mul_f32 v26, v40, v40
    v_mul_f32 v24, s61, v40
    v_mul_f32 v24, v24, v26
    v_mov_b32 v23, v22
    v_mov_b32 v25, v24
    v_mov_b32 v27, v26
    v_mov_b32 v36, v44
    v_mov_b32 v37, v44
    v_pk_fma_f32 v[96:97], v[48:49], v[36:37], v[96:97]
    v_pk_fma_f32 v[100:101], v[52:53], v[36:37], v[100:101]
    v_pk_fma_f32 v[98:99], v[50:51], v[36:37], v[98:99]
    v_pk_fma_f32 v[102:103], v[54:55], v[36:37], v[102:103]
    v_pk_mul_f32 v[28:29], v[96:97], v[96:97]
    v_pk_mul_f32 v[30:31], v[98:99], v[98:99]
    v_pk_fma_f32 v[28:29], v[28:29], v[24:25], v[22:23]
    v_pk_fma_f32 v[30:31], v[30:31], v[24:25], v[22:23]
    v_pk_mul_f32 v[28:29], v[28:29], v[96:97]
    v_pk_mul_f32 v[30:31], v[30:31], v[98:99]
    v_exp_f32 v28, v28
    v_exp_f32 v29, v29
    v_exp_f32 v30, v30
    v_exp_f32 v31, v31
    v_pk_mul_f32 v[32:33], v[96:97], v[100:101]
    v_pk_mul_f32 v[34:35], v[98:99], v[102:103]
    v_pk_add_f32 v[28:29], v[28:29], v[20:21]
    v_pk_add_f32 v[30:31], v[30:31], v[20:21]
    v_rcp_f32 v28, v28
    v_rcp_f32 v29, v29
    v_rcp_f32 v30, v30
    v_rcp_f32 v31, v31
    v_pk_mul_f32 v[32:33], v[32:33], v[26:27]
    v_pk_mul_f32 v[34:35], v[34:35], v[26:27]
    v_pk_mul_f32 v[32:33], v[32:33], v[28:29]
    v_pk_mul_f32 v[34:35], v[34:35], v[30:31]
    v_cvt_pk_bf16_f32 v96, v32, v33
    v_cvt_pk_bf16_f32 v97, v34, v35
    v_pk_fma_f32 v[104:105], v[56:57], v[36:37], v[104:105]
    v_pk_fma_f32 v[108:109], v[60:61], v[36:37], v[108:109]
    v_pk_fma_f32 v[106:107], v[58:59], v[36:37], v[106:107]
    v_pk_fma_f32 v[110:111], v[62:63], v[36:37], v[110:111]
    v_pk_mul_f32 v[28:29], v[104:105], v[104:105]
    v_pk_mul_f32 v[30:31], v[106:107], v[106:107]
    v_pk_fma_f32 v[28:29], v[28:29], v[24:25], v[22:23]
    v_pk_fma_f32 v[30:31], v[30:31], v[24:25], v[22:23]
    v_pk_mul_f32 v[28:29], v[28:29], v[104:105]
    v_pk_mul_f32 v[30:31], v[30:31], v[106:107]
    v_exp_f32 v28, v28
    v_exp_f32 v29, v29
    v_exp_f32 v30, v30
    v_exp_f32 v31, v31
    v_pk_mul_f32 v[32:33], v[104:105], v[108:109]
    v_pk_mul_f32 v[34:35], v[106:107], v[110:111]
    v_pk_add_f32 v[28:29], v[28:29], v[20:21]
    v_pk_add_f32 v[30:31], v[30:31], v[20:21]
    v_rcp_f32 v28, v28
    v_rcp_f32 v29, v29
    v_rcp_f32 v30, v30
    v_rcp_f32 v31, v31
    v_pk_mul_f32 v[32:33], v[32:33], v[26:27]
    v_pk_mul_f32 v[34:35], v[34:35], v[26:27]
    v_pk_mul_f32 v[32:33], v[32:33], v[28:29]
    v_pk_mul_f32 v[34:35], v[34:35], v[30:31]
    v_cvt_pk_bf16_f32 v98, v32, v33
    v_cvt_pk_bf16_f32 v99, v34, v35
    s_nop 1
    v_permlane16_swap_b32 v96, v98
    v_permlane16_swap_b32 v97, v99
    buffer_store_dwordx4 v[96:99], v14, s[52:55], s62 offen offset:0 sc1
    v_pk_fma_f32 v[112:113], v[64:65], v[36:37], v[112:113]
    v_pk_fma_f32 v[116:117], v[68:69], v[36:37], v[116:117]
    v_pk_fma_f32 v[114:115], v[66:67], v[36:37], v[114:115]
    v_pk_fma_f32 v[118:119], v[70:71], v[36:37], v[118:119]
    v_pk_mul_f32 v[28:29], v[112:113], v[112:113]
    v_pk_mul_f32 v[30:31], v[114:115], v[114:115]
    v_pk_fma_f32 v[28:29], v[28:29], v[24:25], v[22:23]
    v_pk_fma_f32 v[30:31], v[30:31], v[24:25], v[22:23]
    v_pk_mul_f32 v[28:29], v[28:29], v[112:113]
    v_pk_mul_f32 v[30:31], v[30:31], v[114:115]
    v_exp_f32 v28, v28
    v_exp_f32 v29, v29
    v_exp_f32 v30, v30
    v_exp_f32 v31, v31
    v_pk_mul_f32 v[32:33], v[112:113], v[116:117]
    v_pk_mul_f32 v[34:35], v[114:115], v[118:119]
    v_pk_add_f32 v[28:29], v[28:29], v[20:21]
    v_pk_add_f32 v[30:31], v[30:31], v[20:21]
    v_rcp_f32 v28, v28
    v_rcp_f32 v29, v29
    v_rcp_f32 v30, v30
    v_rcp_f32 v31, v31
    v_pk_mul_f32 v[32:33], v[32:33], v[26:27]
    v_pk_mul_f32 v[34:35], v[34:35], v[26:27]
    v_pk_mul_f32 v[32:33], v[32:33], v[28:29]
    v_pk_mul_f32 v[34:35], v[34:35], v[30:31]
    v_cvt_pk_bf16_f32 v112, v32, v33
    v_cvt_pk_bf16_f32 v113, v34, v35
    v_pk_fma_f32 v[120:121], v[72:73], v[36:37], v[120:121]
    v_pk_fma_f32 v[124:125], v[76:77], v[36:37], v[124:125]
    v_pk_fma_f32 v[122:123], v[74:75], v[36:37], v[122:123]
    v_pk_fma_f32 v[126:127], v[78:79], v[36:37], v[126:127]
    v_pk_mul_f32 v[28:29], v[120:121], v[120:121]
    v_pk_mul_f32 v[30:31], v[122:123], v[122:123]
    v_pk_fma_f32 v[28:29], v[28:29], v[24:25], v[22:23]
    v_pk_fma_f32 v[30:31], v[30:31], v[24:25], v[22:23]
    v_pk_mul_f32 v[28:29], v[28:29], v[120:121]
    v_pk_mul_f32 v[30:31], v[30:31], v[122:123]
    v_exp_f32 v28, v28
    v_exp_f32 v29, v29
    v_exp_f32 v30, v30
    v_exp_f32 v31, v31
    v_pk_mul_f32 v[32:33], v[120:121], v[124:125]
    v_pk_mul_f32 v[34:35], v[122:123], v[126:127]
    v_pk_add_f32 v[28:29], v[28:29], v[20:21]
    v_pk_add_f32 v[30:31], v[30:31], v[20:21]
    v_rcp_f32 v28, v28
    v_rcp_f32 v29, v29
    v_rcp_f32 v30, v30
    v_rcp_f32 v31, v31
    v_pk_mul_f32 v[32:33], v[32:33], v[26:27]
    v_pk_mul_f32 v[34:35], v[34:35], v[26:27]
    v_pk_mul_f32 v[32:33], v[32:33], v[28:29]
    v_pk_mul_f32 v[34:35], v[34:35], v[30:31]
    v_cvt_pk_bf16_f32 v114, v32, v33
    v_cvt_pk_bf16_f32 v115, v34, v35
    s_nop 1
    v_permlane16_swap_b32 v112, v114
    v_permlane16_swap_b32 v113, v115
    buffer_store_dwordx4 v[112:115], v14, s[52:55], s62 offen offset:1024 sc1
    v_pk_fma_f32 v[128:129], v[80:81], v[36:37], v[128:129]
    v_pk_fma_f32 v[132:133], v[84:85], v[36:37], v[132:133]
    v_pk_fma_f32 v[130:131], v[82:83], v[36:37], v[130:131]
    v_pk_fma_f32 v[134:135], v[86:87], v[36:37], v[134:135]
    v_pk_mul_f32 v[28:29], v[128:129], v[128:129]
    v_pk_mul_f32 v[30:31], v[130:131], v[130:131]
    v_pk_fma_f32 v[28:29], v[28:29], v[24:25], v[22:23]
    v_pk_fma_f32 v[30:31], v[30:31], v[24:25], v[22:23]
    v_pk_mul_f32 v[28:29], v[28:29], v[128:129]
    v_pk_mul_f32 v[30:31], v[30:31], v[130:131]
    v_exp_f32 v28, v28
    v_exp_f32 v29, v29
    v_exp_f32 v30, v30
    v_exp_f32 v31, v31
    v_pk_mul_f32 v[32:33], v[128:129], v[132:133]
    v_pk_mul_f32 v[34:35], v[130:131], v[134:135]
    v_pk_add_f32 v[28:29], v[28:29], v[20:21]
    v_pk_add_f32 v[30:31], v[30:31], v[20:21]
    v_rcp_f32 v28, v28
    v_rcp_f32 v29, v29
    v_rcp_f32 v30, v30
    v_rcp_f32 v31, v31
    v_pk_mul_f32 v[32:33], v[32:33], v[26:27]
    v_pk_mul_f32 v[34:35], v[34:35], v[26:27]
    v_pk_mul_f32 v[32:33], v[32:33], v[28:29]
    v_pk_mul_f32 v[34:35], v[34:35], v[30:31]
    v_cvt_pk_bf16_f32 v128, v32, v33
    v_cvt_pk_bf16_f32 v129, v34, v35
    s_add_u32 s62, s62, 147456
    v_mul_f32 v22, s60, v41
    v_mul_f32 v26, v41, v41
    v_mul_f32 v24, s61, v41
    v_mul_f32 v24, v24, v26
    v_mov_b32 v23, v22
    v_mov_b32 v25, v24
    v_mov_b32 v27, v26
    v_mov_b32 v36, v45
    v_mov_b32 v37, v45
    v_pk_fma_f32 v[136:137], v[48:49], v[36:37], v[136:137]
    v_pk_fma_f32 v[140:141], v[52:53], v[36:37], v[140:141]
    v_pk_fma_f32 v[138:139], v[50:51], v[36:37], v[138:139]
    v_pk_fma_f32 v[142:143], v[54:55], v[36:37], v[142:143]
    v_pk_mul_f32 v[28:29], v[136:137], v[136:137]
    v_pk_mul_f32 v[30:31], v[138:139], v[138:139]
    v_pk_fma_f32 v[28:29], v[28:29], v[24:25], v[22:23]
    v_pk_fma_f32 v[30:31], v[30:31], v[24:25], v[22:23]
    v_pk_mul_f32 v[28:29], v[28:29], v[136:137]
    v_pk_mul_f32 v[30:31], v[30:31], v[138:139]
    v_exp_f32 v28, v28
    v_exp_f32 v29, v29
    v_exp_f32 v30, v30
    v_exp_f32 v31, v31
    v_pk_mul_f32 v[32:33], v[136:137], v[140:141]
    v_pk_mul_f32 v[34:35], v[138:139], v[142:143]
    v_pk_add_f32 v[28:29], v[28:29], v[20:21]
    v_pk_add_f32 v[30:31], v[30:31], v[20:21]
    v_rcp_f32 v28, v28
    v_rcp_f32 v29, v29
    v_rcp_f32 v30, v30
    v_rcp_f32 v31, v31
    v_pk_mul_f32 v[32:33], v[32:33], v[26:27]
    v_pk_mul_f32 v[34:35], v[34:35], v[26:27]
    v_pk_mul_f32 v[32:33], v[32:33], v[28:29]
    v_pk_mul_f32 v[34:35], v[34:35], v[30:31]
    v_cvt_pk_bf16_f32 v136, v32, v33
    v_cvt_pk_bf16_f32 v137, v34, v35
    v_pk_fma_f32 v[144:145], v[56:57], v[36:37], v[144:145]
    v_pk_fma_f32 v[148:149], v[60:61], v[36:37], v[148:149]
    v_pk_fma_f32 v[146:147], v[58:59], v[36:37], v[146:147]
    v_pk_fma_f32 v[150:151], v[62:63], v[36:37], v[150:151]
    v_pk_mul_f32 v[28:29], v[144:145], v[144:145]
    v_pk_mul_f32 v[30:31], v[146:147], v[146:147]
    v_pk_fma_f32 v[28:29], v[28:29], v[24:25], v[22:23]
    v_pk_fma_f32 v[30:31], v[30:31], v[24:25], v[22:23]
    v_pk_mul_f32 v[28:29], v[28:29], v[144:145]
    v_pk_mul_f32 v[30:31], v[30:31], v[146:147]
    v_exp_f32 v28, v28
    v_exp_f32 v29, v29
    v_exp_f32 v30, v30
    v_exp_f32 v31, v31
    v_pk_mul_f32 v[32:33], v[144:145], v[148:149]
    v_pk_mul_f32 v[34:35], v[146:147], v[150:151]
    v_pk_add_f32 v[28:29], v[28:29], v[20:21]
    v_pk_add_f32 v[30:31], v[30:31], v[20:21]
    v_rcp_f32 v28, v28
    v_rcp_f32 v29, v29
    v_rcp_f32 v30, v30
    v_rcp_f32 v31, v31
    v_pk_mul_f32 v[32:33], v[32:33], v[26:27]
    v_pk_mul_f32 v[34:35], v[34:35], v[26:27]
    v_pk_mul_f32 v[32:33], v[32:33], v[28:29]
    v_pk_mul_f32 v[34:35], v[34:35], v[30:31]
    v_cvt_pk_bf16_f32 v138, v32, v33
    v_cvt_pk_bf16_f32 v139, v34, v35
    s_nop 1
    v_permlane16_swap_b32 v136, v138
    v_permlane16_swap_b32 v137, v139
    buffer_store_dwordx4 v[136:139], v14, s[52:55], s62 offen offset:0 sc1
    v_pk_fma_f32 v[152:153], v[64:65], v[36:37], v[152:153]
    v_pk_fma_f32 v[156:157], v[68:69], v[36:37], v[156:157]
    v_pk_fma_f32 v[154:155], v[66:67], v[36:37], v[154:155]
    v_pk_fma_f32 v[158:159], v[70:71], v[36:37], v[158:159]
    v_pk_mul_f32 v[28:29], v[152:153], v[152:153]
    v_pk_mul_f32 v[30:31], v[154:155], v[154:155]
    v_pk_fma_f32 v[28:29], v[28:29], v[24:25], v[22:23]
    v_pk_fma_f32 v[30:31], v[30:31], v[24:25], v[22:23]
    v_pk_mul_f32 v[28:29], v[28:29], v[152:153]
    v_pk_mul_f32 v[30:31], v[30:31], v[154:155]
    v_exp_f32 v28, v28
    v_exp_f32 v29, v29
    v_exp_f32 v30, v30
    v_exp_f32 v31, v31
    v_pk_mul_f32 v[32:33], v[152:153], v[156:157]
    v_pk_mul_f32 v[34:35], v[154:155], v[158:159]
    v_pk_add_f32 v[28:29], v[28:29], v[20:21]
    v_pk_add_f32 v[30:31], v[30:31], v[20:21]
    v_rcp_f32 v28, v28
    v_rcp_f32 v29, v29
    v_rcp_f32 v30, v30
    v_rcp_f32 v31, v31
    v_pk_mul_f32 v[32:33], v[32:33], v[26:27]
    v_pk_mul_f32 v[34:35], v[34:35], v[26:27]
    v_pk_mul_f32 v[32:33], v[32:33], v[28:29]
    v_pk_mul_f32 v[34:35], v[34:35], v[30:31]
    v_cvt_pk_bf16_f32 v152, v32, v33
    v_cvt_pk_bf16_f32 v153, v34, v35
    v_pk_fma_f32 v[160:161], v[72:73], v[36:37], v[160:161]
    v_pk_fma_f32 v[164:165], v[76:77], v[36:37], v[164:165]
    v_pk_fma_f32 v[162:163], v[74:75], v[36:37], v[162:163]
    v_pk_fma_f32 v[166:167], v[78:79], v[36:37], v[166:167]
    v_pk_mul_f32 v[28:29], v[160:161], v[160:161]
    v_pk_mul_f32 v[30:31], v[162:163], v[162:163]
    v_pk_fma_f32 v[28:29], v[28:29], v[24:25], v[22:23]
    v_pk_fma_f32 v[30:31], v[30:31], v[24:25], v[22:23]
    v_pk_mul_f32 v[28:29], v[28:29], v[160:161]
    v_pk_mul_f32 v[30:31], v[30:31], v[162:163]
    v_exp_f32 v28, v28
    v_exp_f32 v29, v29
    v_exp_f32 v30, v30
    v_exp_f32 v31, v31
    v_pk_mul_f32 v[32:33], v[160:161], v[164:165]
    v_pk_mul_f32 v[34:35], v[162:163], v[166:167]
    v_pk_add_f32 v[28:29], v[28:29], v[20:21]
    v_pk_add_f32 v[30:31], v[30:31], v[20:21]
    v_rcp_f32 v28, v28
    v_rcp_f32 v29, v29
    v_rcp_f32 v30, v30
    v_rcp_f32 v31, v31
    v_pk_mul_f32 v[32:33], v[32:33], v[26:27]
    v_pk_mul_f32 v[34:35], v[34:35], v[26:27]
    v_pk_mul_f32 v[32:33], v[32:33], v[28:29]
    v_pk_mul_f32 v[34:35], v[34:35], v[30:31]
    v_cvt_pk_bf16_f32 v154, v32, v33
    v_cvt_pk_bf16_f32 v155, v34, v35
    s_nop 1
    v_permlane16_swap_b32 v152, v154
    v_permlane16_swap_b32 v153, v155
    buffer_store_dwordx4 v[152:155], v14, s[52:55], s62 offen offset:1024 sc1
    v_pk_fma_f32 v[168:169], v[80:81], v[36:37], v[168:169]
    v_pk_fma_f32 v[172:173], v[84:85], v[36:37], v[172:173]
    v_pk_fma_f32 v[170:171], v[82:83], v[36:37], v[170:171]
    v_pk_fma_f32 v[174:175], v[86:87], v[36:37], v[174:175]
    v_pk_mul_f32 v[28:29], v[168:169], v[168:169]
    v_pk_mul_f32 v[30:31], v[170:171], v[170:171]
    v_pk_fma_f32 v[28:29], v[28:29], v[24:25], v[22:23]
    v_pk_fma_f32 v[30:31], v[30:31], v[24:25], v[22:23]
    v_pk_mul_f32 v[28:29], v[28:29], v[168:169]
    v_pk_mul_f32 v[30:31], v[30:31], v[170:171]
    v_exp_f32 v28, v28
    v_exp_f32 v29, v29
    v_exp_f32 v30, v30
    v_exp_f32 v31, v31
    v_pk_mul_f32 v[32:33], v[168:169], v[172:173]
    v_pk_mul_f32 v[34:35], v[170:171], v[174:175]
    v_pk_add_f32 v[28:29], v[28:29], v[20:21]
    v_pk_add_f32 v[30:31], v[30:31], v[20:21]
    v_rcp_f32 v28, v28
    v_rcp_f32 v29, v29
    v_rcp_f32 v30, v30
    v_rcp_f32 v31, v31
    v_pk_mul_f32 v[32:33], v[32:33], v[26:27]
    v_pk_mul_f32 v[34:35], v[34:35], v[26:27]
    v_pk_mul_f32 v[32:33], v[32:33], v[28:29]
    v_pk_mul_f32 v[34:35], v[34:35], v[30:31]
    v_cvt_pk_bf16_f32 v130, v32, v33
    v_cvt_pk_bf16_f32 v131, v34, v35
    s_nop 1
    v_permlane16_swap_b32 v128, v130
    v_permlane16_swap_b32 v129, v131
    s_sub_u32 s63, s62, 147456
    buffer_store_dwordx4 v[128:131], v15, s[52:55], s63 offen offset:2048 sc1
    s_add_u32 s62, s62, 147456
    v_mul_f32 v22, s60, v42
    v_mul_f32 v26, v42, v42
    v_mul_f32 v24, s61, v42
    v_mul_f32 v24, v24, v26
    v_mov_b32 v23, v22
    v_mov_b32 v25, v24
    v_mov_b32 v27, v26
    v_mov_b32 v36, v46
    v_mov_b32 v37, v46
    v_pk_fma_f32 v[176:177], v[48:49], v[36:37], v[176:177]
    v_pk_fma_f32 v[180:181], v[52:53], v[36:37], v[180:181]
    v_pk_fma_f32 v[178:179], v[50:51], v[36:37], v[178:179]
    v_pk_fma_f32 v[182:183], v[54:55], v[36:37], v[182:183]
    v_pk_mul_f32 v[28:29], v[176:177], v[176:177]
    v_pk_mul_f32 v[30:31], v[178:179], v[178:179]
    v_pk_fma_f32 v[28:29], v[28:29], v[24:25], v[22:23]
    v_pk_fma_f32 v[30:31], v[30:31], v[24:25], v[22:23]
    v_pk_mul_f32 v[28:29], v[28:29], v[176:177]
    v_pk_mul_f32 v[30:31], v[30:31], v[178:179]
    v_exp_f32 v28, v28
    v_exp_f32 v29, v29
    v_exp_f32 v30, v30
    v_exp_f32 v31, v31
    v_pk_mul_f32 v[32:33], v[176:177], v[180:181]
    v_pk_mul_f32 v[34:35], v[178:179], v[182:183]
    v_pk_add_f32 v[28:29], v[28:29], v[20:21]
    v_pk_add_f32 v[30:31], v[30:31], v[20:21]
    v_rcp_f32 v28, v28
    v_rcp_f32 v29, v29
    v_rcp_f32 v30, v30
    v_rcp_f32 v31, v31
    v_pk_mul_f32 v[32:33], v[32:33], v[26:27]
    v_pk_mul_f32 v[34:35], v[34:35], v[26:27]
    v_pk_mul_f32 v[32:33], v[32:33], v[28:29]
    v_pk_mul_f32 v[34:35], v[34:35], v[30:31]
    v_cvt_pk_bf16_f32 v176, v32, v33
    v_cvt_pk_bf16_f32 v177, v34, v35
    v_pk_fma_f32 v[184:185], v[56:57], v[36:37], v[184:185]
    v_pk_fma_f32 v[188:189], v[60:61], v[36:37], v[188:189]
    v_pk_fma_f32 v[186:187], v[58:59], v[36:37], v[186:187]
    v_pk_fma_f32 v[190:191], v[62:63], v[36:37], v[190:191]
    v_pk_mul_f32 v[28:29], v[184:185], v[184:185]
    v_pk_mul_f32 v[30:31], v[186:187], v[186:187]
    v_pk_fma_f32 v[28:29], v[28:29], v[24:25], v[22:23]
    v_pk_fma_f32 v[30:31], v[30:31], v[24:25], v[22:23]
    v_pk_mul_f32 v[28:29], v[28:29], v[184:185]
    v_pk_mul_f32 v[30:31], v[30:31], v[186:187]
    v_exp_f32 v28, v28
    v_exp_f32 v29, v29
    v_exp_f32 v30, v30
    v_exp_f32 v31, v31
    v_pk_mul_f32 v[32:33], v[184:185], v[188:189]
    v_pk_mul_f32 v[34:35], v[186:187], v[190:191]
    v_pk_add_f32 v[28:29], v[28:29], v[20:21]
    v_pk_add_f32 v[30:31], v[30:31], v[20:21]
    v_rcp_f32 v28, v28
    v_rcp_f32 v29, v29
    v_rcp_f32 v30, v30
    v_rcp_f32 v31, v31
    v_pk_mul_f32 v[32:33], v[32:33], v[26:27]
    v_pk_mul_f32 v[34:35], v[34:35], v[26:27]
    v_pk_mul_f32 v[32:33], v[32:33], v[28:29]
    v_pk_mul_f32 v[34:35], v[34:35], v[30:31]
    v_cvt_pk_bf16_f32 v178, v32, v33
    v_cvt_pk_bf16_f32 v179, v34, v35
    s_nop 1
    v_permlane16_swap_b32 v176, v178
    v_permlane16_swap_b32 v177, v179
    buffer_store_dwordx4 v[176:179], v14, s[52:55], s62 offen offset:0 sc1
    v_pk_fma_f32 v[192:193], v[64:65], v[36:37], v[192:193]
    v_pk_fma_f32 v[196:197], v[68:69], v[36:37], v[196:197]
    v_pk_fma_f32 v[194:195], v[66:67], v[36:37], v[194:195]
    v_pk_fma_f32 v[198:199], v[70:71], v[36:37], v[198:199]
    v_pk_mul_f32 v[28:29], v[192:193], v[192:193]
    v_pk_mul_f32 v[30:31], v[194:195], v[194:195]
    v_pk_fma_f32 v[28:29], v[28:29], v[24:25], v[22:23]
    v_pk_fma_f32 v[30:31], v[30:31], v[24:25], v[22:23]
    v_pk_mul_f32 v[28:29], v[28:29], v[192:193]
    v_pk_mul_f32 v[30:31], v[30:31], v[194:195]
    v_exp_f32 v28, v28
    v_exp_f32 v29, v29
    v_exp_f32 v30, v30
    v_exp_f32 v31, v31
    v_pk_mul_f32 v[32:33], v[192:193], v[196:197]
    v_pk_mul_f32 v[34:35], v[194:195], v[198:199]
    v_pk_add_f32 v[28:29], v[28:29], v[20:21]
    v_pk_add_f32 v[30:31], v[30:31], v[20:21]
    v_rcp_f32 v28, v28
    v_rcp_f32 v29, v29
    v_rcp_f32 v30, v30
    v_rcp_f32 v31, v31
    v_pk_mul_f32 v[32:33], v[32:33], v[26:27]
    v_pk_mul_f32 v[34:35], v[34:35], v[26:27]
    v_pk_mul_f32 v[32:33], v[32:33], v[28:29]
    v_pk_mul_f32 v[34:35], v[34:35], v[30:31]
    v_cvt_pk_bf16_f32 v192, v32, v33
    v_cvt_pk_bf16_f32 v193, v34, v35
    v_pk_fma_f32 v[200:201], v[72:73], v[36:37], v[200:201]
    v_pk_fma_f32 v[204:205], v[76:77], v[36:37], v[204:205]
    v_pk_fma_f32 v[202:203], v[74:75], v[36:37], v[202:203]
    v_pk_fma_f32 v[206:207], v[78:79], v[36:37], v[206:207]
    v_pk_mul_f32 v[28:29], v[200:201], v[200:201]
    v_pk_mul_f32 v[30:31], v[202:203], v[202:203]
    v_pk_fma_f32 v[28:29], v[28:29], v[24:25], v[22:23]
    v_pk_fma_f32 v[30:31], v[30:31], v[24:25], v[22:23]
    v_pk_mul_f32 v[28:29], v[28:29], v[200:201]
    v_pk_mul_f32 v[30:31], v[30:31], v[202:203]
    v_exp_f32 v28, v28
    v_exp_f32 v29, v29
    v_exp_f32 v30, v30
    v_exp_f32 v31, v31
    v_pk_mul_f32 v[32:33], v[200:201], v[204:205]
    v_pk_mul_f32 v[34:35], v[202:203], v[206:207]
    v_pk_add_f32 v[28:29], v[28:29], v[20:21]
    v_pk_add_f32 v[30:31], v[30:31], v[20:21]
    v_rcp_f32 v28, v28
    v_rcp_f32 v29, v29
    v_rcp_f32 v30, v30
    v_rcp_f32 v31, v31
    v_pk_mul_f32 v[32:33], v[32:33], v[26:27]
    v_pk_mul_f32 v[34:35], v[34:35], v[26:27]
    v_pk_mul_f32 v[32:33], v[32:33], v[28:29]
    v_pk_mul_f32 v[34:35], v[34:35], v[30:31]
    v_cvt_pk_bf16_f32 v194, v32, v33
    v_cvt_pk_bf16_f32 v195, v34, v35
    s_nop 1
    v_permlane16_swap_b32 v192, v194
    v_permlane16_swap_b32 v193, v195
    buffer_store_dwordx4 v[192:195], v14, s[52:55], s62 offen offset:1024 sc1
    v_pk_fma_f32 v[208:209], v[80:81], v[36:37], v[208:209]
    v_pk_fma_f32 v[212:213], v[84:85], v[36:37], v[212:213]
    v_pk_fma_f32 v[210:211], v[82:83], v[36:37], v[210:211]
    v_pk_fma_f32 v[214:215], v[86:87], v[36:37], v[214:215]
    v_pk_mul_f32 v[28:29], v[208:209], v[208:209]
    v_pk_mul_f32 v[30:31], v[210:211], v[210:211]
    v_pk_fma_f32 v[28:29], v[28:29], v[24:25], v[22:23]
    v_pk_fma_f32 v[30:31], v[30:31], v[24:25], v[22:23]
    v_pk_mul_f32 v[28:29], v[28:29], v[208:209]
    v_pk_mul_f32 v[30:31], v[30:31], v[210:211]
    v_exp_f32 v28, v28
    v_exp_f32 v29, v29
    v_exp_f32 v30, v30
    v_exp_f32 v31, v31
    v_pk_mul_f32 v[32:33], v[208:209], v[212:213]
    v_pk_mul_f32 v[34:35], v[210:211], v[214:215]
    v_pk_add_f32 v[28:29], v[28:29], v[20:21]
    v_pk_add_f32 v[30:31], v[30:31], v[20:21]
    v_rcp_f32 v28, v28
    v_rcp_f32 v29, v29
    v_rcp_f32 v30, v30
    v_rcp_f32 v31, v31
    v_pk_mul_f32 v[32:33], v[32:33], v[26:27]
    v_pk_mul_f32 v[34:35], v[34:35], v[26:27]
    v_pk_mul_f32 v[32:33], v[32:33], v[28:29]
    v_pk_mul_f32 v[34:35], v[34:35], v[30:31]
    v_cvt_pk_bf16_f32 v208, v32, v33
    v_cvt_pk_bf16_f32 v209, v34, v35
    s_add_u32 s62, s62, 147456
    v_mul_f32 v22, s60, v43
    v_mul_f32 v26, v43, v43
    v_mul_f32 v24, s61, v43
    v_mul_f32 v24, v24, v26
    v_mov_b32 v23, v22
    v_mov_b32 v25, v24
    v_mov_b32 v27, v26
    v_mov_b32 v36, v47
    v_mov_b32 v37, v47
    v_pk_fma_f32 v[216:217], v[48:49], v[36:37], v[216:217]
    v_pk_fma_f32 v[220:221], v[52:53], v[36:37], v[220:221]
    v_pk_fma_f32 v[218:219], v[50:51], v[36:37], v[218:219]
    v_pk_fma_f32 v[222:223], v[54:55], v[36:37], v[222:223]
    v_pk_mul_f32 v[28:29], v[216:217], v[216:217]
    v_pk_mul_f32 v[30:31], v[218:219], v[218:219]
    v_pk_fma_f32 v[28:29], v[28:29], v[24:25], v[22:23]
    v_pk_fma_f32 v[30:31], v[30:31], v[24:25], v[22:23]
    v_pk_mul_f32 v[28:29], v[28:29], v[216:217]
    v_pk_mul_f32 v[30:31], v[30:31], v[218:219]
    v_exp_f32 v28, v28
    v_exp_f32 v29, v29
    v_exp_f32 v30, v30
    v_exp_f32 v31, v31
    v_pk_mul_f32 v[32:33], v[216:217], v[220:221]
    v_pk_mul_f32 v[34:35], v[218:219], v[222:223]
    v_pk_add_f32 v[28:29], v[28:29], v[20:21]
    v_pk_add_f32 v[30:31], v[30:31], v[20:21]
    v_rcp_f32 v28, v28
    v_rcp_f32 v29, v29
    v_rcp_f32 v30, v30
    v_rcp_f32 v31, v31
    v_pk_mul_f32 v[32:33], v[32:33], v[26:27]
    v_pk_mul_f32 v[34:35], v[34:35], v[26:27]
    v_pk_mul_f32 v[32:33], v[32:33], v[28:29]
    v_pk_mul_f32 v[34:35], v[34:35], v[30:31]
    v_cvt_pk_bf16_f32 v216, v32, v33
    v_cvt_pk_bf16_f32 v217, v34, v35
    v_pk_fma_f32 v[224:225], v[56:57], v[36:37], v[224:225]
    v_pk_fma_f32 v[228:229], v[60:61], v[36:37], v[228:229]
    v_pk_fma_f32 v[226:227], v[58:59], v[36:37], v[226:227]
    v_pk_fma_f32 v[230:231], v[62:63], v[36:37], v[230:231]
    v_pk_mul_f32 v[28:29], v[224:225], v[224:225]
    v_pk_mul_f32 v[30:31], v[226:227], v[226:227]
    v_pk_fma_f32 v[28:29], v[28:29], v[24:25], v[22:23]
    v_pk_fma_f32 v[30:31], v[30:31], v[24:25], v[22:23]
    v_pk_mul_f32 v[28:29], v[28:29], v[224:225]
    v_pk_mul_f32 v[30:31], v[30:31], v[226:227]
    v_exp_f32 v28, v28
    v_exp_f32 v29, v29
    v_exp_f32 v30, v30
    v_exp_f32 v31, v31
    v_pk_mul_f32 v[32:33], v[224:225], v[228:229]
    v_pk_mul_f32 v[34:35], v[226:227], v[230:231]
    v_pk_add_f32 v[28:29], v[28:29], v[20:21]
    v_pk_add_f32 v[30:31], v[30:31], v[20:21]
    v_rcp_f32 v28, v28
    v_rcp_f32 v29, v29
    v_rcp_f32 v30, v30
    v_rcp_f32 v31, v31
    v_pk_mul_f32 v[32:33], v[32:33], v[26:27]
    v_pk_mul_f32 v[34:35], v[34:35], v[26:27]
    v_pk_mul_f32 v[32:33], v[32:33], v[28:29]
    v_pk_mul_f32 v[34:35], v[34:35], v[30:31]
    v_cvt_pk_bf16_f32 v218, v32, v33
    v_cvt_pk_bf16_f32 v219, v34, v35
    s_nop 1
    v_permlane16_swap_b32 v216, v218
    v_permlane16_swap_b32 v217, v219
    buffer_store_dwordx4 v[216:219], v14, s[52:55], s62 offen offset:0 sc1
    v_pk_fma_f32 v[232:233], v[64:65], v[36:37], v[232:233]
    v_pk_fma_f32 v[236:237], v[68:69], v[36:37], v[236:237]
    v_pk_fma_f32 v[234:235], v[66:67], v[36:37], v[234:235]
    v_pk_fma_f32 v[238:239], v[70:71], v[36:37], v[238:239]
    v_pk_mul_f32 v[28:29], v[232:233], v[232:233]
    v_pk_mul_f32 v[30:31], v[234:235], v[234:235]
    v_pk_fma_f32 v[28:29], v[28:29], v[24:25], v[22:23]
    v_pk_fma_f32 v[30:31], v[30:31], v[24:25], v[22:23]
    v_pk_mul_f32 v[28:29], v[28:29], v[232:233]
    v_pk_mul_f32 v[30:31], v[30:31], v[234:235]
    v_exp_f32 v28, v28
    v_exp_f32 v29, v29
    v_exp_f32 v30, v30
    v_exp_f32 v31, v31
    v_pk_mul_f32 v[32:33], v[232:233], v[236:237]
    v_pk_mul_f32 v[34:35], v[234:235], v[238:239]
    v_pk_add_f32 v[28:29], v[28:29], v[20:21]
    v_pk_add_f32 v[30:31], v[30:31], v[20:21]
    v_rcp_f32 v28, v28
    v_rcp_f32 v29, v29
    v_rcp_f32 v30, v30
    v_rcp_f32 v31, v31
    v_pk_mul_f32 v[32:33], v[32:33], v[26:27]
    v_pk_mul_f32 v[34:35], v[34:35], v[26:27]
    v_pk_mul_f32 v[32:33], v[32:33], v[28:29]
    v_pk_mul_f32 v[34:35], v[34:35], v[30:31]
    v_cvt_pk_bf16_f32 v232, v32, v33
    v_cvt_pk_bf16_f32 v233, v34, v35
    v_pk_fma_f32 v[240:241], v[72:73], v[36:37], v[240:241]
    v_pk_fma_f32 v[244:245], v[76:77], v[36:37], v[244:245]
    v_pk_fma_f32 v[242:243], v[74:75], v[36:37], v[242:243]
    v_pk_fma_f32 v[246:247], v[78:79], v[36:37], v[246:247]
    v_pk_mul_f32 v[28:29], v[240:241], v[240:241]
    v_pk_mul_f32 v[30:31], v[242:243], v[242:243]
    v_pk_fma_f32 v[28:29], v[28:29], v[24:25], v[22:23]
    v_pk_fma_f32 v[30:31], v[30:31], v[24:25], v[22:23]
    v_pk_mul_f32 v[28:29], v[28:29], v[240:241]
    v_pk_mul_f32 v[30:31], v[30:31], v[242:243]
    v_exp_f32 v28, v28
    v_exp_f32 v29, v29
    v_exp_f32 v30, v30
    v_exp_f32 v31, v31
    v_pk_mul_f32 v[32:33], v[240:241], v[244:245]
    v_pk_mul_f32 v[34:35], v[242:243], v[246:247]
    v_pk_add_f32 v[28:29], v[28:29], v[20:21]
    v_pk_add_f32 v[30:31], v[30:31], v[20:21]
    v_rcp_f32 v28, v28
    v_rcp_f32 v29, v29
    v_rcp_f32 v30, v30
    v_rcp_f32 v31, v31
    v_pk_mul_f32 v[32:33], v[32:33], v[26:27]
    v_pk_mul_f32 v[34:35], v[34:35], v[26:27]
    v_pk_mul_f32 v[32:33], v[32:33], v[28:29]
    v_pk_mul_f32 v[34:35], v[34:35], v[30:31]
    v_cvt_pk_bf16_f32 v234, v32, v33
    v_cvt_pk_bf16_f32 v235, v34, v35
    s_nop 1
    v_permlane16_swap_b32 v232, v234
    v_permlane16_swap_b32 v233, v235
    buffer_store_dwordx4 v[232:235], v14, s[52:55], s62 offen offset:1024 sc1
    v_pk_fma_f32 v[248:249], v[80:81], v[36:37], v[248:249]
    v_pk_fma_f32 v[252:253], v[84:85], v[36:37], v[252:253]
    v_pk_fma_f32 v[250:251], v[82:83], v[36:37], v[250:251]
    v_pk_fma_f32 v[254:255], v[86:87], v[36:37], v[254:255]
    v_pk_mul_f32 v[28:29], v[248:249], v[248:249]
    v_pk_mul_f32 v[30:31], v[250:251], v[250:251]
    v_pk_fma_f32 v[28:29], v[28:29], v[24:25], v[22:23]
    v_pk_fma_f32 v[30:31], v[30:31], v[24:25], v[22:23]
    v_pk_mul_f32 v[28:29], v[28:29], v[248:249]
    v_pk_mul_f32 v[30:31], v[30:31], v[250:251]
    v_exp_f32 v28, v28
    v_exp_f32 v29, v29
    v_exp_f32 v30, v30
    v_exp_f32 v31, v31
    v_pk_mul_f32 v[32:33], v[248:249], v[252:253]
    v_pk_mul_f32 v[34:35], v[250:251], v[254:255]
    v_pk_add_f32 v[28:29], v[28:29], v[20:21]
    v_pk_add_f32 v[30:31], v[30:31], v[20:21]
    v_rcp_f32 v28, v28
    v_rcp_f32 v29, v29
    v_rcp_f32 v30, v30
    v_rcp_f32 v31, v31
    v_pk_mul_f32 v[32:33], v[32:33], v[26:27]
    v_pk_mul_f32 v[34:35], v[34:35], v[26:27]
    v_pk_mul_f32 v[32:33], v[32:33], v[28:29]
    v_pk_mul_f32 v[34:35], v[34:35], v[30:31]
    v_cvt_pk_bf16_f32 v210, v32, v33
    v_cvt_pk_bf16_f32 v211, v34, v35
    s_nop 1
    v_permlane16_swap_b32 v208, v210
    v_permlane16_swap_b32 v209, v211
    s_sub_u32 s63, s62, 147456
    buffer_store_dwordx4 v[208:211], v15, s[52:55], s63 offen offset:2048 sc1
    s_add_u32 s62, s62, 147456
    s_branch L_ffn_done_8
L_ffn_wn1_7:
    v_mov_b32 v20, 0x3f803f80
    v_mov_b32 v21, 0x3f803f80
    v_mov_b32 v22, 0x3f803f80
    v_mov_b32 v23, 0x3f803f80
    s_waitcnt vmcnt(5)
    s_barrier
    ds_read_b128 v[48:51], v8 offset:0
    ds_read_b128 v[52:55], v8 offset:1024
    ds_read_b128 v[56:59], v8 offset:2048
    ds_read_b128 v[60:63], v8 offset:3072
    ds_read_b64_tr_b16 v[80:81], v24 offset:0
    ds_read_b64_tr_b16 v[82:83], v24 offset:3072
    ds_read_b64_tr_b16 v[84:85], v24 offset:12288
    ds_read_b64_tr_b16 v[86:87], v24 offset:15360
    s_waitcnt vmcnt(3)
    s_barrier
    s_waitcnt lgkmcnt(4)
    s_waitcnt lgkmcnt(2)
    v_mfma_f32_16x16x32_bf16 v[96:99], v[80:83], v[48:51], 0
    ds_read_b64_tr_b16 v[88:89], v25 offset:0
    ds_read_b64_tr_b16 v[90:91], v25 offset:3072
    v_mfma_f32_16x16x32_bf16 v[128:131], v[80:83], v[52:55], 0
    v_mfma_f32_16x16x32_bf16 v[160:163], v[80:83], v[56:59], 0
    s_add_u32 m0, s58, 122880
    s_nop 0
    buffer_load_dwordx4 v2, s[36:39], s56 offen sc1 lds
    v_mfma_f32_16x16x32_bf16 v[192:195], v[80:83], v[60:63], 0
    s_waitcnt lgkmcnt(2)
    v_mfma_f32_16x16x32_bf16 v[100:103], v[84:87], v[48:51], 0
    ds_read_b64_tr_b16 v[92:93], v25 offset:12288
    ds_read_b64_tr_b16 v[94:95], v25 offset:15360
    v_mfma_f32_16x16x32_bf16 v[132:135], v[84:87], v[52:55], 0
    v_mfma_f32_16x16x32_bf16 v[164:167], v[84:87], v[56:59], 0
    s_add_u32 m0, s58, 123904
    s_nop 0
    buffer_load_dwordx4 v3, s[36:39], s56 offen sc1 lds
    s_add_u32 s56, s56, 1024
    v_mfma_f32_16x16x32_bf16 v[196:199], v[84:87], v[60:63], 0
    s_cmp_eq_u32 s5, 0
    s_cbranch_scc0 L_ffn_cw_104
    v_mfma_f32_16x16x32_bf16 v[32:35], v[80:83], v[20:23], 0
    v_mfma_f32_16x16x32_bf16 v[36:39], v[84:87], v[20:23], 0
L_ffn_cw_104:
    s_waitcnt lgkmcnt(2)
    v_mfma_f32_16x16x32_bf16 v[104:107], v[88:91], v[48:51], 0
    ds_read_b64_tr_b16 v[80:81], v26 offset:0
    ds_read_b64_tr_b16 v[82:83], v26 offset:3072
    v_mfma_f32_16x16x32_bf16 v[136:139], v[88:91], v[52:55], 0
    ds_read_b128 v[64:67], v8 offset:40960
    v_mfma_f32_16x16x32_bf16 v[168:171], v[88:91], v[56:59], 0
    s_add_u32 m0, s59, 122880
    s_nop 0
    buffer_load_dwordx4 v4, s[40:43], s57 offen lds
    v_mfma_f32_16x16x32_bf16 v[200:203], v[88:91], v[60:63], 0
    s_waitcnt lgkmcnt(3)
    v_mfma_f32_16x16x32_bf16 v[108:111], v[92:95], v[48:51], 0
    ds_read_b64_tr_b16 v[84:85], v26 offset:12288
    ds_read_b64_tr_b16 v[86:87], v26 offset:15360
    v_mfma_f32_16x16x32_bf16 v[140:143], v[92:95], v[52:55], 0
    ds_read_b128 v[68:71], v8 offset:41984
    v_mfma_f32_16x16x32_bf16 v[172:175], v[92:95], v[56:59], 0
    s_add_u32 m0, s59, 123904
    s_nop 0
    buffer_load_dwordx4 v5, s[40:43], s57 offen lds
    v_mfma_f32_16x16x32_bf16 v[204:207], v[92:95], v[60:63], 0
    s_cmp_eq_u32 s5, 1
    s_cbranch_scc0 L_ffn_cw_105
    v_mfma_f32_16x16x32_bf16 v[32:35], v[88:91], v[20:23], 0
    v_mfma_f32_16x16x32_bf16 v[36:39], v[92:95], v[20:23], 0
L_ffn_cw_105:
    s_waitcnt lgkmcnt(4)
    v_mfma_f32_16x16x32_bf16 v[112:115], v[80:83], v[48:51], 0
    ds_read_b64_tr_b16 v[88:89], v27 offset:0
    ds_read_b64_tr_b16 v[90:91], v27 offset:3072
    v_mfma_f32_16x16x32_bf16 v[144:147], v[80:83], v[52:55], 0
    ds_read_b128 v[72:75], v8 offset:43008
    v_mfma_f32_16x16x32_bf16 v[176:179], v[80:83], v[56:59], 0
    s_add_u32 m0, s59, 124928
    s_nop 0
    buffer_load_dwordx4 v6, s[40:43], s57 offen lds
    s_add_u32 s57, s57, 294912
    v_mfma_f32_16x16x32_bf16 v[208:211], v[80:83], v[60:63], 0
    s_waitcnt lgkmcnt(4)
    v_mfma_f32_16x16x32_bf16 v[116:119], v[84:87], v[48:51], 0
    ds_read_b64_tr_b16 v[92:93], v27 offset:12288
    ds_read_b64_tr_b16 v[94:95], v27 offset:15360
    v_mfma_f32_16x16x32_bf16 v[148:151], v[84:87], v[52:55], 0
    ds_read_b128 v[76:79], v8 offset:44032
    v_mfma_f32_16x16x32_bf16 v[180:183], v[84:87], v[56:59], 0
    v_mfma_f32_16x16x32_bf16 v[212:215], v[84:87], v[60:63], 0
    s_cmp_eq_u32 s5, 2
    s_cbranch_scc0 L_ffn_cw_106
    v_mfma_f32_16x16x32_bf16 v[32:35], v[80:83], v[20:23], 0
    v_mfma_f32_16x16x32_bf16 v[36:39], v[84:87], v[20:23], 0
L_ffn_cw_106:
    s_waitcnt lgkmcnt(4)
    v_mfma_f32_16x16x32_bf16 v[120:123], v[88:91], v[48:51], 0
    ds_read_b64_tr_b16 v[80:81], v24 offset:40960
    ds_read_b64_tr_b16 v[82:83], v24 offset:44032
    v_mfma_f32_16x16x32_bf16 v[152:155], v[88:91], v[52:55], 0
    v_mfma_f32_16x16x32_bf16 v[184:187], v[88:91], v[56:59], 0
    v_mfma_f32_16x16x32_bf16 v[216:219], v[88:91], v[60:63], 0
    s_waitcnt lgkmcnt(3)
    v_mfma_f32_16x16x32_bf16 v[124:127], v[92:95], v[48:51], 0
    ds_read_b64_tr_b16 v[84:85], v24 offset:53248
    ds_read_b64_tr_b16 v[86:87], v24 offset:56320
    v_mfma_f32_16x16x32_bf16 v[156:159], v[92:95], v[52:55], 0
    v_mfma_f32_16x16x32_bf16 v[188:191], v[92:95], v[56:59], 0
    v_mfma_f32_16x16x32_bf16 v[220:223], v[92:95], v[60:63], 0
    s_cmp_eq_u32 s5, 3
    s_cbranch_scc0 L_ffn_cw_107
    v_mfma_f32_16x16x32_bf16 v[32:35], v[88:91], v[20:23], 0
    v_mfma_f32_16x16x32_bf16 v[36:39], v[92:95], v[20:23], 0
L_ffn_cw_107:
    s_waitcnt vmcnt(6)
    s_barrier
    s_waitcnt lgkmcnt(4)
    s_waitcnt lgkmcnt(2)
    v_mfma_f32_16x16x32_bf16 v[96:99], v[80:83], v[64:67], v[96:99]
    ds_read_b64_tr_b16 v[88:89], v25 offset:40960
    ds_read_b64_tr_b16 v[90:91], v25 offset:44032
    v_mfma_f32_16x16x32_bf16 v[128:131], v[80:83], v[68:71], v[128:131]
    v_mfma_f32_16x16x32_bf16 v[160:163], v[80:83], v[72:75], v[160:163]
    s_add_u32 m0, s58, 0
    s_nop 0
    buffer_load_dwordx4 v2, s[36:39], s56 offen sc1 lds
    v_mfma_f32_16x16x32_bf16 v[192:195], v[80:83], v[76:79], v[192:195]
    s_waitcnt lgkmcnt(2)
    v_mfma_f32_16x16x32_bf16 v[100:103], v[84:87], v[64:67], v[100:103]
    ds_read_b64_tr_b16 v[92:93], v25 offset:53248
    ds_read_b64_tr_b16 v[94:95], v25 offset:56320
    v_mfma_f32_16x16x32_bf16 v[132:135], v[84:87], v[68:71], v[132:135]
    v_mfma_f32_16x16x32_bf16 v[164:167], v[84:87], v[72:75], v[164:167]
    s_add_u32 m0, s58, 1024
    s_nop 0
    buffer_load_dwordx4 v3, s[36:39], s56 offen sc1 lds
    s_add_u32 s56, s56, 1024
    v_mfma_f32_16x16x32_bf16 v[196:199], v[84:87], v[76:79], v[196:199]
    s_cmp_eq_u32 s5, 0
    s_cbranch_scc0 L_ffn_cw_108
    v_mfma_f32_16x16x32_bf16 v[32:35], v[80:83], v[20:23], v[32:35]
    v_mfma_f32_16x16x32_bf16 v[36:39], v[84:87], v[20:23], v[36:39]
L_ffn_cw_108:
    s_waitcnt lgkmcnt(2)
    v_mfma_f32_16x16x32_bf16 v[104:107], v[88:91], v[64:67], v[104:107]
    ds_read_b64_tr_b16 v[80:81], v26 offset:40960
    ds_read_b64_tr_b16 v[82:83], v26 offset:44032
    v_mfma_f32_16x16x32_bf16 v[136:139], v[88:91], v[68:71], v[136:139]
    ds_read_b128 v[48:51], v9 offset:0
    v_mfma_f32_16x16x32_bf16 v[168:171], v[88:91], v[72:75], v[168:171]
    s_add_u32 m0, s59, 0
    s_nop 0
    buffer_load_dwordx4 v4, s[40:43], s57 offen lds
    v_mfma_f32_16x16x32_bf16 v[200:203], v[88:91], v[76:79], v[200:203]
    s_waitcnt lgkmcnt(3)
    v_mfma_f32_16x16x32_bf16 v[108:111], v[92:95], v[64:67], v[108:111]
    ds_read_b64_tr_b16 v[84:85], v26 offset:53248
    ds_read_b64_tr_b16 v[86:87], v26 offset:56320
    v_mfma_f32_16x16x32_bf16 v[140:143], v[92:95], v[68:71], v[140:143]
    ds_read_b128 v[52:55], v9 offset:1024
    v_mfma_f32_16x16x32_bf16 v[172:175], v[92:95], v[72:75], v[172:175]
    s_add_u32 m0, s59, 1024
    s_nop 0
    buffer_load_dwordx4 v5, s[40:43], s57 offen lds
    v_mfma_f32_16x16x32_bf16 v[204:207], v[92:95], v[76:79], v[204:207]
    s_cmp_eq_u32 s5, 1
    s_cbranch_scc0 L_ffn_cw_109
    v_mfma_f32_16x16x32_bf16 v[32:35], v[88:91], v[20:23], v[32:35]
    v_mfma_f32_16x16x32_bf16 v[36:39], v[92:95], v[20:23], v[36:39]
L_ffn_cw_109:
    s_waitcnt lgkmcnt(4)
    v_mfma_f32_16x16x32_bf16 v[112:115], v[80:83], v[64:67], v[112:115]
    ds_read_b64_tr_b16 v[88:89], v27 offset:40960
    ds_read_b64_tr_b16 v[90:91], v27 offset:44032
    v_mfma_f32_16x16x32_bf16 v[144:147], v[80:83], v[68:71], v[144:147]
    ds_read_b128 v[56:59], v9 offset:2048
    v_mfma_f32_16x16x32_bf16 v[176:179], v[80:83], v[72:75], v[176:179]
    s_add_u32 m0, s59, 2048
    s_nop 0
    buffer_load_dwordx4 v6, s[40:43], s57 offen lds
    s_add_u32 s57, s57, 294912
    v_mfma_f32_16x16x32_bf16 v[208:211], v[80:83], v[76:79], v[208:211]
    s_waitcnt lgkmcnt(4)
    v_mfma_f32_16x16x32_bf16 v[116:119], v[84:87], v[64:67], v[116:119]
    ds_read_b64_tr_b16 v[92:93], v27 offset:53248
    ds_read_b64_tr_b16 v[94:95], v27 offset:56320
    v_mfma_f32_16x16x32_bf16 v[148:151], v[84:87], v[68:71], v[148:151]
    ds_read_b128 v[60:63], v9 offset:3072
    v_mfma_f32_16x16x32_bf16 v[180:183], v[84:87], v[72:75], v[180:183]
    v_mfma_f32_16x16x32_bf16 v[212:215], v[84:87], v[76:79], v[212:215]
    s_cmp_eq_u32 s5, 2
    s_cbranch_scc0 L_ffn_cw_110
    v_mfma_f32_16x16x32_bf16 v[32:35], v[80:83], v[20:23], v[32:35]
    v_mfma_f32_16x16x32_bf16 v[36:39], v[84:87], v[20:23], v[36:39]
L_ffn_cw_110:
    s_waitcnt lgkmcnt(4)
    v_mfma_f32_16x16x32_bf16 v[120:123], v[88:91], v[64:67], v[120:123]
    ds_read_b64_tr_b16 v[80:81], v28 offset:0
    ds_read_b64_tr_b16 v[82:83], v28 offset:3072
    v_mfma_f32_16x16x32_bf16 v[152:155], v[88:91], v[68:71], v[152:155]
    v_mfma_f32_16x16x32_bf16 v[184:187], v[88:91], v[72:75], v[184:187]
    v_mfma_f32_16x16x32_bf16 v[216:219], v[88:91], v[76:79], v[216:219]
    s_waitcnt lgkmcnt(3)
    v_mfma_f32_16x16x32_bf16 v[124:127], v[92:95], v[64:67], v[124:127]
    ds_read_b64_tr_b16 v[84:85], v28 offset:12288
    ds_read_b64_tr_b16 v[86:87], v28 offset:15360
    v_mfma_f32_16x16x32_bf16 v[156:159], v[92:95], v[68:71], v[156:159]
    v_mfma_f32_16x16x32_bf16 v[188:191], v[92:95], v[72:75], v[188:191]
    v_mfma_f32_16x16x32_bf16 v[220:223], v[92:95], v[76:79], v[220:223]
    s_cmp_eq_u32 s5, 3
    s_cbranch_scc0 L_ffn_cw_111
    v_mfma_f32_16x16x32_bf16 v[32:35], v[88:91], v[20:23], v[32:35]
    v_mfma_f32_16x16x32_bf16 v[36:39], v[92:95], v[20:23], v[36:39]
L_ffn_cw_111:
    s_waitcnt vmcnt(5)
    s_barrier
    s_waitcnt lgkmcnt(4)
    s_waitcnt lgkmcnt(2)
    v_mfma_f32_16x16x32_bf16 v[96:99], v[80:83], v[48:51], v[96:99]
    ds_read_b64_tr_b16 v[88:89], v29 offset:0
    ds_read_b64_tr_b16 v[90:91], v29 offset:3072
    v_mfma_f32_16x16x32_bf16 v[128:131], v[80:83], v[52:55], v[128:131]
    v_mfma_f32_16x16x32_bf16 v[160:163], v[80:83], v[56:59], v[160:163]
    s_add_u32 m0, s58, 40960
    s_nop 0
    buffer_load_dwordx4 v2, s[36:39], s56 offen sc1 lds
    v_mfma_f32_16x16x32_bf16 v[192:195], v[80:83], v[60:63], v[192:195]
    s_waitcnt lgkmcnt(2)
    v_mfma_f32_16x16x32_bf16 v[100:103], v[84:87], v[48:51], v[100:103]
    ds_read_b64_tr_b16 v[92:93], v29 offset:12288
    ds_read_b64_tr_b16 v[94:95], v29 offset:15360
    v_mfma_f32_16x16x32_bf16 v[132:135], v[84:87], v[52:55], v[132:135]
    v_mfma_f32_16x16x32_bf16 v[164:167], v[84:87], v[56:59], v[164:167]
    s_add_u32 m0, s58, 41984
    s_nop 0
    buffer_load_dwordx4 v3, s[36:39], s56 offen sc1 lds
    s_add_u32 s56, s56, 1024
    v_mfma_f32_16x16x32_bf16 v[196:199], v[84:87], v[60:63], v[196:199]
    s_cmp_eq_u32 s5, 0
    s_cbranch_scc0 L_ffn_cw_112
    v_mfma_f32_16x16x32_bf16 v[32:35], v[80:83], v[20:23], v[32:35]
    v_mfma_f32_16x16x32_bf16 v[36:39], v[84:87], v[20:23], v[36:39]
L_ffn_cw_112:
    s_waitcnt lgkmcnt(2)
    v_mfma_f32_16x16x32_bf16 v[104:107], v[88:91], v[48:51], v[104:107]
    ds_read_b64_tr_b16 v[80:81], v30 offset:0
    ds_read_b64_tr_b16 v[82:83], v30 offset:3072
    v_mfma_f32_16x16x32_bf16 v[136:139], v[88:91], v[52:55], v[136:139]
    ds_read_b128 v[64:67], v9 offset:40960
    v_mfma_f32_16x16x32_bf16 v[168:171], v[88:91], v[56:59], v[168:171]
    s_add_u32 m0, s59, 40960
    s_nop 0
    buffer_load_dwordx4 v4, s[40:43], s57 offen lds
    v_mfma_f32_16x16x32_bf16 v[200:203], v[88:91], v[60:63], v[200:203]
    s_waitcnt lgkmcnt(3)
    v_mfma_f32_16x16x32_bf16 v[108:111], v[92:95], v[48:51], v[108:111]
    ds_read_b64_tr_b16 v[84:85], v30 offset:12288
    ds_read_b64_tr_b16 v[86:87], v30 offset:15360
    v_mfma_f32_16x16x32_bf16 v[140:143], v[92:95], v[52:55], v[140:143]
    ds_read_b128 v[68:71], v9 offset:41984
    v_mfma_f32_16x16x32_bf16 v[172:175], v[92:95], v[56:59], v[172:175]
    s_add_u32 m0, s59, 41984
    s_nop 0
    buffer_load_dwordx4 v5, s[40:43], s57 offen lds
    v_mfma_f32_16x16x32_bf16 v[204:207], v[92:95], v[60:63], v[204:207]
    s_cmp_eq_u32 s5, 1
    s_cbranch_scc0 L_ffn_cw_113
    v_mfma_f32_16x16x32_bf16 v[32:35], v[88:91], v[20:23], v[32:35]
    v_mfma_f32_16x16x32_bf16 v[36:39], v[92:95], v[20:23], v[36:39]
L_ffn_cw_113:
    s_waitcnt lgkmcnt(4)
    v_mfma_f32_16x16x32_bf16 v[112:115], v[80:83], v[48:51], v[112:115]
    ds_read_b64_tr_b16 v[88:89], v31 offset:0
    ds_read_b64_tr_b16 v[90:91], v31 offset:3072
    v_mfma_f32_16x16x32_bf16 v[144:147], v[80:83], v[52:55], v[144:147]
    ds_read_b128 v[72:75], v9 offset:43008
    v_mfma_f32_16x16x32_bf16 v[176:179], v[80:83], v[56:59], v[176:179]
    s_add_u32 m0, s59, 43008
    s_nop 0
    buffer_load_dwordx4 v6, s[40:43], s57 offen lds
    s_add_u32 s57, s57, 294912
    v_mfma_f32_16x16x32_bf16 v[208:211], v[80:83], v[60:63], v[208:211]
    s_waitcnt lgkmcnt(4)
    v_mfma_f32_16x16x32_bf16 v[116:119], v[84:87], v[48:51], v[116:119]
    ds_read_b64_tr_b16 v[92:93], v31 offset:12288
    ds_read_b64_tr_b16 v[94:95], v31 offset:15360
    v_mfma_f32_16x16x32_bf16 v[148:151], v[84:87], v[52:55], v[148:151]
    ds_read_b128 v[76:79], v9 offset:44032
    v_mfma_f32_16x16x32_bf16 v[180:183], v[84:87], v[56:59], v[180:183]
    v_mfma_f32_16x16x32_bf16 v[212:215], v[84:87], v[60:63], v[212:215]
    s_cmp_eq_u32 s5, 2
    s_cbranch_scc0 L_ffn_cw_114
    v_mfma_f32_16x16x32_bf16 v[32:35], v[80:83], v[20:23], v[32:35]
    v_mfma_f32_16x16x32_bf16 v[36:39], v[84:87], v[20:23], v[36:39]
L_ffn_cw_114:
    s_waitcnt lgkmcnt(4)
    v_mfma_f32_16x16x32_bf16 v[120:123], v[88:91], v[48:51], v[120:123]
    ds_read_b64_tr_b16 v[80:81], v28 offset:40960
    ds_read_b64_tr_b16 v[82:83], v28 offset:44032
    v_mfma_f32_16x16x32_bf16 v[152:155], v[88:91], v[52:55], v[152:155]
    v_mfma_f32_16x16x32_bf16 v[184:187], v[88:91], v[56:59], v[184:187]
    v_mfma_f32_16x16x32_bf16 v[216:219], v[88:91], v[60:63], v[216:219]
    s_waitcnt lgkmcnt(3)
    v_mfma_f32_16x16x32_bf16 v[124:127], v[92:95], v[48:51], v[124:127]
    ds_read_b64_tr_b16 v[84:85], v28 offset:53248
    ds_read_b64_tr_b16 v[86:87], v28 offset:56320
    v_mfma_f32_16x16x32_bf16 v[156:159], v[92:95], v[52:55], v[156:159]
    v_mfma_f32_16x16x32_bf16 v[188:191], v[92:95], v[56:59], v[188:191]
    v_mfma_f32_16x16x32_bf16 v[220:223], v[92:95], v[60:63], v[220:223]
    s_cmp_eq_u32 s5, 3
    s_cbranch_scc0 L_ffn_cw_115
    v_mfma_f32_16x16x32_bf16 v[32:35], v[88:91], v[20:23], v[32:35]
    v_mfma_f32_16x16x32_bf16 v[36:39], v[92:95], v[20:23], v[36:39]
L_ffn_cw_115:
    s_waitcnt vmcnt(5)
    s_barrier
    s_waitcnt lgkmcnt(4)
    s_waitcnt lgkmcnt(2)
    v_mfma_f32_16x16x32_bf16 v[96:99], v[80:83], v[64:67], v[96:99]
    ds_read_b64_tr_b16 v[88:89], v29 offset:40960
    ds_read_b64_tr_b16 v[90:91], v29 offset:44032
    v_mfma_f32_16x16x32_bf16 v[128:131], v[80:83], v[68:71], v[128:131]
    v_mfma_f32_16x16x32_bf16 v[160:163], v[80:83], v[72:75], v[160:163]
    s_add_u32 m0, s58, 81920
    s_nop 0
    buffer_load_dwordx4 v2, s[36:39], s56 offen sc1 lds
    v_mfma_f32_16x16x32_bf16 v[192:195], v[80:83], v[76:79], v[192:195]
    s_waitcnt lgkmcnt(2)
    v_mfma_f32_16x16x32_bf16 v[100:103], v[84:87], v[64:67], v[100:103]
    ds_read_b64_tr_b16 v[92:93], v29 offset:53248
    ds_read_b64_tr_b16 v[94:95], v29 offset:56320
    v_mfma_f32_16x16x32_bf16 v[132:135], v[84:87], v[68:71], v[132:135]
    v_mfma_f32_16x16x32_bf16 v[164:167], v[84:87], v[72:75], v[164:167]
    s_add_u32 m0, s58, 82944
    s_nop 0
    buffer_load_dwordx4 v3, s[36:39], s56 offen sc1 lds
    s_add_u32 s56, s56, 1024
    v_mfma_f32_16x16x32_bf16 v[196:199], v[84:87], v[76:79], v[196:199]
    s_cmp_eq_u32 s5, 0
    s_cbranch_scc0 L_ffn_cw_116
    v_mfma_f32_16x16x32_bf16 v[32:35], v[80:83], v[20:23], v[32:35]
    v_mfma_f32_16x16x32_bf16 v[36:39], v[84:87], v[20:23], v[36:39]
L_ffn_cw_116:
    s_waitcnt lgkmcnt(2)
    v_mfma_f32_16x16x32_bf16 v[104:107], v[88:91], v[64:67], v[104:107]
    ds_read_b64_tr_b16 v[80:81], v30 offset:40960
    ds_read_b64_tr_b16 v[82:83], v30 offset:44032
    v_mfma_f32_16x16x32_bf16 v[136:139], v[88:91], v[68:71], v[136:139]
    ds_read_b128 v[48:51], v8 offset:0
    v_mfma_f32_16x16x32_bf16 v[168:171], v[88:91], v[72:75], v[168:171]
    s_add_u32 m0, s59, 81920
    s_nop 0
    buffer_load_dwordx4 v4, s[40:43], s57 offen lds
    v_mfma_f32_16x16x32_bf16 v[200:203], v[88:91], v[76:79], v[200:203]
    s_waitcnt lgkmcnt(3)
    v_mfma_f32_16x16x32_bf16 v[108:111], v[92:95], v[64:67], v[108:111]
    ds_read_b64_tr_b16 v[84:85], v30 offset:53248
    ds_read_b64_tr_b16 v[86:87], v30 offset:56320
    v_mfma_f32_16x16x32_bf16 v[140:143], v[92:95], v[68:71], v[140:143]
    ds_read_b128 v[52:55], v8 offset:1024
    v_mfma_f32_16x16x32_bf16 v[172:175], v[92:95], v[72:75], v[172:175]
    s_add_u32 m0, s59, 82944
    s_nop 0
    buffer_load_dwordx4 v5, s[40:43], s57 offen lds
    v_mfma_f32_16x16x32_bf16 v[204:207], v[92:95], v[76:79], v[204:207]
    s_cmp_eq_u32 s5, 1
    s_cbranch_scc0 L_ffn_cw_117
    v_mfma_f32_16x16x32_bf16 v[32:35], v[88:91], v[20:23], v[32:35]
    v_mfma_f32_16x16x32_bf16 v[36:39], v[92:95], v[20:23], v[36:39]
L_ffn_cw_117:
    s_waitcnt lgkmcnt(4)
    v_mfma_f32_16x16x32_bf16 v[112:115], v[80:83], v[64:67], v[112:115]
    ds_read_b64_tr_b16 v[88:89], v31 offset:40960
    ds_read_b64_tr_b16 v[90:91], v31 offset:44032
    v_mfma_f32_16x16x32_bf16 v[144:147], v[80:83], v[68:71], v[144:147]
    ds_read_b128 v[56:59], v8 offset:2048
    v_mfma_f32_16x16x32_bf16 v[176:179], v[80:83], v[72:75], v[176:179]
    s_add_u32 m0, s59, 83968
    s_nop 0
    buffer_load_dwordx4 v6, s[40:43], s57 offen lds
    s_add_u32 s57, s57, 294912
    v_mfma_f32_16x16x32_bf16 v[208:211], v[80:83], v[76:79], v[208:211]
    s_waitcnt lgkmcnt(4)
    v_mfma_f32_16x16x32_bf16 v[116:119], v[84:87], v[64:67], v[116:119]
    ds_read_b64_tr_b16 v[92:93], v31 offset:53248
    ds_read_b64_tr_b16 v[94:95], v31 offset:56320
    v_mfma_f32_16x16x32_bf16 v[148:151], v[84:87], v[68:71], v[148:151]
    ds_read_b128 v[60:63], v8 offset:3072
    v_mfma_f32_16x16x32_bf16 v[180:183], v[84:87], v[72:75], v[180:183]
    v_mfma_f32_16x16x32_bf16 v[212:215], v[84:87], v[76:79], v[212:215]
    s_cmp_eq_u32 s5, 2
    s_cbranch_scc0 L_ffn_cw_118
    v_mfma_f32_16x16x32_bf16 v[32:35], v[80:83], v[20:23], v[32:35]
    v_mfma_f32_16x16x32_bf16 v[36:39], v[84:87], v[20:23], v[36:39]
L_ffn_cw_118:
    s_waitcnt lgkmcnt(4)
    v_mfma_f32_16x16x32_bf16 v[120:123], v[88:91], v[64:67], v[120:123]
    ds_read_b64_tr_b16 v[80:81], v24 offset:0
    ds_read_b64_tr_b16 v[82:83], v24 offset:3072
    v_mfma_f32_16x16x32_bf16 v[152:155], v[88:91], v[68:71], v[152:155]
    v_mfma_f32_16x16x32_bf16 v[184:187], v[88:91], v[72:75], v[184:187]
    v_mfma_f32_16x16x32_bf16 v[216:219], v[88:91], v[76:79], v[216:219]
    s_waitcnt lgkmcnt(3)
    v_mfma_f32_16x16x32_bf16 v[124:127], v[92:95], v[64:67], v[124:127]
    ds_read_b64_tr_b16 v[84:85], v24 offset:12288
    ds_read_b64_tr_b16 v[86:87], v24 offset:15360
    v_mfma_f32_16x16x32_bf16 v[156:159], v[92:95], v[68:71], v[156:159]
    v_mfma_f32_16x16x32_bf16 v[188:191], v[92:95], v[72:75], v[188:191]
    v_mfma_f32_16x16x32_bf16 v[220:223], v[92:95], v[76:79], v[220:223]
    s_cmp_eq_u32 s5, 3
    s_cbranch_scc0 L_ffn_cw_119
    v_mfma_f32_16x16x32_bf16 v[32:35], v[88:91], v[20:23], v[32:35]
    v_mfma_f32_16x16x32_bf16 v[36:39], v[92:95], v[20:23], v[36:39]
L_ffn_cw_119:
    s_waitcnt vmcnt(5)
    s_barrier
    s_waitcnt lgkmcnt(4)
    s_waitcnt lgkmcnt(2)
    v_mfma_f32_16x16x32_bf16 v[96:99], v[80:83], v[48:51], v[96:99]
    ds_read_b64_tr_b16 v[88:89], v25 offset:0
    ds_read_b64_tr_b16 v[90:91], v25 offset:3072
    v_mfma_f32_16x16x32_bf16 v[128:131], v[80:83], v[52:55], v[128:131]
    v_mfma_f32_16x16x32_bf16 v[160:163], v[80:83], v[56:59], v[160:163]
    s_add_u32 m0, s58, 122880
    s_nop 0
    buffer_load_dwordx4 v2, s[36:39], s56 offen sc1 lds
    v_mfma_f32_16x16x32_bf16 v[192:195], v[80:83], v[60:63], v[192:195]
    s_waitcnt lgkmcnt(2)
    v_mfma_f32_16x16x32_bf16 v[100:103], v[84:87], v[48:51], v[100:103]
    ds_read_b64_tr_b16 v[92:93], v25 offset:12288
    ds_read_b64_tr_b16 v[94:95], v25 offset:15360
    v_mfma_f32_16x16x32_bf16 v[132:135], v[84:87], v[52:55], v[132:135]
    v_mfma_f32_16x16x32_bf16 v[164:167], v[84:87], v[56:59], v[164:167]
    s_add_u32 m0, s58, 123904
    s_nop 0
    buffer_load_dwordx4 v3, s[36:39], s56 offen sc1 lds
    s_add_u32 s56, s56, 1024
    v_mfma_f32_16x16x32_bf16 v[196:199], v[84:87], v[60:63], v[196:199]
    s_cmp_eq_u32 s5, 0
    s_cbranch_scc0 L_ffn_cw_120
    v_mfma_f32_16x16x32_bf16 v[32:35], v[80:83], v[20:23], v[32:35]
    v_mfma_f32_16x16x32_bf16 v[36:39], v[84:87], v[20:23], v[36:39]
L_ffn_cw_120:
    s_waitcnt lgkmcnt(2)
    v_mfma_f32_16x16x32_bf16 v[104:107], v[88:91], v[48:51], v[104:107]
    ds_read_b64_tr_b16 v[80:81], v26 offset:0
    ds_read_b64_tr_b16 v[82:83], v26 offset:3072
    v_mfma_f32_16x16x32_bf16 v[136:139], v[88:91], v[52:55], v[136:139]
    ds_read_b128 v[64:67], v8 offset:40960
    v_mfma_f32_16x16x32_bf16 v[168:171], v[88:91], v[56:59], v[168:171]
    s_add_u32 m0, s59, 122880
    s_nop 0
    buffer_load_dwordx4 v4, s[40:43], s57 offen lds
    v_mfma_f32_16x16x32_bf16 v[200:203], v[88:91], v[60:63], v[200:203]
    s_waitcnt lgkmcnt(3)
    v_mfma_f32_16x16x32_bf16 v[108:111], v[92:95], v[48:51], v[108:111]
    ds_read_b64_tr_b16 v[84:85], v26 offset:12288
    ds_read_b64_tr_b16 v[86:87], v26 offset:15360
    v_mfma_f32_16x16x32_bf16 v[140:143], v[92:95], v[52:55], v[140:143]
    ds_read_b128 v[68:71], v8 offset:41984
    v_mfma_f32_16x16x32_bf16 v[172:175], v[92:95], v[56:59], v[172:175]
    s_add_u32 m0, s59, 123904
    s_nop 0
    buffer_load_dwordx4 v5, s[40:43], s57 offen lds
    v_mfma_f32_16x16x32_bf16 v[204:207], v[92:95], v[60:63], v[204:207]
    s_cmp_eq_u32 s5, 1
    s_cbranch_scc0 L_ffn_cw_121
    v_mfma_f32_16x16x32_bf16 v[32:35], v[88:91], v[20:23], v[32:35]
    v_mfma_f32_16x16x32_bf16 v[36:39], v[92:95], v[20:23], v[36:39]
L_ffn_cw_121:
    s_waitcnt lgkmcnt(4)
    v_mfma_f32_16x16x32_bf16 v[112:115], v[80:83], v[48:51], v[112:115]
    ds_read_b64_tr_b16 v[88:89], v27 offset:0
    ds_read_b64_tr_b16 v[90:91], v27 offset:3072
    v_mfma_f32_16x16x32_bf16 v[144:147], v[80:83], v[52:55], v[144:147]
    ds_read_b128 v[72:75], v8 offset:43008
    v_mfma_f32_16x16x32_bf16 v[176:179], v[80:83], v[56:59], v[176:179]
    s_add_u32 m0, s59, 124928
    s_nop 0
    buffer_load_dwordx4 v6, s[40:43], s57 offen lds
    s_add_u32 s57, s57, 294912
    v_mfma_f32_16x16x32_bf16 v[208:211], v[80:83], v[60:63], v[208:211]
    s_waitcnt lgkmcnt(4)
    v_mfma_f32_16x16x32_bf16 v[116:119], v[84:87], v[48:51], v[116:119]
    ds_read_b64_tr_b16 v[92:93], v27 offset:12288
    ds_read_b64_tr_b16 v[94:95], v27 offset:15360
    v_mfma_f32_16x16x32_bf16 v[148:151], v[84:87], v[52:55], v[148:151]
    ds_read_b128 v[76:79], v8 offset:44032
    v_mfma_f32_16x16x32_bf16 v[180:183], v[84:87], v[56:59], v[180:183]
    v_mfma_f32_16x16x32_bf16 v[212:215], v[84:87], v[60:63], v[212:215]
    s_cmp_eq_u32 s5, 2
    s_cbranch_scc0 L_ffn_cw_122
    v_mfma_f32_16x16x32_bf16 v[32:35], v[80:83], v[20:23], v[32:35]
    v_mfma_f32_16x16x32_bf16 v[36:39], v[84:87], v[20:23], v[36:39]
L_ffn_cw_122:
    s_waitcnt lgkmcnt(4)
    v_mfma_f32_16x16x32_bf16 v[120:123], v[88:91], v[48:51], v[120:123]
    ds_read_b64_tr_b16 v[80:81], v24 offset:40960
    ds_read_b64_tr_b16 v[82:83], v24 offset:44032
    v_mfma_f32_16x16x32_bf16 v[152:155], v[88:91], v[52:55], v[152:155]
    v_mfma_f32_16x16x32_bf16 v[184:187], v[88:91], v[56:59], v[184:187]
    v_mfma_f32_16x16x32_bf16 v[216:219], v[88:91], v[60:63], v[216:219]
    s_waitcnt lgkmcnt(3)
    v_mfma_f32_16x16x32_bf16 v[124:127], v[92:95], v[48:51], v[124:127]
    ds_read_b64_tr_b16 v[84:85], v24 offset:53248
    ds_read_b64_tr_b16 v[86:87], v24 offset:56320
    v_mfma_f32_16x16x32_bf16 v[156:159], v[92:95], v[52:55], v[156:159]
    v_mfma_f32_16x16x32_bf16 v[188:191], v[92:95], v[56:59], v[188:191]
    v_mfma_f32_16x16x32_bf16 v[220:223], v[92:95], v[60:63], v[220:223]
    s_cmp_eq_u32 s5, 3
    s_cbranch_scc0 L_ffn_cw_123
    v_mfma_f32_16x16x32_bf16 v[32:35], v[88:91], v[20:23], v[32:35]
    v_mfma_f32_16x16x32_bf16 v[36:39], v[92:95], v[20:23], v[36:39]
L_ffn_cw_123:
    s_waitcnt vmcnt(5)
    s_barrier
    s_waitcnt lgkmcnt(4)
    s_waitcnt lgkmcnt(2)
    v_mfma_f32_16x16x32_bf16 v[96:99], v[80:83], v[64:67], v[96:99]
    ds_read_b64_tr_b16 v[88:89], v25 offset:40960
    ds_read_b64_tr_b16 v[90:91], v25 offset:44032
    v_mfma_f32_16x16x32_bf16 v[128:131], v[80:83], v[68:71], v[128:131]
    v_mfma_f32_16x16x32_bf16 v[160:163], v[80:83], v[72:75], v[160:163]
    s_add_u32 m0, s58, 0
    s_nop 0
    buffer_load_dwordx4 v2, s[36:39], s56 offen sc1 lds
    v_mfma_f32_16x16x32_bf16 v[192:195], v[80:83], v[76:79], v[192:195]
    s_waitcnt lgkmcnt(2)
    v_mfma_f32_16x16x32_bf16 v[100:103], v[84:87], v[64:67], v[100:103]
    ds_read_b64_tr_b16 v[92:93], v25 offset:53248
    ds_read_b64_tr_b16 v[94:95], v25 offset:56320
    v_mfma_f32_16x16x32_bf16 v[132:135], v[84:87], v[68:71], v[132:135]
    v_mfma_f32_16x16x32_bf16 v[164:167], v[84:87], v[72:75], v[164:167]
    s_add_u32 m0, s58, 1024
    s_nop 0
    buffer_load_dwordx4 v3, s[36:39], s56 offen sc1 lds
    s_add_u32 s56, s56, 1024
    v_mfma_f32_16x16x32_bf16 v[196:199], v[84:87], v[76:79], v[196:199]
    s_cmp_eq_u32 s5, 0
    s_cbranch_scc0 L_ffn_cw_124
    v_mfma_f32_16x16x32_bf16 v[32:35], v[80:83], v[20:23], v[32:35]
    v_mfma_f32_16x16x32_bf16 v[36:39], v[84:87], v[20:23], v[36:39]
L_ffn_cw_124:
    s_waitcnt lgkmcnt(2)
    v_mfma_f32_16x16x32_bf16 v[104:107], v[88:91], v[64:67], v[104:107]
    ds_read_b64_tr_b16 v[80:81], v26 offset:40960
    ds_read_b64_tr_b16 v[82:83], v26 offset:44032
    v_mfma_f32_16x16x32_bf16 v[136:139], v[88:91], v[68:71], v[136:139]
    ds_read_b128 v[48:51], v9 offset:0
    v_mfma_f32_16x16x32_bf16 v[168:171], v[88:91], v[72:75], v[168:171]
    s_add_u32 m0, s59, 0
    s_nop 0
    buffer_load_dwordx4 v4, s[40:43], s57 offen lds
    v_mfma_f32_16x16x32_bf16 v[200:203], v[88:91], v[76:79], v[200:203]
    s_waitcnt lgkmcnt(3)
    v_mfma_f32_16x16x32_bf16 v[108:111], v[92:95], v[64:67], v[108:111]
    ds_read_b64_tr_b16 v[84:85], v26 offset:53248
    ds_read_b64_tr_b16 v[86:87], v26 offset:56320
    v_mfma_f32_16x16x32_bf16 v[140:143], v[92:95], v[68:71], v[140:143]
    ds_read_b128 v[52:55], v9 offset:1024
    v_mfma_f32_16x16x32_bf16 v[172:175], v[92:95], v[72:75], v[172:175]
    s_add_u32 m0, s59, 1024
    s_nop 0
    buffer_load_dwordx4 v5, s[40:43], s57 offen lds
    v_mfma_f32_16x16x32_bf16 v[204:207], v[92:95], v[76:79], v[204:207]
    s_cmp_eq_u32 s5, 1
    s_cbranch_scc0 L_ffn_cw_125
    v_mfma_f32_16x16x32_bf16 v[32:35], v[88:91], v[20:23], v[32:35]
    v_mfma_f32_16x16x32_bf16 v[36:39], v[92:95], v[20:23], v[36:39]
L_ffn_cw_125:
    s_waitcnt lgkmcnt(4)
    v_mfma_f32_16x16x32_bf16 v[112:115], v[80:83], v[64:67], v[112:115]
    ds_read_b64_tr_b16 v[88:89], v27 offset:40960
    ds_read_b64_tr_b16 v[90:91], v27 offset:44032
    v_mfma_f32_16x16x32_bf16 v[144:147], v[80:83], v[68:71], v[144:147]
    ds_read_b128 v[56:59], v9 offset:2048
    v_mfma_f32_16x16x32_bf16 v[176:179], v[80:83], v[72:75], v[176:179]
    s_add_u32 m0, s59, 2048
    s_nop 0
    buffer_load_dwordx4 v6, s[40:43], s57 offen lds
    s_add_u32 s57, s57, 294912
    v_mfma_f32_16x16x32_bf16 v[208:211], v[80:83], v[76:79], v[208:211]
    s_waitcnt lgkmcnt(4)
    v_mfma_f32_16x16x32_bf16 v[116:119], v[84:87], v[64:67], v[116:119]
    ds_read_b64_tr_b16 v[92:93], v27 offset:53248
    ds_read_b64_tr_b16 v[94:95], v27 offset:56320
    v_mfma_f32_16x16x32_bf16 v[148:151], v[84:87], v[68:71], v[148:151]
    ds_read_b128 v[60:63], v9 offset:3072
    v_mfma_f32_16x16x32_bf16 v[180:183], v[84:87], v[72:75], v[180:183]
    v_mfma_f32_16x16x32_bf16 v[212:215], v[84:87], v[76:79], v[212:215]
    s_cmp_eq_u32 s5, 2
    s_cbranch_scc0 L_ffn_cw_126
    v_mfma_f32_16x16x32_bf16 v[32:35], v[80:83], v[20:23], v[32:35]
    v_mfma_f32_16x16x32_bf16 v[36:39], v[84:87], v[20:23], v[36:39]
L_ffn_cw_126:
    s_waitcnt lgkmcnt(4)
    v_mfma_f32_16x16x32_bf16 v[120:123], v[88:91], v[64:67], v[120:123]
    ds_read_b64_tr_b16 v[80:81], v28 offset:0
    ds_read_b64_tr_b16 v[82:83], v28 offset:3072
    v_mfma_f32_16x16x32_bf16 v[152:155], v[88:91], v[68:71], v[152:155]
    v_mfma_f32_16x16x32_bf16 v[184:187], v[88:91], v[72:75], v[184:187]
    v_mfma_f32_16x16x32_bf16 v[216:219], v[88:91], v[76:79], v[216:219]
    s_waitcnt lgkmcnt(3)
    v_mfma_f32_16x16x32_bf16 v[124:127], v[92:95], v[64:67], v[124:127]
    ds_read_b64_tr_b16 v[84:85], v28 offset:12288
    ds_read_b64_tr_b16 v[86:87], v28 offset:15360
    v_mfma_f32_16x16x32_bf16 v[156:159], v[92:95], v[68:71], v[156:159]
    v_mfma_f32_16x16x32_bf16 v[188:191], v[92:95], v[72:75], v[188:191]
    v_mfma_f32_16x16x32_bf16 v[220:223], v[92:95], v[76:79], v[220:223]
    s_cmp_eq_u32 s5, 3
    s_cbranch_scc0 L_ffn_cw_127
    v_mfma_f32_16x16x32_bf16 v[32:35], v[88:91], v[20:23], v[32:35]
    v_mfma_f32_16x16x32_bf16 v[36:39], v[92:95], v[20:23], v[36:39]
L_ffn_cw_127:
    s_waitcnt vmcnt(5)
    s_barrier
    s_waitcnt lgkmcnt(4)
    s_waitcnt lgkmcnt(2)
    v_mfma_f32_16x16x32_bf16 v[96:99], v[80:83], v[48:51], v[96:99]
    ds_read_b64_tr_b16 v[88:89], v29 offset:0
    ds_read_b64_tr_b16 v[90:91], v29 offset:3072
    v_mfma_f32_16x16x32_bf16 v[128:131], v[80:83], v[52:55], v[128:131]
    v_mfma_f32_16x16x32_bf16 v[160:163], v[80:83], v[56:59], v[160:163]
    s_add_u32 m0, s58, 40960
    s_nop 0
    buffer_load_dwordx4 v2, s[36:39], s56 offen sc1 lds
    v_mfma_f32_16x16x32_bf16 v[192:195], v[80:83], v[60:63], v[192:195]
    s_waitcnt lgkmcnt(2)
    v_mfma_f32_16x16x32_bf16 v[100:103], v[84:87], v[48:51], v[100:103]
    ds_read_b64_tr_b16 v[92:93], v29 offset:12288
    ds_read_b64_tr_b16 v[94:95], v29 offset:15360
    v_mfma_f32_16x16x32_bf16 v[132:135], v[84:87], v[52:55], v[132:135]
    v_mfma_f32_16x16x32_bf16 v[164:167], v[84:87], v[56:59], v[164:167]
    s_add_u32 m0, s58, 41984
    s_nop 0
    buffer_load_dwordx4 v3, s[36:39], s56 offen sc1 lds
    s_add_u32 s56, s56, 1024
    v_mfma_f32_16x16x32_bf16 v[196:199], v[84:87], v[60:63], v[196:199]
    s_cmp_eq_u32 s5, 0
    s_cbranch_scc0 L_ffn_cw_128
    v_mfma_f32_16x16x32_bf16 v[32:35], v[80:83], v[20:23], v[32:35]
    v_mfma_f32_16x16x32_bf16 v[36:39], v[84:87], v[20:23], v[36:39]
L_ffn_cw_128:
    s_waitcnt lgkmcnt(2)
    v_mfma_f32_16x16x32_bf16 v[104:107], v[88:91], v[48:51], v[104:107]
    ds_read_b64_tr_b16 v[80:81], v30 offset:0
    ds_read_b64_tr_b16 v[82:83], v30 offset:3072
    v_mfma_f32_16x16x32_bf16 v[136:139], v[88:91], v[52:55], v[136:139]
    ds_read_b128 v[64:67], v9 offset:40960
    v_mfma_f32_16x16x32_bf16 v[168:171], v[88:91], v[56:59], v[168:171]
    s_add_u32 m0, s59, 40960
    s_nop 0
    buffer_load_dwordx4 v4, s[40:43], s57 offen lds
    v_mfma_f32_16x16x32_bf16 v[200:203], v[88:91], v[60:63], v[200:203]
    s_waitcnt lgkmcnt(3)
    v_mfma_f32_16x16x32_bf16 v[108:111], v[92:95], v[48:51], v[108:111]
    ds_read_b64_tr_b16 v[84:85], v30 offset:12288
    ds_read_b64_tr_b16 v[86:87], v30 offset:15360
    v_mfma_f32_16x16x32_bf16 v[140:143], v[92:95], v[52:55], v[140:143]
    ds_read_b128 v[68:71], v9 offset:41984
    v_mfma_f32_16x16x32_bf16 v[172:175], v[92:95], v[56:59], v[172:175]
    s_add_u32 m0, s59, 41984
    s_nop 0
    buffer_load_dwordx4 v5, s[40:43], s57 offen lds
    v_mfma_f32_16x16x32_bf16 v[204:207], v[92:95], v[60:63], v[204:207]
    s_cmp_eq_u32 s5, 1
    s_cbranch_scc0 L_ffn_cw_129
    v_mfma_f32_16x16x32_bf16 v[32:35], v[88:91], v[20:23], v[32:35]
    v_mfma_f32_16x16x32_bf16 v[36:39], v[92:95], v[20:23], v[36:39]
L_ffn_cw_129:
    s_waitcnt lgkmcnt(4)
    v_mfma_f32_16x16x32_bf16 v[112:115], v[80:83], v[48:51], v[112:115]
    ds_read_b64_tr_b16 v[88:89], v31 offset:0
    ds_read_b64_tr_b16 v[90:91], v31 offset:3072
    v_mfma_f32_16x16x32_bf16 v[144:147], v[80:83], v[52:55], v[144:147]
    ds_read_b128 v[72:75], v9 offset:43008
    v_mfma_f32_16x16x32_bf16 v[176:179], v[80:83], v[56:59], v[176:179]
    s_add_u32 m0, s59, 43008
    s_nop 0
    buffer_load_dwordx4 v6, s[40:43], s57 offen lds
    s_add_u32 s57, s57, 294912
    v_mfma_f32_16x16x32_bf16 v[208:211], v[80:83], v[60:63], v[208:211]
    s_waitcnt lgkmcnt(4)
    v_mfma_f32_16x16x32_bf16 v[116:119], v[84:87], v[48:51], v[116:119]
    ds_read_b64_tr_b16 v[92:93], v31 offset:12288
    ds_read_b64_tr_b16 v[94:95], v31 offset:15360
    v_mfma_f32_16x16x32_bf16 v[148:151], v[84:87], v[52:55], v[148:151]
    ds_read_b128 v[76:79], v9 offset:44032
    v_mfma_f32_16x16x32_bf16 v[180:183], v[84:87], v[56:59], v[180:183]
    v_mfma_f32_16x16x32_bf16 v[212:215], v[84:87], v[60:63], v[212:215]
    s_cmp_eq_u32 s5, 2
    s_cbranch_scc0 L_ffn_cw_130
    v_mfma_f32_16x16x32_bf16 v[32:35], v[80:83], v[20:23], v[32:35]
    v_mfma_f32_16x16x32_bf16 v[36:39], v[84:87], v[20:23], v[36:39]
L_ffn_cw_130:
    s_waitcnt lgkmcnt(4)
    v_mfma_f32_16x16x32_bf16 v[120:123], v[88:91], v[48:51], v[120:123]
    ds_read_b64_tr_b16 v[80:81], v28 offset:40960
    ds_read_b64_tr_b16 v[82:83], v28 offset:44032
    v_mfma_f32_16x16x32_bf16 v[152:155], v[88:91], v[52:55], v[152:155]
    v_mfma_f32_16x16x32_bf16 v[184:187], v[88:91], v[56:59], v[184:187]
    v_mfma_f32_16x16x32_bf16 v[216:219], v[88:91], v[60:63], v[216:219]
    s_waitcnt lgkmcnt(3)
    v_mfma_f32_16x16x32_bf16 v[124:127], v[92:95], v[48:51], v[124:127]
    ds_read_b64_tr_b16 v[84:85], v28 offset:53248
    ds_read_b64_tr_b16 v[86:87], v28 offset:56320
    v_mfma_f32_16x16x32_bf16 v[156:159], v[92:95], v[52:55], v[156:159]
    v_mfma_f32_16x16x32_bf16 v[188:191], v[92:95], v[56:59], v[188:191]
    v_mfma_f32_16x16x32_bf16 v[220:223], v[92:95], v[60:63], v[220:223]
    s_cmp_eq_u32 s5, 3
    s_cbranch_scc0 L_ffn_cw_131
    v_mfma_f32_16x16x32_bf16 v[32:35], v[88:91], v[20:23], v[32:35]
    v_mfma_f32_16x16x32_bf16 v[36:39], v[92:95], v[20:23], v[36:39]
L_ffn_cw_131:
    s_waitcnt vmcnt(5)
    s_barrier
    s_waitcnt lgkmcnt(4)
    s_waitcnt lgkmcnt(2)
    v_mfma_f32_16x16x32_bf16 v[96:99], v[80:83], v[64:67], v[96:99]
    ds_read_b64_tr_b16 v[88:89], v29 offset:40960
    ds_read_b64_tr_b16 v[90:91], v29 offset:44032
    v_mfma_f32_16x16x32_bf16 v[128:131], v[80:83], v[68:71], v[128:131]
    v_mfma_f32_16x16x32_bf16 v[160:163], v[80:83], v[72:75], v[160:163]
    s_add_u32 m0, s58, 81920
    s_nop 0
    buffer_load_dwordx4 v2, s[36:39], s56 offen sc1 lds
    v_mfma_f32_16x16x32_bf16 v[192:195], v[80:83], v[76:79], v[192:195]
    s_waitcnt lgkmcnt(2)
    v_mfma_f32_16x16x32_bf16 v[100:103], v[84:87], v[64:67], v[100:103]
    ds_read_b64_tr_b16 v[92:93], v29 offset:53248
    ds_read_b64_tr_b16 v[94:95], v29 offset:56320
    v_mfma_f32_16x16x32_bf16 v[132:135], v[84:87], v[68:71], v[132:135]
    v_mfma_f32_16x16x32_bf16 v[164:167], v[84:87], v[72:75], v[164:167]
    s_add_u32 m0, s58, 82944
    s_nop 0
    buffer_load_dwordx4 v3, s[36:39], s56 offen sc1 lds
    s_add_u32 s56, s56, 1024
    v_mfma_f32_16x16x32_bf16 v[196:199], v[84:87], v[76:79], v[196:199]
    s_cmp_eq_u32 s5, 0
    s_cbranch_scc0 L_ffn_cw_132
    v_mfma_f32_16x16x32_bf16 v[32:35], v[80:83], v[20:23], v[32:35]
    v_mfma_f32_16x16x32_bf16 v[36:39], v[84:87], v[20:23], v[36:39]
L_ffn_cw_132:
    s_waitcnt lgkmcnt(2)
    v_mfma_f32_16x16x32_bf16 v[104:107], v[88:91], v[64:67], v[104:107]
    ds_read_b64_tr_b16 v[80:81], v30 offset:40960
    ds_read_b64_tr_b16 v[82:83], v30 offset:44032
    v_mfma_f32_16x16x32_bf16 v[136:139], v[88:91], v[68:71], v[136:139]
    ds_read_b128 v[48:51], v8 offset:0
    v_mfma_f32_16x16x32_bf16 v[168:171], v[88:91], v[72:75], v[168:171]
    s_add_u32 m0, s59, 81920
    s_nop 0
    buffer_load_dwordx4 v4, s[40:43], s57 offen lds
    v_mfma_f32_16x16x32_bf16 v[200:203], v[88:91], v[76:79], v[200:203]
    s_waitcnt lgkmcnt(3)
    v_mfma_f32_16x16x32_bf16 v[108:111], v[92:95], v[64:67], v[108:111]
    ds_read_b64_tr_b16 v[84:85], v30 offset:53248
    ds_read_b64_tr_b16 v[86:87], v30 offset:56320
    v_mfma_f32_16x16x32_bf16 v[140:143], v[92:95], v[68:71], v[140:143]
    ds_read_b128 v[52:55], v8 offset:1024
    v_mfma_f32_16x16x32_bf16 v[172:175], v[92:95], v[72:75], v[172:175]
    s_add_u32 m0, s59, 82944
    s_nop 0
    buffer_load_dwordx4 v5, s[40:43], s57 offen lds
    v_mfma_f32_16x16x32_bf16 v[204:207], v[92:95], v[76:79], v[204:207]
    s_cmp_eq_u32 s5, 1
    s_cbranch_scc0 L_ffn_cw_133
    v_mfma_f32_16x16x32_bf16 v[32:35], v[88:91], v[20:23], v[32:35]
    v_mfma_f32_16x16x32_bf16 v[36:39], v[92:95], v[20:23], v[36:39]
L_ffn_cw_133:
    s_waitcnt lgkmcnt(4)
    v_mfma_f32_16x16x32_bf16 v[112:115], v[80:83], v[64:67], v[112:115]
    ds_read_b64_tr_b16 v[88:89], v31 offset:40960
    ds_read_b64_tr_b16 v[90:91], v31 offset:44032
    v_mfma_f32_16x16x32_bf16 v[144:147], v[80:83], v[68:71], v[144:147]
    ds_read_b128 v[56:59], v8 offset:2048
    v_mfma_f32_16x16x32_bf16 v[176:179], v[80:83], v[72:75], v[176:179]
    s_add_u32 m0, s59, 83968
    s_nop 0
    buffer_load_dwordx4 v6, s[40:43], s57 offen lds
    s_add_u32 s57, s57, 294912
    v_mfma_f32_16x16x32_bf16 v[208:211], v[80:83], v[76:79], v[208:211]
    s_waitcnt lgkmcnt(4)
    v_mfma_f32_16x16x32_bf16 v[116:119], v[84:87], v[64:67], v[116:119]
    ds_read_b64_tr_b16 v[92:93], v31 offset:53248
    ds_read_b64_tr_b16 v[94:95], v31 offset:56320
    v_mfma_f32_16x16x32_bf16 v[148:151], v[84:87], v[68:71], v[148:151]
    ds_read_b128 v[60:63], v8 offset:3072
    v_mfma_f32_16x16x32_bf16 v[180:183], v[84:87], v[72:75], v[180:183]
    v_mfma_f32_16x16x32_bf16 v[212:215], v[84:87], v[76:79], v[212:215]
    s_cmp_eq_u32 s5, 2
    s_cbranch_scc0 L_ffn_cw_134
    v_mfma_f32_16x16x32_bf16 v[32:35], v[80:83], v[20:23], v[32:35]
    v_mfma_f32_16x16x32_bf16 v[36:39], v[84:87], v[20:23], v[36:39]
L_ffn_cw_134:
    s_waitcnt lgkmcnt(4)
    v_mfma_f32_16x16x32_bf16 v[120:123], v[88:91], v[64:67], v[120:123]
    ds_read_b64_tr_b16 v[80:81], v24 offset:0
    ds_read_b64_tr_b16 v[82:83], v24 offset:3072
    v_mfma_f32_16x16x32_bf16 v[152:155], v[88:91], v[68:71], v[152:155]
    v_mfma_f32_16x16x32_bf16 v[184:187], v[88:91], v[72:75], v[184:187]
    v_mfma_f32_16x16x32_bf16 v[216:219], v[88:91], v[76:79], v[216:219]
    s_waitcnt lgkmcnt(3)
    v_mfma_f32_16x16x32_bf16 v[124:127], v[92:95], v[64:67], v[124:127]
    ds_read_b64_tr_b16 v[84:85], v24 offset:12288
    ds_read_b64_tr_b16 v[86:87], v24 offset:15360
    v_mfma_f32_16x16x32_bf16 v[156:159], v[92:95], v[68:71], v[156:159]
    v_mfma_f32_16x16x32_bf16 v[188:191], v[92:95], v[72:75], v[188:191]
    v_mfma_f32_16x16x32_bf16 v[220:223], v[92:95], v[76:79], v[220:223]
    s_cmp_eq_u32 s5, 3
    s_cbranch_scc0 L_ffn_cw_135
    v_mfma_f32_16x16x32_bf16 v[32:35], v[88:91], v[20:23], v[32:35]
    v_mfma_f32_16x16x32_bf16 v[36:39], v[92:95], v[20:23], v[36:39]
L_ffn_cw_135:
    s_waitcnt vmcnt(5)
    s_barrier
    s_waitcnt lgkmcnt(4)
    s_waitcnt lgkmcnt(2)
    v_mfma_f32_16x16x32_bf16 v[96:99], v[80:83], v[48:51], v[96:99]
    ds_read_b64_tr_b16 v[88:89], v25 offset:0
    ds_read_b64_tr_b16 v[90:91], v25 offset:3072
    v_mfma_f32_16x16x32_bf16 v[128:131], v[80:83], v[52:55], v[128:131]
    v_mfma_f32_16x16x32_bf16 v[160:163], v[80:83], v[56:59], v[160:163]
    s_add_u32 m0, s58, 122880
    s_nop 0
    buffer_load_dwordx4 v2, s[36:39], s56 offen sc1 lds
    v_mfma_f32_16x16x32_bf16 v[192:195], v[80:83], v[60:63], v[192:195]
    s_waitcnt lgkmcnt(2)
    v_mfma_f32_16x16x32_bf16 v[100:103], v[84:87], v[48:51], v[100:103]
    ds_read_b64_tr_b16 v[92:93], v25 offset:12288
    ds_read_b64_tr_b16 v[94:95], v25 offset:15360
    v_mfma_f32_16x16x32_bf16 v[132:135], v[84:87], v[52:55], v[132:135]
    v_mfma_f32_16x16x32_bf16 v[164:167], v[84:87], v[56:59], v[164:167]
    s_add_u32 m0, s58, 123904
    s_nop 0
    buffer_load_dwordx4 v3, s[36:39], s56 offen sc1 lds
    s_add_u32 s56, s56, 1024
    v_mfma_f32_16x16x32_bf16 v[196:199], v[84:87], v[60:63], v[196:199]
    s_cmp_eq_u32 s5, 0
    s_cbranch_scc0 L_ffn_cw_136
    v_mfma_f32_16x16x32_bf16 v[32:35], v[80:83], v[20:23], v[32:35]
    v_mfma_f32_16x16x32_bf16 v[36:39], v[84:87], v[20:23], v[36:39]
L_ffn_cw_136:
    s_waitcnt lgkmcnt(2)
    v_mfma_f32_16x16x32_bf16 v[104:107], v[88:91], v[48:51], v[104:107]
    ds_read_b64_tr_b16 v[80:81], v26 offset:0
    ds_read_b64_tr_b16 v[82:83], v26 offset:3072
    v_mfma_f32_16x16x32_bf16 v[136:139], v[88:91], v[52:55], v[136:139]
    ds_read_b128 v[64:67], v8 offset:40960
    v_mfma_f32_16x16x32_bf16 v[168:171], v[88:91], v[56:59], v[168:171]
    s_add_u32 m0, s59, 122880
    s_nop 0
    buffer_load_dwordx4 v4, s[40:43], s57 offen lds
    v_mfma_f32_16x16x32_bf16 v[200:203], v[88:91], v[60:63], v[200:203]
    s_waitcnt lgkmcnt(3)
    v_mfma_f32_16x16x32_bf16 v[108:111], v[92:95], v[48:51], v[108:111]
    ds_read_b64_tr_b16 v[84:85], v26 offset:12288
    ds_read_b64_tr_b16 v[86:87], v26 offset:15360
    v_mfma_f32_16x16x32_bf16 v[140:143], v[92:95], v[52:55], v[140:143]
    ds_read_b128 v[68:71], v8 offset:41984
    v_mfma_f32_16x16x32_bf16 v[172:175], v[92:95], v[56:59], v[172:175]
    s_add_u32 m0, s59, 123904
    s_nop 0
    buffer_load_dwordx4 v5, s[40:43], s57 offen lds
    v_mfma_f32_16x16x32_bf16 v[204:207], v[92:95], v[60:63], v[204:207]
    s_cmp_eq_u32 s5, 1
    s_cbranch_scc0 L_ffn_cw_137
    v_mfma_f32_16x16x32_bf16 v[32:35], v[88:91], v[20:23], v[32:35]
    v_mfma_f32_16x16x32_bf16 v[36:39], v[92:95], v[20:23], v[36:39]
L_ffn_cw_137:
    s_waitcnt lgkmcnt(4)
    v_mfma_f32_16x16x32_bf16 v[112:115], v[80:83], v[48:51], v[112:115]
    ds_read_b64_tr_b16 v[88:89], v27 offset:0
    ds_read_b64_tr_b16 v[90:91], v27 offset:3072
    v_mfma_f32_16x16x32_bf16 v[144:147], v[80:83], v[52:55], v[144:147]
    ds_read_b128 v[72:75], v8 offset:43008
    v_mfma_f32_16x16x32_bf16 v[176:179], v[80:83], v[56:59], v[176:179]
    s_add_u32 m0, s59, 124928
    s_nop 0
    buffer_load_dwordx4 v6, s[40:43], s57 offen lds
    s_add_u32 s57, s57, 294912
    v_mfma_f32_16x16x32_bf16 v[208:211], v[80:83], v[60:63], v[208:211]
    s_waitcnt lgkmcnt(4)
    v_mfma_f32_16x16x32_bf16 v[116:119], v[84:87], v[48:51], v[116:119]
    ds_read_b64_tr_b16 v[92:93], v27 offset:12288
    ds_read_b64_tr_b16 v[94:95], v27 offset:15360
    v_mfma_f32_16x16x32_bf16 v[148:151], v[84:87], v[52:55], v[148:151]
    ds_read_b128 v[76:79], v8 offset:44032
    v_mfma_f32_16x16x32_bf16 v[180:183], v[84:87], v[56:59], v[180:183]
    v_mfma_f32_16x16x32_bf16 v[212:215], v[84:87], v[60:63], v[212:215]
    s_cmp_eq_u32 s5, 2
    s_cbranch_scc0 L_ffn_cw_138
    v_mfma_f32_16x16x32_bf16 v[32:35], v[80:83], v[20:23], v[32:35]
    v_mfma_f32_16x16x32_bf16 v[36:39], v[84:87], v[20:23], v[36:39]
L_ffn_cw_138:
    s_waitcnt lgkmcnt(4)
    v_mfma_f32_16x16x32_bf16 v[120:123], v[88:91], v[48:51], v[120:123]
    ds_read_b64_tr_b16 v[80:81], v24 offset:40960
    ds_read_b64_tr_b16 v[82:83], v24 offset:44032
    v_mfma_f32_16x16x32_bf16 v[152:155], v[88:91], v[52:55], v[152:155]
    v_mfma_f32_16x16x32_bf16 v[184:187], v[88:91], v[56:59], v[184:187]
    v_mfma_f32_16x16x32_bf16 v[216:219], v[88:91], v[60:63], v[216:219]
    s_waitcnt lgkmcnt(3)
    v_mfma_f32_16x16x32_bf16 v[124:127], v[92:95], v[48:51], v[124:127]
    ds_read_b64_tr_b16 v[84:85], v24 offset:53248
    ds_read_b64_tr_b16 v[86:87], v24 offset:56320
    v_mfma_f32_16x16x32_bf16 v[156:159], v[92:95], v[52:55], v[156:159]
    v_mfma_f32_16x16x32_bf16 v[188:191], v[92:95], v[56:59], v[188:191]
    v_mfma_f32_16x16x32_bf16 v[220:223], v[92:95], v[60:63], v[220:223]
    s_cmp_eq_u32 s5, 3
    s_cbranch_scc0 L_ffn_cw_139
    v_mfma_f32_16x16x32_bf16 v[32:35], v[88:91], v[20:23], v[32:35]
    v_mfma_f32_16x16x32_bf16 v[36:39], v[92:95], v[20:23], v[36:39]
L_ffn_cw_139:
    s_waitcnt vmcnt(5)
    s_barrier
    s_waitcnt lgkmcnt(4)
    s_waitcnt lgkmcnt(2)
    v_mfma_f32_16x16x32_bf16 v[96:99], v[80:83], v[64:67], v[96:99]
    ds_read_b64_tr_b16 v[88:89], v25 offset:40960
    ds_read_b64_tr_b16 v[90:91], v25 offset:44032
    v_mfma_f32_16x16x32_bf16 v[128:131], v[80:83], v[68:71], v[128:131]
    v_mfma_f32_16x16x32_bf16 v[160:163], v[80:83], v[72:75], v[160:163]
    s_add_u32 m0, s58, 0
    s_nop 0
    buffer_load_dwordx4 v2, s[36:39], s56 offen sc1 lds
    v_mfma_f32_16x16x32_bf16 v[192:195], v[80:83], v[76:79], v[192:195]
    s_waitcnt lgkmcnt(2)
    v_mfma_f32_16x16x32_bf16 v[100:103], v[84:87], v[64:67], v[100:103]
    ds_read_b64_tr_b16 v[92:93], v25 offset:53248
    ds_read_b64_tr_b16 v[94:95], v25 offset:56320
    v_mfma_f32_16x16x32_bf16 v[132:135], v[84:87], v[68:71], v[132:135]
    v_mfma_f32_16x16x32_bf16 v[164:167], v[84:87], v[72:75], v[164:167]
    s_add_u32 m0, s58, 1024
    s_nop 0
    buffer_load_dwordx4 v3, s[36:39], s56 offen sc1 lds
    s_add_u32 s56, s56, 1024
    v_mfma_f32_16x16x32_bf16 v[196:199], v[84:87], v[76:79], v[196:199]
    s_cmp_eq_u32 s5, 0
    s_cbranch_scc0 L_ffn_cw_140
    v_mfma_f32_16x16x32_bf16 v[32:35], v[80:83], v[20:23], v[32:35]
    v_mfma_f32_16x16x32_bf16 v[36:39], v[84:87], v[20:23], v[36:39]
L_ffn_cw_140:
    s_waitcnt lgkmcnt(2)
    v_mfma_f32_16x16x32_bf16 v[104:107], v[88:91], v[64:67], v[104:107]
    ds_read_b64_tr_b16 v[80:81], v26 offset:40960
    ds_read_b64_tr_b16 v[82:83], v26 offset:44032
    v_mfma_f32_16x16x32_bf16 v[136:139], v[88:91], v[68:71], v[136:139]
    ds_read_b128 v[48:51], v9 offset:0
    v_mfma_f32_16x16x32_bf16 v[168:171], v[88:91], v[72:75], v[168:171]
    s_add_u32 m0, s59, 0
    s_nop 0
    buffer_load_dwordx4 v4, s[40:43], s57 offen lds
    v_mfma_f32_16x16x32_bf16 v[200:203], v[88:91], v[76:79], v[200:203]
    s_waitcnt lgkmcnt(3)
    v_mfma_f32_16x16x32_bf16 v[108:111], v[92:95], v[64:67], v[108:111]
    ds_read_b64_tr_b16 v[84:85], v26 offset:53248
    ds_read_b64_tr_b16 v[86:87], v26 offset:56320
    v_mfma_f32_16x16x32_bf16 v[140:143], v[92:95], v[68:71], v[140:143]
    ds_read_b128 v[52:55], v9 offset:1024
    v_mfma_f32_16x16x32_bf16 v[172:175], v[92:95], v[72:75], v[172:175]
    s_add_u32 m0, s59, 1024
    s_nop 0
    buffer_load_dwordx4 v5, s[40:43], s57 offen lds
    v_mfma_f32_16x16x32_bf16 v[204:207], v[92:95], v[76:79], v[204:207]
    s_cmp_eq_u32 s5, 1
    s_cbranch_scc0 L_ffn_cw_141
    v_mfma_f32_16x16x32_bf16 v[32:35], v[88:91], v[20:23], v[32:35]
    v_mfma_f32_16x16x32_bf16 v[36:39], v[92:95], v[20:23], v[36:39]
L_ffn_cw_141:
    s_waitcnt lgkmcnt(4)
    v_mfma_f32_16x16x32_bf16 v[112:115], v[80:83], v[64:67], v[112:115]
    ds_read_b64_tr_b16 v[88:89], v27 offset:40960
    ds_read_b64_tr_b16 v[90:91], v27 offset:44032
    v_mfma_f32_16x16x32_bf16 v[144:147], v[80:83], v[68:71], v[144:147]
    ds_read_b128 v[56:59], v9 offset:2048
    v_mfma_f32_16x16x32_bf16 v[176:179], v[80:83], v[72:75], v[176:179]
    s_add_u32 m0, s59, 2048
    s_nop 0
    buffer_load_dwordx4 v6, s[40:43], s57 offen lds
    s_add_u32 s57, s57, 294912
    v_mfma_f32_16x16x32_bf16 v[208:211], v[80:83], v[76:79], v[208:211]
    s_waitcnt lgkmcnt(4)
    v_mfma_f32_16x16x32_bf16 v[116:119], v[84:87], v[64:67], v[116:119]
    ds_read_b64_tr_b16 v[92:93], v27 offset:53248
    ds_read_b64_tr_b16 v[94:95], v27 offset:56320
    v_mfma_f32_16x16x32_bf16 v[148:151], v[84:87], v[68:71], v[148:151]
    ds_read_b128 v[60:63], v9 offset:3072
    v_mfma_f32_16x16x32_bf16 v[180:183], v[84:87], v[72:75], v[180:183]
    v_mfma_f32_16x16x32_bf16 v[212:215], v[84:87], v[76:79], v[212:215]
    s_cmp_eq_u32 s5, 2
    s_cbranch_scc0 L_ffn_cw_142
    v_mfma_f32_16x16x32_bf16 v[32:35], v[80:83], v[20:23], v[32:35]
    v_mfma_f32_16x16x32_bf16 v[36:39], v[84:87], v[20:23], v[36:39]
L_ffn_cw_142:
    s_waitcnt lgkmcnt(4)
    v_mfma_f32_16x16x32_bf16 v[120:123], v[88:91], v[64:67], v[120:123]
    ds_read_b64_tr_b16 v[80:81], v28 offset:0
    ds_read_b64_tr_b16 v[82:83], v28 offset:3072
    v_mfma_f32_16x16x32_bf16 v[152:155], v[88:91], v[68:71], v[152:155]
    v_mfma_f32_16x16x32_bf16 v[184:187], v[88:91], v[72:75], v[184:187]
    v_mfma_f32_16x16x32_bf16 v[216:219], v[88:91], v[76:79], v[216:219]
    s_waitcnt lgkmcnt(3)
    v_mfma_f32_16x16x32_bf16 v[124:127], v[92:95], v[64:67], v[124:127]
    ds_read_b64_tr_b16 v[84:85], v28 offset:12288
    ds_read_b64_tr_b16 v[86:87], v28 offset:15360
    v_mfma_f32_16x16x32_bf16 v[156:159], v[92:95], v[68:71], v[156:159]
    v_mfma_f32_16x16x32_bf16 v[188:191], v[92:95], v[72:75], v[188:191]
    v_mfma_f32_16x16x32_bf16 v[220:223], v[92:95], v[76:79], v[220:223]
    s_cmp_eq_u32 s5, 3
    s_cbranch_scc0 L_ffn_cw_143
    v_mfma_f32_16x16x32_bf16 v[32:35], v[88:91], v[20:23], v[32:35]
    v_mfma_f32_16x16x32_bf16 v[36:39], v[92:95], v[20:23], v[36:39]
L_ffn_cw_143:
    s_waitcnt vmcnt(5)
    s_barrier
    s_waitcnt lgkmcnt(4)
    s_waitcnt lgkmcnt(2)
    v_mfma_f32_16x16x32_bf16 v[96:99], v[80:83], v[48:51], v[96:99]
    ds_read_b64_tr_b16 v[88:89], v29 offset:0
    ds_read_b64_tr_b16 v[90:91], v29 offset:3072
    v_mfma_f32_16x16x32_bf16 v[128:131], v[80:83], v[52:55], v[128:131]
    v_mfma_f32_16x16x32_bf16 v[160:163], v[80:83], v[56:59], v[160:163]
    s_add_u32 m0, s58, 40960
    s_nop 0
    buffer_load_dwordx4 v2, s[36:39], s56 offen sc1 lds
    v_mfma_f32_16x16x32_bf16 v[192:195], v[80:83], v[60:63], v[192:195]
    s_waitcnt lgkmcnt(2)
    v_mfma_f32_16x16x32_bf16 v[100:103], v[84:87], v[48:51], v[100:103]
    ds_read_b64_tr_b16 v[92:93], v29 offset:12288
    ds_read_b64_tr_b16 v[94:95], v29 offset:15360
    v_mfma_f32_16x16x32_bf16 v[132:135], v[84:87], v[52:55], v[132:135]
    v_mfma_f32_16x16x32_bf16 v[164:167], v[84:87], v[56:59], v[164:167]
    s_add_u32 m0, s58, 41984
    s_nop 0
    buffer_load_dwordx4 v3, s[36:39], s56 offen sc1 lds
    s_add_u32 s56, s56, 1024
    v_mfma_f32_16x16x32_bf16 v[196:199], v[84:87], v[60:63], v[196:199]
    s_cmp_eq_u32 s5, 0
    s_cbranch_scc0 L_ffn_cw_144
    v_mfma_f32_16x16x32_bf16 v[32:35], v[80:83], v[20:23], v[32:35]
    v_mfma_f32_16x16x32_bf16 v[36:39], v[84:87], v[20:23], v[36:39]
L_ffn_cw_144:
    s_waitcnt lgkmcnt(2)
    v_mfma_f32_16x16x32_bf16 v[104:107], v[88:91], v[48:51], v[104:107]
    ds_read_b64_tr_b16 v[80:81], v30 offset:0
    ds_read_b64_tr_b16 v[82:83], v30 offset:3072
    v_mfma_f32_16x16x32_bf16 v[136:139], v[88:91], v[52:55], v[136:139]
    ds_read_b128 v[64:67], v9 offset:40960
    v_mfma_f32_16x16x32_bf16 v[168:171], v[88:91], v[56:59], v[168:171]
    s_add_u32 m0, s59, 40960
    s_nop 0
    buffer_load_dwordx4 v4, s[40:43], s57 offen lds
    v_mfma_f32_16x16x32_bf16 v[200:203], v[88:91], v[60:63], v[200:203]
    s_waitcnt lgkmcnt(3)
    v_mfma_f32_16x16x32_bf16 v[108:111], v[92:95], v[48:51], v[108:111]
    ds_read_b64_tr_b16 v[84:85], v30 offset:12288
    ds_read_b64_tr_b16 v[86:87], v30 offset:15360
    v_mfma_f32_16x16x32_bf16 v[140:143], v[92:95], v[52:55], v[140:143]
    ds_read_b128 v[68:71], v9 offset:41984
    v_mfma_f32_16x16x32_bf16 v[172:175], v[92:95], v[56:59], v[172:175]
    s_add_u32 m0, s59, 41984
    s_nop 0
    buffer_load_dwordx4 v5, s[40:43], s57 offen lds
    v_mfma_f32_16x16x32_bf16 v[204:207], v[92:95], v[60:63], v[204:207]
    s_cmp_eq_u32 s5, 1
    s_cbranch_scc0 L_ffn_cw_145
    v_mfma_f32_16x16x32_bf16 v[32:35], v[88:91], v[20:23], v[32:35]
    v_mfma_f32_16x16x32_bf16 v[36:39], v[92:95], v[20:23], v[36:39]
L_ffn_cw_145:
    s_waitcnt lgkmcnt(4)
    v_mfma_f32_16x16x32_bf16 v[112:115], v[80:83], v[48:51], v[112:115]
    ds_read_b64_tr_b16 v[88:89], v31 offset:0
    ds_read_b64_tr_b16 v[90:91], v31 offset:3072
    v_mfma_f32_16x16x32_bf16 v[144:147], v[80:83], v[52:55], v[144:147]
    ds_read_b128 v[72:75], v9 offset:43008
    v_mfma_f32_16x16x32_bf16 v[176:179], v[80:83], v[56:59], v[176:179]
    s_add_u32 m0, s59, 43008
    s_nop 0
    buffer_load_dwordx4 v6, s[40:43], s57 offen lds
    s_add_u32 s57, s57, 294912
    v_mfma_f32_16x16x32_bf16 v[208:211], v[80:83], v[60:63], v[208:211]
    s_waitcnt lgkmcnt(4)
    v_mfma_f32_16x16x32_bf16 v[116:119], v[84:87], v[48:51], v[116:119]
    ds_read_b64_tr_b16 v[92:93], v31 offset:12288
    ds_read_b64_tr_b16 v[94:95], v31 offset:15360
    v_mfma_f32_16x16x32_bf16 v[148:151], v[84:87], v[52:55], v[148:151]
    ds_read_b128 v[76:79], v9 offset:44032
    v_mfma_f32_16x16x32_bf16 v[180:183], v[84:87], v[56:59], v[180:183]
    v_mfma_f32_16x16x32_bf16 v[212:215], v[84:87], v[60:63], v[212:215]
    s_cmp_eq_u32 s5, 2
    s_cbranch_scc0 L_ffn_cw_146
    v_mfma_f32_16x16x32_bf16 v[32:35], v[80:83], v[20:23], v[32:35]
    v_mfma_f32_16x16x32_bf16 v[36:39], v[84:87], v[20:23], v[36:39]
L_ffn_cw_146:
    s_waitcnt lgkmcnt(4)
    v_mfma_f32_16x16x32_bf16 v[120:123], v[88:91], v[48:51], v[120:123]
    ds_read_b64_tr_b16 v[80:81], v28 offset:40960
    ds_read_b64_tr_b16 v[82:83], v28 offset:44032
    v_mfma_f32_16x16x32_bf16 v[152:155], v[88:91], v[52:55], v[152:155]
    v_mfma_f32_16x16x32_bf16 v[184:187], v[88:91], v[56:59], v[184:187]
    v_mfma_f32_16x16x32_bf16 v[216:219], v[88:91], v[60:63], v[216:219]
    s_waitcnt lgkmcnt(3)
    v_mfma_f32_16x16x32_bf16 v[124:127], v[92:95], v[48:51], v[124:127]
    ds_read_b64_tr_b16 v[84:85], v28 offset:53248
    ds_read_b64_tr_b16 v[86:87], v28 offset:56320
    v_mfma_f32_16x16x32_bf16 v[156:159], v[92:95], v[52:55], v[156:159]
    v_mfma_f32_16x16x32_bf16 v[188:191], v[92:95], v[56:59], v[188:191]
    v_mfma_f32_16x16x32_bf16 v[220:223], v[92:95], v[60:63], v[220:223]
    s_cmp_eq_u32 s5, 3
    s_cbranch_scc0 L_ffn_cw_147
    v_mfma_f32_16x16x32_bf16 v[32:35], v[88:91], v[20:23], v[32:35]
    v_mfma_f32_16x16x32_bf16 v[36:39], v[92:95], v[20:23], v[36:39]
L_ffn_cw_147:
    s_waitcnt vmcnt(5)
    s_barrier
    s_waitcnt lgkmcnt(4)
    s_waitcnt lgkmcnt(2)
    v_mfma_f32_16x16x32_bf16 v[96:99], v[80:83], v[64:67], v[96:99]
    ds_read_b64_tr_b16 v[88:89], v29 offset:40960
    ds_read_b64_tr_b16 v[90:91], v29 offset:44032
    v_mfma_f32_16x16x32_bf16 v[128:131], v[80:83], v[68:71], v[128:131]
    v_mfma_f32_16x16x32_bf16 v[160:163], v[80:83], v[72:75], v[160:163]
    s_add_u32 m0, s58, 81920
    s_nop 0
    buffer_load_dwordx4 v2, s[36:39], s56 offen sc1 lds
    v_mfma_f32_16x16x32_bf16 v[192:195], v[80:83], v[76:79], v[192:195]
    s_waitcnt lgkmcnt(2)
    v_mfma_f32_16x16x32_bf16 v[100:103], v[84:87], v[64:67], v[100:103]
    ds_read_b64_tr_b16 v[92:93], v29 offset:53248
    ds_read_b64_tr_b16 v[94:95], v29 offset:56320
    v_mfma_f32_16x16x32_bf16 v[132:135], v[84:87], v[68:71], v[132:135]
    v_mfma_f32_16x16x32_bf16 v[164:167], v[84:87], v[72:75], v[164:167]
    s_add_u32 m0, s58, 82944
    s_nop 0
    buffer_load_dwordx4 v3, s[36:39], s56 offen sc1 lds
    s_add_u32 s56, s56, 1024
    v_mfma_f32_16x16x32_bf16 v[196:199], v[84:87], v[76:79], v[196:199]
    s_cmp_eq_u32 s5, 0
    s_cbranch_scc0 L_ffn_cw_148
    v_mfma_f32_16x16x32_bf16 v[32:35], v[80:83], v[20:23], v[32:35]
    v_mfma_f32_16x16x32_bf16 v[36:39], v[84:87], v[20:23], v[36:39]
L_ffn_cw_148:
    s_waitcnt lgkmcnt(2)
    v_mfma_f32_16x16x32_bf16 v[104:107], v[88:91], v[64:67], v[104:107]
    ds_read_b64_tr_b16 v[80:81], v30 offset:40960
    ds_read_b64_tr_b16 v[82:83], v30 offset:44032
    v_mfma_f32_16x16x32_bf16 v[136:139], v[88:91], v[68:71], v[136:139]
    ds_read_b128 v[48:51], v8 offset:0
    v_mfma_f32_16x16x32_bf16 v[168:171], v[88:91], v[72:75], v[168:171]
    s_add_u32 m0, s59, 81920
    s_nop 0
    buffer_load_dwordx4 v4, s[40:43], s57 offen lds
    v_mfma_f32_16x16x32_bf16 v[200:203], v[88:91], v[76:79], v[200:203]
    s_waitcnt lgkmcnt(3)
    v_mfma_f32_16x16x32_bf16 v[108:111], v[92:95], v[64:67], v[108:111]
    ds_read_b64_tr_b16 v[84:85], v30 offset:53248
    ds_read_b64_tr_b16 v[86:87], v30 offset:56320
    v_mfma_f32_16x16x32_bf16 v[140:143], v[92:95], v[68:71], v[140:143]
    ds_read_b128 v[52:55], v8 offset:1024
    v_mfma_f32_16x16x32_bf16 v[172:175], v[92:95], v[72:75], v[172:175]
    s_add_u32 m0, s59, 82944
    s_nop 0
    buffer_load_dwordx4 v5, s[40:43], s57 offen lds
    v_mfma_f32_16x16x32_bf16 v[204:207], v[92:95], v[76:79], v[204:207]
    s_cmp_eq_u32 s5, 1
    s_cbranch_scc0 L_ffn_cw_149
    v_mfma_f32_16x16x32_bf16 v[32:35], v[88:91], v[20:23], v[32:35]
    v_mfma_f32_16x16x32_bf16 v[36:39], v[92:95], v[20:23], v[36:39]
L_ffn_cw_149:
    s_waitcnt lgkmcnt(4)
    v_mfma_f32_16x16x32_bf16 v[112:115], v[80:83], v[64:67], v[112:115]
    ds_read_b64_tr_b16 v[88:89], v31 offset:40960
    ds_read_b64_tr_b16 v[90:91], v31 offset:44032
    v_mfma_f32_16x16x32_bf16 v[144:147], v[80:83], v[68:71], v[144:147]
    ds_read_b128 v[56:59], v8 offset:2048
    v_mfma_f32_16x16x32_bf16 v[176:179], v[80:83], v[72:75], v[176:179]
    s_add_u32 m0, s59, 83968
    s_nop 0
    buffer_load_dwordx4 v6, s[40:43], s57 offen lds
    s_add_u32 s57, s57, 294912
    v_mfma_f32_16x16x32_bf16 v[208:211], v[80:83], v[76:79], v[208:211]
    s_waitcnt lgkmcnt(4)
    v_mfma_f32_16x16x32_bf16 v[116:119], v[84:87], v[64:67], v[116:119]
    ds_read_b64_tr_b16 v[92:93], v31 offset:53248
    ds_read_b64_tr_b16 v[94:95], v31 offset:56320
    v_mfma_f32_16x16x32_bf16 v[148:151], v[84:87], v[68:71], v[148:151]
    ds_read_b128 v[60:63], v8 offset:3072
    v_mfma_f32_16x16x32_bf16 v[180:183], v[84:87], v[72:75], v[180:183]
    v_mfma_f32_16x16x32_bf16 v[212:215], v[84:87], v[76:79], v[212:215]
    s_cmp_eq_u32 s5, 2
    s_cbranch_scc0 L_ffn_cw_150
    v_mfma_f32_16x16x32_bf16 v[32:35], v[80:83], v[20:23], v[32:35]
    v_mfma_f32_16x16x32_bf16 v[36:39], v[84:87], v[20:23], v[36:39]
L_ffn_cw_150:
    s_waitcnt lgkmcnt(4)
    v_mfma_f32_16x16x32_bf16 v[120:123], v[88:91], v[64:67], v[120:123]
    ds_read_b64_tr_b16 v[80:81], v24 offset:0
    ds_read_b64_tr_b16 v[82:83], v24 offset:3072
    v_mfma_f32_16x16x32_bf16 v[152:155], v[88:91], v[68:71], v[152:155]
    v_mfma_f32_16x16x32_bf16 v[184:187], v[88:91], v[72:75], v[184:187]
    v_mfma_f32_16x16x32_bf16 v[216:219], v[88:91], v[76:79], v[216:219]
    s_waitcnt lgkmcnt(3)
    v_mfma_f32_16x16x32_bf16 v[124:127], v[92:95], v[64:67], v[124:127]
    ds_read_b64_tr_b16 v[84:85], v24 offset:12288
    ds_read_b64_tr_b16 v[86:87], v24 offset:15360
    v_mfma_f32_16x16x32_bf16 v[156:159], v[92:95], v[68:71], v[156:159]
    v_mfma_f32_16x16x32_bf16 v[188:191], v[92:95], v[72:75], v[188:191]
    v_mfma_f32_16x16x32_bf16 v[220:223], v[92:95], v[76:79], v[220:223]
    s_cmp_eq_u32 s5, 3
    s_cbranch_scc0 L_ffn_cw_151
    v_mfma_f32_16x16x32_bf16 v[32:35], v[88:91], v[20:23], v[32:35]
    v_mfma_f32_16x16x32_bf16 v[36:39], v[92:95], v[20:23], v[36:39]
L_ffn_cw_151:
    s_waitcnt vmcnt(5)
    s_barrier
    s_waitcnt lgkmcnt(4)
    s_waitcnt lgkmcnt(2)
    v_mfma_f32_16x16x32_bf16 v[96:99], v[80:83], v[48:51], v[96:99]
    ds_read_b64_tr_b16 v[88:89], v25 offset:0
    ds_read_b64_tr_b16 v[90:91], v25 offset:3072
    v_mfma_f32_16x16x32_bf16 v[128:131], v[80:83], v[52:55], v[128:131]
    v_mfma_f32_16x16x32_bf16 v[160:163], v[80:83], v[56:59], v[160:163]
    s_add_u32 m0, s58, 122880
    s_nop 0
    buffer_load_dwordx4 v2, s[36:39], s56 offen sc1 lds
    v_mfma_f32_16x16x32_bf16 v[192:195], v[80:83], v[60:63], v[192:195]
    s_waitcnt lgkmcnt(2)
    v_mfma_f32_16x16x32_bf16 v[100:103], v[84:87], v[48:51], v[100:103]
    ds_read_b64_tr_b16 v[92:93], v25 offset:12288
    ds_read_b64_tr_b16 v[94:95], v25 offset:15360
    v_mfma_f32_16x16x32_bf16 v[132:135], v[84:87], v[52:55], v[132:135]
    v_mfma_f32_16x16x32_bf16 v[164:167], v[84:87], v[56:59], v[164:167]
    s_add_u32 m0, s58, 123904
    s_nop 0
    buffer_load_dwordx4 v3, s[36:39], s56 offen sc1 lds
    s_add_u32 s56, s56, 1024
    v_mfma_f32_16x16x32_bf16 v[196:199], v[84:87], v[60:63], v[196:199]
    s_cmp_eq_u32 s5, 0
    s_cbranch_scc0 L_ffn_cw_152
    v_mfma_f32_16x16x32_bf16 v[32:35], v[80:83], v[20:23], v[32:35]
    v_mfma_f32_16x16x32_bf16 v[36:39], v[84:87], v[20:23], v[36:39]
L_ffn_cw_152:
    s_waitcnt lgkmcnt(2)
    v_mfma_f32_16x16x32_bf16 v[104:107], v[88:91], v[48:51], v[104:107]
    ds_read_b64_tr_b16 v[80:81], v26 offset:0
    ds_read_b64_tr_b16 v[82:83], v26 offset:3072
    v_mfma_f32_16x16x32_bf16 v[136:139], v[88:91], v[52:55], v[136:139]
    ds_read_b128 v[64:67], v8 offset:40960
    v_mfma_f32_16x16x32_bf16 v[168:171], v[88:91], v[56:59], v[168:171]
    s_add_u32 m0, s59, 122880
    s_nop 0
    buffer_load_dwordx4 v4, s[40:43], s57 offen lds
    v_mfma_f32_16x16x32_bf16 v[200:203], v[88:91], v[60:63], v[200:203]
    s_waitcnt lgkmcnt(3)
    v_mfma_f32_16x16x32_bf16 v[108:111], v[92:95], v[48:51], v[108:111]
    ds_read_b64_tr_b16 v[84:85], v26 offset:12288
    ds_read_b64_tr_b16 v[86:87], v26 offset:15360
    v_mfma_f32_16x16x32_bf16 v[140:143], v[92:95], v[52:55], v[140:143]
    ds_read_b128 v[68:71], v8 offset:41984
    v_mfma_f32_16x16x32_bf16 v[172:175], v[92:95], v[56:59], v[172:175]
    s_add_u32 m0, s59, 123904
    s_nop 0
    buffer_load_dwordx4 v5, s[40:43], s57 offen lds
    v_mfma_f32_16x16x32_bf16 v[204:207], v[92:95], v[60:63], v[204:207]
    s_cmp_eq_u32 s5, 1
    s_cbranch_scc0 L_ffn_cw_153
    v_mfma_f32_16x16x32_bf16 v[32:35], v[88:91], v[20:23], v[32:35]
    v_mfma_f32_16x16x32_bf16 v[36:39], v[92:95], v[20:23], v[36:39]
L_ffn_cw_153:
    s_waitcnt lgkmcnt(4)
    v_mfma_f32_16x16x32_bf16 v[112:115], v[80:83], v[48:51], v[112:115]
    ds_read_b64_tr_b16 v[88:89], v27 offset:0
    ds_read_b64_tr_b16 v[90:91], v27 offset:3072
    v_mfma_f32_16x16x32_bf16 v[144:147], v[80:83], v[52:55], v[144:147]
    ds_read_b128 v[72:75], v8 offset:43008
    v_mfma_f32_16x16x32_bf16 v[176:179], v[80:83], v[56:59], v[176:179]
    s_add_u32 m0, s59, 124928
    s_nop 0
    buffer_load_dwordx4 v6, s[40:43], s57 offen lds
    s_add_u32 s57, s57, 294912
    v_mfma_f32_16x16x32_bf16 v[208:211], v[80:83], v[60:63], v[208:211]
    s_waitcnt lgkmcnt(4)
    v_mfma_f32_16x16x32_bf16 v[116:119], v[84:87], v[48:51], v[116:119]
    ds_read_b64_tr_b16 v[92:93], v27 offset:12288
    ds_read_b64_tr_b16 v[94:95], v27 offset:15360
    v_mfma_f32_16x16x32_bf16 v[148:151], v[84:87], v[52:55], v[148:151]
    ds_read_b128 v[76:79], v8 offset:44032
    v_mfma_f32_16x16x32_bf16 v[180:183], v[84:87], v[56:59], v[180:183]
    v_mfma_f32_16x16x32_bf16 v[212:215], v[84:87], v[60:63], v[212:215]
    s_cmp_eq_u32 s5, 2
    s_cbranch_scc0 L_ffn_cw_154
    v_mfma_f32_16x16x32_bf16 v[32:35], v[80:83], v[20:23], v[32:35]
    v_mfma_f32_16x16x32_bf16 v[36:39], v[84:87], v[20:23], v[36:39]
L_ffn_cw_154:
    s_waitcnt lgkmcnt(4)
    v_mfma_f32_16x16x32_bf16 v[120:123], v[88:91], v[48:51], v[120:123]
    ds_read_b64_tr_b16 v[80:81], v24 offset:40960
    ds_read_b64_tr_b16 v[82:83], v24 offset:44032
    v_mfma_f32_16x16x32_bf16 v[152:155], v[88:91], v[52:55], v[152:155]
    v_mfma_f32_16x16x32_bf16 v[184:187], v[88:91], v[56:59], v[184:187]
    v_mfma_f32_16x16x32_bf16 v[216:219], v[88:91], v[60:63], v[216:219]
    s_waitcnt lgkmcnt(3)
    v_mfma_f32_16x16x32_bf16 v[124:127], v[92:95], v[48:51], v[124:127]
    ds_read_b64_tr_b16 v[84:85], v24 offset:53248
    ds_read_b64_tr_b16 v[86:87], v24 offset:56320
    v_mfma_f32_16x16x32_bf16 v[156:159], v[92:95], v[52:55], v[156:159]
    v_mfma_f32_16x16x32_bf16 v[188:191], v[92:95], v[56:59], v[188:191]
    v_mfma_f32_16x16x32_bf16 v[220:223], v[92:95], v[60:63], v[220:223]
    s_cmp_eq_u32 s5, 3
    s_cbranch_scc0 L_ffn_cw_155
    v_mfma_f32_16x16x32_bf16 v[32:35], v[88:91], v[20:23], v[32:35]
    v_mfma_f32_16x16x32_bf16 v[36:39], v[92:95], v[20:23], v[36:39]
L_ffn_cw_155:
    s_waitcnt vmcnt(5)
    s_barrier
    s_waitcnt lgkmcnt(4)
    s_waitcnt lgkmcnt(2)
    v_mfma_f32_16x16x32_bf16 v[96:99], v[80:83], v[64:67], v[96:99]
    ds_read_b64_tr_b16 v[88:89], v25 offset:40960
    ds_read_b64_tr_b16 v[90:91], v25 offset:44032
    v_mfma_f32_16x16x32_bf16 v[128:131], v[80:83], v[68:71], v[128:131]
    v_mfma_f32_16x16x32_bf16 v[160:163], v[80:83], v[72:75], v[160:163]
    s_add_u32 m0, s58, 0
    s_nop 0
    buffer_load_dwordx4 v2, s[36:39], s56 offen sc1 lds
    v_mfma_f32_16x16x32_bf16 v[192:195], v[80:83], v[76:79], v[192:195]
    s_waitcnt lgkmcnt(2)
    v_mfma_f32_16x16x32_bf16 v[100:103], v[84:87], v[64:67], v[100:103]
    ds_read_b64_tr_b16 v[92:93], v25 offset:53248
    ds_read_b64_tr_b16 v[94:95], v25 offset:56320
    v_mfma_f32_16x16x32_bf16 v[132:135], v[84:87], v[68:71], v[132:135]
    v_mfma_f32_16x16x32_bf16 v[164:167], v[84:87], v[72:75], v[164:167]
    s_add_u32 m0, s58, 1024
    s_nop 0
    buffer_load_dwordx4 v3, s[36:39], s56 offen sc1 lds
    s_add_u32 s56, s56, 1024
    v_mfma_f32_16x16x32_bf16 v[196:199], v[84:87], v[76:79], v[196:199]
    s_cmp_eq_u32 s5, 0
    s_cbranch_scc0 L_ffn_cw_156
    v_mfma_f32_16x16x32_bf16 v[32:35], v[80:83], v[20:23], v[32:35]
    v_mfma_f32_16x16x32_bf16 v[36:39], v[84:87], v[20:23], v[36:39]
L_ffn_cw_156:
    s_waitcnt lgkmcnt(2)
    v_mfma_f32_16x16x32_bf16 v[104:107], v[88:91], v[64:67], v[104:107]
    ds_read_b64_tr_b16 v[80:81], v26 offset:40960
    ds_read_b64_tr_b16 v[82:83], v26 offset:44032
    v_mfma_f32_16x16x32_bf16 v[136:139], v[88:91], v[68:71], v[136:139]
    ds_read_b128 v[48:51], v9 offset:0
    v_mfma_f32_16x16x32_bf16 v[168:171], v[88:91], v[72:75], v[168:171]
    s_add_u32 m0, s59, 0
    s_nop 0
    buffer_load_dwordx4 v4, s[40:43], s57 offen lds
    v_mfma_f32_16x16x32_bf16 v[200:203], v[88:91], v[76:79], v[200:203]
    s_waitcnt lgkmcnt(3)
    v_mfma_f32_16x16x32_bf16 v[108:111], v[92:95], v[64:67], v[108:111]
    ds_read_b64_tr_b16 v[84:85], v26 offset:53248
    ds_read_b64_tr_b16 v[86:87], v26 offset:56320
    v_mfma_f32_16x16x32_bf16 v[140:143], v[92:95], v[68:71], v[140:143]
    ds_read_b128 v[52:55], v9 offset:1024
    v_mfma_f32_16x16x32_bf16 v[172:175], v[92:95], v[72:75], v[172:175]
    s_add_u32 m0, s59, 1024
    s_nop 0
    buffer_load_dwordx4 v5, s[40:43], s57 offen lds
    v_mfma_f32_16x16x32_bf16 v[204:207], v[92:95], v[76:79], v[204:207]
    s_cmp_eq_u32 s5, 1
    s_cbranch_scc0 L_ffn_cw_157
    v_mfma_f32_16x16x32_bf16 v[32:35], v[88:91], v[20:23], v[32:35]
    v_mfma_f32_16x16x32_bf16 v[36:39], v[92:95], v[20:23], v[36:39]
L_ffn_cw_157:
    s_waitcnt lgkmcnt(4)
    v_mfma_f32_16x16x32_bf16 v[112:115], v[80:83], v[64:67], v[112:115]
    ds_read_b64_tr_b16 v[88:89], v27 offset:40960
    ds_read_b64_tr_b16 v[90:91], v27 offset:44032
    v_mfma_f32_16x16x32_bf16 v[144:147], v[80:83], v[68:71], v[144:147]
    ds_read_b128 v[56:59], v9 offset:2048
    v_mfma_f32_16x16x32_bf16 v[176:179], v[80:83], v[72:75], v[176:179]
    s_add_u32 m0, s59, 2048
    s_nop 0
    buffer_load_dwordx4 v6, s[40:43], s57 offen lds
    s_add_u32 s57, s57, 294912
    v_mfma_f32_16x16x32_bf16 v[208:211], v[80:83], v[76:79], v[208:211]
    s_waitcnt lgkmcnt(4)
    v_mfma_f32_16x16x32_bf16 v[116:119], v[84:87], v[64:67], v[116:119]
    ds_read_b64_tr_b16 v[92:93], v27 offset:53248
    ds_read_b64_tr_b16 v[94:95], v27 offset:56320
    v_mfma_f32_16x16x32_bf16 v[148:151], v[84:87], v[68:71], v[148:151]
    ds_read_b128 v[60:63], v9 offset:3072
    v_mfma_f32_16x16x32_bf16 v[180:183], v[84:87], v[72:75], v[180:183]
    v_mfma_f32_16x16x32_bf16 v[212:215], v[84:87], v[76:79], v[212:215]
    s_cmp_eq_u32 s5, 2
    s_cbranch_scc0 L_ffn_cw_158
    v_mfma_f32_16x16x32_bf16 v[32:35], v[80:83], v[20:23], v[32:35]
    v_mfma_f32_16x16x32_bf16 v[36:39], v[84:87], v[20:23], v[36:39]
L_ffn_cw_158:
    s_waitcnt lgkmcnt(4)
    v_mfma_f32_16x16x32_bf16 v[120:123], v[88:91], v[64:67], v[120:123]
    ds_read_b64_tr_b16 v[80:81], v28 offset:0
    ds_read_b64_tr_b16 v[82:83], v28 offset:3072
    v_mfma_f32_16x16x32_bf16 v[152:155], v[88:91], v[68:71], v[152:155]
    v_mfma_f32_16x16x32_bf16 v[184:187], v[88:91], v[72:75], v[184:187]
    v_mfma_f32_16x16x32_bf16 v[216:219], v[88:91], v[76:79], v[216:219]
    s_waitcnt lgkmcnt(3)
    v_mfma_f32_16x16x32_bf16 v[124:127], v[92:95], v[64:67], v[124:127]
    ds_read_b64_tr_b16 v[84:85], v28 offset:12288
    ds_read_b64_tr_b16 v[86:87], v28 offset:15360
    v_mfma_f32_16x16x32_bf16 v[156:159], v[92:95], v[68:71], v[156:159]
    v_mfma_f32_16x16x32_bf16 v[188:191], v[92:95], v[72:75], v[188:191]
    v_mfma_f32_16x16x32_bf16 v[220:223], v[92:95], v[76:79], v[220:223]
    s_cmp_eq_u32 s5, 3
    s_cbranch_scc0 L_ffn_cw_159
    v_mfma_f32_16x16x32_bf16 v[32:35], v[88:91], v[20:23], v[32:35]
    v_mfma_f32_16x16x32_bf16 v[36:39], v[92:95], v[20:23], v[36:39]
L_ffn_cw_159:
    s_waitcnt vmcnt(5)
    s_barrier
    s_waitcnt lgkmcnt(4)
    s_waitcnt lgkmcnt(2)
    v_mfma_f32_16x16x32_bf16 v[96:99], v[80:83], v[48:51], v[96:99]
    ds_read_b64_tr_b16 v[88:89], v29 offset:0
    ds_read_b64_tr_b16 v[90:91], v29 offset:3072
    v_mfma_f32_16x16x32_bf16 v[128:131], v[80:83], v[52:55], v[128:131]
    v_mfma_f32_16x16x32_bf16 v[160:163], v[80:83], v[56:59], v[160:163]
    s_add_u32 m0, s58, 40960
    s_nop 0
    buffer_load_dwordx4 v2, s[36:39], s56 offen sc1 lds
    v_mfma_f32_16x16x32_bf16 v[192:195], v[80:83], v[60:63], v[192:195]
    s_waitcnt lgkmcnt(2)
    v_mfma_f32_16x16x32_bf16 v[100:103], v[84:87], v[48:51], v[100:103]
    ds_read_b64_tr_b16 v[92:93], v29 offset:12288
    ds_read_b64_tr_b16 v[94:95], v29 offset:15360
    v_mfma_f32_16x16x32_bf16 v[132:135], v[84:87], v[52:55], v[132:135]
    v_mfma_f32_16x16x32_bf16 v[164:167], v[84:87], v[56:59], v[164:167]
    s_add_u32 m0, s58, 41984
    s_nop 0
    buffer_load_dwordx4 v3, s[36:39], s56 offen sc1 lds
    s_add_u32 s56, s56, 1024
    v_mfma_f32_16x16x32_bf16 v[196:199], v[84:87], v[60:63], v[196:199]
    s_cmp_eq_u32 s5, 0
    s_cbranch_scc0 L_ffn_cw_160
    v_mfma_f32_16x16x32_bf16 v[32:35], v[80:83], v[20:23], v[32:35]
    v_mfma_f32_16x16x32_bf16 v[36:39], v[84:87], v[20:23], v[36:39]
L_ffn_cw_160:
    s_waitcnt lgkmcnt(2)
    v_mfma_f32_16x16x32_bf16 v[104:107], v[88:91], v[48:51], v[104:107]
    ds_read_b64_tr_b16 v[80:81], v30 offset:0
    ds_read_b64_tr_b16 v[82:83], v30 offset:3072
    v_mfma_f32_16x16x32_bf16 v[136:139], v[88:91], v[52:55], v[136:139]
    ds_read_b128 v[64:67], v9 offset:40960
    v_mfma_f32_16x16x32_bf16 v[168:171], v[88:91], v[56:59], v[168:171]
    s_add_u32 m0, s59, 40960
    s_nop 0
    buffer_load_dwordx4 v4, s[40:43], s57 offen lds
    v_mfma_f32_16x16x32_bf16 v[200:203], v[88:91], v[60:63], v[200:203]
    s_waitcnt lgkmcnt(3)
    v_mfma_f32_16x16x32_bf16 v[108:111], v[92:95], v[48:51], v[108:111]
    ds_read_b64_tr_b16 v[84:85], v30 offset:12288
    ds_read_b64_tr_b16 v[86:87], v30 offset:15360
    v_mfma_f32_16x16x32_bf16 v[140:143], v[92:95], v[52:55], v[140:143]
    ds_read_b128 v[68:71], v9 offset:41984
    v_mfma_f32_16x16x32_bf16 v[172:175], v[92:95], v[56:59], v[172:175]
    s_add_u32 m0, s59, 41984
    s_nop 0
    buffer_load_dwordx4 v5, s[40:43], s57 offen lds
    v_mfma_f32_16x16x32_bf16 v[204:207], v[92:95], v[60:63], v[204:207]
    s_cmp_eq_u32 s5, 1
    s_cbranch_scc0 L_ffn_cw_161
    v_mfma_f32_16x16x32_bf16 v[32:35], v[88:91], v[20:23], v[32:35]
    v_mfma_f32_16x16x32_bf16 v[36:39], v[92:95], v[20:23], v[36:39]
L_ffn_cw_161:
    s_waitcnt lgkmcnt(4)
    v_mfma_f32_16x16x32_bf16 v[112:115], v[80:83], v[48:51], v[112:115]
    ds_read_b64_tr_b16 v[88:89], v31 offset:0
    ds_read_b64_tr_b16 v[90:91], v31 offset:3072
    v_mfma_f32_16x16x32_bf16 v[144:147], v[80:83], v[52:55], v[144:147]
    ds_read_b128 v[72:75], v9 offset:43008
    v_mfma_f32_16x16x32_bf16 v[176:179], v[80:83], v[56:59], v[176:179]
    s_add_u32 m0, s59, 43008
    s_nop 0
    buffer_load_dwordx4 v6, s[40:43], s57 offen lds
    s_add_u32 s57, s57, 294912
    v_mfma_f32_16x16x32_bf16 v[208:211], v[80:83], v[60:63], v[208:211]
    s_waitcnt lgkmcnt(4)
    v_mfma_f32_16x16x32_bf16 v[116:119], v[84:87], v[48:51], v[116:119]
    ds_read_b64_tr_b16 v[92:93], v31 offset:12288
    ds_read_b64_tr_b16 v[94:95], v31 offset:15360
    v_mfma_f32_16x16x32_bf16 v[148:151], v[84:87], v[52:55], v[148:151]
    ds_read_b128 v[76:79], v9 offset:44032
    v_mfma_f32_16x16x32_bf16 v[180:183], v[84:87], v[56:59], v[180:183]
    v_mfma_f32_16x16x32_bf16 v[212:215], v[84:87], v[60:63], v[212:215]
    s_cmp_eq_u32 s5, 2
    s_cbranch_scc0 L_ffn_cw_162
    v_mfma_f32_16x16x32_bf16 v[32:35], v[80:83], v[20:23], v[32:35]
    v_mfma_f32_16x16x32_bf16 v[36:39], v[84:87], v[20:23], v[36:39]
L_ffn_cw_162:
    s_waitcnt lgkmcnt(4)
    v_mfma_f32_16x16x32_bf16 v[120:123], v[88:91], v[48:51], v[120:123]
    ds_read_b64_tr_b16 v[80:81], v28 offset:40960
    ds_read_b64_tr_b16 v[82:83], v28 offset:44032
    v_mfma_f32_16x16x32_bf16 v[152:155], v[88:91], v[52:55], v[152:155]
    v_mfma_f32_16x16x32_bf16 v[184:187], v[88:91], v[56:59], v[184:187]
    v_mfma_f32_16x16x32_bf16 v[216:219], v[88:91], v[60:63], v[216:219]
    s_waitcnt lgkmcnt(3)
    v_mfma_f32_16x16x32_bf16 v[124:127], v[92:95], v[48:51], v[124:127]
    ds_read_b64_tr_b16 v[84:85], v28 offset:53248
    ds_read_b64_tr_b16 v[86:87], v28 offset:56320
    v_mfma_f32_16x16x32_bf16 v[156:159], v[92:95], v[52:55], v[156:159]
    v_mfma_f32_16x16x32_bf16 v[188:191], v[92:95], v[56:59], v[188:191]
    v_mfma_f32_16x16x32_bf16 v[220:223], v[92:95], v[60:63], v[220:223]
    s_cmp_eq_u32 s5, 3
    s_cbranch_scc0 L_ffn_cw_163
    v_mfma_f32_16x16x32_bf16 v[32:35], v[88:91], v[20:23], v[32:35]
    v_mfma_f32_16x16x32_bf16 v[36:39], v[92:95], v[20:23], v[36:39]
L_ffn_cw_163:
    s_waitcnt vmcnt(5)
    s_barrier
    s_waitcnt lgkmcnt(4)
    s_waitcnt lgkmcnt(2)
    v_mfma_f32_16x16x32_bf16 v[96:99], v[80:83], v[64:67], v[96:99]
    ds_read_b64_tr_b16 v[88:89], v29 offset:40960
    ds_read_b64_tr_b16 v[90:91], v29 offset:44032
    v_mfma_f32_16x16x32_bf16 v[128:131], v[80:83], v[68:71], v[128:131]
    v_mfma_f32_16x16x32_bf16 v[160:163], v[80:83], v[72:75], v[160:163]
    v_mfma_f32_16x16x32_bf16 v[192:195], v[80:83], v[76:79], v[192:195]
    s_waitcnt lgkmcnt(2)
    v_mfma_f32_16x16x32_bf16 v[100:103], v[84:87], v[64:67], v[100:103]
    ds_read_b64_tr_b16 v[92:93], v29 offset:53248
    ds_read_b64_tr_b16 v[94:95], v29 offset:56320
    v_mfma_f32_16x16x32_bf16 v[132:135], v[84:87], v[68:71], v[132:135]
    v_mfma_f32_16x16x32_bf16 v[164:167], v[84:87], v[72:75], v[164:167]
    v_mfma_f32_16x16x32_bf16 v[196:199], v[84:87], v[76:79], v[196:199]
    s_cmp_eq_u32 s5, 0
    s_cbranch_scc0 L_ffn_cw_164
    v_mfma_f32_16x16x32_bf16 v[32:35], v[80:83], v[20:23], v[32:35]
    v_mfma_f32_16x16x32_bf16 v[36:39], v[84:87], v[20:23], v[36:39]
L_ffn_cw_164:
    s_waitcnt lgkmcnt(2)
    v_mfma_f32_16x16x32_bf16 v[104:107], v[88:91], v[64:67], v[104:107]
    ds_read_b64_tr_b16 v[80:81], v30 offset:40960
    ds_read_b64_tr_b16 v[82:83], v30 offset:44032
    v_mfma_f32_16x16x32_bf16 v[136:139], v[88:91], v[68:71], v[136:139]
    ds_read_b128 v[48:51], v8 offset:0
    v_mfma_f32_16x16x32_bf16 v[168:171], v[88:91], v[72:75], v[168:171]
    v_mfma_f32_16x16x32_bf16 v[200:203], v[88:91], v[76:79], v[200:203]
    s_waitcnt lgkmcnt(3)
    v_mfma_f32_16x16x32_bf16 v[108:111], v[92:95], v[64:67], v[108:111]
    ds_read_b64_tr_b16 v[84:85], v30 offset:53248
    ds_read_b64_tr_b16 v[86:87], v30 offset:56320
    v_mfma_f32_16x16x32_bf16 v[140:143], v[92:95], v[68:71], v[140:143]
    ds_read_b128 v[52:55], v8 offset:1024
    v_mfma_f32_16x16x32_bf16 v[172:175], v[92:95], v[72:75], v[172:175]
    v_mfma_f32_16x16x32_bf16 v[204:207], v[92:95], v[76:79], v[204:207]
    s_cmp_eq_u32 s5, 1
    s_cbranch_scc0 L_ffn_cw_165
    v_mfma_f32_16x16x32_bf16 v[32:35], v[88:91], v[20:23], v[32:35]
    v_mfma_f32_16x16x32_bf16 v[36:39], v[92:95], v[20:23], v[36:39]
L_ffn_cw_165:
    s_waitcnt lgkmcnt(4)
    v_mfma_f32_16x16x32_bf16 v[112:115], v[80:83], v[64:67], v[112:115]
    ds_read_b64_tr_b16 v[88:89], v31 offset:40960
    ds_read_b64_tr_b16 v[90:91], v31 offset:44032
    v_mfma_f32_16x16x32_bf16 v[144:147], v[80:83], v[68:71], v[144:147]
    ds_read_b128 v[56:59], v8 offset:2048
    v_mfma_f32_16x16x32_bf16 v[176:179], v[80:83], v[72:75], v[176:179]
    v_mfma_f32_16x16x32_bf16 v[208:211], v[80:83], v[76:79], v[208:211]
    s_waitcnt lgkmcnt(4)
    v_mfma_f32_16x16x32_bf16 v[116:119], v[84:87], v[64:67], v[116:119]
    ds_read_b64_tr_b16 v[92:93], v31 offset:53248
    ds_read_b64_tr_b16 v[94:95], v31 offset:56320
    v_mfma_f32_16x16x32_bf16 v[148:151], v[84:87], v[68:71], v[148:151]
    ds_read_b128 v[60:63], v8 offset:3072
    v_mfma_f32_16x16x32_bf16 v[180:183], v[84:87], v[72:75], v[180:183]
    v_mfma_f32_16x16x32_bf16 v[212:215], v[84:87], v[76:79], v[212:215]
    s_cmp_eq_u32 s5, 2
    s_cbranch_scc0 L_ffn_cw_166
    v_mfma_f32_16x16x32_bf16 v[32:35], v[80:83], v[20:23], v[32:35]
    v_mfma_f32_16x16x32_bf16 v[36:39], v[84:87], v[20:23], v[36:39]
L_ffn_cw_166:
    s_waitcnt lgkmcnt(4)
    v_mfma_f32_16x16x32_bf16 v[120:123], v[88:91], v[64:67], v[120:123]
    ds_read_b64_tr_b16 v[80:81], v24 offset:0
    ds_read_b64_tr_b16 v[82:83], v24 offset:3072
    v_mfma_f32_16x16x32_bf16 v[152:155], v[88:91], v[68:71], v[152:155]
    v_mfma_f32_16x16x32_bf16 v[184:187], v[88:91], v[72:75], v[184:187]
    v_mfma_f32_16x16x32_bf16 v[216:219], v[88:91], v[76:79], v[216:219]
    s_waitcnt lgkmcnt(3)
    v_mfma_f32_16x16x32_bf16 v[124:127], v[92:95], v[64:67], v[124:127]
    ds_read_b64_tr_b16 v[84:85], v24 offset:12288
    ds_read_b64_tr_b16 v[86:87], v24 offset:15360
    v_mfma_f32_16x16x32_bf16 v[156:159], v[92:95], v[68:71], v[156:159]
    v_mfma_f32_16x16x32_bf16 v[188:191], v[92:95], v[72:75], v[188:191]
    v_mfma_f32_16x16x32_bf16 v[220:223], v[92:95], v[76:79], v[220:223]
    s_cmp_eq_u32 s5, 3
    s_cbranch_scc0 L_ffn_cw_167
    v_mfma_f32_16x16x32_bf16 v[32:35], v[88:91], v[20:23], v[32:35]
    v_mfma_f32_16x16x32_bf16 v[36:39], v[92:95], v[20:23], v[36:39]
L_ffn_cw_167:
    s_waitcnt vmcnt(0)
    s_barrier
    s_waitcnt lgkmcnt(4)
    s_waitcnt lgkmcnt(2)
    v_mfma_f32_16x16x32_bf16 v[96:99], v[80:83], v[48:51], v[96:99]
    ds_read_b64_tr_b16 v[88:89], v25 offset:0
    ds_read_b64_tr_b16 v[90:91], v25 offset:3072
    v_mfma_f32_16x16x32_bf16 v[128:131], v[80:83], v[52:55], v[128:131]
    v_mfma_f32_16x16x32_bf16 v[160:163], v[80:83], v[56:59], v[160:163]
    v_mfma_f32_16x16x32_bf16 v[192:195], v[80:83], v[60:63], v[192:195]
    s_waitcnt lgkmcnt(2)
    v_mfma_f32_16x16x32_bf16 v[100:103], v[84:87], v[48:51], v[100:103]
    ds_read_b64_tr_b16 v[92:93], v25 offset:12288
    ds_read_b64_tr_b16 v[94:95], v25 offset:15360
    v_mfma_f32_16x16x32_bf16 v[132:135], v[84:87], v[52:55], v[132:135]
    v_mfma_f32_16x16x32_bf16 v[164:167], v[84:87], v[56:59], v[164:167]
    v_mfma_f32_16x16x32_bf16 v[196:199], v[84:87], v[60:63], v[196:199]
    s_cmp_eq_u32 s5, 0
    s_cbranch_scc0 L_ffn_cw_168
    v_mfma_f32_16x16x32_bf16 v[32:35], v[80:83], v[20:23], v[32:35]
    v_mfma_f32_16x16x32_bf16 v[36:39], v[84:87], v[20:23], v[36:39]
L_ffn_cw_168:
    s_waitcnt lgkmcnt(2)
    v_mfma_f32_16x16x32_bf16 v[104:107], v[88:91], v[48:51], v[104:107]
    ds_read_b64_tr_b16 v[80:81], v26 offset:0
    ds_read_b64_tr_b16 v[82:83], v26 offset:3072
    v_mfma_f32_16x16x32_bf16 v[136:139], v[88:91], v[52:55], v[136:139]
    ds_read_b128 v[64:67], v8 offset:40960
    v_mfma_f32_16x16x32_bf16 v[168:171], v[88:91], v[56:59], v[168:171]
    v_mfma_f32_16x16x32_bf16 v[200:203], v[88:91], v[60:63], v[200:203]
    s_waitcnt lgkmcnt(3)
    v_mfma_f32_16x16x32_bf16 v[108:111], v[92:95], v[48:51], v[108:111]
    ds_read_b64_tr_b16 v[84:85], v26 offset:12288
    ds_read_b64_tr_b16 v[86:87], v26 offset:15360
    v_mfma_f32_16x16x32_bf16 v[140:143], v[92:95], v[52:55], v[140:143]
    ds_read_b128 v[68:71], v8 offset:41984
    v_mfma_f32_16x16x32_bf16 v[172:175], v[92:95], v[56:59], v[172:175]
    v_mfma_f32_16x16x32_bf16 v[204:207], v[92:95], v[60:63], v[204:207]
    s_cmp_eq_u32 s5, 1
    s_cbranch_scc0 L_ffn_cw_169
    v_mfma_f32_16x16x32_bf16 v[32:35], v[88:91], v[20:23], v[32:35]
    v_mfma_f32_16x16x32_bf16 v[36:39], v[92:95], v[20:23], v[36:39]
L_ffn_cw_169:
    s_waitcnt lgkmcnt(4)
    v_mfma_f32_16x16x32_bf16 v[112:115], v[80:83], v[48:51], v[112:115]
    ds_read_b64_tr_b16 v[88:89], v27 offset:0
    ds_read_b64_tr_b16 v[90:91], v27 offset:3072
    v_mfma_f32_16x16x32_bf16 v[144:147], v[80:83], v[52:55], v[144:147]
    ds_read_b128 v[72:75], v8 offset:43008
    v_mfma_f32_16x16x32_bf16 v[176:179], v[80:83], v[56:59], v[176:179]
    v_mfma_f32_16x16x32_bf16 v[208:211], v[80:83], v[60:63], v[208:211]
    s_waitcnt lgkmcnt(4)
    v_mfma_f32_16x16x32_bf16 v[116:119], v[84:87], v[48:51], v[116:119]
    ds_read_b64_tr_b16 v[92:93], v27 offset:12288
    ds_read_b64_tr_b16 v[94:95], v27 offset:15360
    v_mfma_f32_16x16x32_bf16 v[148:151], v[84:87], v[52:55], v[148:151]
    ds_read_b128 v[76:79], v8 offset:44032
    v_mfma_f32_16x16x32_bf16 v[180:183], v[84:87], v[56:59], v[180:183]
    v_mfma_f32_16x16x32_bf16 v[212:215], v[84:87], v[60:63], v[212:215]
    s_cmp_eq_u32 s5, 2
    s_cbranch_scc0 L_ffn_cw_170
    v_mfma_f32_16x16x32_bf16 v[32:35], v[80:83], v[20:23], v[32:35]
    v_mfma_f32_16x16x32_bf16 v[36:39], v[84:87], v[20:23], v[36:39]
L_ffn_cw_170:
    s_waitcnt lgkmcnt(4)
    v_mfma_f32_16x16x32_bf16 v[120:123], v[88:91], v[48:51], v[120:123]
    ds_read_b64_tr_b16 v[80:81], v24 offset:40960
    ds_read_b64_tr_b16 v[82:83], v24 offset:44032
    v_mfma_f32_16x16x32_bf16 v[152:155], v[88:91], v[52:55], v[152:155]
    v_mfma_f32_16x16x32_bf16 v[184:187], v[88:91], v[56:59], v[184:187]
    v_mfma_f32_16x16x32_bf16 v[216:219], v[88:91], v[60:63], v[216:219]
    s_waitcnt lgkmcnt(3)
    v_mfma_f32_16x16x32_bf16 v[124:127], v[92:95], v[48:51], v[124:127]
    ds_read_b64_tr_b16 v[84:85], v24 offset:53248
    ds_read_b64_tr_b16 v[86:87], v24 offset:56320
    v_mfma_f32_16x16x32_bf16 v[156:159], v[92:95], v[52:55], v[156:159]
    v_mfma_f32_16x16x32_bf16 v[188:191], v[92:95], v[56:59], v[188:191]
    v_mfma_f32_16x16x32_bf16 v[220:223], v[92:95], v[60:63], v[220:223]
    s_cmp_eq_u32 s5, 3
    s_cbranch_scc0 L_ffn_cw_171
    v_mfma_f32_16x16x32_bf16 v[32:35], v[88:91], v[20:23], v[32:35]
    v_mfma_f32_16x16x32_bf16 v[36:39], v[92:95], v[20:23], v[36:39]
L_ffn_cw_171:
    s_waitcnt lgkmcnt(4)
    s_waitcnt lgkmcnt(2)
    v_mfma_f32_16x16x32_bf16 v[96:99], v[80:83], v[64:67], v[96:99]
    ds_read_b64_tr_b16 v[88:89], v25 offset:40960
    ds_read_b64_tr_b16 v[90:91], v25 offset:44032
    v_mfma_f32_16x16x32_bf16 v[128:131], v[80:83], v[68:71], v[128:131]
    v_mfma_f32_16x16x32_bf16 v[160:163], v[80:83], v[72:75], v[160:163]
    v_mfma_f32_16x16x32_bf16 v[192:195], v[80:83], v[76:79], v[192:195]
    s_waitcnt lgkmcnt(2)
    v_mfma_f32_16x16x32_bf16 v[100:103], v[84:87], v[64:67], v[100:103]
    ds_read_b64_tr_b16 v[92:93], v25 offset:53248
    ds_read_b64_tr_b16 v[94:95], v25 offset:56320
    v_mfma_f32_16x16x32_bf16 v[132:135], v[84:87], v[68:71], v[132:135]
    v_mfma_f32_16x16x32_bf16 v[164:167], v[84:87], v[72:75], v[164:167]
    v_mfma_f32_16x16x32_bf16 v[196:199], v[84:87], v[76:79], v[196:199]
    s_cmp_eq_u32 s5, 0
    s_cbranch_scc0 L_ffn_cw_172
    v_mfma_f32_16x16x32_bf16 v[32:35], v[80:83], v[20:23], v[32:35]
    v_mfma_f32_16x16x32_bf16 v[36:39], v[84:87], v[20:23], v[36:39]
L_ffn_cw_172:
    s_waitcnt lgkmcnt(2)
    v_mfma_f32_16x16x32_bf16 v[104:107], v[88:91], v[64:67], v[104:107]
    ds_read_b64_tr_b16 v[80:81], v26 offset:40960
    ds_read_b64_tr_b16 v[82:83], v26 offset:44032
    v_mfma_f32_16x16x32_bf16 v[136:139], v[88:91], v[68:71], v[136:139]
    v_mfma_f32_16x16x32_bf16 v[168:171], v[88:91], v[72:75], v[168:171]
    v_mfma_f32_16x16x32_bf16 v[200:203], v[88:91], v[76:79], v[200:203]
    s_waitcnt lgkmcnt(2)
    v_mfma_f32_16x16x32_bf16 v[108:111], v[92:95], v[64:67], v[108:111]
    ds_read_b64_tr_b16 v[84:85], v26 offset:53248
    ds_read_b64_tr_b16 v[86:87], v26 offset:56320
    v_mfma_f32_16x16x32_bf16 v[140:143], v[92:95], v[68:71], v[140:143]
    v_mfma_f32_16x16x32_bf16 v[172:175], v[92:95], v[72:75], v[172:175]
    v_mfma_f32_16x16x32_bf16 v[204:207], v[92:95], v[76:79], v[204:207]
    s_cmp_eq_u32 s5, 1
    s_cbranch_scc0 L_ffn_cw_173
    v_mfma_f32_16x16x32_bf16 v[32:35], v[88:91], v[20:23], v[32:35]
    v_mfma_f32_16x16x32_bf16 v[36:39], v[92:95], v[20:23], v[36:39]
L_ffn_cw_173:
    s_waitcnt lgkmcnt(2)
    v_mfma_f32_16x16x32_bf16 v[112:115], v[80:83], v[64:67], v[112:115]
    ds_read_b64_tr_b16 v[88:89], v27 offset:40960
    ds_read_b64_tr_b16 v[90:91], v27 offset:44032
    v_mfma_f32_16x16x32_bf16 v[144:147], v[80:83], v[68:71], v[144:147]
    v_mfma_f32_16x16x32_bf16 v[176:179], v[80:83], v[72:75], v[176:179]
    v_mfma_f32_16x16x32_bf16 v[208:211], v[80:83], v[76:79], v[208:211]
    s_waitcnt lgkmcnt(2)
    v_mfma_f32_16x16x32_bf16 v[116:119], v[84:87], v[64:67], v[116:119]
    ds_read_b64_tr_b16 v[92:93], v27 offset:53248
    ds_read_b64_tr_b16 v[94:95], v27 offset:56320
    v_mfma_f32_16x16x32_bf16 v[148:151], v[84:87], v[68:71], v[148:151]
    v_mfma_f32_16x16x32_bf16 v[180:183], v[84:87], v[72:75], v[180:183]
    v_mfma_f32_16x16x32_bf16 v[212:215], v[84:87], v[76:79], v[212:215]
    s_cmp_eq_u32 s5, 2
    s_cbranch_scc0 L_ffn_cw_174
    v_mfma_f32_16x16x32_bf16 v[32:35], v[80:83], v[20:23], v[32:35]
    v_mfma_f32_16x16x32_bf16 v[36:39], v[84:87], v[20:23], v[36:39]
L_ffn_cw_174:
    s_waitcnt lgkmcnt(2)
    v_mfma_f32_16x16x32_bf16 v[120:123], v[88:91], v[64:67], v[120:123]
    v_mfma_f32_16x16x32_bf16 v[152:155], v[88:91], v[68:71], v[152:155]
    v_mfma_f32_16x16x32_bf16 v[184:187], v[88:91], v[72:75], v[184:187]
    v_mfma_f32_16x16x32_bf16 v[216:219], v[88:91], v[76:79], v[216:219]
    s_waitcnt lgkmcnt(0)
    v_mfma_f32_16x16x32_bf16 v[124:127], v[92:95], v[64:67], v[124:127]
    v_mfma_f32_16x16x32_bf16 v[156:159], v[92:95], v[68:71], v[156:159]
    v_mfma_f32_16x16x32_bf16 v[188:191], v[92:95], v[72:75], v[188:191]
    v_mfma_f32_16x16x32_bf16 v[220:223], v[92:95], v[76:79], v[220:223]
    s_cmp_eq_u32 s5, 3
    s_cbranch_scc0 L_ffn_cw_175
    v_mfma_f32_16x16x32_bf16 v[32:35], v[88:91], v[20:23], v[32:35]
    v_mfma_f32_16x16x32_bf16 v[36:39], v[92:95], v[20:23], v[36:39]
L_ffn_cw_175:
    s_nop 7
    s_barrier
    v_lshlrev_b32 v1, 4, v0
    v_add_u32 v1, 10240, v1
    s_cmp_eq_u32 s5, 0
    s_cbranch_scc0 L_ffn_cww_176
    ds_write_b128 v1, v[32:35] offset:0
    ds_write_b128 v1, v[36:39] offset:1024
L_ffn_cww_176:
    s_cmp_eq_u32 s5, 1
    s_cbranch_scc0 L_ffn_cww_177
    ds_write_b128 v1, v[32:35] offset:2048
    ds_write_b128 v1, v[36:39] offset:3072
L_ffn_cww_177:
    s_cmp_eq_u32 s5, 2
    s_cbranch_scc0 L_ffn_cww_178
    ds_write_b128 v1, v[32:35] offset:4096
    ds_write_b128 v1, v[36:39] offset:5120
L_ffn_cww_178:
    s_cmp_eq_u32 s5, 3
    s_cbranch_scc0 L_ffn_cww_179
    ds_write_b128 v1, v[32:35] offset:6144
    ds_write_b128 v1, v[36:39] offset:7168
L_ffn_cww_179:
    s_waitcnt lgkmcnt(0)
    s_barrier
    ds_read_b128 v[48:51], v1 offset:0
    ds_read_b128 v[52:55], v1 offset:1024
    ds_read_b128 v[56:59], v1 offset:2048
    ds_read_b128 v[60:63], v1 offset:3072
    ds_read_b128 v[64:67], v1 offset:4096
    ds_read_b128 v[68:71], v1 offset:5120
    ds_read_b128 v[72:75], v1 offset:6144
    ds_read_b128 v[76:79], v1 offset:7168
    s_waitcnt lgkmcnt(0)
    v_mov_b32 v20, 1.0
    v_mov_b32 v21, 1.0
    s_mov_b32 s60, 0xc0135761
    s_mov_b32 s61, 0xbdd2d3e8
    s_mov_b32 s62, 0
    s_nop 7
    v_mul_f32 v22, s60, v40
    v_mul_f32 v26, v40, v40
    v_mul_f32 v24, s61, v40
    v_mul_f32 v24, v24, v26
    v_mov_b32 v23, v22
    v_mov_b32 v25, v24
    v_mov_b32 v27, v26
    v_mov_b32 v36, v44
    v_mov_b32 v37, v44
    v_pk_fma_f32 v[96:97], v[48:49], v[36:37], v[96:97]
    v_pk_fma_f32 v[100:101], v[52:53], v[36:37], v[100:101]
    v_pk_fma_f32 v[98:99], v[50:51], v[36:37], v[98:99]
    v_pk_fma_f32 v[102:103], v[54:55], v[36:37], v[102:103]
    v_pk_mul_f32 v[28:29], v[96:97], v[96:97]
    v_pk_mul_f32 v[30:31], v[98:99], v[98:99]
    v_pk_fma_f32 v[28:29], v[28:29], v[24:25], v[22:23]
    v_pk_fma_f32 v[30:31], v[30:31], v[24:25], v[22:23]
    v_pk_mul_f32 v[28:29], v[28:29], v[96:97]
    v_pk_mul_f32 v[30:31], v[30:31], v[98:99]
    v_exp_f32 v28, v28
    v_exp_f32 v29, v29
    v_exp_f32 v30, v30
    v_exp_f32 v31, v31
    v_pk_mul_f32 v[32:33], v[96:97], v[100:101]
    v_pk_mul_f32 v[34:35], v[98:99], v[102:103]
    v_pk_add_f32 v[28:29], v[28:29], v[20:21]
    v_pk_add_f32 v[30:31], v[30:31], v[20:21]
    v_rcp_f32 v28, v28
    v_rcp_f32 v29, v29
    v_rcp_f32 v30, v30
    v_rcp_f32 v31, v31
    v_pk_mul_f32 v[32:33], v[32:33], v[26:27]
    v_pk_mul_f32 v[34:35], v[34:35], v[26:27]
    v_pk_mul_f32 v[32:33], v[32:33], v[28:29]
    v_pk_mul_f32 v[34:35], v[34:35], v[30:31]
    v_cvt_pk_bf16_f32 v96, v32, v33
    v_cvt_pk_bf16_f32 v97, v34, v35
    v_pk_fma_f32 v[104:105], v[56:57], v[36:37], v[104:105]
    v_pk_fma_f32 v[108:109], v[60:61], v[36:37], v[108:109]
    v_pk_fma_f32 v[106:107], v[58:59], v[36:37], v[106:107]
    v_pk_fma_f32 v[110:111], v[62:63], v[36:37], v[110:111]
    v_pk_mul_f32 v[28:29], v[104:105], v[104:105]
    v_pk_mul_f32 v[30:31], v[106:107], v[106:107]
    v_pk_fma_f32 v[28:29], v[28:29], v[24:25], v[22:23]
    v_pk_fma_f32 v[30:31], v[30:31], v[24:25], v[22:23]
    v_pk_mul_f32 v[28:29], v[28:29], v[104:105]
    v_pk_mul_f32 v[30:31], v[30:31], v[106:107]
    v_exp_f32 v28, v28
    v_exp_f32 v29, v29
    v_exp_f32 v30, v30
    v_exp_f32 v31, v31
    v_pk_mul_f32 v[32:33], v[104:105], v[108:109]
    v_pk_mul_f32 v[34:35], v[106:107], v[110:111]
    v_pk_add_f32 v[28:29], v[28:29], v[20:21]
    v_pk_add_f32 v[30:31], v[30:31], v[20:21]
    v_rcp_f32 v28, v28
    v_rcp_f32 v29, v29
    v_rcp_f32 v30, v30
    v_rcp_f32 v31, v31
    v_pk_mul_f32 v[32:33], v[32:33], v[26:27]
    v_pk_mul_f32 v[34:35], v[34:35], v[26:27]
    v_pk_mul_f32 v[32:33], v[32:33], v[28:29]
    v_pk_mul_f32 v[34:35], v[34:35], v[30:31]
    v_cvt_pk_bf16_f32 v98, v32, v33
    v_cvt_pk_bf16_f32 v99, v34, v35
    s_nop 1
    v_permlane16_swap_b32 v96, v98
    v_permlane16_swap_b32 v97, v99
    buffer_store_dwordx4 v[96:99], v14, s[52:55], s62 offen offset:0 sc1
    v_pk_fma_f32 v[112:113], v[64:65], v[36:37], v[112:113]
    v_pk_fma_f32 v[116:117], v[68:69], v[36:37], v[116:117]
    v_pk_fma_f32 v[114:115], v[66:67], v[36:37], v[114:115]
    v_pk_fma_f32 v[118:119], v[70:71], v[36:37], v[118:119]
    v_pk_mul_f32 v[28:29], v[112:113], v[112:113]
    v_pk_mul_f32 v[30:31], v[114:115], v[114:115]
    v_pk_fma_f32 v[28:29], v[28:29], v[24:25], v[22:23]
    v_pk_fma_f32 v[30:31], v[30:31], v[24:25], v[22:23]
    v_pk_mul_f32 v[28:29], v[28:29], v[112:113]
    v_pk_mul_f32 v[30:31], v[30:31], v[114:115]
    v_exp_f32 v28, v28
    v_exp_f32 v29, v29
    v_exp_f32 v30, v30
    v_exp_f32 v31, v31
    v_pk_mul_f32 v[32:33], v[112:113], v[116:117]
    v_pk_mul_f32 v[34:35], v[114:115], v[118:119]
    v_pk_add_f32 v[28:29], v[28:29], v[20:21]
    v_pk_add_f32 v[30:31], v[30:31], v[20:21]
    v_rcp_f32 v28, v28
    v_rcp_f32 v29, v29
    v_rcp_f32 v30, v30
    v_rcp_f32 v31, v31
    v_pk_mul_f32 v[32:33], v[32:33], v[26:27]
    v_pk_mul_f32 v[34:35], v[34:35], v[26:27]
    v_pk_mul_f32 v[32:33], v[32:33], v[28:29]
    v_pk_mul_f32 v[34:35], v[34:35], v[30:31]
    v_cvt_pk_bf16_f32 v112, v32, v33
    v_cvt_pk_bf16_f32 v113, v34, v35
    v_pk_fma_f32 v[120:121], v[72:73], v[36:37], v[120:121]
    v_pk_fma_f32 v[124:125], v[76:77], v[36:37], v[124:125]
    v_pk_fma_f32 v[122:123], v[74:75], v[36:37], v[122:123]
    v_pk_fma_f32 v[126:127], v[78:79], v[36:37], v[126:127]
    v_pk_mul_f32 v[28:29], v[120:121], v[120:121]
    v_pk_mul_f32 v[30:31], v[122:123], v[122:123]
    v_pk_fma_f32 v[28:29], v[28:29], v[24:25], v[22:23]
    v_pk_fma_f32 v[30:31], v[30:31], v[24:25], v[22:23]
    v_pk_mul_f32 v[28:29], v[28:29], v[120:121]
    v_pk_mul_f32 v[30:31], v[30:31], v[122:123]
    v_exp_f32 v28, v28
    v_exp_f32 v29, v29
    v_exp_f32 v30, v30
    v_exp_f32 v31, v31
    v_pk_mul_f32 v[32:33], v[120:121], v[124:125]
    v_pk_mul_f32 v[34:35], v[122:123], v[126:127]
    v_pk_add_f32 v[28:29], v[28:29], v[20:21]
    v_pk_add_f32 v[30:31], v[30:31], v[20:21]
    v_rcp_f32 v28, v28
    v_rcp_f32 v29, v29
    v_rcp_f32 v30, v30
    v_rcp_f32 v31, v31
    v_pk_mul_f32 v[32:33], v[32:33], v[26:27]
    v_pk_mul_f32 v[34:35], v[34:35], v[26:27]
    v_pk_mul_f32 v[32:33], v[32:33], v[28:29]
    v_pk_mul_f32 v[34:35], v[34:35], v[30:31]
    v_cvt_pk_bf16_f32 v114, v32, v33
    v_cvt_pk_bf16_f32 v115, v34, v35
    s_nop 1
    v_permlane16_swap_b32 v112, v114
    v_permlane16_swap_b32 v113, v115
    buffer_store_dwordx4 v[112:115], v14, s[52:55], s62 offen offset:1024 sc1
    s_add_u32 s62, s62, 147456
    v_mul_f32 v22, s60, v41
    v_mul_f32 v26, v41, v41
    v_mul_f32 v24, s61, v41
    v_mul_f32 v24, v24, v26
    v_mov_b32 v23, v22
    v_mov_b32 v25, v24
    v_mov_b32 v27, v26
    v_mov_b32 v36, v45
    v_mov_b32 v37, v45
    v_pk_fma_f32 v[128:129], v[48:49], v[36:37], v[128:129]
    v_pk_fma_f32 v[132:133], v[52:53], v[36:37], v[132:133]
    v_pk_fma_f32 v[130:131], v[50:51], v[36:37], v[130:131]
    v_pk_fma_f32 v[134:135], v[54:55], v[36:37], v[134:135]
    v_pk_mul_f32 v[28:29], v[128:129], v[128:129]
    v_pk_mul_f32 v[30:31], v[130:131], v[130:131]
    v_pk_fma_f32 v[28:29], v[28:29], v[24:25], v[22:23]
    v_pk_fma_f32 v[30:31], v[30:31], v[24:25], v[22:23]
    v_pk_mul_f32 v[28:29], v[28:29], v[128:129]
    v_pk_mul_f32 v[30:31], v[30:31], v[130:131]
    v_exp_f32 v28, v28
    v_exp_f32 v29, v29
    v_exp_f32 v30, v30
    v_exp_f32 v31, v31
    v_pk_mul_f32 v[32:33], v[128:129], v[132:133]
    v_pk_mul_f32 v[34:35], v[130:131], v[134:135]
    v_pk_add_f32 v[28:29], v[28:29], v[20:21]
    v_pk_add_f32 v[30:31], v[30:31], v[20:21]
    v_rcp_f32 v28, v28
    v_rcp_f32 v29, v29
    v_rcp_f32 v30, v30
    v_rcp_f32 v31, v31
    v_pk_mul_f32 v[32:33], v[32:33], v[26:27]
    v_pk_mul_f32 v[34:35], v[34:35], v[26:27]
    v_pk_mul_f32 v[32:33], v[32:33], v[28:29]
    v_pk_mul_f32 v[34:35], v[34:35], v[30:31]
    v_cvt_pk_bf16_f32 v128, v32, v33
    v_cvt_pk_bf16_f32 v129, v34, v35
    v_pk_fma_f32 v[136:137], v[56:57], v[36:37], v[136:137]
    v_pk_fma_f32 v[140:141], v[60:61], v[36:37], v[140:141]
    v_pk_fma_f32 v[138:139], v[58:59], v[36:37], v[138:139]
    v_pk_fma_f32 v[142:143], v[62:63], v[36:37], v[142:143]
    v_pk_mul_f32 v[28:29], v[136:137], v[136:137]
    v_pk_mul_f32 v[30:31], v[138:139], v[138:139]
    v_pk_fma_f32 v[28:29], v[28:29], v[24:25], v[22:23]
    v_pk_fma_f32 v[30:31], v[30:31], v[24:25], v[22:23]
    v_pk_mul_f32 v[28:29], v[28:29], v[136:137]
    v_pk_mul_f32 v[30:31], v[30:31], v[138:139]
    v_exp_f32 v28, v28
    v_exp_f32 v29, v29
    v_exp_f32 v30, v30
    v_exp_f32 v31, v31
    v_pk_mul_f32 v[32:33], v[136:137], v[140:141]
    v_pk_mul_f32 v[34:35], v[138:139], v[142:143]
    v_pk_add_f32 v[28:29], v[28:29], v[20:21]
    v_pk_add_f32 v[30:31], v[30:31], v[20:21]
    v_rcp_f32 v28, v28
    v_rcp_f32 v29, v29
    v_rcp_f32 v30, v30
    v_rcp_f32 v31, v31
    v_pk_mul_f32 v[32:33], v[32:33], v[26:27]
    v_pk_mul_f32 v[34:35], v[34:35], v[26:27]
    v_pk_mul_f32 v[32:33], v[32:33], v[28:29]
    v_pk_mul_f32 v[34:35], v[34:35], v[30:31]
    v_cvt_pk_bf16_f32 v130, v32, v33
    v_cvt_pk_bf16_f32 v131, v34, v35
    s_nop 1
    v_permlane16_swap_b32 v128, v130
    v_permlane16_swap_b32 v129, v131
    buffer_store_dwordx4 v[128:131], v14, s[52:55], s62 offen offset:0 sc1
    v_pk_fma_f32 v[144:145], v[64:65], v[36:37], v[144:145]
    v_pk_fma_f32 v[148:149], v[68:69], v[36:37], v[148:149]
    v_pk_fma_f32 v[146:147], v[66:67], v[36:37], v[146:147]
    v_pk_fma_f32 v[150:151], v[70:71], v[36:37], v[150:151]
    v_pk_mul_f32 v[28:29], v[144:145], v[144:145]
    v_pk_mul_f32 v[30:31], v[146:147], v[146:147]
    v_pk_fma_f32 v[28:29], v[28:29], v[24:25], v[22:23]
    v_pk_fma_f32 v[30:31], v[30:31], v[24:25], v[22:23]
    v_pk_mul_f32 v[28:29], v[28:29], v[144:145]
    v_pk_mul_f32 v[30:31], v[30:31], v[146:147]
    v_exp_f32 v28, v28
    v_exp_f32 v29, v29
    v_exp_f32 v30, v30
    v_exp_f32 v31, v31
    v_pk_mul_f32 v[32:33], v[144:145], v[148:149]
    v_pk_mul_f32 v[34:35], v[146:147], v[150:151]
    v_pk_add_f32 v[28:29], v[28:29], v[20:21]
    v_pk_add_f32 v[30:31], v[30:31], v[20:21]
    v_rcp_f32 v28, v28
    v_rcp_f32 v29, v29
    v_rcp_f32 v30, v30
    v_rcp_f32 v31, v31
    v_pk_mul_f32 v[32:33], v[32:33], v[26:27]
    v_pk_mul_f32 v[34:35], v[34:35], v[26:27]
    v_pk_mul_f32 v[32:33], v[32:33], v[28:29]
    v_pk_mul_f32 v[34:35], v[34:35], v[30:31]
    v_cvt_pk_bf16_f32 v144, v32, v33
    v_cvt_pk_bf16_f32 v145, v34, v35
    v_pk_fma_f32 v[152:153], v[72:73], v[36:37], v[152:153]
    v_pk_fma_f32 v[156:157], v[76:77], v[36:37], v[156:157]
    v_pk_fma_f32 v[154:155], v[74:75], v[36:37], v[154:155]
    v_pk_fma_f32 v[158:159], v[78:79], v[36:37], v[158:159]
    v_pk_mul_f32 v[28:29], v[152:153], v[152:153]
    v_pk_mul_f32 v[30:31], v[154:155], v[154:155]
    v_pk_fma_f32 v[28:29], v[28:29], v[24:25], v[22:23]
    v_pk_fma_f32 v[30:31], v[30:31], v[24:25], v[22:23]
    v_pk_mul_f32 v[28:29], v[28:29], v[152:153]
    v_pk_mul_f32 v[30:31], v[30:31], v[154:155]
    v_exp_f32 v28, v28
    v_exp_f32 v29, v29
    v_exp_f32 v30, v30
    v_exp_f32 v31, v31
    v_pk_mul_f32 v[32:33], v[152:153], v[156:157]
    v_pk_mul_f32 v[34:35], v[154:155], v[158:159]
    v_pk_add_f32 v[28:29], v[28:29], v[20:21]
    v_pk_add_f32 v[30:31], v[30:31], v[20:21]
    v_rcp_f32 v28, v28
    v_rcp_f32 v29, v29
    v_rcp_f32 v30, v30
    v_rcp_f32 v31, v31
    v_pk_mul_f32 v[32:33], v[32:33], v[26:27]
    v_pk_mul_f32 v[34:35], v[34:35], v[26:27]
    v_pk_mul_f32 v[32:33], v[32:33], v[28:29]
    v_pk_mul_f32 v[34:35], v[34:35], v[30:31]
    v_cvt_pk_bf16_f32 v146, v32, v33
    v_cvt_pk_bf16_f32 v147, v34, v35
    s_nop 1
    v_permlane16_swap_b32 v144, v146
    v_permlane16_swap_b32 v145, v147
    buffer_store_dwordx4 v[144:147], v14, s[52:55], s62 offen offset:1024 sc1
    s_add_u32 s62, s62, 147456
    v_mul_f32 v22, s60, v42
    v_mul_f32 v26, v42, v42
    v_mul_f32 v24, s61, v42
    v_mul_f32 v24, v24, v26
    v_mov_b32 v23, v22
    v_mov_b32 v25, v24
    v_mov_b32 v27, v26
    v_mov_b32 v36, v46
    v_mov_b32 v37, v46
    v_pk_fma_f32 v[160:161], v[48:49], v[36:37], v[160:161]
    v_pk_fma_f32 v[164:165], v[52:53], v[36:37], v[164:165]
    v_pk_fma_f32 v[162:163], v[50:51], v[36:37], v[162:163]
    v_pk_fma_f32 v[166:167], v[54:55], v[36:37], v[166:167]
    v_pk_mul_f32 v[28:29], v[160:161], v[160:161]
    v_pk_mul_f32 v[30:31], v[162:163], v[162:163]
    v_pk_fma_f32 v[28:29], v[28:29], v[24:25], v[22:23]
    v_pk_fma_f32 v[30:31], v[30:31], v[24:25], v[22:23]
    v_pk_mul_f32 v[28:29], v[28:29], v[160:161]
    v_pk_mul_f32 v[30:31], v[30:31], v[162:163]
    v_exp_f32 v28, v28
    v_exp_f32 v29, v29
    v_exp_f32 v30, v30
    v_exp_f32 v31, v31
    v_pk_mul_f32 v[32:33], v[160:161], v[164:165]
    v_pk_mul_f32 v[34:35], v[162:163], v[166:167]
    v_pk_add_f32 v[28:29], v[28:29], v[20:21]
    v_pk_add_f32 v[30:31], v[30:31], v[20:21]
    v_rcp_f32 v28, v28
    v_rcp_f32 v29, v29
    v_rcp_f32 v30, v30
    v_rcp_f32 v31, v31
    v_pk_mul_f32 v[32:33], v[32:33], v[26:27]
    v_pk_mul_f32 v[34:35], v[34:35], v[26:27]
    v_pk_mul_f32 v[32:33], v[32:33], v[28:29]
    v_pk_mul_f32 v[34:35], v[34:35], v[30:31]
    v_cvt_pk_bf16_f32 v160, v32, v33
    v_cvt_pk_bf16_f32 v161, v34, v35
    v_pk_fma_f32 v[168:169], v[56:57], v[36:37], v[168:169]
    v_pk_fma_f32 v[172:173], v[60:61], v[36:37], v[172:173]
    v_pk_fma_f32 v[170:171], v[58:59], v[36:37], v[170:171]
    v_pk_fma_f32 v[174:175], v[62:63], v[36:37], v[174:175]
    v_pk_mul_f32 v[28:29], v[168:169], v[168:169]
    v_pk_mul_f32 v[30:31], v[170:171], v[170:171]
    v_pk_fma_f32 v[28:29], v[28:29], v[24:25], v[22:23]
    v_pk_fma_f32 v[30:31], v[30:31], v[24:25], v[22:23]
    v_pk_mul_f32 v[28:29], v[28:29], v[168:169]
    v_pk_mul_f32 v[30:31], v[30:31], v[170:171]
    v_exp_f32 v28, v28
    v_exp_f32 v29, v29
    v_exp_f32 v30, v30
    v_exp_f32 v31, v31
    v_pk_mul_f32 v[32:33], v[168:169], v[172:173]
    v_pk_mul_f32 v[34:35], v[170:171], v[174:175]
    v_pk_add_f32 v[28:29], v[28:29], v[20:21]
    v_pk_add_f32 v[30:31], v[30:31], v[20:21]
    v_rcp_f32 v28, v28
    v_rcp_f32 v29, v29
    v_rcp_f32 v30, v30
    v_rcp_f32 v31, v31
    v_pk_mul_f32 v[32:33], v[32:33], v[26:27]
    v_pk_mul_f32 v[34:35], v[34:35], v[26:27]
    v_pk_mul_f32 v[32:33], v[32:33], v[28:29]
    v_pk_mul_f32 v[34:35], v[34:35], v[30:31]
    v_cvt_pk_bf16_f32 v162, v32, v33
    v_cvt_pk_bf16_f32 v163, v34, v35
    s_nop 1
    v_permlane16_swap_b32 v160, v162
    v_permlane16_swap_b32 v161, v163
    buffer_store_dwordx4 v[160:163], v14, s[52:55], s62 offen offset:0 sc1
    v_pk_fma_f32 v[176:177], v[64:65], v[36:37], v[176:177]
    v_pk_fma_f32 v[180:181], v[68:69], v[36:37], v[180:181]
    v_pk_fma_f32 v[178:179], v[66:67], v[36:37], v[178:179]
    v_pk_fma_f32 v[182:183], v[70:71], v[36:37], v[182:183]
    v_pk_mul_f32 v[28:29], v[176:177], v[176:177]
    v_pk_mul_f32 v[30:31], v[178:179], v[178:179]
    v_pk_fma_f32 v[28:29], v[28:29], v[24:25], v[22:23]
    v_pk_fma_f32 v[30:31], v[30:31], v[24:25], v[22:23]
    v_pk_mul_f32 v[28:29], v[28:29], v[176:177]
    v_pk_mul_f32 v[30:31], v[30:31], v[178:179]
    v_exp_f32 v28, v28
    v_exp_f32 v29, v29
    v_exp_f32 v30, v30
    v_exp_f32 v31, v31
    v_pk_mul_f32 v[32:33], v[176:177], v[180:181]
    v_pk_mul_f32 v[34:35], v[178:179], v[182:183]
    v_pk_add_f32 v[28:29], v[28:29], v[20:21]
    v_pk_add_f32 v[30:31], v[30:31], v[20:21]
    v_rcp_f32 v28, v28
    v_rcp_f32 v29, v29
    v_rcp_f32 v30, v30
    v_rcp_f32 v31, v31
    v_pk_mul_f32 v[32:33], v[32:33], v[26:27]
    v_pk_mul_f32 v[34:35], v[34:35], v[26:27]
    v_pk_mul_f32 v[32:33], v[32:33], v[28:29]
    v_pk_mul_f32 v[34:35], v[34:35], v[30:31]
    v_cvt_pk_bf16_f32 v176, v32, v33
    v_cvt_pk_bf16_f32 v177, v34, v35
    v_pk_fma_f32 v[184:185], v[72:73], v[36:37], v[184:185]
    v_pk_fma_f32 v[188:189], v[76:77], v[36:37], v[188:189]
    v_pk_fma_f32 v[186:187], v[74:75], v[36:37], v[186:187]
    v_pk_fma_f32 v[190:191], v[78:79], v[36:37], v[190:191]
    v_pk_mul_f32 v[28:29], v[184:185], v[184:185]
    v_pk_mul_f32 v[30:31], v[186:187], v[186:187]
    v_pk_fma_f32 v[28:29], v[28:29], v[24:25], v[22:23]
    v_pk_fma_f32 v[30:31], v[30:31], v[24:25], v[22:23]
    v_pk_mul_f32 v[28:29], v[28:29], v[184:185]
    v_pk_mul_f32 v[30:31], v[30:31], v[186:187]
    v_exp_f32 v28, v28
    v_exp_f32 v29, v29
    v_exp_f32 v30, v30
    v_exp_f32 v31, v31
    v_pk_mul_f32 v[32:33], v[184:185], v[188:189]
    v_pk_mul_f32 v[34:35], v[186:187], v[190:191]
    v_pk_add_f32 v[28:29], v[28:29], v[20:21]
    v_pk_add_f32 v[30:31], v[30:31], v[20:21]
    v_rcp_f32 v28, v28
    v_rcp_f32 v29, v29
    v_rcp_f32 v30, v30
    v_rcp_f32 v31, v31
    v_pk_mul_f32 v[32:33], v[32:33], v[26:27]
    v_pk_mul_f32 v[34:35], v[34:35], v[26:27]
    v_pk_mul_f32 v[32:33], v[32:33], v[28:29]
    v_pk_mul_f32 v[34:35], v[34:35], v[30:31]
    v_cvt_pk_bf16_f32 v178, v32, v33
    v_cvt_pk_bf16_f32 v179, v34, v35
    s_nop 1
    v_permlane16_swap_b32 v176, v178
    v_permlane16_swap_b32 v177, v179
    buffer_store_dwordx4 v[176:179], v14, s[52:55], s62 offen offset:1024 sc1
    s_add_u32 s62, s62, 147456
    v_mul_f32 v22, s60, v43
    v_mul_f32 v26, v43, v43
    v_mul_f32 v24, s61, v43
    v_mul_f32 v24, v24, v26
    v_mov_b32 v23, v22
    v_mov_b32 v25, v24
    v_mov_b32 v27, v26
    v_mov_b32 v36, v47
    v_mov_b32 v37, v47
    v_pk_fma_f32 v[192:193], v[48:49], v[36:37], v[192:193]
    v_pk_fma_f32 v[196:197], v[52:53], v[36:37], v[196:197]
    v_pk_fma_f32 v[194:195], v[50:51], v[36:37], v[194:195]
    v_pk_fma_f32 v[198:199], v[54:55], v[36:37], v[198:199]
    v_pk_mul_f32 v[28:29], v[192:193], v[192:193]
    v_pk_mul_f32 v[30:31], v[194:195], v[194:195]
    v_pk_fma_f32 v[28:29], v[28:29], v[24:25], v[22:23]
    v_pk_fma_f32 v[30:31], v[30:31], v[24:25], v[22:23]
    v_pk_mul_f32 v[28:29], v[28:29], v[192:193]
    v_pk_mul_f32 v[30:31], v[30:31], v[194:195]
    v_exp_f32 v28, v28
    v_exp_f32 v29, v29
    v_exp_f32 v30, v30
    v_exp_f32 v31, v31
    v_pk_mul_f32 v[32:33], v[192:193], v[196:197]
    v_pk_mul_f32 v[34:35], v[194:195], v[198:199]
    v_pk_add_f32 v[28:29], v[28:29], v[20:21]
    v_pk_add_f32 v[30:31], v[30:31], v[20:21]
    v_rcp_f32 v28, v28
    v_rcp_f32 v29, v29
    v_rcp_f32 v30, v30
    v_rcp_f32 v31, v31
    v_pk_mul_f32 v[32:33], v[32:33], v[26:27]
    v_pk_mul_f32 v[34:35], v[34:35], v[26:27]
    v_pk_mul_f32 v[32:33], v[32:33], v[28:29]
    v_pk_mul_f32 v[34:35], v[34:35], v[30:31]
    v_cvt_pk_bf16_f32 v192, v32, v33
    v_cvt_pk_bf16_f32 v193, v34, v35
    v_pk_fma_f32 v[200:201], v[56:57], v[36:37], v[200:201]
    v_pk_fma_f32 v[204:205], v[60:61], v[36:37], v[204:205]
    v_pk_fma_f32 v[202:203], v[58:59], v[36:37], v[202:203]
    v_pk_fma_f32 v[206:207], v[62:63], v[36:37], v[206:207]
    v_pk_mul_f32 v[28:29], v[200:201], v[200:201]
    v_pk_mul_f32 v[30:31], v[202:203], v[202:203]
    v_pk_fma_f32 v[28:29], v[28:29], v[24:25], v[22:23]
    v_pk_fma_f32 v[30:31], v[30:31], v[24:25], v[22:23]
    v_pk_mul_f32 v[28:29], v[28:29], v[200:201]
    v_pk_mul_f32 v[30:31], v[30:31], v[202:203]
    v_exp_f32 v28, v28
    v_exp_f32 v29, v29
    v_exp_f32 v30, v30
    v_exp_f32 v31, v31
    v_pk_mul_f32 v[32:33], v[200:201], v[204:205]
    v_pk_mul_f32 v[34:35], v[202:203], v[206:207]
    v_pk_add_f32 v[28:29], v[28:29], v[20:21]
    v_pk_add_f32 v[30:31], v[30:31], v[20:21]
    v_rcp_f32 v28, v28
    v_rcp_f32 v29, v29
    v_rcp_f32 v30, v30
    v_rcp_f32 v31, v31
    v_pk_mul_f32 v[32:33], v[32:33], v[26:27]
    v_pk_mul_f32 v[34:35], v[34:35], v[26:27]
    v_pk_mul_f32 v[32:33], v[32:33], v[28:29]
    v_pk_mul_f32 v[34:35], v[34:35], v[30:31]
    v_cvt_pk_bf16_f32 v194, v32, v33
    v_cvt_pk_bf16_f32 v195, v34, v35
    s_nop 1
    v_permlane16_swap_b32 v192, v194
    v_permlane16_swap_b32 v193, v195
    buffer_store_dwordx4 v[192:195], v14, s[52:55], s62 offen offset:0 sc1
    v_pk_fma_f32 v[208:209], v[64:65], v[36:37], v[208:209]
    v_pk_fma_f32 v[212:213], v[68:69], v[36:37], v[212:213]
    v_pk_fma_f32 v[210:211], v[66:67], v[36:37], v[210:211]
    v_pk_fma_f32 v[214:215], v[70:71], v[36:37], v[214:215]
    v_pk_mul_f32 v[28:29], v[208:209], v[208:209]
    v_pk_mul_f32 v[30:31], v[210:211], v[210:211]
    v_pk_fma_f32 v[28:29], v[28:29], v[24:25], v[22:23]
    v_pk_fma_f32 v[30:31], v[30:31], v[24:25], v[22:23]
    v_pk_mul_f32 v[28:29], v[28:29], v[208:209]
    v_pk_mul_f32 v[30:31], v[30:31], v[210:211]
    v_exp_f32 v28, v28
    v_exp_f32 v29, v29
    v_exp_f32 v30, v30
    v_exp_f32 v31, v31
    v_pk_mul_f32 v[32:33], v[208:209], v[212:213]
    v_pk_mul_f32 v[34:35], v[210:211], v[214:215]
    v_pk_add_f32 v[28:29], v[28:29], v[20:21]
    v_pk_add_f32 v[30:31], v[30:31], v[20:21]
    v_rcp_f32 v28, v28
    v_rcp_f32 v29, v29
    v_rcp_f32 v30, v30
    v_rcp_f32 v31, v31
    v_pk_mul_f32 v[32:33], v[32:33], v[26:27]
    v_pk_mul_f32 v[34:35], v[34:35], v[26:27]
    v_pk_mul_f32 v[32:33], v[32:33], v[28:29]
    v_pk_mul_f32 v[34:35], v[34:35], v[30:31]
    v_cvt_pk_bf16_f32 v208, v32, v33
    v_cvt_pk_bf16_f32 v209, v34, v35
    v_pk_fma_f32 v[216:217], v[72:73], v[36:37], v[216:217]
    v_pk_fma_f32 v[220:221], v[76:77], v[36:37], v[220:221]
    v_pk_fma_f32 v[218:219], v[74:75], v[36:37], v[218:219]
    v_pk_fma_f32 v[222:223], v[78:79], v[36:37], v[222:223]
    v_pk_mul_f32 v[28:29], v[216:217], v[216:217]
    v_pk_mul_f32 v[30:31], v[218:219], v[218:219]
    v_pk_fma_f32 v[28:29], v[28:29], v[24:25], v[22:23]
    v_pk_fma_f32 v[30:31], v[30:31], v[24:25], v[22:23]
    v_pk_mul_f32 v[28:29], v[28:29], v[216:217]
    v_pk_mul_f32 v[30:31], v[30:31], v[218:219]
    v_exp_f32 v28, v28
    v_exp_f32 v29, v29
    v_exp_f32 v30, v30
    v_exp_f32 v31, v31
    v_pk_mul_f32 v[32:33], v[216:217], v[220:221]
    v_pk_mul_f32 v[34:35], v[218:219], v[222:223]
    v_pk_add_f32 v[28:29], v[28:29], v[20:21]
    v_pk_add_f32 v[30:31], v[30:31], v[20:21]
    v_rcp_f32 v28, v28
    v_rcp_f32 v29, v29
    v_rcp_f32 v30, v30
    v_rcp_f32 v31, v31
    v_pk_mul_f32 v[32:33], v[32:33], v[26:27]
    v_pk_mul_f32 v[34:35], v[34:35], v[26:27]
    v_pk_mul_f32 v[32:33], v[32:33], v[28:29]
    v_pk_mul_f32 v[34:35], v[34:35], v[30:31]
    v_cvt_pk_bf16_f32 v210, v32, v33
    v_cvt_pk_bf16_f32 v211, v34, v35
    s_nop 1
    v_permlane16_swap_b32 v208, v210
    v_permlane16_swap_b32 v209, v211
    buffer_store_dwordx4 v[208:211], v14, s[52:55], s62 offen offset:1024 sc1
    s_add_u32 s62, s62, 147456
L_ffn_done_8:
    s_add_u32 s64, s34, 0x888000
    s_addc_u32 s65, s35, 0
    s_mov_b32 s66, 0x400
    s_mov_b32 s67, 0x00020000
    s_lshr_b32 s60, s7, 8
    s_lshl_b32 s60, s60, 5
    s_add_u32 s60, s60, s9
    s_lshl_b32 s60, s60, 2
    v_mov_b32 v1, s60
    v_mov_b32 v2, 1
    s_waitcnt vmcnt(0)
    s_barrier
    s_cmp_lg_u32 s4, 0
    s_cbranch_scc1 L_ffn_nf_180
    s_mov_b64 exec, 1
    buffer_store_dword v2, v1, s[64:67], 0 offen sc1
    s_mov_b64 exec, -1
L_ffn_nf_180:
    s_mov_b64 exec, -1
    s_and_b32 s9, s2, 3
    s_bfe_u32 s60, s2, 0x10002
    s_lshr_b32 s61, s2, 3
    s_lshr_b32 s62, s61, 2
    s_lshl_b32 s60, s60, 3
    s_add_u32 s60, s60, s62
    s_lshl_b32 s7, s60, 7
    s_and_b32 s61, s61, 3
    s_mul_i32 s8, s61, 144
    s_lshl_b32 s10, s60, 2
    s_add_u32 s10, s10, s61
    s_and_b32 s11, s4, 3
    s_lshr_b32 s5, s11, 1
    s_and_b32 s6, s11, 1
    v_and_b32 v16, 15, v0
    v_lshrrev_b32 v17, 4, v0
    s_cmp_lt_u32 s4, 4
    s_cbranch_scc1 L_ffn_comp_181
    s_add_u32 s36, s34, 0x1000000
    s_addc_u32 s37, s35, 0
    s_mov_b32 s38, 0x1200000
    s_mov_b32 s39, 0x00020000
    s_mov_b32 s40, s28
    s_mov_b32 s41, s29
    s_mov_b32 s42, 0x510000
    s_mov_b32 s43, 0x00020000
    s_lshr_b32 s60, s7, 4
    s_lshl_b32 s61, s11, 1
    s_add_u32 s60, s60, s61
    s_mul_i32 s60, s60, 147456
    s_mul_i32 s61, s9, 36864
    s_add_u32 s60, s60, s61
    v_lshlrev_b32 v19, 4, v0
    v_add_u32 v2, s60, v19
    v_add_u32 v3, 1024, v2
    v_add_u32 v4, 147456, v2
    v_add_u32 v5, 148480, v2
    s_mul_i32 s64, s11, 48
    s_lshl_b32 s62, s8, 1
    s_and_b32 s62, s62, 0xffffff80
    s_mul_i32 s61, s9, 1152 * 1152
    s_add_u32 s62, s62, s61
    s_movk_i32 s63, 1152
    v_lshrrev_b32 v18, 3, v0
    v_add_u32 v18, s64, v18
    v_mul_u32_u24 v19, 21846, v18
    v_lshrrev_b32 v19, 16, v19
    v_mul_u32_u24 v20, 3, v19
    v_sub_u32 v18, v18, v20
    v_lshlrev_b32 v18, 7, v18
    v_bfe_u32 v20, v19, 1, 2
    v_bfe_u32 v21, v0, 1, 2
    v_xor_b32 v20, v20, v21
    v_lshlrev_b32 v20, 5, v20
    v_and_b32 v21, 1, v0
    v_lshlrev_b32 v21, 4, v21
    v_add3_u32 v18, v18, v20, v21
    v_lshrrev_b32 v23, 5, v19
    v_and_b32 v19, 31, v19
    v_and_b32 v20, 0x33, v19
    v_bfe_u32 v21, v19, 2, 1
    v_lshlrev_b32 v21, 3, v21
    v_bfe_u32 v22, v19, 3, 1
    v_lshlrev_b32 v22, 2, v22
    v_or3_b32 v20, v20, v21, v22
    v_mul_u32_u24 v21, 32, v23
    v_add_u32 v20, v20, v21
    v_mul_lo_u32 v20, v20, s63
    v_add3_u32 v8, v20, v18, s62
    v_lshrrev_b32 v18, 3, v0
    v_add_u32 v18, s64, v18
    v_add_u32 v18, 8, v18
    v_mul_u32_u24 v19, 21846, v18
    v_lshrrev_b32 v19, 16, v19
    v_mul_u32_u24 v20, 3, v19
    v_sub_u32 v18, v18, v20
    v_lshlrev_b32 v18, 7, v18
    v_bfe_u32 v20, v19, 1, 2
    v_bfe_u32 v21, v0, 1, 2
    v_xor_b32 v20, v20, v21
    v_lshlrev_b32 v20, 5, v20
    v_and_b32 v21, 1, v0
    v_lshlrev_b32 v21, 4, v21
    v_add3_u32 v18, v18, v20, v21
    v_lshrrev_b32 v23, 5, v19
    v_and_b32 v19, 31, v19
    v_and_b32 v20, 0x33, v19
    v_bfe_u32 v21, v19, 2, 1
    v_lshlrev_b32 v21, 3, v21
    v_bfe_u32 v22, v19, 3, 1
    v_lshlrev_b32 v22, 2, v22
    v_or3_b32 v20, v20, v21, v22
    v_mul_u32_u24 v21, 32, v23
    v_add_u32 v20, v20, v21
    v_mul_lo_u32 v20, v20, s63
    v_add3_u32 v9, v20, v18, s62
    v_lshrrev_b32 v18, 3, v0
    v_add_u32 v18, s64, v18
    v_add_u32 v18, 16, v18
    v_mul_u32_u24 v19, 21846, v18
    v_lshrrev_b32 v19, 16, v19
    v_mul_u32_u24 v20, 3, v19
    v_sub_u32 v18, v18, v20
    v_lshlrev_b32 v18, 7, v18
    v_bfe_u32 v20, v19, 1, 2
    v_bfe_u32 v21, v0, 1, 2
    v_xor_b32 v20, v20, v21
    v_lshlrev_b32 v20, 5, v20
    v_and_b32 v21, 1, v0
    v_lshlrev_b32 v21, 4, v21
    v_add3_u32 v18, v18, v20, v21
    v_lshrrev_b32 v23, 5, v19
    v_and_b32 v19, 31, v19
    v_and_b32 v20, 0x33, v19
    v_bfe_u32 v21, v19, 2, 1
    v_lshlrev_b32 v21, 3, v21
    v_bfe_u32 v22, v19, 3, 1
    v_lshlrev_b32 v22, 2, v22
    v_or3_b32 v20, v20, v21, v22
    v_mul_u32_u24 v21, 32, v23
    v_add_u32 v20, v20, v21
    v_mul_lo_u32 v20, v20, s63
    v_add3_u32 v10, v20, v18, s62
    v_lshrrev_b32 v18, 3, v0
    v_add_u32 v18, s64, v18
    v_add_u32 v18, 24, v18
    v_mul_u32_u24 v19, 21846, v18
    v_lshrrev_b32 v19, 16, v19
    v_mul_u32_u24 v20, 3, v19
    v_sub_u32 v18, v18, v20
    v_lshlrev_b32 v18, 7, v18
    v_bfe_u32 v20, v19, 1, 2
    v_bfe_u32 v21, v0, 1, 2
    v_xor_b32 v20, v20, v21
    v_lshlrev_b32 v20, 5, v20
    v_and_b32 v21, 1, v0
    v_lshlrev_b32 v21, 4, v21
    v_add3_u32 v18, v18, v20, v21
    v_lshrrev_b32 v23, 5, v19
    v_and_b32 v19, 31, v19
    v_and_b32 v20, 0x33, v19
    v_bfe_u32 v21, v19, 2, 1
    v_lshlrev_b32 v21, 3, v21
    v_bfe_u32 v22, v19, 3, 1
    v_lshlrev_b32 v22, 2, v22
    v_or3_b32 v20, v20, v21, v22
    v_mul_u32_u24 v21, 32, v23
    v_add_u32 v20, v20, v21
    v_mul_lo_u32 v20, v20, s63
    v_add3_u32 v11, v20, v18, s62
    v_lshrrev_b32 v18, 3, v0
    v_add_u32 v18, s64, v18
    v_add_u32 v18, 32, v18
    v_mul_u32_u24 v19, 21846, v18
    v_lshrrev_b32 v19, 16, v19
    v_mul_u32_u24 v20, 3, v19
    v_sub_u32 v18, v18, v20
    v_lshlrev_b32 v18, 7, v18
    v_bfe_u32 v20, v19, 1, 2
    v_bfe_u32 v21, v0, 1, 2
    v_xor_b32 v20, v20, v21
    v_lshlrev_b32 v20, 5, v20
    v_and_b32 v21, 1, v0
    v_lshlrev_b32 v21, 4, v21
    v_add3_u32 v18, v18, v20, v21
    v_lshrrev_b32 v23, 5, v19
    v_and_b32 v19, 31, v19
    v_and_b32 v20, 0x33, v19
    v_bfe_u32 v21, v19, 2, 1
    v_lshlrev_b32 v21, 3, v21
    v_bfe_u32 v22, v19, 3, 1
    v_lshlrev_b32 v22, 2, v22
    v_or3_b32 v20, v20, v21, v22
    v_mul_u32_u24 v21, 32, v23
    v_add_u32 v20, v20, v21
    v_mul_lo_u32 v20, v20, s63
    v_add3_u32 v12, v20, v18, s62
    v_lshrrev_b32 v18, 3, v0
    v_add_u32 v18, s64, v18
    v_add_u32 v18, 40, v18
    v_mul_u32_u24 v19, 21846, v18
    v_lshrrev_b32 v19, 16, v19
    v_mul_u32_u24 v20, 3, v19
    v_sub_u32 v18, v18, v20
    v_lshlrev_b32 v18, 7, v18
    v_bfe_u32 v20, v19, 1, 2
    v_bfe_u32 v21, v0, 1, 2
    v_xor_b32 v20, v20, v21
    v_lshlrev_b32 v20, 5, v20
    v_and_b32 v21, 1, v0
    v_lshlrev_b32 v21, 4, v21
    v_add3_u32 v18, v18, v20, v21
    v_lshrrev_b32 v23, 5, v19
    v_and_b32 v19, 31, v19
    v_and_b32 v20, 0x33, v19
    v_bfe_u32 v21, v19, 2, 1
    v_lshlrev_b32 v21, 3, v21
    v_bfe_u32 v22, v19, 3, 1
    v_lshlrev_b32 v22, 2, v22
    v_or3_b32 v20, v20, v21, v22
    v_mul_u32_u24 v21, 32, v23
    v_add_u32 v20, v20, v21
    v_mul_lo_u32 v20, v20, s63
    v_add3_u32 v13, v20, v18, s62
    s_mov_b32 s56, 0
    s_mov_b32 s57, 0
    s_lshl_b32 s58, s11, 12
    s_mul_i32 s59, s11, 6144
    s_add_u32 s59, s59, 16384
    s_add_u32 m0, s59, 0
    s_nop 0
    buffer_load_dwordx4 v8, s[40:43], s57 offen lds
    s_add_u32 m0, s59, 1024
    s_nop 0
    buffer_load_dwordx4 v9, s[40:43], s57 offen lds
    s_add_u32 m0, s59, 2048
    s_nop 0
    buffer_load_dwordx4 v10, s[40:43], s57 offen lds
    s_add_u32 m0, s59, 3072
    s_nop 0
    buffer_load_dwordx4 v11, s[40:43], s57 offen lds
    s_add_u32 m0, s59, 4096
    s_nop 0
    buffer_load_dwordx4 v12, s[40:43], s57 offen lds
    s_add_u32 m0, s59, 5120
    s_nop 0
    buffer_load_dwordx4 v13, s[40:43], s57 offen lds
    s_add_u32 s57, s57, 73728
    s_add_u32 m0, s59, 40960
    s_nop 0
    buffer_load_dwordx4 v8, s[40:43], s57 offen lds
    s_add_u32 m0, s59, 41984
    s_nop 0
    buffer_load_dwordx4 v9, s[40:43], s57 offen lds
    s_add_u32 m0, s59, 43008
    s_nop 0
    buffer_load_dwordx4 v10, s[40:43], s57 offen lds
    s_add_u32 m0, s59, 44032
    s_nop 0
    buffer_load_dwordx4 v11, s[40:43], s57 offen lds
    s_add_u32 m0, s59, 45056
    s_nop 0
    buffer_load_dwordx4 v12, s[40:43], s57 offen lds
    s_add_u32 m0, s59, 46080
    s_nop 0
    buffer_load_dwordx4 v13, s[40:43], s57 offen lds
    s_add_u32 s57, s57, 73728
    s_add_u32 m0, s59, 81920
    s_nop 0
    buffer_load_dwordx4 v8, s[40:43], s57 offen lds
    s_add_u32 m0, s59, 82944
    s_nop 0
    buffer_load_dwordx4 v9, s[40:43], s57 offen lds
    s_add_u32 m0, s59, 83968
    s_nop 0
    buffer_load_dwordx4 v10, s[40:43], s57 offen lds
    s_add_u32 m0, s59, 84992
    s_nop 0
    buffer_load_dwordx4 v11, s[40:43], s57 offen lds
    s_add_u32 m0, s59, 86016
    s_nop 0
    buffer_load_dwordx4 v12, s[40:43], s57 offen lds
    s_add_u32 m0, s59, 87040
    s_nop 0
    buffer_load_dwordx4 v13, s[40:43], s57 offen lds
    s_add_u32 s57, s57, 73728
    s_add_u32 s84, s34, 0x888000
    s_addc_u32 s85, s35, 0
    s_mov_b32 s86, 0x400
    s_mov_b32 s87, 0x00020000
    s_lshr_b32 s60, s7, 8
    s_lshl_b32 s60, s60, 7
    s_lshl_b32 s61, s9, 5
    s_add_u32 s60, s60, s61
    v_mov_b32 v20, s60
L_ffn_pollA_182:
    buffer_load_dwordx4 v[24:27], v20, s[84:87], 0 offen sc1
    buffer_load_dwordx4 v[28:31], v20, s[84:87], 0 offen offset:16 sc1
    s_waitcnt vmcnt(0)
    v_add3_u32 v24, v24, v25, v26
    v_add3_u32 v24, v24, v27, v28
    v_add3_u32 v24, v24, v29, v30
    v_add_u32 v24, v24, v31
    s_nop 0
    v_readfirstlane_b32 s61, v24
    s_cmp_ge_u32 s61, 8
    s_cbranch_scc1 L_ffn_goA_183
    s_sleep 2
    s_branch L_ffn_pollA_182
L_ffn_goA_183:
    s_add_u32 m0, s58, 0
    s_nop 0
    buffer_load_dwordx4 v2, s[36:39], s56 offen sc1 lds
    s_add_u32 m0, s58, 1024
    s_nop 0
    buffer_load_dwordx4 v3, s[36:39], s56 offen sc1 lds
    s_add_u32 m0, s58, 2048
    s_nop 0
    buffer_load_dwordx4 v4, s[36:39], s56 offen sc1 lds
    s_add_u32 m0, s58, 3072
    s_nop 0
    buffer_load_dwordx4 v5, s[36:39], s56 offen sc1 lds
    s_add_u32 s56, s56, 2048
    s_add_u32 m0, s58, 40960
    s_nop 0
    buffer_load_dwordx4 v2, s[36:39], s56 offen sc1 lds
    s_add_u32 m0, s58, 41984
    s_nop 0
    buffer_load_dwordx4 v3, s[36:39], s56 offen sc1 lds
    s_add_u32 m0, s58, 43008
    s_nop 0
    buffer_load_dwordx4 v4, s[36:39], s56 offen sc1 lds
    s_add_u32 m0, s58, 44032
    s_nop 0
    buffer_load_dwordx4 v5, s[36:39], s56 offen sc1 lds
    s_add_u32 s56, s56, 2048
    s_add_u32 m0, s58, 81920
    s_nop 0
    buffer_load_dwordx4 v2, s[36:39], s56 offen sc1 lds
    s_add_u32 m0, s58, 82944
    s_nop 0
    buffer_load_dwordx4 v3, s[36:39], s56 offen sc1 lds
    s_add_u32 m0, s58, 83968
    s_nop 0
    buffer_load_dwordx4 v4, s[36:39], s56 offen sc1 lds
    s_add_u32 m0, s58, 84992
    s_nop 0
    buffer_load_dwordx4 v5, s[36:39], s56 offen sc1 lds
    s_add_u32 s56, s56, 2048
    s_waitcnt vmcnt(8)
    s_barrier
    s_waitcnt vmcnt(4)
    s_barrier
    s_add_u32 m0, s58, 122880
    s_nop 0
    buffer_load_dwordx4 v2, s[36:39], s56 offen sc1 lds
    s_add_u32 m0, s58, 123904
    s_nop 0
    buffer_load_dwordx4 v3, s[36:39], s56 offen sc1 lds
    s_add_u32 m0, s58, 124928
    s_nop 0
    buffer_load_dwordx4 v4, s[36:39], s56 offen sc1 lds
    s_add_u32 m0, s58, 125952
    s_nop 0
    buffer_load_dwordx4 v5, s[36:39], s56 offen sc1 lds
    s_add_u32 s56, s56, 2048
    s_add_u32 m0, s59, 122880
    s_nop 0
    buffer_load_dwordx4 v8, s[40:43], s57 offen lds
    s_add_u32 m0, s59, 123904
    s_nop 0
    buffer_load_dwordx4 v9, s[40:43], s57 offen lds
    s_add_u32 m0, s59, 124928
    s_nop 0
    buffer_load_dwordx4 v10, s[40:43], s57 offen lds
    s_add_u32 m0, s59, 125952
    s_nop 0
    buffer_load_dwordx4 v11, s[40:43], s57 offen lds
    s_add_u32 m0, s59, 126976
    s_nop 0
    buffer_load_dwordx4 v12, s[40:43], s57 offen lds
    s_add_u32 m0, s59, 128000
    s_nop 0
    buffer_load_dwordx4 v13, s[40:43], s57 offen lds
    s_add_u32 s57, s57, 73728
    s_waitcnt vmcnt(10)
    s_barrier
    s_add_u32 m0, s58, 0
    s_nop 0
    buffer_load_dwordx4 v2, s[36:39], s56 offen sc1 lds
    s_add_u32 m0, s58, 1024
    s_nop 0
    buffer_load_dwordx4 v3, s[36:39], s56 offen sc1 lds
    s_add_u32 m0, s58, 2048
    s_nop 0
    buffer_load_dwordx4 v4, s[36:39], s56 offen sc1 lds
    s_add_u32 m0, s58, 3072
    s_nop 0
    buffer_load_dwordx4 v5, s[36:39], s56 offen sc1 lds
    s_add_u32 s56, s56, 2048
    s_add_u32 m0, s59, 0
    s_nop 0
    buffer_load_dwordx4 v8, s[40:43], s57 offen lds
    s_add_u32 m0, s59, 1024
    s_nop 0
    buffer_load_dwordx4 v9, s[40:43], s57 offen lds
    s_add_u32 m0, s59, 2048
    s_nop 0
    buffer_load_dwordx4 v10, s[40:43], s57 offen lds
    s_add_u32 m0, s59, 3072
    s_nop 0
    buffer_load_dwordx4 v11, s[40:43], s57 offen lds
    s_add_u32 m0, s59, 4096
    s_nop 0
    buffer_load_dwordx4 v12, s[40:43], s57 offen lds
    s_add_u32 m0, s59, 5120
    s_nop 0
    buffer_load_dwordx4 v13, s[40:43], s57 offen lds
    s_add_u32 s57, s57, 73728
    s_waitcnt vmcnt(10)
    s_barrier
    s_add_u32 m0, s58, 40960
    s_nop 0
    buffer_load_dwordx4 v2, s[36:39], s56 offen sc1 lds
    s_add_u32 m0, s58, 41984
    s_nop 0
    buffer_load_dwordx4 v3, s[36:39], s56 offen sc1 lds
    s_add_u32 m0, s58, 43008
    s_nop 0
    buffer_load_dwordx4 v4, s[36:39], s56 offen sc1 lds
    s_add_u32 m0, s58, 44032
    s_nop 0
    buffer_load_dwordx4 v5, s[36:39], s56 offen sc1 lds
    s_add_u32 s56, s56, 2048
    s_add_u32 m0, s59, 40960
    s_nop 0
    buffer_load_dwordx4 v8, s[40:43], s57 offen lds
    s_add_u32 m0, s59, 41984
    s_nop 0
    buffer_load_dwordx4 v9, s[40:43], s57 offen lds
    s_add_u32 m0, s59, 43008
    s_nop 0
    buffer_load_dwordx4 v10, s[40:43], s57 offen lds
    s_add_u32 m0, s59, 44032
    s_nop 0
    buffer_load_dwordx4 v11, s[40:43], s57 offen lds
    s_add_u32 m0, s59, 45056
    s_nop 0
    buffer_load_dwordx4 v12, s[40:43], s57 offen lds
    s_add_u32 m0, s59, 46080
    s_nop 0
    buffer_load_dwordx4 v13, s[40:43], s57 offen lds
    s_add_u32 s57, s57, 73728
    s_waitcnt vmcnt(10)
    s_barrier
    s_add_u32 m0, s58, 81920
    s_nop 0
    buffer_load_dwordx4 v2, s[36:39], s56 offen sc1 lds
    s_add_u32 m0, s58, 82944
    s_nop 0
    buffer_load_dwordx4 v3, s[36:39], s56 offen sc1 lds
    s_add_u32 m0, s58, 83968
    s_nop 0
    buffer_load_dwordx4 v4, s[36:39], s56 offen sc1 lds
    s_add_u32 m0, s58, 84992
    s_nop 0
    buffer_load_dwordx4 v5, s[36:39], s56 offen sc1 lds
    s_add_u32 s56, s56, 2048
    s_add_u32 m0, s59, 81920
    s_nop 0
    buffer_load_dwordx4 v8, s[40:43], s57 offen lds
    s_add_u32 m0, s59, 82944
    s_nop 0
    buffer_load_dwordx4 v9, s[40:43], s57 offen lds
    s_add_u32 m0, s59, 83968
    s_nop 0
    buffer_load_dwordx4 v10, s[40:43], s57 offen lds
    s_add_u32 m0, s59, 84992
    s_nop 0
    buffer_load_dwordx4 v11, s[40:43], s57 offen lds
    s_add_u32 m0, s59, 86016
    s_nop 0
    buffer_load_dwordx4 v12, s[40:43], s57 offen lds
    s_add_u32 m0, s59, 87040
    s_nop 0
    buffer_load_dwordx4 v13, s[40:43], s57 offen lds
    s_add_u32 s57, s57, 73728
    s_waitcnt vmcnt(10)
    s_barrier
    s_add_u32 m0, s58, 122880
    s_nop 0
    buffer_load_dwordx4 v2, s[36:39], s56 offen sc1 lds
    s_add_u32 m0, s58, 123904
    s_nop 0
    buffer_load_dwordx4 v3, s[36:39], s56 offen sc1 lds
    s_add_u32 m0, s58, 124928
    s_nop 0
    buffer_load_dwordx4 v4, s[36:39], s56 offen sc1 lds
    s_add_u32 m0, s58, 125952
    s_nop 0
    buffer_load_dwordx4 v5, s[36:39], s56 offen sc1 lds
    s_add_u32 s56, s56, 2048
    s_add_u32 m0, s59, 122880
    s_nop 0
    buffer_load_dwordx4 v8, s[40:43], s57 offen lds
    s_add_u32 m0, s59, 123904
    s_nop 0
    buffer_load_dwordx4 v9, s[40:43], s57 offen lds
    s_add_u32 m0, s59, 124928
    s_nop 0
    buffer_load_dwordx4 v10, s[40:43], s57 offen lds
    s_add_u32 m0, s59, 125952
    s_nop 0
    buffer_load_dwordx4 v11, s[40:43], s57 offen lds
    s_add_u32 m0, s59, 126976
    s_nop 0
    buffer_load_dwordx4 v12, s[40:43], s57 offen lds
    s_add_u32 m0, s59, 128000
    s_nop 0
    buffer_load_dwordx4 v13, s[40:43], s57 offen lds
    s_add_u32 s57, s57, 73728
    s_waitcnt vmcnt(10)
    s_barrier
    s_add_u32 m0, s58, 0
    s_nop 0
    buffer_load_dwordx4 v2, s[36:39], s56 offen sc1 lds
    s_add_u32 m0, s58, 1024
    s_nop 0
    buffer_load_dwordx4 v3, s[36:39], s56 offen sc1 lds
    s_add_u32 m0, s58, 2048
    s_nop 0
    buffer_load_dwordx4 v4, s[36:39], s56 offen sc1 lds
    s_add_u32 m0, s58, 3072
    s_nop 0
    buffer_load_dwordx4 v5, s[36:39], s56 offen sc1 lds
    s_add_u32 s56, s56, 2048
    s_add_u32 m0, s59, 0
    s_nop 0
    buffer_load_dwordx4 v8, s[40:43], s57 offen lds
    s_add_u32 m0, s59, 1024
    s_nop 0
    buffer_load_dwordx4 v9, s[40:43], s57 offen lds
    s_add_u32 m0, s59, 2048
    s_nop 0
    buffer_load_dwordx4 v10, s[40:43], s57 offen lds
    s_add_u32 m0, s59, 3072
    s_nop 0
    buffer_load_dwordx4 v11, s[40:43], s57 offen lds
    s_add_u32 m0, s59, 4096
    s_nop 0
    buffer_load_dwordx4 v12, s[40:43], s57 offen lds
    s_add_u32 m0, s59, 5120
    s_nop 0
    buffer_load_dwordx4 v13, s[40:43], s57 offen lds
    s_add_u32 s57, s57, 73728
    s_waitcnt vmcnt(10)
    s_barrier
    s_add_u32 m0, s58, 40960
    s_nop 0
    buffer_load_dwordx4 v2, s[36:39], s56 offen sc1 lds
    s_add_u32 m0, s58, 41984
    s_nop 0
    buffer_load_dwordx4 v3, s[36:39], s56 offen sc1 lds
    s_add_u32 m0, s58, 43008
    s_nop 0
    buffer_load_dwordx4 v4, s[36:39], s56 offen sc1 lds
    s_add_u32 m0, s58, 44032
    s_nop 0
    buffer_load_dwordx4 v5, s[36:39], s56 offen sc1 lds
    s_add_u32 s56, s56, 2048
    s_add_u32 m0, s59, 40960
    s_nop 0
    buffer_load_dwordx4 v8, s[40:43], s57 offen lds
    s_add_u32 m0, s59, 41984
    s_nop 0
    buffer_load_dwordx4 v9, s[40:43], s57 offen lds
    s_add_u32 m0, s59, 43008
    s_nop 0
    buffer_load_dwordx4 v10, s[40:43], s57 offen lds
    s_add_u32 m0, s59, 44032
    s_nop 0
    buffer_load_dwordx4 v11, s[40:43], s57 offen lds
    s_add_u32 m0, s59, 45056
    s_nop 0
    buffer_load_dwordx4 v12, s[40:43], s57 offen lds
    s_add_u32 m0, s59, 46080
    s_nop 0
    buffer_load_dwordx4 v13, s[40:43], s57 offen lds
    s_add_u32 s57, s57, 73728
    s_waitcnt vmcnt(10)
    s_barrier
    s_add_u32 m0, s58, 81920
    s_nop 0
    buffer_load_dwordx4 v2, s[36:39], s56 offen sc1 lds
    s_add_u32 m0, s58, 82944
    s_nop 0
    buffer_load_dwordx4 v3, s[36:39], s56 offen sc1 lds
    s_add_u32 m0, s58, 83968
    s_nop 0
    buffer_load_dwordx4 v4, s[36:39], s56 offen sc1 lds
    s_add_u32 m0, s58, 84992
    s_nop 0
    buffer_load_dwordx4 v5, s[36:39], s56 offen sc1 lds
    s_add_u32 s56, s56, 2048
    s_add_u32 m0, s59, 81920
    s_nop 0
    buffer_load_dwordx4 v8, s[40:43], s57 offen lds
    s_add_u32 m0, s59, 82944
    s_nop 0
    buffer_load_dwordx4 v9, s[40:43], s57 offen lds
    s_add_u32 m0, s59, 83968
    s_nop 0
    buffer_load_dwordx4 v10, s[40:43], s57 offen lds
    s_add_u32 m0, s59, 84992
    s_nop 0
    buffer_load_dwordx4 v11, s[40:43], s57 offen lds
    s_add_u32 m0, s59, 86016
    s_nop 0
    buffer_load_dwordx4 v12, s[40:43], s57 offen lds
    s_add_u32 m0, s59, 87040
    s_nop 0
    buffer_load_dwordx4 v13, s[40:43], s57 offen lds
    s_add_u32 s57, s57, 73728
    s_waitcnt vmcnt(10)
    s_barrier
    s_add_u32 m0, s58, 122880
    s_nop 0
    buffer_load_dwordx4 v2, s[36:39], s56 offen sc1 lds
    s_add_u32 m0, s58, 123904
    s_nop 0
    buffer_load_dwordx4 v3, s[36:39], s56 offen sc1 lds
    s_add_u32 m0, s58, 124928
    s_nop 0
    buffer_load_dwordx4 v4, s[36:39], s56 offen sc1 lds
    s_add_u32 m0, s58, 125952
    s_nop 0
    buffer_load_dwordx4 v5, s[36:39], s56 offen sc1 lds
    s_add_u32 s56, s56, 2048
    s_add_u32 m0, s59, 122880
    s_nop 0
    buffer_load_dwordx4 v8, s[40:43], s57 offen lds
    s_add_u32 m0, s59, 123904
    s_nop 0
    buffer_load_dwordx4 v9, s[40:43], s57 offen lds
    s_add_u32 m0, s59, 124928
    s_nop 0
    buffer_load_dwordx4 v10, s[40:43], s57 offen lds
    s_add_u32 m0, s59, 125952
    s_nop 0
    buffer_load_dwordx4 v11, s[40:43], s57 offen lds
    s_add_u32 m0, s59, 126976
    s_nop 0
    buffer_load_dwordx4 v12, s[40:43], s57 offen lds
    s_add_u32 m0, s59, 128000
    s_nop 0
    buffer_load_dwordx4 v13, s[40:43], s57 offen lds
    s_add_u32 s57, s57, 73728
    s_waitcnt vmcnt(10)
    s_barrier
    s_add_u32 m0, s58, 0
    s_nop 0
    buffer_load_dwordx4 v2, s[36:39], s56 offen sc1 lds
    s_add_u32 m0, s58, 1024
    s_nop 0
    buffer_load_dwordx4 v3, s[36:39], s56 offen sc1 lds
    s_add_u32 m0, s58, 2048
    s_nop 0
    buffer_load_dwordx4 v4, s[36:39], s56 offen sc1 lds
    s_add_u32 m0, s58, 3072
    s_nop 0
    buffer_load_dwordx4 v5, s[36:39], s56 offen sc1 lds
    s_add_u32 s56, s56, 2048
    s_add_u32 m0, s59, 0
    s_nop 0
    buffer_load_dwordx4 v8, s[40:43], s57 offen lds
    s_add_u32 m0, s59, 1024
    s_nop 0
    buffer_load_dwordx4 v9, s[40:43], s57 offen lds
    s_add_u32 m0, s59, 2048
    s_nop 0
    buffer_load_dwordx4 v10, s[40:43], s57 offen lds
    s_add_u32 m0, s59, 3072
    s_nop 0
    buffer_load_dwordx4 v11, s[40:43], s57 offen lds
    s_add_u32 m0, s59, 4096
    s_nop 0
    buffer_load_dwordx4 v12, s[40:43], s57 offen lds
    s_add_u32 m0, s59, 5120
    s_nop 0
    buffer_load_dwordx4 v13, s[40:43], s57 offen lds
    s_add_u32 s57, s57, 73728
    s_waitcnt vmcnt(10)
    s_barrier
    s_add_u32 m0, s58, 40960
    s_nop 0
    buffer_load_dwordx4 v2, s[36:39], s56 offen sc1 lds
    s_add_u32 m0, s58, 41984
    s_nop 0
    buffer_load_dwordx4 v3, s[36:39], s56 offen sc1 lds
    s_add_u32 m0, s58, 43008
    s_nop 0
    buffer_load_dwordx4 v4, s[36:39], s56 offen sc1 lds
    s_add_u32 m0, s58, 44032
    s_nop 0
    buffer_load_dwordx4 v5, s[36:39], s56 offen sc1 lds
    s_add_u32 s56, s56, 2048
    s_add_u32 m0, s59, 40960
    s_nop 0
    buffer_load_dwordx4 v8, s[40:43], s57 offen lds
    s_add_u32 m0, s59, 41984
    s_nop 0
    buffer_load_dwordx4 v9, s[40:43], s57 offen lds
    s_add_u32 m0, s59, 43008
    s_nop 0
    buffer_load_dwordx4 v10, s[40:43], s57 offen lds
    s_add_u32 m0, s59, 44032
    s_nop 0
    buffer_load_dwordx4 v11, s[40:43], s57 offen lds
    s_add_u32 m0, s59, 45056
    s_nop 0
    buffer_load_dwordx4 v12, s[40:43], s57 offen lds
    s_add_u32 m0, s59, 46080
    s_nop 0
    buffer_load_dwordx4 v13, s[40:43], s57 offen lds
    s_add_u32 s57, s57, 73728
    s_waitcnt vmcnt(10)
    s_barrier
    s_add_u32 m0, s58, 81920
    s_nop 0
    buffer_load_dwordx4 v2, s[36:39], s56 offen sc1 lds
    s_add_u32 m0, s58, 82944
    s_nop 0
    buffer_load_dwordx4 v3, s[36:39], s56 offen sc1 lds
    s_add_u32 m0, s58, 83968
    s_nop 0
    buffer_load_dwordx4 v4, s[36:39], s56 offen sc1 lds
    s_add_u32 m0, s58, 84992
    s_nop 0
    buffer_load_dwordx4 v5, s[36:39], s56 offen sc1 lds
    s_add_u32 s56, s56, 2048
    s_add_u32 m0, s59, 81920
    s_nop 0
    buffer_load_dwordx4 v8, s[40:43], s57 offen lds
    s_add_u32 m0, s59, 82944
    s_nop 0
    buffer_load_dwordx4 v9, s[40:43], s57 offen lds
    s_add_u32 m0, s59, 83968
    s_nop 0
    buffer_load_dwordx4 v10, s[40:43], s57 offen lds
    s_add_u32 m0, s59, 84992
    s_nop 0
    buffer_load_dwordx4 v11, s[40:43], s57 offen lds
    s_add_u32 m0, s59, 86016
    s_nop 0
    buffer_load_dwordx4 v12, s[40:43], s57 offen lds
    s_add_u32 m0, s59, 87040
    s_nop 0
    buffer_load_dwordx4 v13, s[40:43], s57 offen lds
    s_add_u32 s57, s57, 73728
    s_waitcnt vmcnt(10)
    s_barrier
    s_add_u32 m0, s58, 122880
    s_nop 0
    buffer_load_dwordx4 v2, s[36:39], s56 offen sc1 lds
    s_add_u32 m0, s58, 123904
    s_nop 0
    buffer_load_dwordx4 v3, s[36:39], s56 offen sc1 lds
    s_add_u32 m0, s58, 124928
    s_nop 0
    buffer_load_dwordx4 v4, s[36:39], s56 offen sc1 lds
    s_add_u32 m0, s58, 125952
    s_nop 0
    buffer_load_dwordx4 v5, s[36:39], s56 offen sc1 lds
    s_add_u32 s56, s56, 2048
    s_add_u32 m0, s59, 122880
    s_nop 0
    buffer_load_dwordx4 v8, s[40:43], s57 offen lds
    s_add_u32 m0, s59, 123904
    s_nop 0
    buffer_load_dwordx4 v9, s[40:43], s57 offen lds
    s_add_u32 m0, s59, 124928
    s_nop 0
    buffer_load_dwordx4 v10, s[40:43], s57 offen lds
    s_add_u32 m0, s59, 125952
    s_nop 0
    buffer_load_dwordx4 v11, s[40:43], s57 offen lds
    s_add_u32 m0, s59, 126976
    s_nop 0
    buffer_load_dwordx4 v12, s[40:43], s57 offen lds
    s_add_u32 m0, s59, 128000
    s_nop 0
    buffer_load_dwordx4 v13, s[40:43], s57 offen lds
    s_add_u32 s57, s57, 73728
    s_waitcnt vmcnt(10)
    s_barrier
    s_add_u32 m0, s58, 0
    s_nop 0
    buffer_load_dwordx4 v2, s[36:39], s56 offen sc1 lds
    s_add_u32 m0, s58, 1024
    s_nop 0
    buffer_load_dwordx4 v3, s[36:39], s56 offen sc1 lds
    s_add_u32 m0, s58, 2048
    s_nop 0
    buffer_load_dwordx4 v4, s[36:39], s56 offen sc1 lds
    s_add_u32 m0, s58, 3072
    s_nop 0
    buffer_load_dwordx4 v5, s[36:39], s56 offen sc1 lds
    s_add_u32 s56, s56, 2048
    s_add_u32 m0, s59, 0
    s_nop 0
    buffer_load_dwordx4 v8, s[40:43], s57 offen lds
    s_add_u32 m0, s59, 1024
    s_nop 0
    buffer_load_dwordx4 v9, s[40:43], s57 offen lds
    s_add_u32 m0, s59, 2048
    s_nop 0
    buffer_load_dwordx4 v10, s[40:43], s57 offen lds
    s_add_u32 m0, s59, 3072
    s_nop 0
    buffer_load_dwordx4 v11, s[40:43], s57 offen lds
    s_add_u32 m0, s59, 4096
    s_nop 0
    buffer_load_dwordx4 v12, s[40:43], s57 offen lds
    s_add_u32 m0, s59, 5120
    s_nop 0
    buffer_load_dwordx4 v13, s[40:43], s57 offen lds
    s_add_u32 s57, s57, 73728
    s_waitcnt vmcnt(10)
    s_barrier
    s_add_u32 m0, s58, 40960
    s_nop 0
    buffer_load_dwordx4 v2, s[36:39], s56 offen sc1 lds
    s_add_u32 m0, s58, 41984
    s_nop 0
    buffer_load_dwordx4 v3, s[36:39], s56 offen sc1 lds
    s_add_u32 m0, s58, 43008
    s_nop 0
    buffer_load_dwordx4 v4, s[36:39], s56 offen sc1 lds
    s_add_u32 m0, s58, 44032
    s_nop 0
    buffer_load_dwordx4 v5, s[36:39], s56 offen sc1 lds
    s_add_u32 s56, s56, 2048
    s_add_u32 m0, s59, 40960
    s_nop 0
    buffer_load_dwordx4 v8, s[40:43], s57 offen lds
    s_add_u32 m0, s59, 41984
    s_nop 0
    buffer_load_dwordx4 v9, s[40:43], s57 offen lds
    s_add_u32 m0, s59, 43008
    s_nop 0
    buffer_load_dwordx4 v10, s[40:43], s57 offen lds
    s_add_u32 m0, s59, 44032
    s_nop 0
    buffer_load_dwordx4 v11, s[40:43], s57 offen lds
    s_add_u32 m0, s59, 45056
    s_nop 0
    buffer_load_dwordx4 v12, s[40:43], s57 offen lds
    s_add_u32 m0, s59, 46080
    s_nop 0
    buffer_load_dwordx4 v13, s[40:43], s57 offen lds
    s_add_u32 s57, s57, 73728
    s_waitcnt vmcnt(10)
    s_barrier
    s_waitcnt vmcnt(0)
    s_barrier
    s_endpgm
L_ffn_comp_181:
    s_add_u32 s44, s34, 0x3000000
    s_addc_u32 s45, s35, 0
    s_mov_b32 s46, 0x1200000
    s_mov_b32 s47, 0x00020000
    s_mov_b32 s48, s30
    s_mov_b32 s49, s31
    s_mov_b32 s50, 0x240000
    s_mov_b32 s51, 0x00020000
    s_add_u32 s52, s34, 0x400000
    s_addc_u32 s53, s35, 0
    s_mov_b32 s54, 0x240000
    s_mov_b32 s55, 0x00020000
    s_add_u32 s64, s34, 0x880000
    s_addc_u32 s65, s35, 0
    s_mov_b32 s66, 0x8000
    s_mov_b32 s67, 0x00020000
    s_lshl_b32 s60, s4, 12
    v_lshlrev_b32 v18, 4, v0
    v_add_u32 v2, s60, v18
    v_add_u32 v3, 40960, v2
    v_add_u32 v4, 81920, v2
    v_add_u32 v5, 122880, v2
    s_bfe_u32 s62, s8, 0x20004
    s_movk_i32 s63, 16384
    v_lshrrev_b32 v19, 5, v0
    v_lshlrev_b32 v18, 4, v19
    v_bfe_u32 v19, v0, 4, 1
    v_lshlrev_b32 v19, 2, v19
    v_add_u32 v18, v18, v19
    v_bfe_u32 v20, v0, 2, 2
    v_add_u32 v18, v18, v20
    v_bfe_u32 v19, v18, 1, 2
    v_mul_u32_u24 v18, 384, v18
    v_and_b32 v20, 3, v0
    v_lshlrev_b32 v20, 3, v20
    v_add3_u32 v18, v18, v20, s63
    s_add_u32 s60, s62, 0
    s_and_b32 s61, s60, 3
    s_lshr_b32 s60, s60, 2
    s_lshl_b32 s60, s60, 7
    v_xor_b32 v20, s61, v19
    v_lshlrev_b32 v20, 5, v20
    v_add3_u32 v24, v18, v20, s60
    s_add_u32 s60, s62, 1
    s_and_b32 s61, s60, 3
    s_lshr_b32 s60, s60, 2
    s_lshl_b32 s60, s60, 7
    v_xor_b32 v20, s61, v19
    v_lshlrev_b32 v20, 5, v20
    v_add3_u32 v25, v18, v20, s60
    s_add_u32 s60, s62, 2
    s_and_b32 s61, s60, 3
    s_lshr_b32 s60, s60, 2
    s_lshl_b32 s60, s60, 7
    v_xor_b32 v20, s61, v19
    v_lshlrev_b32 v20, 5, v20
    v_add3_u32 v26, v18, v20, s60
    s_add_u32 s60, s62, 3
    s_and_b32 s61, s60, 3
    s_lshr_b32 s60, s60, 2
    s_lshl_b32 s60, s60, 7
    v_xor_b32 v20, s61, v19
    v_lshlrev_b32 v20, 5, v20
    v_add3_u32 v27, v18, v20, s60
    v_add_u32 v28, 40960, v24
    v_add_u32 v29, 40960, v25
    v_add_u32 v30, 40960, v26
    v_add_u32 v31, 40960, v27
    v_add_u32 v32, 81920, v24
    v_add_u32 v33, 81920, v25
    v_add_u32 v34, 81920, v26
    v_add_u32 v35, 81920, v27
    v_add_u32 v36, 122880, v24
    v_add_u32 v37, 122880, v25
    v_add_u32 v38, 122880, v26
    v_add_u32 v39, 122880, v27
    s_barrier
    ds_read_b128 v[48:51], v2 offset:0
    ds_read_b128 v[52:55], v2 offset:2048
    ds_read_b64_tr_b16 v[64:65], v24 offset:0
    ds_read_b64_tr_b16 v[66:67], v24 offset:3072
    ds_read_b64_tr_b16 v[68:69], v25 offset:0
    ds_read_b64_tr_b16 v[70:71], v25 offset:3072
    ds_read_b64_tr_b16 v[72:73], v26 offset:0
    ds_read_b64_tr_b16 v[74:75], v26 offset:3072
    ds_read_b64_tr_b16 v[76:77], v27 offset:0
    ds_read_b64_tr_b16 v[78:79], v27 offset:3072
    ds_read_b64_tr_b16 v[80:81], v24 offset:128
    ds_read_b64_tr_b16 v[82:83], v24 offset:3200
    ds_read_b64_tr_b16 v[84:85], v25 offset:128
    ds_read_b64_tr_b16 v[86:87], v25 offset:3200
    s_waitcnt lgkmcnt(12)
    s_waitcnt lgkmcnt(10)
    v_mfma_f32_16x16x32_bf16 v[112:115], v[64:67], v[48:51], 0
    ds_read_b64_tr_b16 v[88:89], v26 offset:128
    ds_read_b64_tr_b16 v[90:91], v26 offset:3200
    v_mfma_f32_16x16x32_bf16 v[148:151], v[64:67], v[52:55], 0
    s_waitcnt lgkmcnt(10)
    v_mfma_f32_16x16x32_bf16 v[116:119], v[68:71], v[48:51], 0
    ds_read_b64_tr_b16 v[92:93], v27 offset:128
    ds_read_b64_tr_b16 v[94:95], v27 offset:3200
    v_mfma_f32_16x16x32_bf16 v[152:155], v[68:71], v[52:55], 0
    s_waitcnt lgkmcnt(10)
    v_mfma_f32_16x16x32_bf16 v[120:123], v[72:75], v[48:51], 0
    ds_read_b64_tr_b16 v[64:65], v24 offset:256
    ds_read_b64_tr_b16 v[66:67], v24 offset:3328
    v_mfma_f32_16x16x32_bf16 v[156:159], v[72:75], v[52:55], 0
    ds_read_b128 v[56:59], v2 offset:1024
    s_waitcnt lgkmcnt(11)
    v_mfma_f32_16x16x32_bf16 v[124:127], v[76:79], v[48:51], 0
    ds_read_b64_tr_b16 v[68:69], v24 offset:12288
    ds_read_b64_tr_b16 v[70:71], v24 offset:15360
    v_mfma_f32_16x16x32_bf16 v[160:163], v[76:79], v[52:55], 0
    ds_read_b128 v[60:63], v2 offset:3072
    s_waitcnt lgkmcnt(12)
    v_mfma_f32_16x16x32_bf16 v[128:131], v[80:83], v[48:51], 0
    ds_read_b64_tr_b16 v[72:73], v25 offset:12288
    ds_read_b64_tr_b16 v[74:75], v25 offset:15360
    v_mfma_f32_16x16x32_bf16 v[164:167], v[80:83], v[52:55], 0
    s_waitcnt lgkmcnt(12)
    v_mfma_f32_16x16x32_bf16 v[132:135], v[84:87], v[48:51], 0
    ds_read_b64_tr_b16 v[76:77], v26 offset:12288
    ds_read_b64_tr_b16 v[78:79], v26 offset:15360
    v_mfma_f32_16x16x32_bf16 v[168:171], v[84:87], v[52:55], 0
    s_waitcnt lgkmcnt(12)
    v_mfma_f32_16x16x32_bf16 v[136:139], v[88:91], v[48:51], 0
    ds_read_b64_tr_b16 v[80:81], v27 offset:12288
    ds_read_b64_tr_b16 v[82:83], v27 offset:15360
    v_mfma_f32_16x16x32_bf16 v[172:175], v[88:91], v[52:55], 0
    s_waitcnt lgkmcnt(12)
    v_mfma_f32_16x16x32_bf16 v[140:143], v[92:95], v[48:51], 0
    ds_read_b64_tr_b16 v[84:85], v24 offset:12416
    ds_read_b64_tr_b16 v[86:87], v24 offset:15488
    v_mfma_f32_16x16x32_bf16 v[176:179], v[92:95], v[52:55], 0
    s_waitcnt lgkmcnt(12)
    v_mfma_f32_16x16x32_bf16 v[144:147], v[64:67], v[48:51], 0
    ds_read_b64_tr_b16 v[88:89], v25 offset:12416
    ds_read_b64_tr_b16 v[90:91], v25 offset:15488
    v_mfma_f32_16x16x32_bf16 v[180:183], v[64:67], v[52:55], 0
    s_barrier
    s_waitcnt lgkmcnt(10)
    v_mfma_f32_16x16x32_bf16 v[112:115], v[68:71], v[56:59], v[112:115]
    ds_read_b64_tr_b16 v[92:93], v26 offset:12416
    ds_read_b64_tr_b16 v[94:95], v26 offset:15488
    v_mfma_f32_16x16x32_bf16 v[148:151], v[68:71], v[60:63], v[148:151]
    s_waitcnt lgkmcnt(10)
    v_mfma_f32_16x16x32_bf16 v[116:119], v[72:75], v[56:59], v[116:119]
    ds_read_b64_tr_b16 v[64:65], v27 offset:12416
    ds_read_b64_tr_b16 v[66:67], v27 offset:15488
    v_mfma_f32_16x16x32_bf16 v[152:155], v[72:75], v[60:63], v[152:155]
    s_waitcnt lgkmcnt(10)
    v_mfma_f32_16x16x32_bf16 v[120:123], v[76:79], v[56:59], v[120:123]
    ds_read_b64_tr_b16 v[68:69], v24 offset:12544
    ds_read_b64_tr_b16 v[70:71], v24 offset:15616
    v_mfma_f32_16x16x32_bf16 v[156:159], v[76:79], v[60:63], v[156:159]
    ds_read_b128 v[48:51], v3 offset:0
    s_waitcnt lgkmcnt(11)
    v_mfma_f32_16x16x32_bf16 v[124:127], v[80:83], v[56:59], v[124:127]
    ds_read_b64_tr_b16 v[72:73], v28 offset:0
    ds_read_b64_tr_b16 v[74:75], v28 offset:3072
    v_mfma_f32_16x16x32_bf16 v[160:163], v[80:83], v[60:63], v[160:163]
    ds_read_b128 v[52:55], v3 offset:2048
    s_waitcnt lgkmcnt(12)
    v_mfma_f32_16x16x32_bf16 v[128:131], v[84:87], v[56:59], v[128:131]
    ds_read_b64_tr_b16 v[76:77], v29 offset:0
    ds_read_b64_tr_b16 v[78:79], v29 offset:3072
    v_mfma_f32_16x16x32_bf16 v[164:167], v[84:87], v[60:63], v[164:167]
    s_waitcnt lgkmcnt(12)
    v_mfma_f32_16x16x32_bf16 v[132:135], v[88:91], v[56:59], v[132:135]
    ds_read_b64_tr_b16 v[80:81], v30 offset:0
    ds_read_b64_tr_b16 v[82:83], v30 offset:3072
    v_mfma_f32_16x16x32_bf16 v[168:171], v[88:91], v[60:63], v[168:171]
    s_waitcnt lgkmcnt(12)
    v_mfma_f32_16x16x32_bf16 v[136:139], v[92:95], v[56:59], v[136:139]
    ds_read_b64_tr_b16 v[84:85], v31 offset:0
    ds_read_b64_tr_b16 v[86:87], v31 offset:3072
    v_mfma_f32_16x16x32_bf16 v[172:175], v[92:95], v[60:63], v[172:175]
    s_waitcnt lgkmcnt(12)
    v_mfma_f32_16x16x32_bf16 v[140:143], v[64:67], v[56:59], v[140:143]
    ds_read_b64_tr_b16 v[88:89], v28 offset:128
    ds_read_b64_tr_b16 v[90:91], v28 offset:3200
    v_mfma_f32_16x16x32_bf16 v[176:179], v[64:67], v[60:63], v[176:179]
    s_waitcnt lgkmcnt(12)
    v_mfma_f32_16x16x32_bf16 v[144:147], v[68:71], v[56:59], v[144:147]
    ds_read_b64_tr_b16 v[92:93], v29 offset:128
    ds_read_b64_tr_b16 v[94:95], v29 offset:3200
    v_mfma_f32_16x16x32_bf16 v[180:183], v[68:71], v[60:63], v[180:183]
    s_waitcnt lgkmcnt(10)
    v_mfma_f32_16x16x32_bf16 v[112:115], v[72:75], v[48:51], v[112:115]
    ds_read_b64_tr_b16 v[64:65], v30 offset:128
    ds_read_b64_tr_b16 v[66:67], v30 offset:3200
    v_mfma_f32_16x16x32_bf16 v[148:151], v[72:75], v[52:55], v[148:151]
    s_waitcnt lgkmcnt(10)
    v_mfma_f32_16x16x32_bf16 v[116:119], v[76:79], v[48:51], v[116:119]
    ds_read_b64_tr_b16 v[68:69], v31 offset:128
    ds_read_b64_tr_b16 v[70:71], v31 offset:3200
    v_mfma_f32_16x16x32_bf16 v[152:155], v[76:79], v[52:55], v[152:155]
    s_waitcnt lgkmcnt(10)
    v_mfma_f32_16x16x32_bf16 v[120:123], v[80:83], v[48:51], v[120:123]
    ds_read_b64_tr_b16 v[72:73], v28 offset:256
    ds_read_b64_tr_b16 v[74:75], v28 offset:3328
    v_mfma_f32_16x16x32_bf16 v[156:159], v[80:83], v[52:55], v[156:159]
    ds_read_b128 v[56:59], v3 offset:1024
    s_waitcnt lgkmcnt(11)
    v_mfma_f32_16x16x32_bf16 v[124:127], v[84:87], v[48:51], v[124:127]
    ds_read_b64_tr_b16 v[76:77], v28 offset:12288
    ds_read_b64_tr_b16 v[78:79], v28 offset:15360
    v_mfma_f32_16x16x32_bf16 v[160:163], v[84:87], v[52:55], v[160:163]
    ds_read_b128 v[60:63], v3 offset:3072
    s_waitcnt lgkmcnt(12)
    v_mfma_f32_16x16x32_bf16 v[128:131], v[88:91], v[48:51], v[128:131]
    ds_read_b64_tr_b16 v[80:81], v29 offset:12288
    ds_read_b64_tr_b16 v[82:83], v29 offset:15360
    v_mfma_f32_16x16x32_bf16 v[164:167], v[88:91], v[52:55], v[164:167]
    s_waitcnt lgkmcnt(12)
    v_mfma_f32_16x16x32_bf16 v[132:135], v[92:95], v[48:51], v[132:135]
    ds_read_b64_tr_b16 v[84:85], v30 offset:12288
    ds_read_b64_tr_b16 v[86:87], v30 offset:15360
    v_mfma_f32_16x16x32_bf16 v[168:171], v[92:95], v[52:55], v[168:171]
    s_waitcnt lgkmcnt(12)
    v_mfma_f32_16x16x32_bf16 v[136:139], v[64:67], v[48:51], v[136:139]
    ds_read_b64_tr_b16 v[88:89], v31 offset:12288
    ds_read_b64_tr_b16 v[90:91], v31 offset:15360
    v_mfma_f32_16x16x32_bf16 v[172:175], v[64:67], v[52:55], v[172:175]
    s_waitcnt lgkmcnt(12)
    v_mfma_f32_16x16x32_bf16 v[140:143], v[68:71], v[48:51], v[140:143]
    ds_read_b64_tr_b16 v[92:93], v28 offset:12416
    ds_read_b64_tr_b16 v[94:95], v28 offset:15488
    v_mfma_f32_16x16x32_bf16 v[176:179], v[68:71], v[52:55], v[176:179]
    s_waitcnt lgkmcnt(12)
    v_mfma_f32_16x16x32_bf16 v[144:147], v[72:75], v[48:51], v[144:147]
    ds_read_b64_tr_b16 v[64:65], v29 offset:12416
    ds_read_b64_tr_b16 v[66:67], v29 offset:15488
    v_mfma_f32_16x16x32_bf16 v[180:183], v[72:75], v[52:55], v[180:183]
    s_barrier
    s_waitcnt lgkmcnt(10)
    v_mfma_f32_16x16x32_bf16 v[112:115], v[76:79], v[56:59], v[112:115]
    ds_read_b64_tr_b16 v[68:69], v30 offset:12416
    ds_read_b64_tr_b16 v[70:71], v30 offset:15488
    v_mfma_f32_16x16x32_bf16 v[148:151], v[76:79], v[60:63], v[148:151]
    s_waitcnt lgkmcnt(10)
    v_mfma_f32_16x16x32_bf16 v[116:119], v[80:83], v[56:59], v[116:119]
    ds_read_b64_tr_b16 v[72:73], v31 offset:12416
    ds_read_b64_tr_b16 v[74:75], v31 offset:15488
    v_mfma_f32_16x16x32_bf16 v[152:155], v[80:83], v[60:63], v[152:155]
    s_waitcnt lgkmcnt(10)
    v_mfma_f32_16x16x32_bf16 v[120:123], v[84:87], v[56:59], v[120:123]
    ds_read_b64_tr_b16 v[76:77], v28 offset:12544
    ds_read_b64_tr_b16 v[78:79], v28 offset:15616
    v_mfma_f32_16x16x32_bf16 v[156:159], v[84:87], v[60:63], v[156:159]
    ds_read_b128 v[48:51], v4 offset:0
    s_waitcnt lgkmcnt(11)
    v_mfma_f32_16x16x32_bf16 v[124:127], v[88:91], v[56:59], v[124:127]
    ds_read_b64_tr_b16 v[80:81], v32 offset:0
    ds_read_b64_tr_b16 v[82:83], v32 offset:3072
    v_mfma_f32_16x16x32_bf16 v[160:163], v[88:91], v[60:63], v[160:163]
    ds_read_b128 v[52:55], v4 offset:2048
    s_waitcnt lgkmcnt(12)
    v_mfma_f32_16x16x32_bf16 v[128:131], v[92:95], v[56:59], v[128:131]
    ds_read_b64_tr_b16 v[84:85], v33 offset:0
    ds_read_b64_tr_b16 v[86:87], v33 offset:3072
    v_mfma_f32_16x16x32_bf16 v[164:167], v[92:95], v[60:63], v[164:167]
    s_waitcnt lgkmcnt(12)
    v_mfma_f32_16x16x32_bf16 v[132:135], v[64:67], v[56:59], v[132:135]
    ds_read_b64_tr_b16 v[88:89], v34 offset:0
    ds_read_b64_tr_b16 v[90:91], v34 offset:3072
    v_mfma_f32_16x16x32_bf16 v[168:171], v[64:67], v[60:63], v[168:171]
    s_waitcnt lgkmcnt(12)
    v_mfma_f32_16x16x32_bf16 v[136:139], v[68:71], v[56:59], v[136:139]
    ds_read_b64_tr_b16 v[92:93], v35 offset:0
    ds_read_b64_tr_b16 v[94:95], v35 offset:3072
    v_mfma_f32_16x16x32_bf16 v[172:175], v[68:71], v[60:63], v[172:175]
    s_waitcnt lgkmcnt(12)
    v_mfma_f32_16x16x32_bf16 v[140:143], v[72:75], v[56:59], v[140:143]
    ds_read_b64_tr_b16 v[64:65], v32 offset:128
    ds_read_b64_tr_b16 v[66:67], v32 offset:3200
    v_mfma_f32_16x16x32_bf16 v[176:179], v[72:75], v[60:63], v[176:179]
    s_waitcnt lgkmcnt(12)
    v_mfma_f32_16x16x32_bf16 v[144:147], v[76:79], v[56:59], v[144:147]
    ds_read_b64_tr_b16 v[68:69], v33 offset:128
    ds_read_b64_tr_b16 v[70:71], v33 offset:3200
    v_mfma_f32_16x16x32_bf16 v[180:183], v[76:79], v[60:63], v[180:183]
    s_waitcnt lgkmcnt(10)
    v_mfma_f32_16x16x32_bf16 v[112:115], v[80:83], v[48:51], v[112:115]
    ds_read_b64_tr_b16 v[72:73], v34 offset:128
    ds_read_b64_tr_b16 v[74:75], v34 offset:3200
    v_mfma_f32_16x16x32_bf16 v[148:151], v[80:83], v[52:55], v[148:151]
    s_waitcnt lgkmcnt(10)
    v_mfma_f32_16x16x32_bf16 v[116:119], v[84:87], v[48:51], v[116:119]
    ds_read_b64_tr_b16 v[76:77], v35 offset:128
    ds_read_b64_tr_b16 v[78:79], v35 offset:3200
    v_mfma_f32_16x16x32_bf16 v[152:155], v[84:87], v[52:55], v[152:155]
    s_waitcnt lgkmcnt(10)
    v_mfma_f32_16x16x32_bf16 v[120:123], v[88:91], v[48:51], v[120:123]
    ds_read_b64_tr_b16 v[80:81], v32 offset:256
    ds_read_b64_tr_b16 v[82:83], v32 offset:3328
    v_mfma_f32_16x16x32_bf16 v[156:159], v[88:91], v[52:55], v[156:159]
    ds_read_b128 v[56:59], v4 offset:1024
    s_waitcnt lgkmcnt(11)
    v_mfma_f32_16x16x32_bf16 v[124:127], v[92:95], v[48:51], v[124:127]
    ds_read_b64_tr_b16 v[84:85], v32 offset:12288
    ds_read_b64_tr_b16 v[86:87], v32 offset:15360
    v_mfma_f32_16x16x32_bf16 v[160:163], v[92:95], v[52:55], v[160:163]
    ds_read_b128 v[60:63], v4 offset:3072
    s_waitcnt lgkmcnt(12)
    v_mfma_f32_16x16x32_bf16 v[128:131], v[64:67], v[48:51], v[128:131]
    ds_read_b64_tr_b16 v[88:89], v33 offset:12288
    ds_read_b64_tr_b16 v[90:91], v33 offset:15360
    v_mfma_f32_16x16x32_bf16 v[164:167], v[64:67], v[52:55], v[164:167]
    s_waitcnt lgkmcnt(12)
    v_mfma_f32_16x16x32_bf16 v[132:135], v[68:71], v[48:51], v[132:135]
    ds_read_b64_tr_b16 v[92:93], v34 offset:12288
    ds_read_b64_tr_b16 v[94:95], v34 offset:15360
    v_mfma_f32_16x16x32_bf16 v[168:171], v[68:71], v[52:55], v[168:171]
    s_waitcnt lgkmcnt(12)
    v_mfma_f32_16x16x32_bf16 v[136:139], v[72:75], v[48:51], v[136:139]
    ds_read_b64_tr_b16 v[64:65], v35 offset:12288
    ds_read_b64_tr_b16 v[66:67], v35 offset:15360
    v_mfma_f32_16x16x32_bf16 v[172:175], v[72:75], v[52:55], v[172:175]
    s_waitcnt lgkmcnt(12)
    v_mfma_f32_16x16x32_bf16 v[140:143], v[76:79], v[48:51], v[140:143]
    ds_read_b64_tr_b16 v[68:69], v32 offset:12416
    ds_read_b64_tr_b16 v[70:71], v32 offset:15488
    v_mfma_f32_16x16x32_bf16 v[176:179], v[76:79], v[52:55], v[176:179]
    s_waitcnt lgkmcnt(12)
    v_mfma_f32_16x16x32_bf16 v[144:147], v[80:83], v[48:51], v[144:147]
    ds_read_b64_tr_b16 v[72:73], v33 offset:12416
    ds_read_b64_tr_b16 v[74:75], v33 offset:15488
    v_mfma_f32_16x16x32_bf16 v[180:183], v[80:83], v[52:55], v[180:183]
    s_barrier
    s_waitcnt lgkmcnt(10)
    v_mfma_f32_16x16x32_bf16 v[112:115], v[84:87], v[56:59], v[112:115]
    ds_read_b64_tr_b16 v[76:77], v34 offset:12416
    ds_read_b64_tr_b16 v[78:79], v34 offset:15488
    v_mfma_f32_16x16x32_bf16 v[148:151], v[84:87], v[60:63], v[148:151]
    s_waitcnt lgkmcnt(10)
    v_mfma_f32_16x16x32_bf16 v[116:119], v[88:91], v[56:59], v[116:119]
    ds_read_b64_tr_b16 v[80:81], v35 offset:12416
    ds_read_b64_tr_b16 v[82:83], v35 offset:15488
    v_mfma_f32_16x16x32_bf16 v[152:155], v[88:91], v[60:63], v[152:155]
    s_waitcnt lgkmcnt(10)
    v_mfma_f32_16x16x32_bf16 v[120:123], v[92:95], v[56:59], v[120:123]
    ds_read_b64_tr_b16 v[84:85], v32 offset:12544
    ds_read_b64_tr_b16 v[86:87], v32 offset:15616
    v_mfma_f32_16x16x32_bf16 v[156:159], v[92:95], v[60:63], v[156:159]
    ds_read_b128 v[48:51], v5 offset:0
    s_waitcnt lgkmcnt(11)
    v_mfma_f32_16x16x32_bf16 v[124:127], v[64:67], v[56:59], v[124:127]
    ds_read_b64_tr_b16 v[88:89], v36 offset:0
    ds_read_b64_tr_b16 v[90:91], v36 offset:3072
    v_mfma_f32_16x16x32_bf16 v[160:163], v[64:67], v[60:63], v[160:163]
    ds_read_b128 v[52:55], v5 offset:2048
    s_waitcnt lgkmcnt(12)
    v_mfma_f32_16x16x32_bf16 v[128:131], v[68:71], v[56:59], v[128:131]
    ds_read_b64_tr_b16 v[92:93], v37 offset:0
    ds_read_b64_tr_b16 v[94:95], v37 offset:3072
    v_mfma_f32_16x16x32_bf16 v[164:167], v[68:71], v[60:63], v[164:167]
    s_waitcnt lgkmcnt(12)
    v_mfma_f32_16x16x32_bf16 v[132:135], v[72:75], v[56:59], v[132:135]
    ds_read_b64_tr_b16 v[64:65], v38 offset:0
    ds_read_b64_tr_b16 v[66:67], v38 offset:3072
    v_mfma_f32_16x16x32_bf16 v[168:171], v[72:75], v[60:63], v[168:171]
    s_waitcnt lgkmcnt(12)
    v_mfma_f32_16x16x32_bf16 v[136:139], v[76:79], v[56:59], v[136:139]
    ds_read_b64_tr_b16 v[68:69], v39 offset:0
    ds_read_b64_tr_b16 v[70:71], v39 offset:3072
    v_mfma_f32_16x16x32_bf16 v[172:175], v[76:79], v[60:63], v[172:175]
    s_waitcnt lgkmcnt(12)
    v_mfma_f32_16x16x32_bf16 v[140:143], v[80:83], v[56:59], v[140:143]
    ds_read_b64_tr_b16 v[72:73], v36 offset:128
    ds_read_b64_tr_b16 v[74:75], v36 offset:3200
    v_mfma_f32_16x16x32_bf16 v[176:179], v[80:83], v[60:63], v[176:179]
    s_waitcnt lgkmcnt(12)
    v_mfma_f32_16x16x32_bf16 v[144:147], v[84:87], v[56:59], v[144:147]
    ds_read_b64_tr_b16 v[76:77], v37 offset:128
    ds_read_b64_tr_b16 v[78:79], v37 offset:3200
    v_mfma_f32_16x16x32_bf16 v[180:183], v[84:87], v[60:63], v[180:183]
    s_waitcnt lgkmcnt(10)
    v_mfma_f32_16x16x32_bf16 v[112:115], v[88:91], v[48:51], v[112:115]
    ds_read_b64_tr_b16 v[80:81], v38 offset:128
    ds_read_b64_tr_b16 v[82:83], v38 offset:3200
    v_mfma_f32_16x16x32_bf16 v[148:151], v[88:91], v[52:55], v[148:151]
    s_waitcnt lgkmcnt(10)
    v_mfma_f32_16x16x32_bf16 v[116:119], v[92:95], v[48:51], v[116:119]
    ds_read_b64_tr_b16 v[84:85], v39 offset:128
    ds_read_b64_tr_b16 v[86:87], v39 offset:3200
    v_mfma_f32_16x16x32_bf16 v[152:155], v[92:95], v[52:55], v[152:155]
    s_waitcnt lgkmcnt(10)
    v_mfma_f32_16x16x32_bf16 v[120:123], v[64:67], v[48:51], v[120:123]
    ds_read_b64_tr_b16 v[88:89], v36 offset:256
    ds_read_b64_tr_b16 v[90:91], v36 offset:3328
    v_mfma_f32_16x16x32_bf16 v[156:159], v[64:67], v[52:55], v[156:159]
    ds_read_b128 v[56:59], v5 offset:1024
    s_waitcnt lgkmcnt(11)
    v_mfma_f32_16x16x32_bf16 v[124:127], v[68:71], v[48:51], v[124:127]
    ds_read_b64_tr_b16 v[92:93], v36 offset:12288
    ds_read_b64_tr_b16 v[94:95], v36 offset:15360
    v_mfma_f32_16x16x32_bf16 v[160:163], v[68:71], v[52:55], v[160:163]
    ds_read_b128 v[60:63], v5 offset:3072
    s_waitcnt lgkmcnt(12)
    v_mfma_f32_16x16x32_bf16 v[128:131], v[72:75], v[48:51], v[128:131]
    ds_read_b64_tr_b16 v[64:65], v37 offset:12288
    ds_read_b64_tr_b16 v[66:67], v37 offset:15360
    v_mfma_f32_16x16x32_bf16 v[164:167], v[72:75], v[52:55], v[164:167]
    s_waitcnt lgkmcnt(12)
    v_mfma_f32_16x16x32_bf16 v[132:135], v[76:79], v[48:51], v[132:135]
    ds_read_b64_tr_b16 v[68:69], v38 offset:12288
    ds_read_b64_tr_b16 v[70:71], v38 offset:15360
    v_mfma_f32_16x16x32_bf16 v[168:171], v[76:79], v[52:55], v[168:171]
    s_waitcnt lgkmcnt(12)
    v_mfma_f32_16x16x32_bf16 v[136:139], v[80:83], v[48:51], v[136:139]
    ds_read_b64_tr_b16 v[72:73], v39 offset:12288
    ds_read_b64_tr_b16 v[74:75], v39 offset:15360
    v_mfma_f32_16x16x32_bf16 v[172:175], v[80:83], v[52:55], v[172:175]
    s_waitcnt lgkmcnt(12)
    v_mfma_f32_16x16x32_bf16 v[140:143], v[84:87], v[48:51], v[140:143]
    ds_read_b64_tr_b16 v[76:77], v36 offset:12416
    ds_read_b64_tr_b16 v[78:79], v36 offset:15488
    v_mfma_f32_16x16x32_bf16 v[176:179], v[84:87], v[52:55], v[176:179]
    s_waitcnt lgkmcnt(12)
    v_mfma_f32_16x16x32_bf16 v[144:147], v[88:91], v[48:51], v[144:147]
    ds_read_b64_tr_b16 v[80:81], v37 offset:12416
    ds_read_b64_tr_b16 v[82:83], v37 offset:15488
    v_mfma_f32_16x16x32_bf16 v[180:183], v[88:91], v[52:55], v[180:183]
    s_barrier
    s_waitcnt lgkmcnt(10)
    v_mfma_f32_16x16x32_bf16 v[112:115], v[92:95], v[56:59], v[112:115]
    ds_read_b64_tr_b16 v[84:85], v38 offset:12416
    ds_read_b64_tr_b16 v[86:87], v38 offset:15488
    v_mfma_f32_16x16x32_bf16 v[148:151], v[92:95], v[60:63], v[148:151]
    s_waitcnt lgkmcnt(10)
    v_mfma_f32_16x16x32_bf16 v[116:119], v[64:67], v[56:59], v[116:119]
    ds_read_b64_tr_b16 v[88:89], v39 offset:12416
    ds_read_b64_tr_b16 v[90:91], v39 offset:15488
    v_mfma_f32_16x16x32_bf16 v[152:155], v[64:67], v[60:63], v[152:155]
    s_waitcnt lgkmcnt(10)
    v_mfma_f32_16x16x32_bf16 v[120:123], v[68:71], v[56:59], v[120:123]
    ds_read_b64_tr_b16 v[92:93], v36 offset:12544
    ds_read_b64_tr_b16 v[94:95], v36 offset:15616
    v_mfma_f32_16x16x32_bf16 v[156:159], v[68:71], v[60:63], v[156:159]
    ds_read_b128 v[48:51], v2 offset:0
    s_waitcnt lgkmcnt(11)
    v_mfma_f32_16x16x32_bf16 v[124:127], v[72:75], v[56:59], v[124:127]
    ds_read_b64_tr_b16 v[64:65], v24 offset:0
    ds_read_b64_tr_b16 v[66:67], v24 offset:3072
    v_mfma_f32_16x16x32_bf16 v[160:163], v[72:75], v[60:63], v[160:163]
    ds_read_b128 v[52:55], v2 offset:2048
    s_waitcnt lgkmcnt(12)
    v_mfma_f32_16x16x32_bf16 v[128:131], v[76:79], v[56:59], v[128:131]
    ds_read_b64_tr_b16 v[68:69], v25 offset:0
    ds_read_b64_tr_b16 v[70:71], v25 offset:3072
    v_mfma_f32_16x16x32_bf16 v[164:167], v[76:79], v[60:63], v[164:167]
    s_waitcnt lgkmcnt(12)
    v_mfma_f32_16x16x32_bf16 v[132:135], v[80:83], v[56:59], v[132:135]
    ds_read_b64_tr_b16 v[72:73], v26 offset:0
    ds_read_b64_tr_b16 v[74:75], v26 offset:3072
    v_mfma_f32_16x16x32_bf16 v[168:171], v[80:83], v[60:63], v[168:171]
    s_waitcnt lgkmcnt(12)
    v_mfma_f32_16x16x32_bf16 v[136:139], v[84:87], v[56:59], v[136:139]
    ds_read_b64_tr_b16 v[76:77], v27 offset:0
    ds_read_b64_tr_b16 v[78:79], v27 offset:3072
    v_mfma_f32_16x16x32_bf16 v[172:175], v[84:87], v[60:63], v[172:175]
    s_waitcnt lgkmcnt(12)
    v_mfma_f32_16x16x32_bf16 v[140:143], v[88:91], v[56:59], v[140:143]
    ds_read_b64_tr_b16 v[80:81], v24 offset:128
    ds_read_b64_tr_b16 v[82:83], v24 offset:3200
    v_mfma_f32_16x16x32_bf16 v[176:179], v[88:91], v[60:63], v[176:179]
    s_waitcnt lgkmcnt(12)
    v_mfma_f32_16x16x32_bf16 v[144:147], v[92:95], v[56:59], v[144:147]
    ds_read_b64_tr_b16 v[84:85], v25 offset:128
    ds_read_b64_tr_b16 v[86:87], v25 offset:3200
    v_mfma_f32_16x16x32_bf16 v[180:183], v[92:95], v[60:63], v[180:183]
    s_waitcnt lgkmcnt(10)
    v_mfma_f32_16x16x32_bf16 v[112:115], v[64:67], v[48:51], v[112:115]
    ds_read_b64_tr_b16 v[88:89], v26 offset:128
    ds_read_b64_tr_b16 v[90:91], v26 offset:3200
    v_mfma_f32_16x16x32_bf16 v[148:151], v[64:67], v[52:55], v[148:151]
    s_waitcnt lgkmcnt(10)
    v_mfma_f32_16x16x32_bf16 v[116:119], v[68:71], v[48:51], v[116:119]
    ds_read_b64_tr_b16 v[92:93], v27 offset:128
    ds_read_b64_tr_b16 v[94:95], v27 offset:3200
    v_mfma_f32_16x16x32_bf16 v[152:155], v[68:71], v[52:55], v[152:155]
    s_waitcnt lgkmcnt(10)
    v_mfma_f32_16x16x32_bf16 v[120:123], v[72:75], v[48:51], v[120:123]
    ds_read_b64_tr_b16 v[64:65], v24 offset:256
    ds_read_b64_tr_b16 v[66:67], v24 offset:3328
    v_mfma_f32_16x16x32_bf16 v[156:159], v[72:75], v[52:55], v[156:159]
    ds_read_b128 v[56:59], v2 offset:1024
    s_waitcnt lgkmcnt(11)
    v_mfma_f32_16x16x32_bf16 v[124:127], v[76:79], v[48:51], v[124:127]
    ds_read_b64_tr_b16 v[68:69], v24 offset:12288
    ds_read_b64_tr_b16 v[70:71], v24 offset:15360
    v_mfma_f32_16x16x32_bf16 v[160:163], v[76:79], v[52:55], v[160:163]
    ds_read_b128 v[60:63], v2 offset:3072
    s_waitcnt lgkmcnt(12)
    v_mfma_f32_16x16x32_bf16 v[128:131], v[80:83], v[48:51], v[128:131]
    ds_read_b64_tr_b16 v[72:73], v25 offset:12288
    ds_read_b64_tr_b16 v[74:75], v25 offset:15360
    v_mfma_f32_16x16x32_bf16 v[164:167], v[80:83], v[52:55], v[164:167]
    s_waitcnt lgkmcnt(12)
    v_mfma_f32_16x16x32_bf16 v[132:135], v[84:87], v[48:51], v[132:135]
    ds_read_b64_tr_b16 v[76:77], v26 offset:12288
    ds_read_b64_tr_b16 v[78:79], v26 offset:15360
    v_mfma_f32_16x16x32_bf16 v[168:171], v[84:87], v[52:55], v[168:171]
    s_waitcnt lgkmcnt(12)
    v_mfma_f32_16x16x32_bf16 v[136:139], v[88:91], v[48:51], v[136:139]
    ds_read_b64_tr_b16 v[80:81], v27 offset:12288
    ds_read_b64_tr_b16 v[82:83], v27 offset:15360
    v_mfma_f32_16x16x32_bf16 v[172:175], v[88:91], v[52:55], v[172:175]
    s_waitcnt lgkmcnt(12)
    v_mfma_f32_16x16x32_bf16 v[140:143], v[92:95], v[48:51], v[140:143]
    ds_read_b64_tr_b16 v[84:85], v24 offset:12416
    ds_read_b64_tr_b16 v[86:87], v24 offset:15488
    v_mfma_f32_16x16x32_bf16 v[176:179], v[92:95], v[52:55], v[176:179]
    s_waitcnt lgkmcnt(12)
    v_mfma_f32_16x16x32_bf16 v[144:147], v[64:67], v[48:51], v[144:147]
    ds_read_b64_tr_b16 v[88:89], v25 offset:12416
    ds_read_b64_tr_b16 v[90:91], v25 offset:15488
    v_mfma_f32_16x16x32_bf16 v[180:183], v[64:67], v[52:55], v[180:183]
    s_barrier
    s_waitcnt lgkmcnt(10)
    v_mfma_f32_16x16x32_bf16 v[112:115], v[68:71], v[56:59], v[112:115]
    ds_read_b64_tr_b16 v[92:93], v26 offset:12416
    ds_read_b64_tr_b16 v[94:95], v26 offset:15488
    v_mfma_f32_16x16x32_bf16 v[148:151], v[68:71], v[60:63], v[148:151]
    s_waitcnt lgkmcnt(10)
    v_mfma_f32_16x16x32_bf16 v[116:119], v[72:75], v[56:59], v[116:119]
    ds_read_b64_tr_b16 v[64:65], v27 offset:12416
    ds_read_b64_tr_b16 v[66:67], v27 offset:15488
    v_mfma_f32_16x16x32_bf16 v[152:155], v[72:75], v[60:63], v[152:155]
    s_waitcnt lgkmcnt(10)
    v_mfma_f32_16x16x32_bf16 v[120:123], v[76:79], v[56:59], v[120:123]
    ds_read_b64_tr_b16 v[68:69], v24 offset:12544
    ds_read_b64_tr_b16 v[70:71], v24 offset:15616
    v_mfma_f32_16x16x32_bf16 v[156:159], v[76:79], v[60:63], v[156:159]
    ds_read_b128 v[48:51], v3 offset:0
    s_waitcnt lgkmcnt(11)
    v_mfma_f32_16x16x32_bf16 v[124:127], v[80:83], v[56:59], v[124:127]
    ds_read_b64_tr_b16 v[72:73], v28 offset:0
    ds_read_b64_tr_b16 v[74:75], v28 offset:3072
    v_mfma_f32_16x16x32_bf16 v[160:163], v[80:83], v[60:63], v[160:163]
    ds_read_b128 v[52:55], v3 offset:2048
    s_waitcnt lgkmcnt(12)
    v_mfma_f32_16x16x32_bf16 v[128:131], v[84:87], v[56:59], v[128:131]
    ds_read_b64_tr_b16 v[76:77], v29 offset:0
    ds_read_b64_tr_b16 v[78:79], v29 offset:3072
    v_mfma_f32_16x16x32_bf16 v[164:167], v[84:87], v[60:63], v[164:167]
    s_waitcnt lgkmcnt(12)
    v_mfma_f32_16x16x32_bf16 v[132:135], v[88:91], v[56:59], v[132:135]
    ds_read_b64_tr_b16 v[80:81], v30 offset:0
    ds_read_b64_tr_b16 v[82:83], v30 offset:3072
    v_mfma_f32_16x16x32_bf16 v[168:171], v[88:91], v[60:63], v[168:171]
    s_waitcnt lgkmcnt(12)
    v_mfma_f32_16x16x32_bf16 v[136:139], v[92:95], v[56:59], v[136:139]
    ds_read_b64_tr_b16 v[84:85], v31 offset:0
    ds_read_b64_tr_b16 v[86:87], v31 offset:3072
    v_mfma_f32_16x16x32_bf16 v[172:175], v[92:95], v[60:63], v[172:175]
    s_waitcnt lgkmcnt(12)
    v_mfma_f32_16x16x32_bf16 v[140:143], v[64:67], v[56:59], v[140:143]
    ds_read_b64_tr_b16 v[88:89], v28 offset:128
    ds_read_b64_tr_b16 v[90:91], v28 offset:3200
    v_mfma_f32_16x16x32_bf16 v[176:179], v[64:67], v[60:63], v[176:179]
    s_waitcnt lgkmcnt(12)
    v_mfma_f32_16x16x32_bf16 v[144:147], v[68:71], v[56:59], v[144:147]
    ds_read_b64_tr_b16 v[92:93], v29 offset:128
    ds_read_b64_tr_b16 v[94:95], v29 offset:3200
    v_mfma_f32_16x16x32_bf16 v[180:183], v[68:71], v[60:63], v[180:183]
    s_waitcnt lgkmcnt(10)
    v_mfma_f32_16x16x32_bf16 v[112:115], v[72:75], v[48:51], v[112:115]
    ds_read_b64_tr_b16 v[64:65], v30 offset:128
    ds_read_b64_tr_b16 v[66:67], v30 offset:3200
    v_mfma_f32_16x16x32_bf16 v[148:151], v[72:75], v[52:55], v[148:151]
    s_waitcnt lgkmcnt(10)
    v_mfma_f32_16x16x32_bf16 v[116:119], v[76:79], v[48:51], v[116:119]
    ds_read_b64_tr_b16 v[68:69], v31 offset:128
    ds_read_b64_tr_b16 v[70:71], v31 offset:3200
    v_mfma_f32_16x16x32_bf16 v[152:155], v[76:79], v[52:55], v[152:155]
    s_waitcnt lgkmcnt(10)
    v_mfma_f32_16x16x32_bf16 v[120:123], v[80:83], v[48:51], v[120:123]
    ds_read_b64_tr_b16 v[72:73], v28 offset:256
    ds_read_b64_tr_b16 v[74:75], v28 offset:3328
    v_mfma_f32_16x16x32_bf16 v[156:159], v[80:83], v[52:55], v[156:159]
    ds_read_b128 v[56:59], v3 offset:1024
    s_waitcnt lgkmcnt(11)
    v_mfma_f32_16x16x32_bf16 v[124:127], v[84:87], v[48:51], v[124:127]
    ds_read_b64_tr_b16 v[76:77], v28 offset:12288
    ds_read_b64_tr_b16 v[78:79], v28 offset:15360
    v_mfma_f32_16x16x32_bf16 v[160:163], v[84:87], v[52:55], v[160:163]
    ds_read_b128 v[60:63], v3 offset:3072
    s_waitcnt lgkmcnt(12)
    v_mfma_f32_16x16x32_bf16 v[128:131], v[88:91], v[48:51], v[128:131]
    ds_read_b64_tr_b16 v[80:81], v29 offset:12288
    ds_read_b64_tr_b16 v[82:83], v29 offset:15360
    v_mfma_f32_16x16x32_bf16 v[164:167], v[88:91], v[52:55], v[164:167]
    s_waitcnt lgkmcnt(12)
    v_mfma_f32_16x16x32_bf16 v[132:135], v[92:95], v[48:51], v[132:135]
    ds_read_b64_tr_b16 v[84:85], v30 offset:12288
    ds_read_b64_tr_b16 v[86:87], v30 offset:15360
    v_mfma_f32_16x16x32_bf16 v[168:171], v[92:95], v[52:55], v[168:171]
    s_waitcnt lgkmcnt(12)
    v_mfma_f32_16x16x32_bf16 v[136:139], v[64:67], v[48:51], v[136:139]
    ds_read_b64_tr_b16 v[88:89], v31 offset:12288
    ds_read_b64_tr_b16 v[90:91], v31 offset:15360
    v_mfma_f32_16x16x32_bf16 v[172:175], v[64:67], v[52:55], v[172:175]
    s_waitcnt lgkmcnt(12)
    v_mfma_f32_16x16x32_bf16 v[140:143], v[68:71], v[48:51], v[140:143]
    ds_read_b64_tr_b16 v[92:93], v28 offset:12416
    ds_read_b64_tr_b16 v[94:95], v28 offset:15488
    v_mfma_f32_16x16x32_bf16 v[176:179], v[68:71], v[52:55], v[176:179]
    s_waitcnt lgkmcnt(12)
    v_mfma_f32_16x16x32_bf16 v[144:147], v[72:75], v[48:51], v[144:147]
    ds_read_b64_tr_b16 v[64:65], v29 offset:12416
    ds_read_b64_tr_b16 v[66:67], v29 offset:15488
    v_mfma_f32_16x16x32_bf16 v[180:183], v[72:75], v[52:55], v[180:183]
    s_barrier
    s_waitcnt lgkmcnt(10)
    v_mfma_f32_16x16x32_bf16 v[112:115], v[76:79], v[56:59], v[112:115]
    ds_read_b64_tr_b16 v[68:69], v30 offset:12416
    ds_read_b64_tr_b16 v[70:71], v30 offset:15488
    v_mfma_f32_16x16x32_bf16 v[148:151], v[76:79], v[60:63], v[148:151]
    s_waitcnt lgkmcnt(10)
    v_mfma_f32_16x16x32_bf16 v[116:119], v[80:83], v[56:59], v[116:119]
    ds_read_b64_tr_b16 v[72:73], v31 offset:12416
    ds_read_b64_tr_b16 v[74:75], v31 offset:15488
    v_mfma_f32_16x16x32_bf16 v[152:155], v[80:83], v[60:63], v[152:155]
    s_waitcnt lgkmcnt(10)
    v_mfma_f32_16x16x32_bf16 v[120:123], v[84:87], v[56:59], v[120:123]
    ds_read_b64_tr_b16 v[76:77], v28 offset:12544
    ds_read_b64_tr_b16 v[78:79], v28 offset:15616
    v_mfma_f32_16x16x32_bf16 v[156:159], v[84:87], v[60:63], v[156:159]
    ds_read_b128 v[48:51], v4 offset:0
    s_waitcnt lgkmcnt(11)
    v_mfma_f32_16x16x32_bf16 v[124:127], v[88:91], v[56:59], v[124:127]
    ds_read_b64_tr_b16 v[80:81], v32 offset:0
    ds_read_b64_tr_b16 v[82:83], v32 offset:3072
    v_mfma_f32_16x16x32_bf16 v[160:163], v[88:91], v[60:63], v[160:163]
    ds_read_b128 v[52:55], v4 offset:2048
    s_waitcnt lgkmcnt(12)
    v_mfma_f32_16x16x32_bf16 v[128:131], v[92:95], v[56:59], v[128:131]
    ds_read_b64_tr_b16 v[84:85], v33 offset:0
    ds_read_b64_tr_b16 v[86:87], v33 offset:3072
    v_mfma_f32_16x16x32_bf16 v[164:167], v[92:95], v[60:63], v[164:167]
    s_waitcnt lgkmcnt(12)
    v_mfma_f32_16x16x32_bf16 v[132:135], v[64:67], v[56:59], v[132:135]
    ds_read_b64_tr_b16 v[88:89], v34 offset:0
    ds_read_b64_tr_b16 v[90:91], v34 offset:3072
    v_mfma_f32_16x16x32_bf16 v[168:171], v[64:67], v[60:63], v[168:171]
    s_waitcnt lgkmcnt(12)
    v_mfma_f32_16x16x32_bf16 v[136:139], v[68:71], v[56:59], v[136:139]
    ds_read_b64_tr_b16 v[92:93], v35 offset:0
    ds_read_b64_tr_b16 v[94:95], v35 offset:3072
    v_mfma_f32_16x16x32_bf16 v[172:175], v[68:71], v[60:63], v[172:175]
    s_waitcnt lgkmcnt(12)
    v_mfma_f32_16x16x32_bf16 v[140:143], v[72:75], v[56:59], v[140:143]
    ds_read_b64_tr_b16 v[64:65], v32 offset:128
    ds_read_b64_tr_b16 v[66:67], v32 offset:3200
    v_mfma_f32_16x16x32_bf16 v[176:179], v[72:75], v[60:63], v[176:179]
    s_waitcnt lgkmcnt(12)
    v_mfma_f32_16x16x32_bf16 v[144:147], v[76:79], v[56:59], v[144:147]
    ds_read_b64_tr_b16 v[68:69], v33 offset:128
    ds_read_b64_tr_b16 v[70:71], v33 offset:3200
    v_mfma_f32_16x16x32_bf16 v[180:183], v[76:79], v[60:63], v[180:183]
    s_waitcnt lgkmcnt(10)
    v_mfma_f32_16x16x32_bf16 v[112:115], v[80:83], v[48:51], v[112:115]
    ds_read_b64_tr_b16 v[72:73], v34 offset:128
    ds_read_b64_tr_b16 v[74:75], v34 offset:3200
    v_mfma_f32_16x16x32_bf16 v[148:151], v[80:83], v[52:55], v[148:151]
    s_waitcnt lgkmcnt(10)
    v_mfma_f32_16x16x32_bf16 v[116:119], v[84:87], v[48:51], v[116:119]
    ds_read_b64_tr_b16 v[76:77], v35 offset:128
    ds_read_b64_tr_b16 v[78:79], v35 offset:3200
    v_mfma_f32_16x16x32_bf16 v[152:155], v[84:87], v[52:55], v[152:155]
    s_waitcnt lgkmcnt(10)
    v_mfma_f32_16x16x32_bf16 v[120:123], v[88:91], v[48:51], v[120:123]
    ds_read_b64_tr_b16 v[80:81], v32 offset:256
    ds_read_b64_tr_b16 v[82:83], v32 offset:3328
    v_mfma_f32_16x16x32_bf16 v[156:159], v[88:91], v[52:55], v[156:159]
    ds_read_b128 v[56:59], v4 offset:1024
    s_waitcnt lgkmcnt(11)
    v_mfma_f32_16x16x32_bf16 v[124:127], v[92:95], v[48:51], v[124:127]
    ds_read_b64_tr_b16 v[84:85], v32 offset:12288
    ds_read_b64_tr_b16 v[86:87], v32 offset:15360
    v_mfma_f32_16x16x32_bf16 v[160:163], v[92:95], v[52:55], v[160:163]
    ds_read_b128 v[60:63], v4 offset:3072
    s_waitcnt lgkmcnt(12)
    v_mfma_f32_16x16x32_bf16 v[128:131], v[64:67], v[48:51], v[128:131]
    ds_read_b64_tr_b16 v[88:89], v33 offset:12288
    ds_read_b64_tr_b16 v[90:91], v33 offset:15360
    v_mfma_f32_16x16x32_bf16 v[164:167], v[64:67], v[52:55], v[164:167]
    s_waitcnt lgkmcnt(12)
    v_mfma_f32_16x16x32_bf16 v[132:135], v[68:71], v[48:51], v[132:135]
    ds_read_b64_tr_b16 v[92:93], v34 offset:12288
    ds_read_b64_tr_b16 v[94:95], v34 offset:15360
    v_mfma_f32_16x16x32_bf16 v[168:171], v[68:71], v[52:55], v[168:171]
    s_waitcnt lgkmcnt(12)
    v_mfma_f32_16x16x32_bf16 v[136:139], v[72:75], v[48:51], v[136:139]
    ds_read_b64_tr_b16 v[64:65], v35 offset:12288
    ds_read_b64_tr_b16 v[66:67], v35 offset:15360
    v_mfma_f32_16x16x32_bf16 v[172:175], v[72:75], v[52:55], v[172:175]
    s_waitcnt lgkmcnt(12)
    v_mfma_f32_16x16x32_bf16 v[140:143], v[76:79], v[48:51], v[140:143]
    ds_read_b64_tr_b16 v[68:69], v32 offset:12416
    ds_read_b64_tr_b16 v[70:71], v32 offset:15488
    v_mfma_f32_16x16x32_bf16 v[176:179], v[76:79], v[52:55], v[176:179]
    s_waitcnt lgkmcnt(12)
    v_mfma_f32_16x16x32_bf16 v[144:147], v[80:83], v[48:51], v[144:147]
    ds_read_b64_tr_b16 v[72:73], v33 offset:12416
    ds_read_b64_tr_b16 v[74:75], v33 offset:15488
    v_mfma_f32_16x16x32_bf16 v[180:183], v[80:83], v[52:55], v[180:183]
    s_barrier
    s_waitcnt lgkmcnt(10)
    v_mfma_f32_16x16x32_bf16 v[112:115], v[84:87], v[56:59], v[112:115]
    ds_read_b64_tr_b16 v[76:77], v34 offset:12416
    ds_read_b64_tr_b16 v[78:79], v34 offset:15488
    v_mfma_f32_16x16x32_bf16 v[148:151], v[84:87], v[60:63], v[148:151]
    s_waitcnt lgkmcnt(10)
    v_mfma_f32_16x16x32_bf16 v[116:119], v[88:91], v[56:59], v[116:119]
    ds_read_b64_tr_b16 v[80:81], v35 offset:12416
    ds_read_b64_tr_b16 v[82:83], v35 offset:15488
    v_mfma_f32_16x16x32_bf16 v[152:155], v[88:91], v[60:63], v[152:155]
    s_waitcnt lgkmcnt(10)
    v_mfma_f32_16x16x32_bf16 v[120:123], v[92:95], v[56:59], v[120:123]
    ds_read_b64_tr_b16 v[84:85], v32 offset:12544
    ds_read_b64_tr_b16 v[86:87], v32 offset:15616
    v_mfma_f32_16x16x32_bf16 v[156:159], v[92:95], v[60:63], v[156:159]
    ds_read_b128 v[48:51], v5 offset:0
    s_waitcnt lgkmcnt(11)
    v_mfma_f32_16x16x32_bf16 v[124:127], v[64:67], v[56:59], v[124:127]
    ds_read_b64_tr_b16 v[88:89], v36 offset:0
    ds_read_b64_tr_b16 v[90:91], v36 offset:3072
    v_mfma_f32_16x16x32_bf16 v[160:163], v[64:67], v[60:63], v[160:163]
    ds_read_b128 v[52:55], v5 offset:2048
    s_waitcnt lgkmcnt(12)
    v_mfma_f32_16x16x32_bf16 v[128:131], v[68:71], v[56:59], v[128:131]
    ds_read_b64_tr_b16 v[92:93], v37 offset:0
    ds_read_b64_tr_b16 v[94:95], v37 offset:3072
    v_mfma_f32_16x16x32_bf16 v[164:167], v[68:71], v[60:63], v[164:167]
    s_waitcnt lgkmcnt(12)
    v_mfma_f32_16x16x32_bf16 v[132:135], v[72:75], v[56:59], v[132:135]
    ds_read_b64_tr_b16 v[64:65], v38 offset:0
    ds_read_b64_tr_b16 v[66:67], v38 offset:3072
    v_mfma_f32_16x16x32_bf16 v[168:171], v[72:75], v[60:63], v[168:171]
    s_waitcnt lgkmcnt(12)
    v_mfma_f32_16x16x32_bf16 v[136:139], v[76:79], v[56:59], v[136:139]
    ds_read_b64_tr_b16 v[68:69], v39 offset:0
    ds_read_b64_tr_b16 v[70:71], v39 offset:3072
    v_mfma_f32_16x16x32_bf16 v[172:175], v[76:79], v[60:63], v[172:175]
    s_waitcnt lgkmcnt(12)
    v_mfma_f32_16x16x32_bf16 v[140:143], v[80:83], v[56:59], v[140:143]
    ds_read_b64_tr_b16 v[72:73], v36 offset:128
    ds_read_b64_tr_b16 v[74:75], v36 offset:3200
    v_mfma_f32_16x16x32_bf16 v[176:179], v[80:83], v[60:63], v[176:179]
    s_waitcnt lgkmcnt(12)
    v_mfma_f32_16x16x32_bf16 v[144:147], v[84:87], v[56:59], v[144:147]
    ds_read_b64_tr_b16 v[76:77], v37 offset:128
    ds_read_b64_tr_b16 v[78:79], v37 offset:3200
    v_mfma_f32_16x16x32_bf16 v[180:183], v[84:87], v[60:63], v[180:183]
    s_waitcnt lgkmcnt(10)
    v_mfma_f32_16x16x32_bf16 v[112:115], v[88:91], v[48:51], v[112:115]
    ds_read_b64_tr_b16 v[80:81], v38 offset:128
    ds_read_b64_tr_b16 v[82:83], v38 offset:3200
    v_mfma_f32_16x16x32_bf16 v[148:151], v[88:91], v[52:55], v[148:151]
    s_waitcnt lgkmcnt(10)
    v_mfma_f32_16x16x32_bf16 v[116:119], v[92:95], v[48:51], v[116:119]
    ds_read_b64_tr_b16 v[84:85], v39 offset:128
    ds_read_b64_tr_b16 v[86:87], v39 offset:3200
    v_mfma_f32_16x16x32_bf16 v[152:155], v[92:95], v[52:55], v[152:155]
    s_waitcnt lgkmcnt(10)
    v_mfma_f32_16x16x32_bf16 v[120:123], v[64:67], v[48:51], v[120:123]
    ds_read_b64_tr_b16 v[88:89], v36 offset:256
    ds_read_b64_tr_b16 v[90:91], v36 offset:3328
    v_mfma_f32_16x16x32_bf16 v[156:159], v[64:67], v[52:55], v[156:159]
    ds_read_b128 v[56:59], v5 offset:1024
    s_waitcnt lgkmcnt(11)
    v_mfma_f32_16x16x32_bf16 v[124:127], v[68:71], v[48:51], v[124:127]
    ds_read_b64_tr_b16 v[92:93], v36 offset:12288
    ds_read_b64_tr_b16 v[94:95], v36 offset:15360
    v_mfma_f32_16x16x32_bf16 v[160:163], v[68:71], v[52:55], v[160:163]
    ds_read_b128 v[60:63], v5 offset:3072
    s_waitcnt lgkmcnt(12)
    v_mfma_f32_16x16x32_bf16 v[128:131], v[72:75], v[48:51], v[128:131]
    ds_read_b64_tr_b16 v[64:65], v37 offset:12288
    ds_read_b64_tr_b16 v[66:67], v37 offset:15360
    v_mfma_f32_16x16x32_bf16 v[164:167], v[72:75], v[52:55], v[164:167]
    s_waitcnt lgkmcnt(12)
    v_mfma_f32_16x16x32_bf16 v[132:135], v[76:79], v[48:51], v[132:135]
    ds_read_b64_tr_b16 v[68:69], v38 offset:12288
    ds_read_b64_tr_b16 v[70:71], v38 offset:15360
    v_mfma_f32_16x16x32_bf16 v[168:171], v[76:79], v[52:55], v[168:171]
    s_waitcnt lgkmcnt(12)
    v_mfma_f32_16x16x32_bf16 v[136:139], v[80:83], v[48:51], v[136:139]
    ds_read_b64_tr_b16 v[72:73], v39 offset:12288
    ds_read_b64_tr_b16 v[74:75], v39 offset:15360
    v_mfma_f32_16x16x32_bf16 v[172:175], v[80:83], v[52:55], v[172:175]
    s_waitcnt lgkmcnt(12)
    v_mfma_f32_16x16x32_bf16 v[140:143], v[84:87], v[48:51], v[140:143]
    ds_read_b64_tr_b16 v[76:77], v36 offset:12416
    ds_read_b64_tr_b16 v[78:79], v36 offset:15488
    v_mfma_f32_16x16x32_bf16 v[176:179], v[84:87], v[52:55], v[176:179]
    s_waitcnt lgkmcnt(12)
    v_mfma_f32_16x16x32_bf16 v[144:147], v[88:91], v[48:51], v[144:147]
    ds_read_b64_tr_b16 v[80:81], v37 offset:12416
    ds_read_b64_tr_b16 v[82:83], v37 offset:15488
    v_mfma_f32_16x16x32_bf16 v[180:183], v[88:91], v[52:55], v[180:183]
    s_barrier
    s_waitcnt lgkmcnt(10)
    v_mfma_f32_16x16x32_bf16 v[112:115], v[92:95], v[56:59], v[112:115]
    ds_read_b64_tr_b16 v[84:85], v38 offset:12416
    ds_read_b64_tr_b16 v[86:87], v38 offset:15488
    v_mfma_f32_16x16x32_bf16 v[148:151], v[92:95], v[60:63], v[148:151]
    s_waitcnt lgkmcnt(10)
    v_mfma_f32_16x16x32_bf16 v[116:119], v[64:67], v[56:59], v[116:119]
    ds_read_b64_tr_b16 v[88:89], v39 offset:12416
    ds_read_b64_tr_b16 v[90:91], v39 offset:15488
    v_mfma_f32_16x16x32_bf16 v[152:155], v[64:67], v[60:63], v[152:155]
    s_waitcnt lgkmcnt(10)
    v_mfma_f32_16x16x32_bf16 v[120:123], v[68:71], v[56:59], v[120:123]
    ds_read_b64_tr_b16 v[92:93], v36 offset:12544
    ds_read_b64_tr_b16 v[94:95], v36 offset:15616
    v_mfma_f32_16x16x32_bf16 v[156:159], v[68:71], v[60:63], v[156:159]
    ds_read_b128 v[48:51], v2 offset:0
    s_waitcnt lgkmcnt(11)
    v_mfma_f32_16x16x32_bf16 v[124:127], v[72:75], v[56:59], v[124:127]
    ds_read_b64_tr_b16 v[64:65], v24 offset:0
    ds_read_b64_tr_b16 v[66:67], v24 offset:3072
    v_mfma_f32_16x16x32_bf16 v[160:163], v[72:75], v[60:63], v[160:163]
    ds_read_b128 v[52:55], v2 offset:2048
    s_waitcnt lgkmcnt(12)
    v_mfma_f32_16x16x32_bf16 v[128:131], v[76:79], v[56:59], v[128:131]
    ds_read_b64_tr_b16 v[68:69], v25 offset:0
    ds_read_b64_tr_b16 v[70:71], v25 offset:3072
    v_mfma_f32_16x16x32_bf16 v[164:167], v[76:79], v[60:63], v[164:167]
    s_waitcnt lgkmcnt(12)
    v_mfma_f32_16x16x32_bf16 v[132:135], v[80:83], v[56:59], v[132:135]
    ds_read_b64_tr_b16 v[72:73], v26 offset:0
    ds_read_b64_tr_b16 v[74:75], v26 offset:3072
    v_mfma_f32_16x16x32_bf16 v[168:171], v[80:83], v[60:63], v[168:171]
    s_waitcnt lgkmcnt(12)
    v_mfma_f32_16x16x32_bf16 v[136:139], v[84:87], v[56:59], v[136:139]
    ds_read_b64_tr_b16 v[76:77], v27 offset:0
    ds_read_b64_tr_b16 v[78:79], v27 offset:3072
    v_mfma_f32_16x16x32_bf16 v[172:175], v[84:87], v[60:63], v[172:175]
    s_waitcnt lgkmcnt(12)
    v_mfma_f32_16x16x32_bf16 v[140:143], v[88:91], v[56:59], v[140:143]
    ds_read_b64_tr_b16 v[80:81], v24 offset:128
    ds_read_b64_tr_b16 v[82:83], v24 offset:3200
    v_mfma_f32_16x16x32_bf16 v[176:179], v[88:91], v[60:63], v[176:179]
    s_waitcnt lgkmcnt(12)
    v_mfma_f32_16x16x32_bf16 v[144:147], v[92:95], v[56:59], v[144:147]
    ds_read_b64_tr_b16 v[84:85], v25 offset:128
    ds_read_b64_tr_b16 v[86:87], v25 offset:3200
    v_mfma_f32_16x16x32_bf16 v[180:183], v[92:95], v[60:63], v[180:183]
    s_waitcnt lgkmcnt(10)
    v_mfma_f32_16x16x32_bf16 v[112:115], v[64:67], v[48:51], v[112:115]
    ds_read_b64_tr_b16 v[88:89], v26 offset:128
    ds_read_b64_tr_b16 v[90:91], v26 offset:3200
    v_mfma_f32_16x16x32_bf16 v[148:151], v[64:67], v[52:55], v[148:151]
    s_waitcnt lgkmcnt(10)
    v_mfma_f32_16x16x32_bf16 v[116:119], v[68:71], v[48:51], v[116:119]
    ds_read_b64_tr_b16 v[92:93], v27 offset:128
    ds_read_b64_tr_b16 v[94:95], v27 offset:3200
    v_mfma_f32_16x16x32_bf16 v[152:155], v[68:71], v[52:55], v[152:155]
    s_waitcnt lgkmcnt(10)
    v_mfma_f32_16x16x32_bf16 v[120:123], v[72:75], v[48:51], v[120:123]
    ds_read_b64_tr_b16 v[64:65], v24 offset:256
    ds_read_b64_tr_b16 v[66:67], v24 offset:3328
    v_mfma_f32_16x16x32_bf16 v[156:159], v[72:75], v[52:55], v[156:159]
    ds_read_b128 v[56:59], v2 offset:1024
    s_waitcnt lgkmcnt(11)
    v_mfma_f32_16x16x32_bf16 v[124:127], v[76:79], v[48:51], v[124:127]
    ds_read_b64_tr_b16 v[68:69], v24 offset:12288
    ds_read_b64_tr_b16 v[70:71], v24 offset:15360
    v_mfma_f32_16x16x32_bf16 v[160:163], v[76:79], v[52:55], v[160:163]
    ds_read_b128 v[60:63], v2 offset:3072
    s_waitcnt lgkmcnt(12)
    v_mfma_f32_16x16x32_bf16 v[128:131], v[80:83], v[48:51], v[128:131]
    ds_read_b64_tr_b16 v[72:73], v25 offset:12288
    ds_read_b64_tr_b16 v[74:75], v25 offset:15360
    v_mfma_f32_16x16x32_bf16 v[164:167], v[80:83], v[52:55], v[164:167]
    s_waitcnt lgkmcnt(12)
    v_mfma_f32_16x16x32_bf16 v[132:135], v[84:87], v[48:51], v[132:135]
    ds_read_b64_tr_b16 v[76:77], v26 offset:12288
    ds_read_b64_tr_b16 v[78:79], v26 offset:15360
    v_mfma_f32_16x16x32_bf16 v[168:171], v[84:87], v[52:55], v[168:171]
    s_waitcnt lgkmcnt(12)
    v_mfma_f32_16x16x32_bf16 v[136:139], v[88:91], v[48:51], v[136:139]
    ds_read_b64_tr_b16 v[80:81], v27 offset:12288
    ds_read_b64_tr_b16 v[82:83], v27 offset:15360
    v_mfma_f32_16x16x32_bf16 v[172:175], v[88:91], v[52:55], v[172:175]
    s_waitcnt lgkmcnt(12)
    v_mfma_f32_16x16x32_bf16 v[140:143], v[92:95], v[48:51], v[140:143]
    ds_read_b64_tr_b16 v[84:85], v24 offset:12416
    ds_read_b64_tr_b16 v[86:87], v24 offset:15488
    v_mfma_f32_16x16x32_bf16 v[176:179], v[92:95], v[52:55], v[176:179]
    s_waitcnt lgkmcnt(12)
    v_mfma_f32_16x16x32_bf16 v[144:147], v[64:67], v[48:51], v[144:147]
    ds_read_b64_tr_b16 v[88:89], v25 offset:12416
    ds_read_b64_tr_b16 v[90:91], v25 offset:15488
    v_mfma_f32_16x16x32_bf16 v[180:183], v[64:67], v[52:55], v[180:183]
    s_barrier
    s_waitcnt lgkmcnt(10)
    v_mfma_f32_16x16x32_bf16 v[112:115], v[68:71], v[56:59], v[112:115]
    ds_read_b64_tr_b16 v[92:93], v26 offset:12416
    ds_read_b64_tr_b16 v[94:95], v26 offset:15488
    v_mfma_f32_16x16x32_bf16 v[148:151], v[68:71], v[60:63], v[148:151]
    s_waitcnt lgkmcnt(10)
    v_mfma_f32_16x16x32_bf16 v[116:119], v[72:75], v[56:59], v[116:119]
    ds_read_b64_tr_b16 v[64:65], v27 offset:12416
    ds_read_b64_tr_b16 v[66:67], v27 offset:15488
    v_mfma_f32_16x16x32_bf16 v[152:155], v[72:75], v[60:63], v[152:155]
    s_waitcnt lgkmcnt(10)
    v_mfma_f32_16x16x32_bf16 v[120:123], v[76:79], v[56:59], v[120:123]
    ds_read_b64_tr_b16 v[68:69], v24 offset:12544
    ds_read_b64_tr_b16 v[70:71], v24 offset:15616
    v_mfma_f32_16x16x32_bf16 v[156:159], v[76:79], v[60:63], v[156:159]
    ds_read_b128 v[48:51], v3 offset:0
    s_waitcnt lgkmcnt(11)
    v_mfma_f32_16x16x32_bf16 v[124:127], v[80:83], v[56:59], v[124:127]
    ds_read_b64_tr_b16 v[72:73], v28 offset:0
    ds_read_b64_tr_b16 v[74:75], v28 offset:3072
    v_mfma_f32_16x16x32_bf16 v[160:163], v[80:83], v[60:63], v[160:163]
    ds_read_b128 v[52:55], v3 offset:2048
    s_waitcnt lgkmcnt(12)
    v_mfma_f32_16x16x32_bf16 v[128:131], v[84:87], v[56:59], v[128:131]
    ds_read_b64_tr_b16 v[76:77], v29 offset:0
    ds_read_b64_tr_b16 v[78:79], v29 offset:3072
    v_mfma_f32_16x16x32_bf16 v[164:167], v[84:87], v[60:63], v[164:167]
    s_waitcnt lgkmcnt(12)
    v_mfma_f32_16x16x32_bf16 v[132:135], v[88:91], v[56:59], v[132:135]
    ds_read_b64_tr_b16 v[80:81], v30 offset:0
    ds_read_b64_tr_b16 v[82:83], v30 offset:3072
    v_mfma_f32_16x16x32_bf16 v[168:171], v[88:91], v[60:63], v[168:171]
    s_waitcnt lgkmcnt(12)
    v_mfma_f32_16x16x32_bf16 v[136:139], v[92:95], v[56:59], v[136:139]
    ds_read_b64_tr_b16 v[84:85], v31 offset:0
    ds_read_b64_tr_b16 v[86:87], v31 offset:3072
    v_mfma_f32_16x16x32_bf16 v[172:175], v[92:95], v[60:63], v[172:175]
    s_waitcnt lgkmcnt(12)
    v_mfma_f32_16x16x32_bf16 v[140:143], v[64:67], v[56:59], v[140:143]
    ds_read_b64_tr_b16 v[88:89], v28 offset:128
    ds_read_b64_tr_b16 v[90:91], v28 offset:3200
    v_mfma_f32_16x16x32_bf16 v[176:179], v[64:67], v[60:63], v[176:179]
    s_waitcnt lgkmcnt(12)
    v_mfma_f32_16x16x32_bf16 v[144:147], v[68:71], v[56:59], v[144:147]
    ds_read_b64_tr_b16 v[92:93], v29 offset:128
    ds_read_b64_tr_b16 v[94:95], v29 offset:3200
    v_mfma_f32_16x16x32_bf16 v[180:183], v[68:71], v[60:63], v[180:183]
    s_waitcnt lgkmcnt(10)
    v_mfma_f32_16x16x32_bf16 v[112:115], v[72:75], v[48:51], v[112:115]
    ds_read_b64_tr_b16 v[64:65], v30 offset:128
    ds_read_b64_tr_b16 v[66:67], v30 offset:3200
    v_mfma_f32_16x16x32_bf16 v[148:151], v[72:75], v[52:55], v[148:151]
    s_waitcnt lgkmcnt(10)
    v_mfma_f32_16x16x32_bf16 v[116:119], v[76:79], v[48:51], v[116:119]
    ds_read_b64_tr_b16 v[68:69], v31 offset:128
    ds_read_b64_tr_b16 v[70:71], v31 offset:3200
    v_mfma_f32_16x16x32_bf16 v[152:155], v[76:79], v[52:55], v[152:155]
    s_waitcnt lgkmcnt(10)
    v_mfma_f32_16x16x32_bf16 v[120:123], v[80:83], v[48:51], v[120:123]
    ds_read_b64_tr_b16 v[72:73], v28 offset:256
    ds_read_b64_tr_b16 v[74:75], v28 offset:3328
    v_mfma_f32_16x16x32_bf16 v[156:159], v[80:83], v[52:55], v[156:159]
    ds_read_b128 v[56:59], v3 offset:1024
    s_waitcnt lgkmcnt(11)
    v_mfma_f32_16x16x32_bf16 v[124:127], v[84:87], v[48:51], v[124:127]
    ds_read_b64_tr_b16 v[76:77], v28 offset:12288
    ds_read_b64_tr_b16 v[78:79], v28 offset:15360
    v_mfma_f32_16x16x32_bf16 v[160:163], v[84:87], v[52:55], v[160:163]
    ds_read_b128 v[60:63], v3 offset:3072
    s_waitcnt lgkmcnt(12)
    v_mfma_f32_16x16x32_bf16 v[128:131], v[88:91], v[48:51], v[128:131]
    ds_read_b64_tr_b16 v[80:81], v29 offset:12288
    ds_read_b64_tr_b16 v[82:83], v29 offset:15360
    v_mfma_f32_16x16x32_bf16 v[164:167], v[88:91], v[52:55], v[164:167]
    s_waitcnt lgkmcnt(12)
    v_mfma_f32_16x16x32_bf16 v[132:135], v[92:95], v[48:51], v[132:135]
    ds_read_b64_tr_b16 v[84:85], v30 offset:12288
    ds_read_b64_tr_b16 v[86:87], v30 offset:15360
    v_mfma_f32_16x16x32_bf16 v[168:171], v[92:95], v[52:55], v[168:171]
    s_waitcnt lgkmcnt(12)
    v_mfma_f32_16x16x32_bf16 v[136:139], v[64:67], v[48:51], v[136:139]
    ds_read_b64_tr_b16 v[88:89], v31 offset:12288
    ds_read_b64_tr_b16 v[90:91], v31 offset:15360
    v_mfma_f32_16x16x32_bf16 v[172:175], v[64:67], v[52:55], v[172:175]
    s_waitcnt lgkmcnt(12)
    v_mfma_f32_16x16x32_bf16 v[140:143], v[68:71], v[48:51], v[140:143]
    ds_read_b64_tr_b16 v[92:93], v28 offset:12416
    ds_read_b64_tr_b16 v[94:95], v28 offset:15488
    v_mfma_f32_16x16x32_bf16 v[176:179], v[68:71], v[52:55], v[176:179]
    s_waitcnt lgkmcnt(12)
    v_mfma_f32_16x16x32_bf16 v[144:147], v[72:75], v[48:51], v[144:147]
    ds_read_b64_tr_b16 v[64:65], v29 offset:12416
    ds_read_b64_tr_b16 v[66:67], v29 offset:15488
    v_mfma_f32_16x16x32_bf16 v[180:183], v[72:75], v[52:55], v[180:183]
    s_barrier
    s_waitcnt lgkmcnt(10)
    v_mfma_f32_16x16x32_bf16 v[112:115], v[76:79], v[56:59], v[112:115]
    ds_read_b64_tr_b16 v[68:69], v30 offset:12416
    ds_read_b64_tr_b16 v[70:71], v30 offset:15488
    v_mfma_f32_16x16x32_bf16 v[148:151], v[76:79], v[60:63], v[148:151]
    s_waitcnt lgkmcnt(10)
    v_mfma_f32_16x16x32_bf16 v[116:119], v[80:83], v[56:59], v[116:119]
    ds_read_b64_tr_b16 v[72:73], v31 offset:12416
    ds_read_b64_tr_b16 v[74:75], v31 offset:15488
    v_mfma_f32_16x16x32_bf16 v[152:155], v[80:83], v[60:63], v[152:155]
    s_waitcnt lgkmcnt(10)
    v_mfma_f32_16x16x32_bf16 v[120:123], v[84:87], v[56:59], v[120:123]
    ds_read_b64_tr_b16 v[76:77], v28 offset:12544
    ds_read_b64_tr_b16 v[78:79], v28 offset:15616
    v_mfma_f32_16x16x32_bf16 v[156:159], v[84:87], v[60:63], v[156:159]
    ds_read_b128 v[48:51], v4 offset:0
    s_waitcnt lgkmcnt(11)
    v_mfma_f32_16x16x32_bf16 v[124:127], v[88:91], v[56:59], v[124:127]
    ds_read_b64_tr_b16 v[80:81], v32 offset:0
    ds_read_b64_tr_b16 v[82:83], v32 offset:3072
    v_mfma_f32_16x16x32_bf16 v[160:163], v[88:91], v[60:63], v[160:163]
    ds_read_b128 v[52:55], v4 offset:2048
    s_waitcnt lgkmcnt(12)
    v_mfma_f32_16x16x32_bf16 v[128:131], v[92:95], v[56:59], v[128:131]
    ds_read_b64_tr_b16 v[84:85], v33 offset:0
    ds_read_b64_tr_b16 v[86:87], v33 offset:3072
    v_mfma_f32_16x16x32_bf16 v[164:167], v[92:95], v[60:63], v[164:167]
    s_waitcnt lgkmcnt(12)
    v_mfma_f32_16x16x32_bf16 v[132:135], v[64:67], v[56:59], v[132:135]
    ds_read_b64_tr_b16 v[88:89], v34 offset:0
    ds_read_b64_tr_b16 v[90:91], v34 offset:3072
    v_mfma_f32_16x16x32_bf16 v[168:171], v[64:67], v[60:63], v[168:171]
    s_waitcnt lgkmcnt(12)
    v_mfma_f32_16x16x32_bf16 v[136:139], v[68:71], v[56:59], v[136:139]
    ds_read_b64_tr_b16 v[92:93], v35 offset:0
    ds_read_b64_tr_b16 v[94:95], v35 offset:3072
    v_mfma_f32_16x16x32_bf16 v[172:175], v[68:71], v[60:63], v[172:175]
    s_waitcnt lgkmcnt(12)
    v_mfma_f32_16x16x32_bf16 v[140:143], v[72:75], v[56:59], v[140:143]
    ds_read_b64_tr_b16 v[64:65], v32 offset:128
    ds_read_b64_tr_b16 v[66:67], v32 offset:3200
    v_mfma_f32_16x16x32_bf16 v[176:179], v[72:75], v[60:63], v[176:179]
    s_waitcnt lgkmcnt(12)
    v_mfma_f32_16x16x32_bf16 v[144:147], v[76:79], v[56:59], v[144:147]
    ds_read_b64_tr_b16 v[68:69], v33 offset:128
    ds_read_b64_tr_b16 v[70:71], v33 offset:3200
    v_mfma_f32_16x16x32_bf16 v[180:183], v[76:79], v[60:63], v[180:183]
    s_waitcnt lgkmcnt(10)
    v_mfma_f32_16x16x32_bf16 v[112:115], v[80:83], v[48:51], v[112:115]
    ds_read_b64_tr_b16 v[72:73], v34 offset:128
    ds_read_b64_tr_b16 v[74:75], v34 offset:3200
    v_mfma_f32_16x16x32_bf16 v[148:151], v[80:83], v[52:55], v[148:151]
    s_waitcnt lgkmcnt(10)
    v_mfma_f32_16x16x32_bf16 v[116:119], v[84:87], v[48:51], v[116:119]
    ds_read_b64_tr_b16 v[76:77], v35 offset:128
    ds_read_b64_tr_b16 v[78:79], v35 offset:3200
    v_mfma_f32_16x16x32_bf16 v[152:155], v[84:87], v[52:55], v[152:155]
    s_waitcnt lgkmcnt(10)
    v_mfma_f32_16x16x32_bf16 v[120:123], v[88:91], v[48:51], v[120:123]
    ds_read_b64_tr_b16 v[80:81], v32 offset:256
    ds_read_b64_tr_b16 v[82:83], v32 offset:3328
    v_mfma_f32_16x16x32_bf16 v[156:159], v[88:91], v[52:55], v[156:159]
    ds_read_b128 v[56:59], v4 offset:1024
    s_waitcnt lgkmcnt(11)
    v_mfma_f32_16x16x32_bf16 v[124:127], v[92:95], v[48:51], v[124:127]
    ds_read_b64_tr_b16 v[84:85], v32 offset:12288
    ds_read_b64_tr_b16 v[86:87], v32 offset:15360
    v_mfma_f32_16x16x32_bf16 v[160:163], v[92:95], v[52:55], v[160:163]
    ds_read_b128 v[60:63], v4 offset:3072
    s_waitcnt lgkmcnt(12)
    v_mfma_f32_16x16x32_bf16 v[128:131], v[64:67], v[48:51], v[128:131]
    ds_read_b64_tr_b16 v[88:89], v33 offset:12288
    ds_read_b64_tr_b16 v[90:91], v33 offset:15360
    v_mfma_f32_16x16x32_bf16 v[164:167], v[64:67], v[52:55], v[164:167]
    s_waitcnt lgkmcnt(12)
    v_mfma_f32_16x16x32_bf16 v[132:135], v[68:71], v[48:51], v[132:135]
    ds_read_b64_tr_b16 v[92:93], v34 offset:12288
    ds_read_b64_tr_b16 v[94:95], v34 offset:15360
    v_mfma_f32_16x16x32_bf16 v[168:171], v[68:71], v[52:55], v[168:171]
    s_waitcnt lgkmcnt(12)
    v_mfma_f32_16x16x32_bf16 v[136:139], v[72:75], v[48:51], v[136:139]
    ds_read_b64_tr_b16 v[64:65], v35 offset:12288
    ds_read_b64_tr_b16 v[66:67], v35 offset:15360
    v_mfma_f32_16x16x32_bf16 v[172:175], v[72:75], v[52:55], v[172:175]
    s_waitcnt lgkmcnt(12)
    v_mfma_f32_16x16x32_bf16 v[140:143], v[76:79], v[48:51], v[140:143]
    ds_read_b64_tr_b16 v[68:69], v32 offset:12416
    ds_read_b64_tr_b16 v[70:71], v32 offset:15488
    v_mfma_f32_16x16x32_bf16 v[176:179], v[76:79], v[52:55], v[176:179]
    s_waitcnt lgkmcnt(12)
    v_mfma_f32_16x16x32_bf16 v[144:147], v[80:83], v[48:51], v[144:147]
    ds_read_b64_tr_b16 v[72:73], v33 offset:12416
    ds_read_b64_tr_b16 v[74:75], v33 offset:15488
    v_mfma_f32_16x16x32_bf16 v[180:183], v[80:83], v[52:55], v[180:183]
    s_barrier
    s_waitcnt lgkmcnt(10)
    v_mfma_f32_16x16x32_bf16 v[112:115], v[84:87], v[56:59], v[112:115]
    ds_read_b64_tr_b16 v[76:77], v34 offset:12416
    ds_read_b64_tr_b16 v[78:79], v34 offset:15488
    v_mfma_f32_16x16x32_bf16 v[148:151], v[84:87], v[60:63], v[148:151]
    s_waitcnt lgkmcnt(10)
    v_mfma_f32_16x16x32_bf16 v[116:119], v[88:91], v[56:59], v[116:119]
    ds_read_b64_tr_b16 v[80:81], v35 offset:12416
    ds_read_b64_tr_b16 v[82:83], v35 offset:15488
    v_mfma_f32_16x16x32_bf16 v[152:155], v[88:91], v[60:63], v[152:155]
    s_waitcnt lgkmcnt(10)
    v_mfma_f32_16x16x32_bf16 v[120:123], v[92:95], v[56:59], v[120:123]
    ds_read_b64_tr_b16 v[84:85], v32 offset:12544
    ds_read_b64_tr_b16 v[86:87], v32 offset:15616
    v_mfma_f32_16x16x32_bf16 v[156:159], v[92:95], v[60:63], v[156:159]
    ds_read_b128 v[48:51], v5 offset:0
    s_waitcnt lgkmcnt(11)
    v_mfma_f32_16x16x32_bf16 v[124:127], v[64:67], v[56:59], v[124:127]
    ds_read_b64_tr_b16 v[88:89], v36 offset:0
    ds_read_b64_tr_b16 v[90:91], v36 offset:3072
    v_mfma_f32_16x16x32_bf16 v[160:163], v[64:67], v[60:63], v[160:163]
    ds_read_b128 v[52:55], v5 offset:2048
    s_waitcnt lgkmcnt(12)
    v_mfma_f32_16x16x32_bf16 v[128:131], v[68:71], v[56:59], v[128:131]
    ds_read_b64_tr_b16 v[92:93], v37 offset:0
    ds_read_b64_tr_b16 v[94:95], v37 offset:3072
    v_mfma_f32_16x16x32_bf16 v[164:167], v[68:71], v[60:63], v[164:167]
    s_waitcnt lgkmcnt(12)
    v_mfma_f32_16x16x32_bf16 v[132:135], v[72:75], v[56:59], v[132:135]
    ds_read_b64_tr_b16 v[64:65], v38 offset:0
    ds_read_b64_tr_b16 v[66:67], v38 offset:3072
    v_mfma_f32_16x16x32_bf16 v[168:171], v[72:75], v[60:63], v[168:171]
    s_waitcnt lgkmcnt(12)
    v_mfma_f32_16x16x32_bf16 v[136:139], v[76:79], v[56:59], v[136:139]
    ds_read_b64_tr_b16 v[68:69], v39 offset:0
    ds_read_b64_tr_b16 v[70:71], v39 offset:3072
    v_mfma_f32_16x16x32_bf16 v[172:175], v[76:79], v[60:63], v[172:175]
    s_waitcnt lgkmcnt(12)
    v_mfma_f32_16x16x32_bf16 v[140:143], v[80:83], v[56:59], v[140:143]
    ds_read_b64_tr_b16 v[72:73], v36 offset:128
    ds_read_b64_tr_b16 v[74:75], v36 offset:3200
    v_mfma_f32_16x16x32_bf16 v[176:179], v[80:83], v[60:63], v[176:179]
    s_waitcnt lgkmcnt(12)
    v_mfma_f32_16x16x32_bf16 v[144:147], v[84:87], v[56:59], v[144:147]
    ds_read_b64_tr_b16 v[76:77], v37 offset:128
    ds_read_b64_tr_b16 v[78:79], v37 offset:3200
    v_mfma_f32_16x16x32_bf16 v[180:183], v[84:87], v[60:63], v[180:183]
    s_waitcnt lgkmcnt(10)
    v_mfma_f32_16x16x32_bf16 v[112:115], v[88:91], v[48:51], v[112:115]
    ds_read_b64_tr_b16 v[80:81], v38 offset:128
    ds_read_b64_tr_b16 v[82:83], v38 offset:3200
    v_mfma_f32_16x16x32_bf16 v[148:151], v[88:91], v[52:55], v[148:151]
    s_waitcnt lgkmcnt(10)
    v_mfma_f32_16x16x32_bf16 v[116:119], v[92:95], v[48:51], v[116:119]
    ds_read_b64_tr_b16 v[84:85], v39 offset:128
    ds_read_b64_tr_b16 v[86:87], v39 offset:3200
    v_mfma_f32_16x16x32_bf16 v[152:155], v[92:95], v[52:55], v[152:155]
    s_waitcnt lgkmcnt(10)
    v_mfma_f32_16x16x32_bf16 v[120:123], v[64:67], v[48:51], v[120:123]
    ds_read_b64_tr_b16 v[88:89], v36 offset:256
    ds_read_b64_tr_b16 v[90:91], v36 offset:3328
    v_mfma_f32_16x16x32_bf16 v[156:159], v[64:67], v[52:55], v[156:159]
    ds_read_b128 v[56:59], v5 offset:1024
    s_waitcnt lgkmcnt(11)
    v_mfma_f32_16x16x32_bf16 v[124:127], v[68:71], v[48:51], v[124:127]
    ds_read_b64_tr_b16 v[92:93], v36 offset:12288
    ds_read_b64_tr_b16 v[94:95], v36 offset:15360
    v_mfma_f32_16x16x32_bf16 v[160:163], v[68:71], v[52:55], v[160:163]
    ds_read_b128 v[60:63], v5 offset:3072
    s_waitcnt lgkmcnt(12)
    v_mfma_f32_16x16x32_bf16 v[128:131], v[72:75], v[48:51], v[128:131]
    ds_read_b64_tr_b16 v[64:65], v37 offset:12288
    ds_read_b64_tr_b16 v[66:67], v37 offset:15360
    v_mfma_f32_16x16x32_bf16 v[164:167], v[72:75], v[52:55], v[164:167]
    s_waitcnt lgkmcnt(12)
    v_mfma_f32_16x16x32_bf16 v[132:135], v[76:79], v[48:51], v[132:135]
    ds_read_b64_tr_b16 v[68:69], v38 offset:12288
    ds_read_b64_tr_b16 v[70:71], v38 offset:15360
    v_mfma_f32_16x16x32_bf16 v[168:171], v[76:79], v[52:55], v[168:171]
    s_waitcnt lgkmcnt(12)
    v_mfma_f32_16x16x32_bf16 v[136:139], v[80:83], v[48:51], v[136:139]
    ds_read_b64_tr_b16 v[72:73], v39 offset:12288
    ds_read_b64_tr_b16 v[74:75], v39 offset:15360
    v_mfma_f32_16x16x32_bf16 v[172:175], v[80:83], v[52:55], v[172:175]
    s_waitcnt lgkmcnt(12)
    v_mfma_f32_16x16x32_bf16 v[140:143], v[84:87], v[48:51], v[140:143]
    ds_read_b64_tr_b16 v[76:77], v36 offset:12416
    ds_read_b64_tr_b16 v[78:79], v36 offset:15488
    v_mfma_f32_16x16x32_bf16 v[176:179], v[84:87], v[52:55], v[176:179]
    s_waitcnt lgkmcnt(12)
    v_mfma_f32_16x16x32_bf16 v[144:147], v[88:91], v[48:51], v[144:147]
    ds_read_b64_tr_b16 v[80:81], v37 offset:12416
    ds_read_b64_tr_b16 v[82:83], v37 offset:15488
    v_mfma_f32_16x16x32_bf16 v[180:183], v[88:91], v[52:55], v[180:183]
    s_barrier
    s_waitcnt lgkmcnt(10)
    v_mfma_f32_16x16x32_bf16 v[112:115], v[92:95], v[56:59], v[112:115]
    ds_read_b64_tr_b16 v[84:85], v38 offset:12416
    ds_read_b64_tr_b16 v[86:87], v38 offset:15488
    v_mfma_f32_16x16x32_bf16 v[148:151], v[92:95], v[60:63], v[148:151]
    s_waitcnt lgkmcnt(10)
    v_mfma_f32_16x16x32_bf16 v[116:119], v[64:67], v[56:59], v[116:119]
    ds_read_b64_tr_b16 v[88:89], v39 offset:12416
    ds_read_b64_tr_b16 v[90:91], v39 offset:15488
    v_mfma_f32_16x16x32_bf16 v[152:155], v[64:67], v[60:63], v[152:155]
    s_waitcnt lgkmcnt(10)
    v_mfma_f32_16x16x32_bf16 v[120:123], v[68:71], v[56:59], v[120:123]
    ds_read_b64_tr_b16 v[92:93], v36 offset:12544
    ds_read_b64_tr_b16 v[94:95], v36 offset:15616
    v_mfma_f32_16x16x32_bf16 v[156:159], v[68:71], v[60:63], v[156:159]
    ds_read_b128 v[48:51], v2 offset:0
    s_waitcnt lgkmcnt(11)
    v_mfma_f32_16x16x32_bf16 v[124:127], v[72:75], v[56:59], v[124:127]
    ds_read_b64_tr_b16 v[64:65], v24 offset:0
    ds_read_b64_tr_b16 v[66:67], v24 offset:3072
    v_mfma_f32_16x16x32_bf16 v[160:163], v[72:75], v[60:63], v[160:163]
    ds_read_b128 v[52:55], v2 offset:2048
    s_waitcnt lgkmcnt(12)
    v_mfma_f32_16x16x32_bf16 v[128:131], v[76:79], v[56:59], v[128:131]
    ds_read_b64_tr_b16 v[68:69], v25 offset:0
    ds_read_b64_tr_b16 v[70:71], v25 offset:3072
    v_mfma_f32_16x16x32_bf16 v[164:167], v[76:79], v[60:63], v[164:167]
    s_waitcnt lgkmcnt(12)
    v_mfma_f32_16x16x32_bf16 v[132:135], v[80:83], v[56:59], v[132:135]
    ds_read_b64_tr_b16 v[72:73], v26 offset:0
    ds_read_b64_tr_b16 v[74:75], v26 offset:3072
    v_mfma_f32_16x16x32_bf16 v[168:171], v[80:83], v[60:63], v[168:171]
    s_waitcnt lgkmcnt(12)
    v_mfma_f32_16x16x32_bf16 v[136:139], v[84:87], v[56:59], v[136:139]
    ds_read_b64_tr_b16 v[76:77], v27 offset:0
    ds_read_b64_tr_b16 v[78:79], v27 offset:3072
    v_mfma_f32_16x16x32_bf16 v[172:175], v[84:87], v[60:63], v[172:175]
    s_waitcnt lgkmcnt(12)
    v_mfma_f32_16x16x32_bf16 v[140:143], v[88:91], v[56:59], v[140:143]
    ds_read_b64_tr_b16 v[80:81], v24 offset:128
    ds_read_b64_tr_b16 v[82:83], v24 offset:3200
    v_mfma_f32_16x16x32_bf16 v[176:179], v[88:91], v[60:63], v[176:179]
    s_waitcnt lgkmcnt(12)
    v_mfma_f32_16x16x32_bf16 v[144:147], v[92:95], v[56:59], v[144:147]
    ds_read_b64_tr_b16 v[84:85], v25 offset:128
    ds_read_b64_tr_b16 v[86:87], v25 offset:3200
    v_mfma_f32_16x16x32_bf16 v[180:183], v[92:95], v[60:63], v[180:183]
    s_waitcnt lgkmcnt(10)
    v_mfma_f32_16x16x32_bf16 v[112:115], v[64:67], v[48:51], v[112:115]
    ds_read_b64_tr_b16 v[88:89], v26 offset:128
    ds_read_b64_tr_b16 v[90:91], v26 offset:3200
    v_mfma_f32_16x16x32_bf16 v[148:151], v[64:67], v[52:55], v[148:151]
    s_waitcnt lgkmcnt(10)
    v_mfma_f32_16x16x32_bf16 v[116:119], v[68:71], v[48:51], v[116:119]
    ds_read_b64_tr_b16 v[92:93], v27 offset:128
    ds_read_b64_tr_b16 v[94:95], v27 offset:3200
    v_mfma_f32_16x16x32_bf16 v[152:155], v[68:71], v[52:55], v[152:155]
    s_waitcnt lgkmcnt(10)
    v_mfma_f32_16x16x32_bf16 v[120:123], v[72:75], v[48:51], v[120:123]
    ds_read_b64_tr_b16 v[64:65], v24 offset:256
    ds_read_b64_tr_b16 v[66:67], v24 offset:3328
    v_mfma_f32_16x16x32_bf16 v[156:159], v[72:75], v[52:55], v[156:159]
    ds_read_b128 v[56:59], v2 offset:1024
    s_waitcnt lgkmcnt(11)
    v_mfma_f32_16x16x32_bf16 v[124:127], v[76:79], v[48:51], v[124:127]
    ds_read_b64_tr_b16 v[68:69], v24 offset:12288
    ds_read_b64_tr_b16 v[70:71], v24 offset:15360
    v_mfma_f32_16x16x32_bf16 v[160:163], v[76:79], v[52:55], v[160:163]
    ds_read_b128 v[60:63], v2 offset:3072
    s_waitcnt lgkmcnt(12)
    v_mfma_f32_16x16x32_bf16 v[128:131], v[80:83], v[48:51], v[128:131]
    ds_read_b64_tr_b16 v[72:73], v25 offset:12288
    ds_read_b64_tr_b16 v[74:75], v25 offset:15360
    v_mfma_f32_16x16x32_bf16 v[164:167], v[80:83], v[52:55], v[164:167]
    s_waitcnt lgkmcnt(12)
    v_mfma_f32_16x16x32_bf16 v[132:135], v[84:87], v[48:51], v[132:135]
    ds_read_b64_tr_b16 v[76:77], v26 offset:12288
    ds_read_b64_tr_b16 v[78:79], v26 offset:15360
    v_mfma_f32_16x16x32_bf16 v[168:171], v[84:87], v[52:55], v[168:171]
    s_waitcnt lgkmcnt(12)
    v_mfma_f32_16x16x32_bf16 v[136:139], v[88:91], v[48:51], v[136:139]
    ds_read_b64_tr_b16 v[80:81], v27 offset:12288
    ds_read_b64_tr_b16 v[82:83], v27 offset:15360
    v_mfma_f32_16x16x32_bf16 v[172:175], v[88:91], v[52:55], v[172:175]
    s_waitcnt lgkmcnt(12)
    v_mfma_f32_16x16x32_bf16 v[140:143], v[92:95], v[48:51], v[140:143]
    ds_read_b64_tr_b16 v[84:85], v24 offset:12416
    ds_read_b64_tr_b16 v[86:87], v24 offset:15488
    v_mfma_f32_16x16x32_bf16 v[176:179], v[92:95], v[52:55], v[176:179]
    s_waitcnt lgkmcnt(12)
    v_mfma_f32_16x16x32_bf16 v[144:147], v[64:67], v[48:51], v[144:147]
    ds_read_b64_tr_b16 v[88:89], v25 offset:12416
    ds_read_b64_tr_b16 v[90:91], v25 offset:15488
    v_mfma_f32_16x16x32_bf16 v[180:183], v[64:67], v[52:55], v[180:183]
    s_barrier
    s_waitcnt lgkmcnt(10)
    v_mfma_f32_16x16x32_bf16 v[112:115], v[68:71], v[56:59], v[112:115]
    ds_read_b64_tr_b16 v[92:93], v26 offset:12416
    ds_read_b64_tr_b16 v[94:95], v26 offset:15488
    v_mfma_f32_16x16x32_bf16 v[148:151], v[68:71], v[60:63], v[148:151]
    s_waitcnt lgkmcnt(10)
    v_mfma_f32_16x16x32_bf16 v[116:119], v[72:75], v[56:59], v[116:119]
    ds_read_b64_tr_b16 v[64:65], v27 offset:12416
    ds_read_b64_tr_b16 v[66:67], v27 offset:15488
    v_mfma_f32_16x16x32_bf16 v[152:155], v[72:75], v[60:63], v[152:155]
    s_waitcnt lgkmcnt(10)
    v_mfma_f32_16x16x32_bf16 v[120:123], v[76:79], v[56:59], v[120:123]
    ds_read_b64_tr_b16 v[68:69], v24 offset:12544
    ds_read_b64_tr_b16 v[70:71], v24 offset:15616
    v_mfma_f32_16x16x32_bf16 v[156:159], v[76:79], v[60:63], v[156:159]
    ds_read_b128 v[48:51], v3 offset:0
    s_waitcnt lgkmcnt(11)
    v_mfma_f32_16x16x32_bf16 v[124:127], v[80:83], v[56:59], v[124:127]
    ds_read_b64_tr_b16 v[72:73], v28 offset:0
    ds_read_b64_tr_b16 v[74:75], v28 offset:3072
    v_mfma_f32_16x16x32_bf16 v[160:163], v[80:83], v[60:63], v[160:163]
    ds_read_b128 v[52:55], v3 offset:2048
    s_waitcnt lgkmcnt(12)
    v_mfma_f32_16x16x32_bf16 v[128:131], v[84:87], v[56:59], v[128:131]
    ds_read_b64_tr_b16 v[76:77], v29 offset:0
    ds_read_b64_tr_b16 v[78:79], v29 offset:3072
    v_mfma_f32_16x16x32_bf16 v[164:167], v[84:87], v[60:63], v[164:167]
    s_waitcnt lgkmcnt(12)
    v_mfma_f32_16x16x32_bf16 v[132:135], v[88:91], v[56:59], v[132:135]
    ds_read_b64_tr_b16 v[80:81], v30 offset:0
    ds_read_b64_tr_b16 v[82:83], v30 offset:3072
    v_mfma_f32_16x16x32_bf16 v[168:171], v[88:91], v[60:63], v[168:171]
    s_waitcnt lgkmcnt(12)
    v_mfma_f32_16x16x32_bf16 v[136:139], v[92:95], v[56:59], v[136:139]
    ds_read_b64_tr_b16 v[84:85], v31 offset:0
    ds_read_b64_tr_b16 v[86:87], v31 offset:3072
    v_mfma_f32_16x16x32_bf16 v[172:175], v[92:95], v[60:63], v[172:175]
    s_waitcnt lgkmcnt(12)
    v_mfma_f32_16x16x32_bf16 v[140:143], v[64:67], v[56:59], v[140:143]
    ds_read_b64_tr_b16 v[88:89], v28 offset:128
    ds_read_b64_tr_b16 v[90:91], v28 offset:3200
    v_mfma_f32_16x16x32_bf16 v[176:179], v[64:67], v[60:63], v[176:179]
    s_waitcnt lgkmcnt(12)
    v_mfma_f32_16x16x32_bf16 v[144:147], v[68:71], v[56:59], v[144:147]
    ds_read_b64_tr_b16 v[92:93], v29 offset:128
    ds_read_b64_tr_b16 v[94:95], v29 offset:3200
    v_mfma_f32_16x16x32_bf16 v[180:183], v[68:71], v[60:63], v[180:183]
    s_waitcnt lgkmcnt(10)
    v_mfma_f32_16x16x32_bf16 v[112:115], v[72:75], v[48:51], v[112:115]
    ds_read_b64_tr_b16 v[64:65], v30 offset:128
    ds_read_b64_tr_b16 v[66:67], v30 offset:3200
    v_mfma_f32_16x16x32_bf16 v[148:151], v[72:75], v[52:55], v[148:151]
    s_waitcnt lgkmcnt(10)
    v_mfma_f32_16x16x32_bf16 v[116:119], v[76:79], v[48:51], v[116:119]
    ds_read_b64_tr_b16 v[68:69], v31 offset:128
    ds_read_b64_tr_b16 v[70:71], v31 offset:3200
    v_mfma_f32_16x16x32_bf16 v[152:155], v[76:79], v[52:55], v[152:155]
    s_waitcnt lgkmcnt(10)
    v_mfma_f32_16x16x32_bf16 v[120:123], v[80:83], v[48:51], v[120:123]
    ds_read_b64_tr_b16 v[72:73], v28 offset:256
    ds_read_b64_tr_b16 v[74:75], v28 offset:3328
    v_mfma_f32_16x16x32_bf16 v[156:159], v[80:83], v[52:55], v[156:159]
    ds_read_b128 v[56:59], v3 offset:1024
    s_waitcnt lgkmcnt(11)
    v_mfma_f32_16x16x32_bf16 v[124:127], v[84:87], v[48:51], v[124:127]
    ds_read_b64_tr_b16 v[76:77], v28 offset:12288
    ds_read_b64_tr_b16 v[78:79], v28 offset:15360
    v_mfma_f32_16x16x32_bf16 v[160:163], v[84:87], v[52:55], v[160:163]
    ds_read_b128 v[60:63], v3 offset:3072
    s_waitcnt lgkmcnt(12)
    v_mfma_f32_16x16x32_bf16 v[128:131], v[88:91], v[48:51], v[128:131]
    ds_read_b64_tr_b16 v[80:81], v29 offset:12288
    ds_read_b64_tr_b16 v[82:83], v29 offset:15360
    v_mfma_f32_16x16x32_bf16 v[164:167], v[88:91], v[52:55], v[164:167]
    s_waitcnt lgkmcnt(12)
    v_mfma_f32_16x16x32_bf16 v[132:135], v[92:95], v[48:51], v[132:135]
    ds_read_b64_tr_b16 v[84:85], v30 offset:12288
    ds_read_b64_tr_b16 v[86:87], v30 offset:15360
    v_mfma_f32_16x16x32_bf16 v[168:171], v[92:95], v[52:55], v[168:171]
    s_waitcnt lgkmcnt(12)
    v_mfma_f32_16x16x32_bf16 v[136:139], v[64:67], v[48:51], v[136:139]
    ds_read_b64_tr_b16 v[88:89], v31 offset:12288
    ds_read_b64_tr_b16 v[90:91], v31 offset:15360
    v_mfma_f32_16x16x32_bf16 v[172:175], v[64:67], v[52:55], v[172:175]
    s_waitcnt lgkmcnt(12)
    v_mfma_f32_16x16x32_bf16 v[140:143], v[68:71], v[48:51], v[140:143]
    ds_read_b64_tr_b16 v[92:93], v28 offset:12416
    ds_read_b64_tr_b16 v[94:95], v28 offset:15488
    v_mfma_f32_16x16x32_bf16 v[176:179], v[68:71], v[52:55], v[176:179]
    s_waitcnt lgkmcnt(12)
    v_mfma_f32_16x16x32_bf16 v[144:147], v[72:75], v[48:51], v[144:147]
    ds_read_b64_tr_b16 v[64:65], v29 offset:12416
    ds_read_b64_tr_b16 v[66:67], v29 offset:15488
    v_mfma_f32_16x16x32_bf16 v[180:183], v[72:75], v[52:55], v[180:183]
    s_barrier
    s_waitcnt lgkmcnt(10)
    v_mfma_f32_16x16x32_bf16 v[112:115], v[76:79], v[56:59], v[112:115]
    ds_read_b64_tr_b16 v[68:69], v30 offset:12416
    ds_read_b64_tr_b16 v[70:71], v30 offset:15488
    v_mfma_f32_16x16x32_bf16 v[148:151], v[76:79], v[60:63], v[148:151]
    s_waitcnt lgkmcnt(10)
    v_mfma_f32_16x16x32_bf16 v[116:119], v[80:83], v[56:59], v[116:119]
    ds_read_b64_tr_b16 v[72:73], v31 offset:12416
    ds_read_b64_tr_b16 v[74:75], v31 offset:15488
    v_mfma_f32_16x16x32_bf16 v[152:155], v[80:83], v[60:63], v[152:155]
    s_waitcnt lgkmcnt(10)
    v_mfma_f32_16x16x32_bf16 v[120:123], v[84:87], v[56:59], v[120:123]
    ds_read_b64_tr_b16 v[76:77], v28 offset:12544
    ds_read_b64_tr_b16 v[78:79], v28 offset:15616
    v_mfma_f32_16x16x32_bf16 v[156:159], v[84:87], v[60:63], v[156:159]
    ds_read_b128 v[48:51], v4 offset:0
    s_waitcnt lgkmcnt(11)
    v_mfma_f32_16x16x32_bf16 v[124:127], v[88:91], v[56:59], v[124:127]
    ds_read_b64_tr_b16 v[80:81], v32 offset:0
    ds_read_b64_tr_b16 v[82:83], v32 offset:3072
    v_mfma_f32_16x16x32_bf16 v[160:163], v[88:91], v[60:63], v[160:163]
    ds_read_b128 v[52:55], v4 offset:2048
    s_waitcnt lgkmcnt(12)
    v_mfma_f32_16x16x32_bf16 v[128:131], v[92:95], v[56:59], v[128:131]
    ds_read_b64_tr_b16 v[84:85], v33 offset:0
    ds_read_b64_tr_b16 v[86:87], v33 offset:3072
    v_mfma_f32_16x16x32_bf16 v[164:167], v[92:95], v[60:63], v[164:167]
    s_waitcnt lgkmcnt(12)
    v_mfma_f32_16x16x32_bf16 v[132:135], v[64:67], v[56:59], v[132:135]
    ds_read_b64_tr_b16 v[88:89], v34 offset:0
    ds_read_b64_tr_b16 v[90:91], v34 offset:3072
    v_mfma_f32_16x16x32_bf16 v[168:171], v[64:67], v[60:63], v[168:171]
    s_waitcnt lgkmcnt(12)
    v_mfma_f32_16x16x32_bf16 v[136:139], v[68:71], v[56:59], v[136:139]
    ds_read_b64_tr_b16 v[92:93], v35 offset:0
    ds_read_b64_tr_b16 v[94:95], v35 offset:3072
    v_mfma_f32_16x16x32_bf16 v[172:175], v[68:71], v[60:63], v[172:175]
    s_waitcnt lgkmcnt(12)
    v_mfma_f32_16x16x32_bf16 v[140:143], v[72:75], v[56:59], v[140:143]
    ds_read_b64_tr_b16 v[64:65], v32 offset:128
    ds_read_b64_tr_b16 v[66:67], v32 offset:3200
    v_mfma_f32_16x16x32_bf16 v[176:179], v[72:75], v[60:63], v[176:179]
    s_waitcnt lgkmcnt(12)
    v_mfma_f32_16x16x32_bf16 v[144:147], v[76:79], v[56:59], v[144:147]
    ds_read_b64_tr_b16 v[68:69], v33 offset:128
    ds_read_b64_tr_b16 v[70:71], v33 offset:3200
    v_mfma_f32_16x16x32_bf16 v[180:183], v[76:79], v[60:63], v[180:183]
    s_waitcnt lgkmcnt(10)
    v_mfma_f32_16x16x32_bf16 v[112:115], v[80:83], v[48:51], v[112:115]
    ds_read_b64_tr_b16 v[72:73], v34 offset:128
    ds_read_b64_tr_b16 v[74:75], v34 offset:3200
    v_mfma_f32_16x16x32_bf16 v[148:151], v[80:83], v[52:55], v[148:151]
    s_waitcnt lgkmcnt(10)
    v_mfma_f32_16x16x32_bf16 v[116:119], v[84:87], v[48:51], v[116:119]
    ds_read_b64_tr_b16 v[76:77], v35 offset:128
    ds_read_b64_tr_b16 v[78:79], v35 offset:3200
    v_mfma_f32_16x16x32_bf16 v[152:155], v[84:87], v[52:55], v[152:155]
    s_waitcnt lgkmcnt(10)
    v_mfma_f32_16x16x32_bf16 v[120:123], v[88:91], v[48:51], v[120:123]
    ds_read_b64_tr_b16 v[80:81], v32 offset:256
    ds_read_b64_tr_b16 v[82:83], v32 offset:3328
    v_mfma_f32_16x16x32_bf16 v[156:159], v[88:91], v[52:55], v[156:159]
    ds_read_b128 v[56:59], v4 offset:1024
    s_waitcnt lgkmcnt(11)
    v_mfma_f32_16x16x32_bf16 v[124:127], v[92:95], v[48:51], v[124:127]
    ds_read_b64_tr_b16 v[84:85], v32 offset:12288
    ds_read_b64_tr_b16 v[86:87], v32 offset:15360
    v_mfma_f32_16x16x32_bf16 v[160:163], v[92:95], v[52:55], v[160:163]
    ds_read_b128 v[60:63], v4 offset:3072
    s_waitcnt lgkmcnt(12)
    v_mfma_f32_16x16x32_bf16 v[128:131], v[64:67], v[48:51], v[128:131]
    ds_read_b64_tr_b16 v[88:89], v33 offset:12288
    ds_read_b64_tr_b16 v[90:91], v33 offset:15360
    v_mfma_f32_16x16x32_bf16 v[164:167], v[64:67], v[52:55], v[164:167]
    s_waitcnt lgkmcnt(12)
    v_mfma_f32_16x16x32_bf16 v[132:135], v[68:71], v[48:51], v[132:135]
    ds_read_b64_tr_b16 v[92:93], v34 offset:12288
    ds_read_b64_tr_b16 v[94:95], v34 offset:15360
    v_mfma_f32_16x16x32_bf16 v[168:171], v[68:71], v[52:55], v[168:171]
    s_waitcnt lgkmcnt(12)
    v_mfma_f32_16x16x32_bf16 v[136:139], v[72:75], v[48:51], v[136:139]
    ds_read_b64_tr_b16 v[64:65], v35 offset:12288
    ds_read_b64_tr_b16 v[66:67], v35 offset:15360
    v_mfma_f32_16x16x32_bf16 v[172:175], v[72:75], v[52:55], v[172:175]
    s_waitcnt lgkmcnt(12)
    v_mfma_f32_16x16x32_bf16 v[140:143], v[76:79], v[48:51], v[140:143]
    ds_read_b64_tr_b16 v[68:69], v32 offset:12416
    ds_read_b64_tr_b16 v[70:71], v32 offset:15488
    v_mfma_f32_16x16x32_bf16 v[176:179], v[76:79], v[52:55], v[176:179]
    s_waitcnt lgkmcnt(12)
    v_mfma_f32_16x16x32_bf16 v[144:147], v[80:83], v[48:51], v[144:147]
    ds_read_b64_tr_b16 v[72:73], v33 offset:12416
    ds_read_b64_tr_b16 v[74:75], v33 offset:15488
    v_mfma_f32_16x16x32_bf16 v[180:183], v[80:83], v[52:55], v[180:183]
    s_barrier
    s_waitcnt lgkmcnt(10)
    v_mfma_f32_16x16x32_bf16 v[112:115], v[84:87], v[56:59], v[112:115]
    ds_read_b64_tr_b16 v[76:77], v34 offset:12416
    ds_read_b64_tr_b16 v[78:79], v34 offset:15488
    v_mfma_f32_16x16x32_bf16 v[148:151], v[84:87], v[60:63], v[148:151]
    s_waitcnt lgkmcnt(10)
    v_mfma_f32_16x16x32_bf16 v[116:119], v[88:91], v[56:59], v[116:119]
    ds_read_b64_tr_b16 v[80:81], v35 offset:12416
    ds_read_b64_tr_b16 v[82:83], v35 offset:15488
    v_mfma_f32_16x16x32_bf16 v[152:155], v[88:91], v[60:63], v[152:155]
    s_waitcnt lgkmcnt(10)
    v_mfma_f32_16x16x32_bf16 v[120:123], v[92:95], v[56:59], v[120:123]
    ds_read_b64_tr_b16 v[84:85], v32 offset:12544
    ds_read_b64_tr_b16 v[86:87], v32 offset:15616
    v_mfma_f32_16x16x32_bf16 v[156:159], v[92:95], v[60:63], v[156:159]
    ds_read_b128 v[48:51], v5 offset:0
    s_waitcnt lgkmcnt(11)
    v_mfma_f32_16x16x32_bf16 v[124:127], v[64:67], v[56:59], v[124:127]
    ds_read_b64_tr_b16 v[88:89], v36 offset:0
    ds_read_b64_tr_b16 v[90:91], v36 offset:3072
    v_mfma_f32_16x16x32_bf16 v[160:163], v[64:67], v[60:63], v[160:163]
    ds_read_b128 v[52:55], v5 offset:2048
    s_waitcnt lgkmcnt(12)
    v_mfma_f32_16x16x32_bf16 v[128:131], v[68:71], v[56:59], v[128:131]
    ds_read_b64_tr_b16 v[92:93], v37 offset:0
    ds_read_b64_tr_b16 v[94:95], v37 offset:3072
    v_mfma_f32_16x16x32_bf16 v[164:167], v[68:71], v[60:63], v[164:167]
    s_waitcnt lgkmcnt(12)
    v_mfma_f32_16x16x32_bf16 v[132:135], v[72:75], v[56:59], v[132:135]
    ds_read_b64_tr_b16 v[64:65], v38 offset:0
    ds_read_b64_tr_b16 v[66:67], v38 offset:3072
    v_mfma_f32_16x16x32_bf16 v[168:171], v[72:75], v[60:63], v[168:171]
    s_waitcnt lgkmcnt(12)
    v_mfma_f32_16x16x32_bf16 v[136:139], v[76:79], v[56:59], v[136:139]
    ds_read_b64_tr_b16 v[68:69], v39 offset:0
    ds_read_b64_tr_b16 v[70:71], v39 offset:3072
    v_mfma_f32_16x16x32_bf16 v[172:175], v[76:79], v[60:63], v[172:175]
    s_waitcnt lgkmcnt(12)
    v_mfma_f32_16x16x32_bf16 v[140:143], v[80:83], v[56:59], v[140:143]
    ds_read_b64_tr_b16 v[72:73], v36 offset:128
    ds_read_b64_tr_b16 v[74:75], v36 offset:3200
    v_mfma_f32_16x16x32_bf16 v[176:179], v[80:83], v[60:63], v[176:179]
    s_waitcnt lgkmcnt(12)
    v_mfma_f32_16x16x32_bf16 v[144:147], v[84:87], v[56:59], v[144:147]
    ds_read_b64_tr_b16 v[76:77], v37 offset:128
    ds_read_b64_tr_b16 v[78:79], v37 offset:3200
    v_mfma_f32_16x16x32_bf16 v[180:183], v[84:87], v[60:63], v[180:183]
    s_waitcnt lgkmcnt(10)
    v_mfma_f32_16x16x32_bf16 v[112:115], v[88:91], v[48:51], v[112:115]
    ds_read_b64_tr_b16 v[80:81], v38 offset:128
    ds_read_b64_tr_b16 v[82:83], v38 offset:3200
    v_mfma_f32_16x16x32_bf16 v[148:151], v[88:91], v[52:55], v[148:151]
    s_waitcnt lgkmcnt(10)
    v_mfma_f32_16x16x32_bf16 v[116:119], v[92:95], v[48:51], v[116:119]
    ds_read_b64_tr_b16 v[84:85], v39 offset:128
    ds_read_b64_tr_b16 v[86:87], v39 offset:3200
    v_mfma_f32_16x16x32_bf16 v[152:155], v[92:95], v[52:55], v[152:155]
    s_waitcnt lgkmcnt(10)
    v_mfma_f32_16x16x32_bf16 v[120:123], v[64:67], v[48:51], v[120:123]
    ds_read_b64_tr_b16 v[88:89], v36 offset:256
    ds_read_b64_tr_b16 v[90:91], v36 offset:3328
    v_mfma_f32_16x16x32_bf16 v[156:159], v[64:67], v[52:55], v[156:159]
    ds_read_b128 v[56:59], v5 offset:1024
    s_waitcnt lgkmcnt(11)
    v_mfma_f32_16x16x32_bf16 v[124:127], v[68:71], v[48:51], v[124:127]
    ds_read_b64_tr_b16 v[92:93], v36 offset:12288
    ds_read_b64_tr_b16 v[94:95], v36 offset:15360
    v_mfma_f32_16x16x32_bf16 v[160:163], v[68:71], v[52:55], v[160:163]
    ds_read_b128 v[60:63], v5 offset:3072
    s_waitcnt lgkmcnt(12)
    v_mfma_f32_16x16x32_bf16 v[128:131], v[72:75], v[48:51], v[128:131]
    ds_read_b64_tr_b16 v[64:65], v37 offset:12288
    ds_read_b64_tr_b16 v[66:67], v37 offset:15360
    v_mfma_f32_16x16x32_bf16 v[164:167], v[72:75], v[52:55], v[164:167]
    s_waitcnt lgkmcnt(12)
    v_mfma_f32_16x16x32_bf16 v[132:135], v[76:79], v[48:51], v[132:135]
    ds_read_b64_tr_b16 v[68:69], v38 offset:12288
    ds_read_b64_tr_b16 v[70:71], v38 offset:15360
    v_mfma_f32_16x16x32_bf16 v[168:171], v[76:79], v[52:55], v[168:171]
    s_waitcnt lgkmcnt(12)
    v_mfma_f32_16x16x32_bf16 v[136:139], v[80:83], v[48:51], v[136:139]
    ds_read_b64_tr_b16 v[72:73], v39 offset:12288
    ds_read_b64_tr_b16 v[74:75], v39 offset:15360
    v_mfma_f32_16x16x32_bf16 v[172:175], v[80:83], v[52:55], v[172:175]
    s_waitcnt lgkmcnt(12)
    v_mfma_f32_16x16x32_bf16 v[140:143], v[84:87], v[48:51], v[140:143]
    ds_read_b64_tr_b16 v[76:77], v36 offset:12416
    ds_read_b64_tr_b16 v[78:79], v36 offset:15488
    v_mfma_f32_16x16x32_bf16 v[176:179], v[84:87], v[52:55], v[176:179]
    s_waitcnt lgkmcnt(12)
    v_mfma_f32_16x16x32_bf16 v[144:147], v[88:91], v[48:51], v[144:147]
    ds_read_b64_tr_b16 v[80:81], v37 offset:12416
    ds_read_b64_tr_b16 v[82:83], v37 offset:15488
    v_mfma_f32_16x16x32_bf16 v[180:183], v[88:91], v[52:55], v[180:183]
    s_barrier
    s_waitcnt lgkmcnt(10)
    v_mfma_f32_16x16x32_bf16 v[112:115], v[92:95], v[56:59], v[112:115]
    ds_read_b64_tr_b16 v[84:85], v38 offset:12416
    ds_read_b64_tr_b16 v[86:87], v38 offset:15488
    v_mfma_f32_16x16x32_bf16 v[148:151], v[92:95], v[60:63], v[148:151]
    s_waitcnt lgkmcnt(10)
    v_mfma_f32_16x16x32_bf16 v[116:119], v[64:67], v[56:59], v[116:119]
    ds_read_b64_tr_b16 v[88:89], v39 offset:12416
    ds_read_b64_tr_b16 v[90:91], v39 offset:15488
    v_mfma_f32_16x16x32_bf16 v[152:155], v[64:67], v[60:63], v[152:155]
    s_waitcnt lgkmcnt(10)
    v_mfma_f32_16x16x32_bf16 v[120:123], v[68:71], v[56:59], v[120:123]
    ds_read_b64_tr_b16 v[92:93], v36 offset:12544
    ds_read_b64_tr_b16 v[94:95], v36 offset:15616
    v_mfma_f32_16x16x32_bf16 v[156:159], v[68:71], v[60:63], v[156:159]
    ds_read_b128 v[48:51], v2 offset:0
    s_waitcnt lgkmcnt(11)
    v_mfma_f32_16x16x32_bf16 v[124:127], v[72:75], v[56:59], v[124:127]
    ds_read_b64_tr_b16 v[64:65], v24 offset:0
    ds_read_b64_tr_b16 v[66:67], v24 offset:3072
    v_mfma_f32_16x16x32_bf16 v[160:163], v[72:75], v[60:63], v[160:163]
    ds_read_b128 v[52:55], v2 offset:2048
    s_waitcnt lgkmcnt(12)
    v_mfma_f32_16x16x32_bf16 v[128:131], v[76:79], v[56:59], v[128:131]
    ds_read_b64_tr_b16 v[68:69], v25 offset:0
    ds_read_b64_tr_b16 v[70:71], v25 offset:3072
    v_mfma_f32_16x16x32_bf16 v[164:167], v[76:79], v[60:63], v[164:167]
    s_waitcnt lgkmcnt(12)
    v_mfma_f32_16x16x32_bf16 v[132:135], v[80:83], v[56:59], v[132:135]
    ds_read_b64_tr_b16 v[72:73], v26 offset:0
    ds_read_b64_tr_b16 v[74:75], v26 offset:3072
    v_mfma_f32_16x16x32_bf16 v[168:171], v[80:83], v[60:63], v[168:171]
    s_waitcnt lgkmcnt(12)
    v_mfma_f32_16x16x32_bf16 v[136:139], v[84:87], v[56:59], v[136:139]
    ds_read_b64_tr_b16 v[76:77], v27 offset:0
    ds_read_b64_tr_b16 v[78:79], v27 offset:3072
    v_mfma_f32_16x16x32_bf16 v[172:175], v[84:87], v[60:63], v[172:175]
    s_waitcnt lgkmcnt(12)
    v_mfma_f32_16x16x32_bf16 v[140:143], v[88:91], v[56:59], v[140:143]
    ds_read_b64_tr_b16 v[80:81], v24 offset:128
    ds_read_b64_tr_b16 v[82:83], v24 offset:3200
    v_mfma_f32_16x16x32_bf16 v[176:179], v[88:91], v[60:63], v[176:179]
    s_waitcnt lgkmcnt(12)
    v_mfma_f32_16x16x32_bf16 v[144:147], v[92:95], v[56:59], v[144:147]
    ds_read_b64_tr_b16 v[84:85], v25 offset:128
    ds_read_b64_tr_b16 v[86:87], v25 offset:3200
    v_mfma_f32_16x16x32_bf16 v[180:183], v[92:95], v[60:63], v[180:183]
    s_waitcnt lgkmcnt(10)
    v_mfma_f32_16x16x32_bf16 v[112:115], v[64:67], v[48:51], v[112:115]
    ds_read_b64_tr_b16 v[88:89], v26 offset:128
    ds_read_b64_tr_b16 v[90:91], v26 offset:3200
    v_mfma_f32_16x16x32_bf16 v[148:151], v[64:67], v[52:55], v[148:151]
    s_waitcnt lgkmcnt(10)
    v_mfma_f32_16x16x32_bf16 v[116:119], v[68:71], v[48:51], v[116:119]
    ds_read_b64_tr_b16 v[92:93], v27 offset:128
    ds_read_b64_tr_b16 v[94:95], v27 offset:3200
    v_mfma_f32_16x16x32_bf16 v[152:155], v[68:71], v[52:55], v[152:155]
    s_waitcnt lgkmcnt(10)
    v_mfma_f32_16x16x32_bf16 v[120:123], v[72:75], v[48:51], v[120:123]
    ds_read_b64_tr_b16 v[64:65], v24 offset:256
    ds_read_b64_tr_b16 v[66:67], v24 offset:3328
    v_mfma_f32_16x16x32_bf16 v[156:159], v[72:75], v[52:55], v[156:159]
    ds_read_b128 v[56:59], v2 offset:1024
    s_waitcnt lgkmcnt(11)
    v_mfma_f32_16x16x32_bf16 v[124:127], v[76:79], v[48:51], v[124:127]
    ds_read_b64_tr_b16 v[68:69], v24 offset:12288
    ds_read_b64_tr_b16 v[70:71], v24 offset:15360
    v_mfma_f32_16x16x32_bf16 v[160:163], v[76:79], v[52:55], v[160:163]
    ds_read_b128 v[60:63], v2 offset:3072
    s_waitcnt lgkmcnt(12)
    v_mfma_f32_16x16x32_bf16 v[128:131], v[80:83], v[48:51], v[128:131]
    ds_read_b64_tr_b16 v[72:73], v25 offset:12288
    ds_read_b64_tr_b16 v[74:75], v25 offset:15360
    v_mfma_f32_16x16x32_bf16 v[164:167], v[80:83], v[52:55], v[164:167]
    s_waitcnt lgkmcnt(12)
    v_mfma_f32_16x16x32_bf16 v[132:135], v[84:87], v[48:51], v[132:135]
    ds_read_b64_tr_b16 v[76:77], v26 offset:12288
    ds_read_b64_tr_b16 v[78:79], v26 offset:15360
    v_mfma_f32_16x16x32_bf16 v[168:171], v[84:87], v[52:55], v[168:171]
    s_waitcnt lgkmcnt(12)
    v_mfma_f32_16x16x32_bf16 v[136:139], v[88:91], v[48:51], v[136:139]
    ds_read_b64_tr_b16 v[80:81], v27 offset:12288
    ds_read_b64_tr_b16 v[82:83], v27 offset:15360
    v_mfma_f32_16x16x32_bf16 v[172:175], v[88:91], v[52:55], v[172:175]
    s_waitcnt lgkmcnt(12)
    v_mfma_f32_16x16x32_bf16 v[140:143], v[92:95], v[48:51], v[140:143]
    ds_read_b64_tr_b16 v[84:85], v24 offset:12416
    ds_read_b64_tr_b16 v[86:87], v24 offset:15488
    v_mfma_f32_16x16x32_bf16 v[176:179], v[92:95], v[52:55], v[176:179]
    s_waitcnt lgkmcnt(12)
    v_mfma_f32_16x16x32_bf16 v[144:147], v[64:67], v[48:51], v[144:147]
    ds_read_b64_tr_b16 v[88:89], v25 offset:12416
    ds_read_b64_tr_b16 v[90:91], v25 offset:15488
    v_mfma_f32_16x16x32_bf16 v[180:183], v[64:67], v[52:55], v[180:183]
    s_barrier
    s_waitcnt lgkmcnt(10)
    v_mfma_f32_16x16x32_bf16 v[112:115], v[68:71], v[56:59], v[112:115]
    ds_read_b64_tr_b16 v[92:93], v26 offset:12416
    ds_read_b64_tr_b16 v[94:95], v26 offset:15488
    v_mfma_f32_16x16x32_bf16 v[148:151], v[68:71], v[60:63], v[148:151]
    s_waitcnt lgkmcnt(10)
    v_mfma_f32_16x16x32_bf16 v[116:119], v[72:75], v[56:59], v[116:119]
    ds_read_b64_tr_b16 v[64:65], v27 offset:12416
    ds_read_b64_tr_b16 v[66:67], v27 offset:15488
    v_mfma_f32_16x16x32_bf16 v[152:155], v[72:75], v[60:63], v[152:155]
    s_waitcnt lgkmcnt(10)
    v_mfma_f32_16x16x32_bf16 v[120:123], v[76:79], v[56:59], v[120:123]
    ds_read_b64_tr_b16 v[68:69], v24 offset:12544
    ds_read_b64_tr_b16 v[70:71], v24 offset:15616
    v_mfma_f32_16x16x32_bf16 v[156:159], v[76:79], v[60:63], v[156:159]
    ds_read_b128 v[48:51], v3 offset:0
    s_waitcnt lgkmcnt(11)
    v_mfma_f32_16x16x32_bf16 v[124:127], v[80:83], v[56:59], v[124:127]
    ds_read_b64_tr_b16 v[72:73], v28 offset:0
    ds_read_b64_tr_b16 v[74:75], v28 offset:3072
    v_mfma_f32_16x16x32_bf16 v[160:163], v[80:83], v[60:63], v[160:163]
    ds_read_b128 v[52:55], v3 offset:2048
    s_waitcnt lgkmcnt(12)
    v_mfma_f32_16x16x32_bf16 v[128:131], v[84:87], v[56:59], v[128:131]
    ds_read_b64_tr_b16 v[76:77], v29 offset:0
    ds_read_b64_tr_b16 v[78:79], v29 offset:3072
    v_mfma_f32_16x16x32_bf16 v[164:167], v[84:87], v[60:63], v[164:167]
    s_waitcnt lgkmcnt(12)
    v_mfma_f32_16x16x32_bf16 v[132:135], v[88:91], v[56:59], v[132:135]
    ds_read_b64_tr_b16 v[80:81], v30 offset:0
    ds_read_b64_tr_b16 v[82:83], v30 offset:3072
    v_mfma_f32_16x16x32_bf16 v[168:171], v[88:91], v[60:63], v[168:171]
    s_waitcnt lgkmcnt(12)
    v_mfma_f32_16x16x32_bf16 v[136:139], v[92:95], v[56:59], v[136:139]
    ds_read_b64_tr_b16 v[84:85], v31 offset:0
    ds_read_b64_tr_b16 v[86:87], v31 offset:3072
    v_mfma_f32_16x16x32_bf16 v[172:175], v[92:95], v[60:63], v[172:175]
    s_waitcnt lgkmcnt(12)
    v_mfma_f32_16x16x32_bf16 v[140:143], v[64:67], v[56:59], v[140:143]
    ds_read_b64_tr_b16 v[88:89], v28 offset:128
    ds_read_b64_tr_b16 v[90:91], v28 offset:3200
    v_mfma_f32_16x16x32_bf16 v[176:179], v[64:67], v[60:63], v[176:179]
    s_waitcnt lgkmcnt(12)
    v_mfma_f32_16x16x32_bf16 v[144:147], v[68:71], v[56:59], v[144:147]
    ds_read_b64_tr_b16 v[92:93], v29 offset:128
    ds_read_b64_tr_b16 v[94:95], v29 offset:3200
    v_mfma_f32_16x16x32_bf16 v[180:183], v[68:71], v[60:63], v[180:183]
    s_waitcnt lgkmcnt(10)
    v_mfma_f32_16x16x32_bf16 v[112:115], v[72:75], v[48:51], v[112:115]
    ds_read_b64_tr_b16 v[64:65], v30 offset:128
    ds_read_b64_tr_b16 v[66:67], v30 offset:3200
    v_mfma_f32_16x16x32_bf16 v[148:151], v[72:75], v[52:55], v[148:151]
    s_waitcnt lgkmcnt(10)
    v_mfma_f32_16x16x32_bf16 v[116:119], v[76:79], v[48:51], v[116:119]
    ds_read_b64_tr_b16 v[68:69], v31 offset:128
    ds_read_b64_tr_b16 v[70:71], v31 offset:3200
    v_mfma_f32_16x16x32_bf16 v[152:155], v[76:79], v[52:55], v[152:155]
    s_waitcnt lgkmcnt(10)
    v_mfma_f32_16x16x32_bf16 v[120:123], v[80:83], v[48:51], v[120:123]
    ds_read_b64_tr_b16 v[72:73], v28 offset:256
    ds_read_b64_tr_b16 v[74:75], v28 offset:3328
    v_mfma_f32_16x16x32_bf16 v[156:159], v[80:83], v[52:55], v[156:159]
    ds_read_b128 v[56:59], v3 offset:1024
    s_waitcnt lgkmcnt(11)
    v_mfma_f32_16x16x32_bf16 v[124:127], v[84:87], v[48:51], v[124:127]
    ds_read_b64_tr_b16 v[76:77], v28 offset:12288
    ds_read_b64_tr_b16 v[78:79], v28 offset:15360
    v_mfma_f32_16x16x32_bf16 v[160:163], v[84:87], v[52:55], v[160:163]
    ds_read_b128 v[60:63], v3 offset:3072
    s_waitcnt lgkmcnt(12)
    v_mfma_f32_16x16x32_bf16 v[128:131], v[88:91], v[48:51], v[128:131]
    ds_read_b64_tr_b16 v[80:81], v29 offset:12288
    ds_read_b64_tr_b16 v[82:83], v29 offset:15360
    v_mfma_f32_16x16x32_bf16 v[164:167], v[88:91], v[52:55], v[164:167]
    s_waitcnt lgkmcnt(12)
    v_mfma_f32_16x16x32_bf16 v[132:135], v[92:95], v[48:51], v[132:135]
    ds_read_b64_tr_b16 v[84:85], v30 offset:12288
    ds_read_b64_tr_b16 v[86:87], v30 offset:15360
    v_mfma_f32_16x16x32_bf16 v[168:171], v[92:95], v[52:55], v[168:171]
    s_waitcnt lgkmcnt(12)
    v_mfma_f32_16x16x32_bf16 v[136:139], v[64:67], v[48:51], v[136:139]
    ds_read_b64_tr_b16 v[88:89], v31 offset:12288
    ds_read_b64_tr_b16 v[90:91], v31 offset:15360
    v_mfma_f32_16x16x32_bf16 v[172:175], v[64:67], v[52:55], v[172:175]
    s_waitcnt lgkmcnt(12)
    v_mfma_f32_16x16x32_bf16 v[140:143], v[68:71], v[48:51], v[140:143]
    ds_read_b64_tr_b16 v[92:93], v28 offset:12416
    ds_read_b64_tr_b16 v[94:95], v28 offset:15488
    v_mfma_f32_16x16x32_bf16 v[176:179], v[68:71], v[52:55], v[176:179]
    s_waitcnt lgkmcnt(12)
    v_mfma_f32_16x16x32_bf16 v[144:147], v[72:75], v[48:51], v[144:147]
    ds_read_b64_tr_b16 v[64:65], v29 offset:12416
    ds_read_b64_tr_b16 v[66:67], v29 offset:15488
    v_mfma_f32_16x16x32_bf16 v[180:183], v[72:75], v[52:55], v[180:183]
    s_waitcnt lgkmcnt(10)
    v_mfma_f32_16x16x32_bf16 v[112:115], v[76:79], v[56:59], v[112:115]
    ds_read_b64_tr_b16 v[68:69], v30 offset:12416
    ds_read_b64_tr_b16 v[70:71], v30 offset:15488
    v_mfma_f32_16x16x32_bf16 v[148:151], v[76:79], v[60:63], v[148:151]
    s_waitcnt lgkmcnt(10)
    v_mfma_f32_16x16x32_bf16 v[116:119], v[80:83], v[56:59], v[116:119]
    ds_read_b64_tr_b16 v[72:73], v31 offset:12416
    ds_read_b64_tr_b16 v[74:75], v31 offset:15488
    v_mfma_f32_16x16x32_bf16 v[152:155], v[80:83], v[60:63], v[152:155]
    s_waitcnt lgkmcnt(10)
    v_mfma_f32_16x16x32_bf16 v[120:123], v[84:87], v[56:59], v[120:123]
    ds_read_b64_tr_b16 v[76:77], v28 offset:12544
    ds_read_b64_tr_b16 v[78:79], v28 offset:15616
    v_mfma_f32_16x16x32_bf16 v[156:159], v[84:87], v[60:63], v[156:159]
    s_waitcnt lgkmcnt(10)
    v_mfma_f32_16x16x32_bf16 v[124:127], v[88:91], v[56:59], v[124:127]
    v_mfma_f32_16x16x32_bf16 v[160:163], v[88:91], v[60:63], v[160:163]
    s_waitcnt lgkmcnt(8)
    v_mfma_f32_16x16x32_bf16 v[128:131], v[92:95], v[56:59], v[128:131]
    v_mfma_f32_16x16x32_bf16 v[164:167], v[92:95], v[60:63], v[164:167]
    s_waitcnt lgkmcnt(6)
    v_mfma_f32_16x16x32_bf16 v[132:135], v[64:67], v[56:59], v[132:135]
    v_mfma_f32_16x16x32_bf16 v[168:171], v[64:67], v[60:63], v[168:171]
    s_waitcnt lgkmcnt(4)
    v_mfma_f32_16x16x32_bf16 v[136:139], v[68:71], v[56:59], v[136:139]
    v_mfma_f32_16x16x32_bf16 v[172:175], v[68:71], v[60:63], v[172:175]
    s_waitcnt lgkmcnt(2)
    v_mfma_f32_16x16x32_bf16 v[140:143], v[72:75], v[56:59], v[140:143]
    v_mfma_f32_16x16x32_bf16 v[176:179], v[72:75], v[60:63], v[176:179]
    s_waitcnt lgkmcnt(0)
    v_mfma_f32_16x16x32_bf16 v[144:147], v[76:79], v[56:59], v[144:147]
    v_mfma_f32_16x16x32_bf16 v[180:183], v[76:79], v[60:63], v[180:183]
    v_lshlrev_b32 v18, 4, v0
    s_lshl_b32 s60, s10, 2
    s_add_u32 s60, s60, s9
    s_lshl_b32 s60, s60, 2
    s_add_u32 s60, s60, s4
    s_mul_i32 s60, s60, 9216
    v_add_u32 v21, s60, v18
    s_lshl_b32 s60, s10, 2
    s_add_u32 s61, s60, s4
    s_lshl_b32 s61, s61, 7
    s_lshl_b32 s62, s9, 2
    s_add_u32 s61, s61, s62
    v_mov_b32 v23, s61
    s_add_u32 s60, s60, s9
    s_lshl_b32 s60, s60, 7
    v_mov_b32 v26, s60
    v_mov_b32 v24, 1
    s_nop 7
    s_barrier
    s_cmp_eq_u32 s4, s9
    s_cbranch_scc1 L_ffn_own_184
    v_cvt_pk_bf16_f32 v112, v112, v113
    v_cvt_pk_bf16_f32 v113, v114, v115
    v_cvt_pk_bf16_f32 v114, v116, v117
    v_cvt_pk_bf16_f32 v115, v118, v119
    buffer_store_dwordx4 v[112:115], v21, s[44:47], 0 offen offset:0 sc1
    v_cvt_pk_bf16_f32 v120, v120, v121
    v_cvt_pk_bf16_f32 v121, v122, v123
    v_cvt_pk_bf16_f32 v122, v124, v125
    v_cvt_pk_bf16_f32 v123, v126, v127
    buffer_store_dwordx4 v[120:123], v21, s[44:47], 0 offen offset:1024 sc1
    v_cvt_pk_bf16_f32 v128, v128, v129
    v_cvt_pk_bf16_f32 v129, v130, v131
    v_cvt_pk_bf16_f32 v130, v132, v133
    v_cvt_pk_bf16_f32 v131, v134, v135
    buffer_store_dwordx4 v[128:131], v21, s[44:47], 0 offen offset:2048 sc1
    v_cvt_pk_bf16_f32 v136, v136, v137
    v_cvt_pk_bf16_f32 v137, v138, v139
    v_cvt_pk_bf16_f32 v138, v140, v141
    v_cvt_pk_bf16_f32 v139, v142, v143
    buffer_store_dwordx4 v[136:139], v21, s[44:47], 0 offen offset:3072 sc1
    v_cvt_pk_bf16_f32 v144, v144, v145
    v_cvt_pk_bf16_f32 v145, v146, v147
    v_cvt_pk_bf16_f32 v146, v148, v149
    v_cvt_pk_bf16_f32 v147, v150, v151
    s_movk_i32 s61, 4096
    buffer_store_dwordx4 v[144:147], v21, s[44:47], s61 offen offset:0 sc1
    v_cvt_pk_bf16_f32 v152, v152, v153
    v_cvt_pk_bf16_f32 v153, v154, v155
    v_cvt_pk_bf16_f32 v154, v156, v157
    v_cvt_pk_bf16_f32 v155, v158, v159
    s_movk_i32 s61, 4096
    buffer_store_dwordx4 v[152:155], v21, s[44:47], s61 offen offset:1024 sc1
    v_cvt_pk_bf16_f32 v160, v160, v161
    v_cvt_pk_bf16_f32 v161, v162, v163
    v_cvt_pk_bf16_f32 v162, v164, v165
    v_cvt_pk_bf16_f32 v163, v166, v167
    s_movk_i32 s61, 4096
    buffer_store_dwordx4 v[160:163], v21, s[44:47], s61 offen offset:2048 sc1
    v_cvt_pk_bf16_f32 v168, v168, v169
    v_cvt_pk_bf16_f32 v169, v170, v171
    v_cvt_pk_bf16_f32 v170, v172, v173
    v_cvt_pk_bf16_f32 v171, v174, v175
    s_movk_i32 s61, 4096
    buffer_store_dwordx4 v[168:171], v21, s[44:47], s61 offen offset:3072 sc1
    v_cvt_pk_bf16_f32 v176, v176, v177
    v_cvt_pk_bf16_f32 v177, v178, v179
    v_cvt_pk_bf16_f32 v178, v180, v181
    v_cvt_pk_bf16_f32 v179, v182, v183
    s_movk_i32 s61, 8192
    buffer_store_dwordx4 v[176:179], v21, s[44:47], s61 offen offset:0 sc1
    s_barrier
    s_branch L_ffn_j_185
L_ffn_own_184:
    ds_write_b128 v18, v[112:115] offset:0
    ds_write_b128 v18, v[116:119] offset:1024
    ds_write_b128 v18, v[120:123] offset:2048
    ds_write_b128 v18, v[124:127] offset:3072
    ds_write_b128 v18, v[128:131] offset:4096
    ds_write_b128 v18, v[132:135] offset:5120
    ds_write_b128 v18, v[136:139] offset:6144
    ds_write_b128 v18, v[140:143] offset:7168
    ds_write_b128 v18, v[144:147] offset:8192
    ds_write_b128 v18, v[148:151] offset:9216
    ds_write_b128 v18, v[152:155] offset:10240
    ds_write_b128 v18, v[156:159] offset:11264
    ds_write_b128 v18, v[160:163] offset:12288
    ds_write_b128 v18, v[164:167] offset:13312
    ds_write_b128 v18, v[168:171] offset:14336
    ds_write_b128 v18, v[172:175] offset:15360
    ds_write_b128 v18, v[176:179] offset:16384
    ds_write_b128 v18, v[180:183] offset:17408
    s_waitcnt lgkmcnt(0)
    s_barrier
    s_branch L_ffn_end
L_ffn_j_185:
    s_sub_u32 s62, s4, s9
    s_sub_u32 s62, s62, 1
    s_and_b32 s62, s62, 3
    s_mul_i32 s63, s62, 6144
    v_add_u32 v22, s63, v18
    ds_read_b128 v[48:51], v22 offset:0
    ds_read_b128 v[52:55], v22 offset:1024
    ds_read_b128 v[56:59], v22 offset:2048
    ds_read_b128 v[60:63], v22 offset:3072
    ds_read_b128 v[64:67], v22 offset:4096
    ds_read_b128 v[68:71], v22 offset:5120
    s_lshl_b32 s60, s9, 5
    s_add_u32 s60, s60, s7
    v_add_u32 v19, s60, v16
    v_mul_u32_u24 v19, 1152, v19
    v_lshlrev_b32 v20, 3, v17
    s_lshl_b32 s60, s8, 1
    v_add3_u32 v19, v19, v20, s60
    v_lshrrev_b32 v45, 1, v17
    v_lshlrev_b32 v44, 8, v45
    v_lshlrev_b32 v45, 4, v16
    v_add_u32 v44, v44, v45
    v_and_b32 v45, 1, v17
    v_lshlrev_b32 v45, 3, v45
    v_add_u32 v44, v44, v45
    s_lshr_b32 s60, s7, 4
    s_lshl_b32 s61, s9, 1
    s_add_u32 s60, s60, s61
    s_mul_i32 s60, s60, 18432
    s_lshl_b32 s61, s8, 5
    s_add_u32 s60, s60, s61
    v_add_u32 v44, s60, v44
    s_waitcnt vmcnt(0)
    s_mov_b64 exec, 1
    buffer_store_dword v24, v23, s[64:67], 0 offen sc1
    s_mov_b64 exec, -1
    s_mul_i32 s62, s62, 6
    s_add_u32 s60, s62, 0
    s_cmp_ge_u32 s60, 9
    s_cselect_b32 s61, 18144, 0
    s_cselect_b32 s69, 13824, 0
    s_lshl_b32 s68, s60, 9
    s_add_u32 s68, s68, s69
    s_lshl_b32 s60, s60, 5
    s_add_u32 s84, s60, s61
    buffer_load_dwordx2 v[96:97], v44, s[52:55], s68 offen sc1
    s_add_u32 s60, s62, 1
    s_cmp_ge_u32 s60, 9
    s_cselect_b32 s61, 18144, 0
    s_cselect_b32 s69, 13824, 0
    s_lshl_b32 s68, s60, 9
    s_add_u32 s68, s68, s69
    s_lshl_b32 s60, s60, 5
    s_add_u32 s85, s60, s61
    buffer_load_dwordx2 v[98:99], v44, s[52:55], s68 offen sc1
    s_add_u32 s60, s62, 2
    s_cmp_ge_u32 s60, 9
    s_cselect_b32 s61, 18144, 0
    s_cselect_b32 s69, 13824, 0
    s_lshl_b32 s68, s60, 9
    s_add_u32 s68, s68, s69
    s_lshl_b32 s60, s60, 5
    s_add_u32 s86, s60, s61
    buffer_load_dwordx2 v[100:101], v44, s[52:55], s68 offen sc1
    s_add_u32 s60, s62, 3
    s_cmp_ge_u32 s60, 9
    s_cselect_b32 s61, 18144, 0
    s_cselect_b32 s69, 13824, 0
    s_lshl_b32 s68, s60, 9
    s_add_u32 s68, s68, s69
    s_lshl_b32 s60, s60, 5
    s_add_u32 s87, s60, s61
    buffer_load_dwordx2 v[102:103], v44, s[52:55], s68 offen sc1
    s_add_u32 s60, s62, 4
    s_cmp_ge_u32 s60, 9
    s_cselect_b32 s61, 18144, 0
    s_cselect_b32 s69, 13824, 0
    s_lshl_b32 s68, s60, 9
    s_add_u32 s68, s68, s69
    s_lshl_b32 s60, s60, 5
    s_add_u32 s88, s60, s61
    buffer_load_dwordx2 v[104:105], v44, s[52:55], s68 offen sc1
    s_add_u32 s60, s62, 5
    s_cmp_ge_u32 s60, 9
    s_cselect_b32 s61, 18144, 0
    s_cselect_b32 s69, 13824, 0
    s_lshl_b32 s68, s60, 9
    s_add_u32 s68, s68, s69
    s_lshl_b32 s60, s60, 5
    s_add_u32 s89, s60, s61
    buffer_load_dwordx2 v[106:107], v44, s[52:55], s68 offen sc1
L_ffn_poll_186:
    buffer_load_dwordx4 v[28:31], v26, s[64:67], 0 offen sc1
    s_waitcnt vmcnt(0)
    v_add_u32 v28, v28, v29
    v_add3_u32 v28, v28, v30, v31
    s_nop 0
    v_readfirstlane_b32 s61, v28
    s_cmp_ge_u32 s61, 3
    s_cbranch_scc1 L_ffn_go_187
    s_sleep 1
    s_branch L_ffn_poll_186
L_ffn_go_187:
    s_lshl_b32 s60, s10, 4
    s_add_u32 s60, s60, s9
    s_mul_i32 s60, s60, 9216
    s_lshr_b32 s63, s63, 1
    s_add_u32 s60, s60, s63
    v_add_u32 v21, s60, v18
    s_add_u32 s61, s9, 1
    s_and_b32 s61, s61, 3
    s_mul_i32 s61, s61, 36864
    buffer_load_dwordx4 v[112:115], v21, s[44:47], s61 offen offset:0 sc1
    buffer_load_dwordx4 v[116:119], v21, s[44:47], s61 offen offset:1024 sc1
    buffer_load_dwordx4 v[120:123], v21, s[44:47], s61 offen offset:2048 sc1
    s_add_u32 s61, s9, 2
    s_and_b32 s61, s61, 3
    s_mul_i32 s61, s61, 36864
    buffer_load_dwordx4 v[124:127], v21, s[44:47], s61 offen offset:0 sc1
    buffer_load_dwordx4 v[128:131], v21, s[44:47], s61 offen offset:1024 sc1
    buffer_load_dwordx4 v[132:135], v21, s[44:47], s61 offen offset:2048 sc1
    s_add_u32 s61, s9, 3
    s_and_b32 s61, s61, 3
    s_mul_i32 s61, s61, 36864
    buffer_load_dwordx4 v[136:139], v21, s[44:47], s61 offen offset:0 sc1
    buffer_load_dwordx4 v[140:143], v21, s[44:47], s61 offen offset:1024 sc1
    buffer_load_dwordx4 v[144:147], v21, s[44:47], s61 offen offset:2048 sc1
    s_waitcnt lgkmcnt(0)
    v_lshlrev_b32 v42, 16, v96
    v_and_b32 v43, 0xffff0000, v96
    v_add_f32 v48, v48, v42
    v_add_f32 v49, v49, v43
    v_lshlrev_b32 v42, 16, v97
    v_and_b32 v43, 0xffff0000, v97
    v_add_f32 v50, v50, v42
    v_add_f32 v51, v51, v43
    v_lshlrev_b32 v42, 16, v98
    v_and_b32 v43, 0xffff0000, v98
    v_add_f32 v52, v52, v42
    v_add_f32 v53, v53, v43
    v_lshlrev_b32 v42, 16, v99
    v_and_b32 v43, 0xffff0000, v99
    v_add_f32 v54, v54, v42
    v_add_f32 v55, v55, v43
    v_lshlrev_b32 v42, 16, v100
    v_and_b32 v43, 0xffff0000, v100
    v_add_f32 v56, v56, v42
    v_add_f32 v57, v57, v43
    v_lshlrev_b32 v42, 16, v101
    v_and_b32 v43, 0xffff0000, v101
    v_add_f32 v58, v58, v42
    v_add_f32 v59, v59, v43
    v_lshlrev_b32 v42, 16, v102
    v_and_b32 v43, 0xffff0000, v102
    v_add_f32 v60, v60, v42
    v_add_f32 v61, v61, v43
    v_lshlrev_b32 v42, 16, v103
    v_and_b32 v43, 0xffff0000, v103
    v_add_f32 v62, v62, v42
    v_add_f32 v63, v63, v43
    v_lshlrev_b32 v42, 16, v104
    v_and_b32 v43, 0xffff0000, v104
    v_add_f32 v64, v64, v42
    v_add_f32 v65, v65, v43
    v_lshlrev_b32 v42, 16, v105
    v_and_b32 v43, 0xffff0000, v105
    v_add_f32 v66, v66, v42
    v_add_f32 v67, v67, v43
    v_lshlrev_b32 v42, 16, v106
    v_and_b32 v43, 0xffff0000, v106
    v_add_f32 v68, v68, v42
    v_add_f32 v69, v69, v43
    v_lshlrev_b32 v42, 16, v107
    v_and_b32 v43, 0xffff0000, v107
    v_add_f32 v70, v70, v42
    v_add_f32 v71, v71, v43
    s_waitcnt vmcnt(8)
    v_lshlrev_b32 v42, 16, v112
    v_and_b32 v43, 0xffff0000, v112
    v_add_f32 v48, v48, v42
    v_add_f32 v49, v49, v43
    v_lshlrev_b32 v42, 16, v113
    v_and_b32 v43, 0xffff0000, v113
    v_add_f32 v50, v50, v42
    v_add_f32 v51, v51, v43
    v_lshlrev_b32 v42, 16, v114
    v_and_b32 v43, 0xffff0000, v114
    v_add_f32 v52, v52, v42
    v_add_f32 v53, v53, v43
    v_lshlrev_b32 v42, 16, v115
    v_and_b32 v43, 0xffff0000, v115
    v_add_f32 v54, v54, v42
    v_add_f32 v55, v55, v43
    s_waitcnt vmcnt(7)
    v_lshlrev_b32 v42, 16, v116
    v_and_b32 v43, 0xffff0000, v116
    v_add_f32 v56, v56, v42
    v_add_f32 v57, v57, v43
    v_lshlrev_b32 v42, 16, v117
    v_and_b32 v43, 0xffff0000, v117
    v_add_f32 v58, v58, v42
    v_add_f32 v59, v59, v43
    v_lshlrev_b32 v42, 16, v118
    v_and_b32 v43, 0xffff0000, v118
    v_add_f32 v60, v60, v42
    v_add_f32 v61, v61, v43
    v_lshlrev_b32 v42, 16, v119
    v_and_b32 v43, 0xffff0000, v119
    v_add_f32 v62, v62, v42
    v_add_f32 v63, v63, v43
    s_waitcnt vmcnt(6)
    v_lshlrev_b32 v42, 16, v120
    v_and_b32 v43, 0xffff0000, v120
    v_add_f32 v64, v64, v42
    v_add_f32 v65, v65, v43
    v_lshlrev_b32 v42, 16, v121
    v_and_b32 v43, 0xffff0000, v121
    v_add_f32 v66, v66, v42
    v_add_f32 v67, v67, v43
    v_lshlrev_b32 v42, 16, v122
    v_and_b32 v43, 0xffff0000, v122
    v_add_f32 v68, v68, v42
    v_add_f32 v69, v69, v43
    v_lshlrev_b32 v42, 16, v123
    v_and_b32 v43, 0xffff0000, v123
    v_add_f32 v70, v70, v42
    v_add_f32 v71, v71, v43
    s_waitcnt vmcnt(5)
    v_lshlrev_b32 v42, 16, v124
    v_and_b32 v43, 0xffff0000, v124
    v_add_f32 v48, v48, v42
    v_add_f32 v49, v49, v43
    v_lshlrev_b32 v42, 16, v125
    v_and_b32 v43, 0xffff0000, v125
    v_add_f32 v50, v50, v42
    v_add_f32 v51, v51, v43
    v_lshlrev_b32 v42, 16, v126
    v_and_b32 v43, 0xffff0000, v126
    v_add_f32 v52, v52, v42
    v_add_f32 v53, v53, v43
    v_lshlrev_b32 v42, 16, v127
    v_and_b32 v43, 0xffff0000, v127
    v_add_f32 v54, v54, v42
    v_add_f32 v55, v55, v43
    s_waitcnt vmcnt(4)
    v_lshlrev_b32 v42, 16, v128
    v_and_b32 v43, 0xffff0000, v128
    v_add_f32 v56, v56, v42
    v_add_f32 v57, v57, v43
    v_lshlrev_b32 v42, 16, v129
    v_and_b32 v43, 0xffff0000, v129
    v_add_f32 v58, v58, v42
    v_add_f32 v59, v59, v43
    v_lshlrev_b32 v42, 16, v130
    v_and_b32 v43, 0xffff0000, v130
    v_add_f32 v60, v60, v42
    v_add_f32 v61, v61, v43
    v_lshlrev_b32 v42, 16, v131
    v_and_b32 v43, 0xffff0000, v131
    v_add_f32 v62, v62, v42
    v_add_f32 v63, v63, v43
    s_waitcnt vmcnt(3)
    v_lshlrev_b32 v42, 16, v132
    v_and_b32 v43, 0xffff0000, v132
    v_add_f32 v64, v64, v42
    v_add_f32 v65, v65, v43
    v_lshlrev_b32 v42, 16, v133
    v_and_b32 v43, 0xffff0000, v133
    v_add_f32 v66, v66, v42
    v_add_f32 v67, v67, v43
    v_lshlrev_b32 v42, 16, v134
    v_and_b32 v43, 0xffff0000, v134
    v_add_f32 v68, v68, v42
    v_add_f32 v69, v69, v43
    v_lshlrev_b32 v42, 16, v135
    v_and_b32 v43, 0xffff0000, v135
    v_add_f32 v70, v70, v42
    v_add_f32 v71, v71, v43
    s_waitcnt vmcnt(2)
    v_lshlrev_b32 v42, 16, v136
    v_and_b32 v43, 0xffff0000, v136
    v_add_f32 v48, v48, v42
    v_add_f32 v49, v49, v43
    v_lshlrev_b32 v42, 16, v137
    v_and_b32 v43, 0xffff0000, v137
    v_add_f32 v50, v50, v42
    v_add_f32 v51, v51, v43
    v_cvt_pk_bf16_f32 v96, v48, v49
    v_cvt_pk_bf16_f32 v97, v50, v51
    buffer_store_dwordx2 v[96:97], v19, s[48:51], s84 offen
    v_lshlrev_b32 v42, 16, v138
    v_and_b32 v43, 0xffff0000, v138
    v_add_f32 v52, v52, v42
    v_add_f32 v53, v53, v43
    v_lshlrev_b32 v42, 16, v139
    v_and_b32 v43, 0xffff0000, v139
    v_add_f32 v54, v54, v42
    v_add_f32 v55, v55, v43
    v_cvt_pk_bf16_f32 v98, v52, v53
    v_cvt_pk_bf16_f32 v99, v54, v55
    buffer_store_dwordx2 v[98:99], v19, s[48:51], s85 offen
    s_waitcnt vmcnt(3)
    v_lshlrev_b32 v42, 16, v140
    v_and_b32 v43, 0xffff0000, v140
    v_add_f32 v56, v56, v42
    v_add_f32 v57, v57, v43
    v_lshlrev_b32 v42, 16, v141
    v_and_b32 v43, 0xffff0000, v141
    v_add_f32 v58, v58, v42
    v_add_f32 v59, v59, v43
    v_cvt_pk_bf16_f32 v100, v56, v57
    v_cvt_pk_bf16_f32 v101, v58, v59
    buffer_store_dwordx2 v[100:101], v19, s[48:51], s86 offen
    v_lshlrev_b32 v42, 16, v142
    v_and_b32 v43, 0xffff0000, v142
    v_add_f32 v60, v60, v42
    v_add_f32 v61, v61, v43
    v_lshlrev_b32 v42, 16, v143
    v_and_b32 v43, 0xffff0000, v143
    v_add_f32 v62, v62, v42
    v_add_f32 v63, v63, v43
    v_cvt_pk_bf16_f32 v102, v60, v61
    v_cvt_pk_bf16_f32 v103, v62, v63
    buffer_store_dwordx2 v[102:103], v19, s[48:51], s87 offen
    s_waitcnt vmcnt(4)
    v_lshlrev_b32 v42, 16, v144
    v_and_b32 v43, 0xffff0000, v144
    v_add_f32 v64, v64, v42
    v_add_f32 v65, v65, v43
    v_lshlrev_b32 v42, 16, v145
    v_and_b32 v43, 0xffff0000, v145
    v_add_f32 v66, v66, v42
    v_add_f32 v67, v67, v43
    v_cvt_pk_bf16_f32 v104, v64, v65
    v_cvt_pk_bf16_f32 v105, v66, v67
    buffer_store_dwordx2 v[104:105], v19, s[48:51], s88 offen
    v_lshlrev_b32 v42, 16, v146
    v_and_b32 v43, 0xffff0000, v146
    v_add_f32 v68, v68, v42
    v_add_f32 v69, v69, v43
    v_lshlrev_b32 v42, 16, v147
    v_and_b32 v43, 0xffff0000, v147
    v_add_f32 v70, v70, v42
    v_add_f32 v71, v71, v43
    v_cvt_pk_bf16_f32 v106, v68, v69
    v_cvt_pk_bf16_f32 v107, v70, v71
    buffer_store_dwordx2 v[106:107], v19, s[48:51], s89 offen
L_ffn_end:
    s_endpgm
.section .rodata,"a"
.p2align 6
.amdhsa_kernel qkv_kernel
  .amdhsa_next_free_vgpr 232
  .amdhsa_next_free_sgpr 102
  .amdhsa_accum_offset 232
  .amdhsa_group_segment_fixed_size 0
  .amdhsa_kernarg_size 80
  .amdhsa_user_sgpr_count 2
  .amdhsa_user_sgpr_kernarg_segment_ptr 1
  .amdhsa_system_sgpr_workgroup_id_x 1
.end_amdhsa_kernel
.p2align 6
.amdhsa_kernel ffn_kernel
  .amdhsa_next_free_vgpr 256
  .amdhsa_next_free_sgpr 102
  .amdhsa_accum_offset 256
  .amdhsa_group_segment_fixed_size 0
  .amdhsa_kernarg_size 80
  .amdhsa_user_sgpr_count 2
  .amdhsa_user_sgpr_kernarg_segment_ptr 1
  .amdhsa_system_sgpr_workgroup_id_x 1
.end_amdhsa_kernel
```
